```python
import torch

def _softmax(x, axis=-1):
    return torch.softmax(x, dim=axis)
def _gelu(x):
    return torch.nn.functional.gelu(x, approximate="tanh")
def _silu(x):
    return torch.nn.functional.silu(x)
def _sigmoid(x):
    return torch.sigmoid(x)
def _layernorm(x, axis=-1, eps=1e-5):
    m = x.mean(dim=axis, keepdim=True)
    v = x.var(dim=axis, keepdim=True, unbiased=False)
    return (x - m) / torch.sqrt(v + eps)
def _scatter_add(tgt, idx, src, axis=0):
    return tgt.clone().index_add_(axis, idx, src)
def _segment_sum(src, seg, n):
    out = torch.zeros((n,) + src.shape[1:], dtype=src.dtype)
    return out.index_add_(0, seg, src)
def _pad(x, pw):
    flat = tuple(v for pair in reversed(pw) for v in pair)
    return torch.nn.functional.pad(x, flat)

kernel_name = 'sequential_preLN__sliding_block__mixer_s_mlp__prompt'

def setup_inputs():

    _w = (lambda a: (lambda t: t.to(torch.bfloat16) if t.is_floating_point() else t)(torch.as_tensor(a)))
    def _A_setup():
        B, S, D = 1, 2048, 512
        return {
            "x": _w((lambda *s: torch.randn(*s, dtype=torch.bfloat16) * 0.05)(B, S, D)),
            "wqkv": _w((lambda *s: torch.randn(*s, dtype=torch.bfloat16) * 0.05)(D, 3 * D)),
            "wo": _w((lambda *s: torch.randn(*s, dtype=torch.bfloat16) * 0.05)(D, D)),
        }
    _A_in = _A_setup()

    def _B_setup():
        B, S, D, F = 1, 2048, 512, 1792
        return {
            "x":  _w((lambda *s: torch.randn(*s, dtype=torch.bfloat16) * 0.05)(B, S, D)),
            "w1": _w((lambda *s: torch.randn(*s, dtype=torch.bfloat16) * 3.2)(D, D) * (D ** -0.5)),
            "w2": _w((lambda *s: torch.randn(*s, dtype=torch.bfloat16) * 3.2)(D, D) * (D ** -0.5)),
            "w3": _w((lambda *s: torch.randn(*s, dtype=torch.bfloat16) * 3.2)(D, F) * (D ** -0.5)),
            "w4": _w((lambda *s: torch.randn(*s, dtype=torch.bfloat16) * 3.2)(F, D) * (F ** -0.5)),
        }
    _B_in = _B_setup()

    return {
        "A_x": _A_in["x"],
        "A_wqkv": _A_in["wqkv"],
        "A_wo": _A_in["wo"],
        "B_x": _B_in["x"],
        "B_w1": _B_in["w1"],
        "B_w2": _B_in["w2"],
        "B_w3": _B_in["w3"],
        "B_w4": _B_in["w4"],
    }

def reference(A_x, A_wqkv, A_wo, B_x, B_w1, B_w2, B_w3, B_w4):
    def _A_ref(x, wqkv, wo):
        B, S, D = x.shape
        H = 32; Dh = D // H; W = 256
        qkv = (lambda x, *d: x.permute(*d))((x @ wqkv).reshape(B, S, 3, H, Dh), 2, 0, 3, 1, 4)
        q, k, v = qkv[0], qkv[1], qkv[2]
        scores = torch.einsum("bhqd,bhkd->bhqk", q, k) * (Dh ** -0.5)
        idx = torch.arange(S)
        mask = (idx[:, None] - idx[None, :] >= 0) & (idx[:, None] - idx[None, :] < W)
        scores = torch.where(mask[None, None], scores, -1e9)
        p = _softmax(scores, axis=-1)
        o = torch.einsum("bhqk,bhkd->bhqd", p, v)
        return (lambda x, *d: x.permute(*d))(o, 0, 2, 1, 3).reshape(B, S, D) @ wo

    def _B_ref(x, w1, w2, w3, w4):
        B, S, D = x.shape
        h = _gelu(_layernorm(x, axis=-1) @ w1)
        c = D // 4
        g0 = _pad(h[:, :, 0*c:1*c], ((0, 0), (1, 0), (0, 0)))[:, :S, :]
        g1 = _pad(h[:, :, 1*c:2*c], ((0, 0), (0, 1), (0, 0)))[:, 1:, :]
        g2 = _pad(h[:, :, 2*c:3*c], ((0, 0), (2, 0), (0, 0)))[:, :S, :]
        g3 = _pad(h[:, :, 3*c:   ], ((0, 0), (0, 2), (0, 0)))[:, 2:, :]
        hs = torch.concatenate([g0, g1, g2, g3], axis=-1) @ w2
        x1 = x + hs
        h2 = _gelu(_layernorm(x1, axis=-1) @ w3) @ w4
        return x1 + h2

    x = A_x
    h = x + _A_ref(_layernorm(x, axis=-1), A_wqkv, A_wo)
    h2 = h + _B_ref(_layernorm(h, axis=-1), B_w1, B_w2, B_w3, B_w4)
    return h2
```

```asm
; @launch grid=(256,1,1) block=(256,1,1) lds=163840
.amdgcn_target "amdgcn-amd-amdhsa--gfx950"
.text
.globl sequential_preLN__sliding_block__mixer_s_mlp__prompt_kernel
.p2align 12
.fill 832, 4, 0xbf810000
.p2align 8
.type sequential_preLN__sliding_block__mixer_s_mlp__prompt_kernel,@function
sequential_preLN__sliding_block__mixer_s_mlp__prompt_kernel:
  s_cmp_ge_u32 s2, 256
  s_cbranch_scc1 L_end
  s_load_dwordx2 s[4:5], s[0:1], 0
  s_load_dwordx2 s[8:9], s[0:1], 8
  s_load_dwordx2 s[12:13], s[0:1], 72
  s_lshr_b32 s3, s2, 3
  s_getpc_b64 s[82:83]
L_pc:
  v_lshrrev_b32 v255, 4, v0
  v_lshlrev_b32 v255, 5, v255
  v_add_u32 v255, s3, v255
  v_lshlrev_b32 v255, 7, v255
  v_min_u32 v255, L_slow-L_pc-4, v255
  v_mov_b32 v249, s83
  v_add_co_u32 v248, vcc, s82, v255
  s_nop 1
  v_addc_co_u32 v249, vcc, 0, v249, vcc
  global_load_dword v254, v[248:249], off
  v_lshrrev_b32 v255, 6, v0
  v_and_b32 v0, 63, v0
  v_readfirstlane_b32 s95, v255
  s_and_b32 s93, s3, 7
  s_lshr_b32 s92, s3, 3
  s_and_b32 s94, s2, 7
  s_lshl_b32 s94, s94, 2
  s_add_u32 s94, s94, s92
  s_lshl_b32 s85, s93, 7
  v_lshrrev_b32 v251, 4, v0
  s_mov_b32 s6, 2097152
  s_mov_b32 s7, 0x20000
  s_mov_b32 s10, 1572864
  s_mov_b32 s11, s7
  v_lshrrev_b32 v250, 3, v0
  v_and_b32 v249, 7, v0
  v_xor_b32 v249, v251, v249
  v_lshlrev_b32 v249, 4, v249
  v_lshl_add_u32 v248, v250, 10, v249
  v_xor_b32 v247, 64, v248
  v_add_u32 v247, 7168, v247
  v_lshrrev_b32 v243, 3, v0
  v_and_b32 v242, 7, v0
  s_mov_b32 s90, s95
  v_bfe_u32 v240, v243, 1, 1
  s_and_b32 s91, s90, 1
  s_lshl_b32 s91, s91, 1
  v_or_b32 v240, s91, v240
  v_lshlrev_b32 v240, 1, v240
  v_xor_b32 v242, v242, v240
  v_lshlrev_b32 v242, 4, v242
  s_lshl_b32 s91, s90, 3
  v_add_u32 v241, s91, v243
  s_mov_b32 s91, 3072
  v_mad_u32_u24 v244, v241, s91, v242
  v_add_u32 v244, s85, v244
  v_add_u32 v246, 1024, v244
  v_add_u32 v245, 97280, v244
  s_lshl_b32 s77, s94, 2
  s_add_u32 s77, s77, s95
  s_lshl_b32 s77, s77, 14
  s_lshl_b32 s76, s95, 11
  s_lshl_b32 s75, s95, 12
  s_add_u32 s74, s94, s93
  s_and_b32 s74, s74, 1
  s_mul_i32 s73, s74, 196608
  s_lshl_b32 s74, s74, 7
  s_or_b32 s74, s74, s77
  s_waitcnt lgkmcnt(0)
  s_add_u32 m0, s76, 0
  s_xor_b32 s87, s74, 0
  buffer_load_dwordx4 v248, s[4:7], s87 offen lds
  buffer_load_dwordx4 v247, s[4:7], s87 offen offset:1024 lds
  s_add_u32 m0, s75, 65536
  s_add_u32 s87, 0, s73
  buffer_load_dwordx4 v246, s[8:11], s87 offen lds
  buffer_load_dwordx4 v246, s[8:11], s87 offen offset:1024 lds
  buffer_load_dwordx4 v245, s[8:11], s87 offen offset:2048 lds
  buffer_load_dwordx4 v245, s[8:11], s87 offen offset:3072 lds
  s_load_dwordx2 s[16:17], s[0:1], 80
  s_load_dwordx2 s[20:21], s[0:1], 16
  s_load_dwordx2 s[24:25], s[0:1], 32
  s_load_dwordx2 s[28:29], s[0:1], 40
  s_load_dwordx2 s[32:33], s[0:1], 48
  s_load_dwordx2 s[36:37], s[0:1], 56
  s_load_dwordx2 s[40:41], s[0:1], 64
  s_and_b32 s92, s3, 15
  s_mul_i32 s86, s94, 360448
  s_mov_b32 s89, 65536
  v_lshlrev_b32 v253, 4, v0
  v_and_b32 v252, 15, v0
  s_mov_b32 s14, 256
  s_mov_b32 s15, s7
  s_mov_b32 s18, 11534336
  s_mov_b32 s19, s7
  s_mov_b32 s22, 524288
  s_mov_b32 s23, s7
  s_mov_b32 s26, 524288
  s_mov_b32 s27, s7
  s_mov_b32 s30, 524288
  s_mov_b32 s31, s7
  s_mov_b32 s34, 1835008
  s_mov_b32 s35, s7
  s_mov_b32 s38, 1835008
  s_mov_b32 s39, s7
  s_mov_b32 s42, 2097152
  s_mov_b32 s43, s7
  s_mov_b32 s82, 0x0000ffff
  s_mov_b32 s83, s82
  s_mov_b32 s80, 0x00010001
  s_mov_b32 s81, s80
  s_lshr_b32 s71, s2, 3
  s_lshl_b32 s71, s71, 2
  s_add_u32 s71, s71, s95
  v_lshlrev_b32 v243, 7, v0
  s_and_b32 s70, s2, 7
  s_lshl_b32 s70, s70, 7
  s_add_u32 s70, s70, s71
  s_lshl_b32 s70, s70, 11
  s_mul_i32 s69, s71, 3072
  s_add_u32 s69, s69, 1024
  v_lshrrev_b32 v242, 3, v0
  v_mul_u32_u24 v242, 2048, v242
  v_add_u32 v242, v242, v243
  v_lshlrev_b32 v240, 10, v0
  v_or_b32 v240, 384, v240
  s_lshl_b32 s68, s2, 2
  s_add_u32 s68, s68, s95
  s_mul_i32 s68, s68, 1024
  s_waitcnt lgkmcnt(0)
  s_mov_b64 s[44:45], s[20:21]
  s_mov_b32 s46, 524288
  s_mov_b32 s47, 0x20000
  s_cmp_ge_u32 s68, s46
  s_cselect_b64 s[44:45], s[24:25], s[44:45]
  s_cselect_b32 s91, s46, 0
  s_cselect_b32 s46, 524288, s46
  s_sub_u32 s68, s68, s91
  v_lshrrev_b32 v250, 1, v252
  v_add_u32 v249, 0, v251
  v_xor_b32 v250, v250, v249
  v_lshlrev_b32 v250, 4, v250
  s_mov_b64 exec, 0xffff
  buffer_load_dword a5, v243, s[4:7], s70 offen
  s_mov_b64 exec, -1
  v_lshl_add_u32 v238, v252, 7, v250
  v_add_u32 v236, s76, v238
  v_lshrrev_b32 v250, 1, v252
  s_or_b32 s97, s2, s95
  s_cbranch_scc0 L_draw_1
L_drawn_2:
  v_add_u32 v249, 4, v251
  v_xor_b32 v250, v250, v249
  v_lshlrev_b32 v250, 4, v250
  s_lshl_b32 s70, s2, 2
  s_add_u32 s70, s70, s95
  s_mul_i32 s70, s70, 1536
  s_mov_b64 exec, 0xfff
  buffer_load_dword a5, v243, s[8:11], s70 offen
  s_mov_b64 exec, -1
  v_lshl_add_u32 v237, v252, 7, v250
  v_add_u32 v235, s76, v237
  v_bfe_u32 v232, v0, 2, 2
  v_lshrrev_b32 v231, 1, v232
  s_mul_i32 s70, s71, 12288
  s_mov_b64 exec, 0xfff
  buffer_load_dword a5, v240, s[8:11], s70 offen
  s_mov_b64 exec, -1
  v_and_b32 v234, 1, v251
  v_lshl_or_b32 v231, v234, 1, v231
  v_xor_b32 v231, s95, v231
  s_add_u32 m0, s76, 8192
  s_xor_b32 s87, s74, 128
  buffer_load_dwordx4 v248, s[4:7], s87 offen lds
  v_lshlrev_b32 v231, 5, v231
  v_lshl_add_u32 v231, v232, 7, v231
  v_lshl_add_u32 v231, v251, 12, v231
  buffer_load_dwordx4 v247, s[4:7], s87 offen offset:1024 lds
  v_and_b32 v232, 3, v0
  v_lshl_add_u32 v234, v232, 3, v231
  v_add_u32 v234, 65536, v234
  v_add_u32 v233, 65536, v234
  s_add_u32 m0, s75, 81920
  s_sub_u32 s87, 196608, s73
  buffer_load_dwordx4 v246, s[8:11], s87 offen lds
  v_mov_b32 v4, 0x3f803f80
  v_mov_b32 v5, 0x3f803f80
  v_mov_b32 v6, 0x3f803f80
  buffer_load_dwordx4 v246, s[8:11], s87 offen offset:1024 lds
  v_mov_b32 v7, 0x3f803f80
  v_and_b32 v250, 11, v252
  v_cmp_eq_u32 vcc, 0, v250
  buffer_load_dwordx4 v245, s[8:11], s87 offen offset:2048 lds
  s_nop 0
  v_cndmask_b32 v232, 0, v4, vcc
  v_mov_b32 v8, v232
  v_mov_b32 v9, v232
  buffer_load_dwordx4 v245, s[8:11], s87 offen offset:3072 lds
  v_accvgpr_write_b32 a8, -1
  v_accvgpr_write_b32 a9, -1
  v_accvgpr_write_b32 a10, -1
  v_accvgpr_write_b32 a11, -1
  s_lshl_b32 s65, s93, 2
  s_add_u32 s65, s65, s95
  s_lshl_b32 s65, s65, 11
  s_add_u32 s64, s65, s86
  s_add_u32 s64, s64, 65536
  v_and_b32 v250, 1, v251
  v_lshlrev_b32 v250, 9, v250
  v_lshrrev_b32 v249, 1, v251
  v_lshl_add_u32 v250, v249, 8, v250
  v_lshl_add_u32 v239, v252, 4, v250
  v_add_u32 v239, 65536, v239
  v_mov_b64 v[10:11], v[8:9]
  v_mov_b64 v[12:13], v[8:9]
  v_mov_b64 v[14:15], v[8:9]
  v_mov_b64 v[16:17], v[8:9]
  v_mov_b64 v[18:19], v[8:9]
  v_mov_b64 v[20:21], v[8:9]
  v_mov_b64 v[22:23], v[8:9]
  v_mov_b64 v[24:25], v[8:9]
  v_mov_b64 v[26:27], v[8:9]
  v_mov_b64 v[28:29], v[8:9]
  v_mov_b64 v[30:31], v[8:9]
  v_mov_b64 v[32:33], v[8:9]
  v_mov_b64 v[34:35], v[8:9]
  v_mov_b64 v[36:37], v[8:9]
  v_mov_b64 v[38:39], v[8:9]
  v_mov_b64 v[40:41], v[8:9]
  v_mov_b64 v[42:43], v[8:9]
  v_mov_b64 v[44:45], v[8:9]
  v_mov_b64 v[46:47], v[8:9]
  v_mov_b64 v[48:49], v[8:9]
  v_mov_b64 v[50:51], v[8:9]
  v_mov_b64 v[52:53], v[8:9]
  v_mov_b64 v[54:55], v[8:9]
  v_mov_b64 v[56:57], v[8:9]
  v_mov_b64 v[58:59], v[8:9]
  v_mov_b64 v[60:61], v[8:9]
  v_mov_b64 v[62:63], v[8:9]
  v_mov_b64 v[64:65], v[8:9]
  v_mov_b64 v[66:67], v[8:9]
  v_mov_b64 v[68:69], v[8:9]
  v_mov_b64 v[70:71], v[8:9]
  v_and_b32 v250, 31, v0
  v_lshrrev_b32 v249, 5, v0
  v_lshlrev_b32 v249, 2, v249
  v_sub_u32 v250, v250, v249
  v_mov_b32 v249, 0xf149f2ca
  v_cmp_le_i32 s[62:63], 0, v250
  v_cmp_le_i32 s[60:61], 1, v250
  v_cmp_le_i32 s[58:59], 2, v250
  v_cmp_le_i32 s[56:57], 3, v250
  v_cndmask_b32 v72, v249, 0, s[62:63]
  v_cndmask_b32 v88, 0, v249, s[62:63]
  v_cndmask_b32 v73, v249, 0, s[60:61]
  v_cndmask_b32 v89, 0, v249, s[60:61]
  v_cndmask_b32 v74, v249, 0, s[58:59]
  v_cndmask_b32 v90, 0, v249, s[58:59]
  v_cndmask_b32 v75, v249, 0, s[56:57]
  v_cndmask_b32 v91, 0, v249, s[56:57]
  v_cmp_le_i32 s[62:63], 8, v250
  v_cmp_le_i32 s[60:61], 9, v250
  v_cmp_le_i32 s[58:59], 10, v250
  v_cmp_le_i32 s[56:57], 11, v250
  v_cndmask_b32 v76, v249, 0, s[62:63]
  v_cndmask_b32 v92, 0, v249, s[62:63]
  v_cndmask_b32 v77, v249, 0, s[60:61]
  v_cndmask_b32 v93, 0, v249, s[60:61]
  v_cndmask_b32 v78, v249, 0, s[58:59]
  v_cndmask_b32 v94, 0, v249, s[58:59]
  v_cndmask_b32 v79, v249, 0, s[56:57]
  v_cndmask_b32 v95, 0, v249, s[56:57]
  v_cmp_le_i32 s[62:63], 16, v250
  v_cmp_le_i32 s[60:61], 17, v250
  v_cmp_le_i32 s[58:59], 18, v250
  v_cmp_le_i32 s[56:57], 19, v250
  v_cndmask_b32 v80, v249, 0, s[62:63]
  v_cndmask_b32 v96, 0, v249, s[62:63]
  v_cndmask_b32 v81, v249, 0, s[60:61]
  v_cndmask_b32 v97, 0, v249, s[60:61]
  v_cndmask_b32 v82, v249, 0, s[58:59]
  v_cndmask_b32 v98, 0, v249, s[58:59]
  v_cndmask_b32 v83, v249, 0, s[56:57]
  v_cndmask_b32 v99, 0, v249, s[56:57]
  v_cmp_le_i32 s[62:63], 24, v250
  v_cmp_le_i32 s[60:61], 25, v250
  v_cmp_le_i32 s[58:59], 26, v250
  v_cmp_le_i32 s[56:57], 27, v250
  v_cndmask_b32 v84, v249, 0, s[62:63]
  v_cndmask_b32 v100, 0, v249, s[62:63]
  v_cndmask_b32 v85, v249, 0, s[60:61]
  v_cndmask_b32 v101, 0, v249, s[60:61]
  v_cndmask_b32 v86, v249, 0, s[58:59]
  v_cndmask_b32 v102, 0, v249, s[58:59]
  v_cndmask_b32 v87, v249, 0, s[56:57]
  v_cndmask_b32 v103, 0, v249, s[56:57]
  v_and_b32 v231, 1, v251
  v_lshlrev_b32 v231, 14, v231
  v_lshrrev_b32 v249, 1, v251
  v_lshl_add_u32 v231, v249, 8, v231
  v_lshl_add_u32 v231, v252, 4, v231
  v_lshrrev_b32 v230, 5, v0
  v_lshlrev_b32 v230, 2, v230
  v_lshl_add_u32 v230, v252, 3, v230
  s_lshr_b32 s91, s93, 2
  s_add_u32 s63, s91, 1
  s_sub_i32 s91, 0, s63
  s_bitcmp1_b32 s93, 1
  s_cselect_b32 s63, s91, s63
  s_lshl_b32 s91, s95, 4
  s_add_i32 s91, s91, s63
  v_add_u32 v250, s91, v252
  v_lshrrev_b32 v249, 4, v250
  v_lshlrev_b32 v249, 14, v249
  v_and_b32 v229, 15, v250
  v_lshl_add_u32 v229, v229, 4, v249
  v_lshl_add_u32 v229, v251, 8, v229
  v_mov_b32 v249, 0x80000000
  v_cmp_gt_u32 vcc, 64, v250
  s_nop 1
  v_cndmask_b32 v229, v249, v229, vcc
  s_cmp_gt_i32 s63, 0
  s_cselect_b32 s91, 1, -1
  s_add_i32 s91, s91, s94
  s_mul_i32 s90, s91, 360448
  s_add_u32 s90, s90, 335872
  s_cmp_lt_u32 s91, 32
  s_cselect_b32 s90, s90, 0x80000000
  v_and_b32 v228, 1, v250
  v_lshlrev_b32 v228, 4, v228
  v_lshl_add_u32 v228, v251, 5, v228
  v_add_u32 v228, s90, v228
  v_cndmask_b32 v228, v228, v249, vcc
  s_and_b32 s63, s94, -2
  s_lshr_b32 s91, s95, 1
  s_add_u32 s63, s63, s91
  s_mul_i32 s63, s63, 360448
  s_and_b32 s62, s95, 1
  s_lshl_b32 s62, s62, 1
  s_lshr_b32 s61, s92, 2
  s_lshl_b32 s61, s61, 16
  s_and_b32 s91, s92, 3
  s_lshl_b32 s91, s91, 12
  s_add_u32 s61, s61, s91
  s_add_u32 s61, s61, s63
  v_and_b32 v250, 1, v251
  v_add_u32 v250, s62, v250
  v_lshrrev_b32 v249, 5, v0
  v_lshlrev_b32 v227, 14, v250
  v_lshl_add_u32 v227, v249, 8, v227
  v_lshl_add_u32 v227, v252, 4, v227
  v_accvgpr_write_b32 a0, v231
  v_accvgpr_write_b32 a1, v230
  v_accvgpr_write_b32 a2, v229
  v_accvgpr_write_b32 a3, v228
  v_accvgpr_write_b32 a4, v227
  v_bfe_u32 v250, v0, 3, 1
  v_and_b32 v249, 7, v0
  v_lshlrev_b32 v249, 4, v249
  s_lshl_b32 s91, s93, 11
  s_add_u32 s91, s91, 335872
  s_cmp_eq_u32 s95, 0
  s_cselect_b32 s91, s91, 0x80000000
  v_lshl_add_u32 v230, v250, 10, v249
  v_add_u32 v230, s91, v230
  s_lshl_b32 s91, s95, 10
  s_add_u32 s91, s91, s85
  s_add_u32 s91, s91, 327680
  v_lshl_add_u32 v249, v250, 12, v249
  v_add_u32 v249, s91, v249
  v_cndmask_b32 v230, v249, v230, s[82:83]
  s_bitcmp1_b32 s93, 1
  s_cselect_b32 s91, 31, 0
  s_cmp_eq_u32 s91, s94
  s_cselect_b32 s91, 1, 0
  v_cndmask_b32 v250, -1, 0, s[82:83]
  v_or_b32 v249, s91, v250
  v_accvgpr_write_b32 a12, v249
  s_mov_b64 exec, 0
  s_cmp_eq_u32 s95, 0
  s_cbranch_scc1 L_page_1
  s_cmp_eq_u32 s95, 1
  s_cbranch_scc1 L_page_2
  s_cmp_eq_u32 s95, 2
  s_cbranch_scc1 L_page_3
  s_branch L_page_4
L_pageret_0:
  s_mov_b64 exec, -1
  s_mov_b64 exec, 0
  s_cmp_eq_u32 s95, 0
  s_cbranch_scc1 L_page_5
  s_cmp_eq_u32 s95, 1
  s_cbranch_scc1 L_page_6
  s_cmp_eq_u32 s95, 2
  s_cbranch_scc1 L_page_7
  s_branch L_page_8
L_pageret_1:
  s_mov_b64 exec, -1
  v_accvgpr_write_b32 a13, v250
  v_accvgpr_write_b32 a14, v250
  v_accvgpr_write_b32 a15, v250
  s_lshl_b32 s60, s95, 14
  s_add_u32 m0, s76, 16384
  s_xor_b32 s87, s74, 256
  buffer_load_dwordx4 v248, s[4:7], s87 offen lds
  s_add_u32 s60, s60, s86
  s_lshl_b32 s59, s95, 10
  s_add_u32 s59, s59, s86
  buffer_load_dwordx4 v247, s[4:7], s87 offen offset:1024 lds
  s_lshr_b32 s58, s65, 2
  s_add_u32 s58, s58, s86
  s_lshl_b32 s57, s93, 11
  s_add_u32 m0, s75, 98304
  s_add_u32 s87, 393216, s73
  buffer_load_dwordx4 v246, s[8:11], s87 offen lds
  s_lshr_b32 s56, s65, 4
  s_add_u32 s56, s56, 352256
  s_getreg_b32 s84, hwreg(HW_REG_XCC_ID, 0, 4)
  s_lshl_b32 s84, s84, 1
  buffer_load_dwordx4 v246, s[8:11], s87 offen offset:1024 lds
  v_and_b32 v250, 3, v0
  v_add_u32 v250, 1, v250
  v_min_u32 v250, s94, v250
  buffer_load_dwordx4 v245, s[8:11], s87 offen offset:2048 lds
  v_sub_u32 v250, s94, v250
  s_mov_b32 s91, 360448
  v_mul_lo_u32 v226, v250, s91
  buffer_load_dwordx4 v245, s[8:11], s87 offen offset:3072 lds
  s_waitcnt vmcnt(15)
  s_barrier
  ds_read_b128 v[104:107], v238 offset:0
  ds_read_b64_tr_b16 v[176:177], v234 offset:0
  ds_read_b64_tr_b16 v[178:179], v234 offset:512
  ds_read_b64_tr_b16 v[180:181], v234 offset:1024
  ds_read_b64_tr_b16 v[182:183], v234 offset:1536
  ds_read_b128 v[108:111], v238 offset:2048
  ds_read_b128 v[112:115], v238 offset:4096
  ds_read_b128 v[116:119], v238 offset:6144
  ds_read_b128 v[120:123], v236 offset:0
  s_waitcnt lgkmcnt(6)
  v_mfma_f32_16x16x32_bf16 v[144:147], v[176:179], v[104:107], 0
  s_waitcnt lgkmcnt(4)
  ds_read_b128 v[124:127], v237 offset:0
  v_mfma_f32_16x16x32_bf16 v[160:163], v[104:107], v[180:183], 0
  ds_read_b64_tr_b16 v[184:185], v234 offset:2048
  v_mfma_f32_16x16x32_bf16 v[192:195], v[176:179], v[4:7], 0
  ds_read_b64_tr_b16 v[186:187], v234 offset:2560
  v_mfma_f32_16x16x32_bf16 v[196:199], v[4:7], v[180:183], 0
  s_add_u32 m0, s76, 24576
  s_xor_b32 s87, s74, 384
  buffer_load_dwordx4 v248, s[4:7], s87 offen lds
  s_waitcnt lgkmcnt(6)
  v_mfma_f32_16x16x32_bf16 v[148:151], v[176:179], v[108:111], 0
  ds_read_b64_tr_b16 v[188:189], v234 offset:3072
  v_mfma_f32_16x16x32_bf16 v[164:167], v[108:111], v[180:183], 0
  s_waitcnt lgkmcnt(6)
  ds_read_b64_tr_b16 v[190:191], v234 offset:3584
  v_mfma_f32_16x16x32_bf16 v[152:155], v[176:179], v[112:115], 0
  buffer_load_dwordx4 v247, s[4:7], s87 offen offset:1024 lds
  v_mfma_f32_16x16x32_bf16 v[168:171], v[112:115], v[180:183], 0
  s_waitcnt lgkmcnt(6)
  ds_read_b128 v[128:131], v237 offset:2048
  v_mfma_f32_16x16x32_bf16 v[156:159], v[176:179], v[116:119], 0
  ds_read_b128 v[132:135], v237 offset:4096
  v_mfma_f32_16x16x32_bf16 v[172:175], v[116:119], v[180:183], 0
  s_add_u32 m0, s75, 114688
  s_sub_u32 s87, 589824, s73
  buffer_load_dwordx4 v246, s[8:11], s87 offen lds
  s_waitcnt lgkmcnt(7)
  v_mfma_f32_16x16x32_bf16 v[200:203], v[4:7], v[120:123], 0
  ds_read_b128 v[136:139], v237 offset:6144
  v_mfma_f32_16x16x32_bf16 v[204:207], v[120:123], v[120:123], 0
  s_waitcnt lgkmcnt(5)
  ds_read_b128 v[140:143], v235 offset:0
  buffer_load_dwordx4 v246, s[8:11], s87 offen offset:1024 lds
  v_mfma_f32_16x16x32_bf16 v[144:147], v[184:187], v[124:127], v[144:147]
  s_waitcnt lgkmcnt(4)
  v_mfma_f32_16x16x32_bf16 v[160:163], v[124:127], v[188:191], v[160:163]
  s_waitcnt lgkmcnt(0)
  s_waitcnt vmcnt(10)
  s_barrier
  v_mfma_f32_16x16x32_bf16 v[192:195], v[184:187], v[4:7], v[192:195]
  ds_read_b128 v[104:107], v238 offset:8192
  v_mfma_f32_16x16x32_bf16 v[196:199], v[4:7], v[188:191], v[196:199]
  ds_read_b64_tr_b16 v[176:177], v234 offset:16384
  v_mfma_f32_16x16x32_bf16 v[148:151], v[184:187], v[128:131], v[148:151]
  ds_read_b64_tr_b16 v[178:179], v234 offset:16896
  v_mfma_f32_16x16x32_bf16 v[164:167], v[128:131], v[188:191], v[164:167]
  buffer_load_dwordx4 v245, s[8:11], s87 offen offset:2048 lds
  ds_read_b64_tr_b16 v[180:181], v234 offset:17408
  v_mfma_f32_16x16x32_bf16 v[152:155], v[184:187], v[132:135], v[152:155]
  ds_read_b64_tr_b16 v[182:183], v234 offset:17920
  v_mfma_f32_16x16x32_bf16 v[168:171], v[132:135], v[188:191], v[168:171]
  buffer_load_dwordx4 v245, s[8:11], s87 offen offset:3072 lds
  v_mfma_f32_16x16x32_bf16 v[156:159], v[184:187], v[136:139], v[156:159]
  ds_read_b128 v[108:111], v238 offset:10240
  ds_read_b128 v[112:115], v238 offset:12288
  v_mfma_f32_16x16x32_bf16 v[172:175], v[136:139], v[188:191], v[172:175]
  s_add_u32 m0, s76, 32768
  s_xor_b32 s87, s74, 512
  buffer_load_dwordx4 v248, s[4:7], s87 offen lds
  v_mfma_f32_16x16x32_bf16 v[200:203], v[4:7], v[140:143], v[200:203]
  ds_read_b128 v[116:119], v238 offset:14336
  v_mfma_f32_16x16x32_bf16 v[204:207], v[140:143], v[140:143], v[204:207]
  s_waitcnt lgkmcnt(5)
  ds_read_b128 v[120:123], v236 offset:8192
  buffer_load_dwordx4 v247, s[4:7], s87 offen offset:1024 lds
  v_mfma_f32_16x16x32_bf16 v[144:147], v[176:179], v[104:107], v[144:147]
  s_waitcnt lgkmcnt(4)
  ds_read_b128 v[124:127], v237 offset:8192
  v_mfma_f32_16x16x32_bf16 v[160:163], v[104:107], v[180:183], v[160:163]
  ds_read_b64_tr_b16 v[184:185], v234 offset:18432
  v_mfma_f32_16x16x32_bf16 v[192:195], v[176:179], v[4:7], v[192:195]
  ds_read_b64_tr_b16 v[186:187], v234 offset:18944
  v_mfma_f32_16x16x32_bf16 v[196:199], v[4:7], v[180:183], v[196:199]
  s_add_u32 m0, s75, 131072
  s_add_u32 s87, 786432, s73
  buffer_load_dwordx4 v246, s[8:11], s87 offen lds
  s_waitcnt lgkmcnt(6)
  v_mfma_f32_16x16x32_bf16 v[148:151], v[176:179], v[108:111], v[148:151]
  ds_read_b64_tr_b16 v[188:189], v234 offset:19456
  v_mfma_f32_16x16x32_bf16 v[164:167], v[108:111], v[180:183], v[164:167]
  s_waitcnt lgkmcnt(6)
  ds_read_b64_tr_b16 v[190:191], v234 offset:19968
  v_mfma_f32_16x16x32_bf16 v[152:155], v[176:179], v[112:115], v[152:155]
  buffer_load_dwordx4 v246, s[8:11], s87 offen offset:1024 lds
  v_mfma_f32_16x16x32_bf16 v[168:171], v[112:115], v[180:183], v[168:171]
  s_waitcnt lgkmcnt(6)
  ds_read_b128 v[128:131], v237 offset:10240
  v_mfma_f32_16x16x32_bf16 v[156:159], v[176:179], v[116:119], v[156:159]
  ds_read_b128 v[132:135], v237 offset:12288
  v_mfma_f32_16x16x32_bf16 v[172:175], v[116:119], v[180:183], v[172:175]
  s_waitcnt lgkmcnt(7)
  buffer_load_dwordx4 v245, s[8:11], s87 offen offset:2048 lds
  v_mfma_f32_16x16x32_bf16 v[200:203], v[4:7], v[120:123], v[200:203]
  ds_read_b128 v[136:139], v237 offset:14336
  v_mfma_f32_16x16x32_bf16 v[204:207], v[120:123], v[120:123], v[204:207]
  s_waitcnt lgkmcnt(5)
  ds_read_b128 v[140:143], v235 offset:8192
  buffer_load_dwordx4 v245, s[8:11], s87 offen offset:3072 lds
  v_mfma_f32_16x16x32_bf16 v[144:147], v[184:187], v[124:127], v[144:147]
  s_waitcnt lgkmcnt(4)
  v_mfma_f32_16x16x32_bf16 v[160:163], v[124:127], v[188:191], v[160:163]
  s_waitcnt lgkmcnt(0)
  s_waitcnt vmcnt(12)
  s_barrier
  v_mfma_f32_16x16x32_bf16 v[192:195], v[184:187], v[4:7], v[192:195]
  ds_read_b128 v[104:107], v238 offset:16384
  v_mfma_f32_16x16x32_bf16 v[196:199], v[4:7], v[188:191], v[196:199]
  ds_read_b64_tr_b16 v[176:177], v234 offset:32768
  v_mfma_f32_16x16x32_bf16 v[148:151], v[184:187], v[128:131], v[148:151]
  ds_read_b64_tr_b16 v[178:179], v234 offset:33280
  v_mfma_f32_16x16x32_bf16 v[164:167], v[128:131], v[188:191], v[164:167]
  s_add_u32 m0, s76, 40960
  s_xor_b32 s87, s74, 640
  buffer_load_dwordx4 v248, s[4:7], s87 offen lds
  ds_read_b64_tr_b16 v[180:181], v234 offset:33792
  v_mfma_f32_16x16x32_bf16 v[152:155], v[184:187], v[132:135], v[152:155]
  ds_read_b64_tr_b16 v[182:183], v234 offset:34304
  v_mfma_f32_16x16x32_bf16 v[168:171], v[132:135], v[188:191], v[168:171]
  buffer_load_dwordx4 v247, s[4:7], s87 offen offset:1024 lds
  v_mfma_f32_16x16x32_bf16 v[156:159], v[184:187], v[136:139], v[156:159]
  ds_read_b128 v[108:111], v238 offset:18432
  ds_read_b128 v[112:115], v238 offset:20480
  v_mfma_f32_16x16x32_bf16 v[172:175], v[136:139], v[188:191], v[172:175]
  s_add_u32 m0, s75, 147456
  s_sub_u32 s87, 983040, s73
  buffer_load_dwordx4 v246, s[8:11], s87 offen lds
  v_mfma_f32_16x16x32_bf16 v[200:203], v[4:7], v[140:143], v[200:203]
  ds_read_b128 v[116:119], v238 offset:22528
  v_mfma_f32_16x16x32_bf16 v[204:207], v[140:143], v[140:143], v[204:207]
  s_waitcnt lgkmcnt(5)
  ds_read_b128 v[120:123], v236 offset:16384
  buffer_load_dwordx4 v246, s[8:11], s87 offen offset:1024 lds
  v_mfma_f32_16x16x32_bf16 v[144:147], v[176:179], v[104:107], v[144:147]
  s_waitcnt lgkmcnt(4)
  ds_read_b128 v[124:127], v237 offset:16384
  v_mfma_f32_16x16x32_bf16 v[160:163], v[104:107], v[180:183], v[160:163]
  ds_read_b64_tr_b16 v[184:185], v234 offset:34816
  v_mfma_f32_16x16x32_bf16 v[192:195], v[176:179], v[4:7], v[192:195]
  ds_read_b64_tr_b16 v[186:187], v234 offset:35328
  v_mfma_f32_16x16x32_bf16 v[196:199], v[4:7], v[180:183], v[196:199]
  s_waitcnt lgkmcnt(6)
  buffer_load_dwordx4 v245, s[8:11], s87 offen offset:2048 lds
  v_mfma_f32_16x16x32_bf16 v[148:151], v[176:179], v[108:111], v[148:151]
  ds_read_b64_tr_b16 v[188:189], v234 offset:35840
  v_mfma_f32_16x16x32_bf16 v[164:167], v[108:111], v[180:183], v[164:167]
  s_waitcnt lgkmcnt(6)
  ds_read_b64_tr_b16 v[190:191], v234 offset:36352
  v_mfma_f32_16x16x32_bf16 v[152:155], v[176:179], v[112:115], v[152:155]
  buffer_load_dwordx4 v245, s[8:11], s87 offen offset:3072 lds
  v_mfma_f32_16x16x32_bf16 v[168:171], v[112:115], v[180:183], v[168:171]
  s_waitcnt lgkmcnt(6)
  ds_read_b128 v[128:131], v237 offset:18432
  v_mfma_f32_16x16x32_bf16 v[156:159], v[176:179], v[116:119], v[156:159]
  ds_read_b128 v[132:135], v237 offset:20480
  v_mfma_f32_16x16x32_bf16 v[172:175], v[116:119], v[180:183], v[172:175]
  s_add_u32 m0, s76, 49152
  s_xor_b32 s87, s74, 768
  buffer_load_dwordx4 v248, s[4:7], s87 offen lds
  s_waitcnt lgkmcnt(7)
  v_mfma_f32_16x16x32_bf16 v[200:203], v[4:7], v[120:123], v[200:203]
  ds_read_b128 v[136:139], v237 offset:22528
  v_mfma_f32_16x16x32_bf16 v[204:207], v[120:123], v[120:123], v[204:207]
  s_waitcnt lgkmcnt(5)
  ds_read_b128 v[140:143], v235 offset:16384
  buffer_load_dwordx4 v247, s[4:7], s87 offen offset:1024 lds
  v_mfma_f32_16x16x32_bf16 v[144:147], v[184:187], v[124:127], v[144:147]
  s_waitcnt lgkmcnt(4)
  v_mfma_f32_16x16x32_bf16 v[160:163], v[124:127], v[188:191], v[160:163]
  s_waitcnt lgkmcnt(0)
  s_waitcnt vmcnt(14)
  s_barrier
  v_mfma_f32_16x16x32_bf16 v[192:195], v[184:187], v[4:7], v[192:195]
  ds_read_b128 v[104:107], v238 offset:24576
  v_mfma_f32_16x16x32_bf16 v[196:199], v[4:7], v[188:191], v[196:199]
  ds_read_b64_tr_b16 v[176:177], v234 offset:49152
  v_mfma_f32_16x16x32_bf16 v[148:151], v[184:187], v[128:131], v[148:151]
  ds_read_b64_tr_b16 v[178:179], v234 offset:49664
  s_add_u32 m0, s75, 65536
  s_add_u32 s87, 1179648, s73
  buffer_load_dwordx4 v246, s[8:11], s87 offen lds
  v_mfma_f32_16x16x32_bf16 v[164:167], v[128:131], v[188:191], v[164:167]
  ds_read_b64_tr_b16 v[180:181], v234 offset:50176
  v_mfma_f32_16x16x32_bf16 v[152:155], v[184:187], v[132:135], v[152:155]
  ds_read_b64_tr_b16 v[182:183], v234 offset:50688
  buffer_load_dwordx4 v246, s[8:11], s87 offen offset:1024 lds
  v_mfma_f32_16x16x32_bf16 v[168:171], v[132:135], v[188:191], v[168:171]
  ds_read_b128 v[108:111], v238 offset:26624
  v_mfma_f32_16x16x32_bf16 v[156:159], v[184:187], v[136:139], v[156:159]
  ds_read_b128 v[112:115], v238 offset:28672
  v_mfma_f32_16x16x32_bf16 v[172:175], v[136:139], v[188:191], v[172:175]
  buffer_load_dwordx4 v245, s[8:11], s87 offen offset:2048 lds
  ds_read_b128 v[116:119], v238 offset:30720
  v_mfma_f32_16x16x32_bf16 v[200:203], v[4:7], v[140:143], v[200:203]
  ds_read_b128 v[120:123], v236 offset:24576
  v_mfma_f32_16x16x32_bf16 v[204:207], v[140:143], v[140:143], v[204:207]
  s_waitcnt lgkmcnt(6)
  buffer_load_dwordx4 v245, s[8:11], s87 offen offset:3072 lds
  buffer_load_dword v225, off, s[12:15], 0 sc1
  v_mfma_f32_16x16x32_bf16 v[144:147], v[176:179], v[104:107], v[144:147]
  s_waitcnt lgkmcnt(4)
  ds_read_b128 v[124:127], v237 offset:24576
  v_mfma_f32_16x16x32_bf16 v[160:163], v[104:107], v[180:183], v[160:163]
  ds_read_b64_tr_b16 v[184:185], v234 offset:51200
  v_mfma_f32_16x16x32_bf16 v[192:195], v[176:179], v[4:7], v[192:195]
  ds_read_b64_tr_b16 v[186:187], v234 offset:51712
  v_mfma_f32_16x16x32_bf16 v[196:199], v[4:7], v[180:183], v[196:199]
  s_add_u32 m0, s76, 57344
  s_xor_b32 s87, s74, 896
  buffer_load_dwordx4 v248, s[4:7], s87 offen lds
  s_waitcnt lgkmcnt(6)
  v_mfma_f32_16x16x32_bf16 v[148:151], v[176:179], v[108:111], v[148:151]
  ds_read_b64_tr_b16 v[188:189], v234 offset:52224
  v_mfma_f32_16x16x32_bf16 v[164:167], v[108:111], v[180:183], v[164:167]
  s_waitcnt lgkmcnt(6)
  ds_read_b64_tr_b16 v[190:191], v234 offset:52736
L_page_1:
  s_cbranch_execz L_pageret_0
  v_mfma_f32_16x16x32_bf16 v[152:155], v[176:179], v[112:115], v[152:155]
  buffer_load_dwordx4 v247, s[4:7], s87 offen offset:1024 lds
  v_mfma_f32_16x16x32_bf16 v[168:171], v[112:115], v[180:183], v[168:171]
  s_waitcnt lgkmcnt(6)
  ds_read_b128 v[128:131], v237 offset:26624
  v_mfma_f32_16x16x32_bf16 v[156:159], v[176:179], v[116:119], v[156:159]
  ds_read_b128 v[132:135], v237 offset:28672
  v_mfma_f32_16x16x32_bf16 v[172:175], v[116:119], v[180:183], v[172:175]
  s_add_u32 m0, s75, 81920
  s_sub_u32 s87, 1376256, s73
  buffer_load_dwordx4 v246, s[8:11], s87 offen lds
  s_waitcnt lgkmcnt(7)
  v_mfma_f32_16x16x32_bf16 v[200:203], v[4:7], v[120:123], v[200:203]
  ds_read_b128 v[136:139], v237 offset:30720
  v_mfma_f32_16x16x32_bf16 v[204:207], v[120:123], v[120:123], v[204:207]
  s_waitcnt lgkmcnt(5)
  ds_read_b128 v[140:143], v235 offset:24576
  buffer_load_dwordx4 v246, s[8:11], s87 offen offset:1024 lds
  v_mfma_f32_16x16x32_bf16 v[144:147], v[184:187], v[124:127], v[144:147]
  s_waitcnt lgkmcnt(4)
  v_mfma_f32_16x16x32_bf16 v[160:163], v[124:127], v[188:191], v[160:163]
  s_waitcnt lgkmcnt(0)
  s_waitcnt vmcnt(17)
  s_barrier
  v_mfma_f32_16x16x32_bf16 v[192:195], v[184:187], v[4:7], v[192:195]
  ds_read_b128 v[104:107], v238 offset:32768
  v_mfma_f32_16x16x32_bf16 v[196:199], v[4:7], v[188:191], v[196:199]
  ds_read_b64_tr_b16 v[176:177], v233 offset:0
  v_mfma_f32_16x16x32_bf16 v[148:151], v[184:187], v[128:131], v[148:151]
  ds_read_b64_tr_b16 v[178:179], v233 offset:512
  v_mfma_f32_16x16x32_bf16 v[164:167], v[128:131], v[188:191], v[164:167]
  ds_read_b64_tr_b16 v[180:181], v233 offset:1024
  v_mfma_f32_16x16x32_bf16 v[152:155], v[184:187], v[132:135], v[152:155]
  ds_read_b64_tr_b16 v[182:183], v233 offset:1536
  v_mfma_f32_16x16x32_bf16 v[168:171], v[132:135], v[188:191], v[168:171]
  buffer_load_dwordx4 v245, s[8:11], s87 offen offset:2048 lds
  v_mfma_f32_16x16x32_bf16 v[156:159], v[184:187], v[136:139], v[156:159]
  ds_read_b128 v[108:111], v238 offset:34816
  v_mfma_f32_16x16x32_bf16 v[172:175], v[136:139], v[188:191], v[172:175]
  ds_read_b128 v[112:115], v238 offset:36864
  v_mfma_f32_16x16x32_bf16 v[200:203], v[4:7], v[140:143], v[200:203]
  ds_read_b128 v[116:119], v238 offset:38912
  v_mfma_f32_16x16x32_bf16 v[204:207], v[140:143], v[140:143], v[204:207]
  s_waitcnt lgkmcnt(5)
  ds_read_b128 v[120:123], v236 offset:32768
  buffer_load_dwordx4 v245, s[8:11], s87 offen offset:3072 lds
  v_mfma_f32_16x16x32_bf16 v[144:147], v[176:179], v[104:107], v[144:147]
  s_waitcnt lgkmcnt(4)
  v_mfma_f32_16x16x32_bf16 v[160:163], v[104:107], v[180:183], v[160:163]
  ds_read_b128 v[124:127], v237 offset:32768
  v_mfma_f32_16x16x32_bf16 v[192:195], v[176:179], v[4:7], v[192:195]
  ds_read_b64_tr_b16 v[184:185], v233 offset:2048
  v_mfma_f32_16x16x32_bf16 v[196:199], v[4:7], v[180:183], v[196:199]
  s_waitcnt lgkmcnt(5)
  ds_read_b64_tr_b16 v[186:187], v233 offset:2560
  v_mfma_f32_16x16x32_bf16 v[148:151], v[176:179], v[108:111], v[148:151]
  ds_read_b64_tr_b16 v[188:189], v233 offset:3072
  v_mfma_f32_16x16x32_bf16 v[164:167], v[108:111], v[180:183], v[164:167]
  s_waitcnt lgkmcnt(6)
  ds_read_b64_tr_b16 v[190:191], v233 offset:3584
  v_mfma_f32_16x16x32_bf16 v[152:155], v[176:179], v[112:115], v[152:155]
  ds_read_b128 v[128:131], v237 offset:34816
  v_mfma_f32_16x16x32_bf16 v[168:171], v[112:115], v[180:183], v[168:171]
  s_waitcnt lgkmcnt(7)
  ds_read_b128 v[132:135], v237 offset:36864
  v_mfma_f32_16x16x32_bf16 v[156:159], v[176:179], v[116:119], v[156:159]
  ds_read_b128 v[136:139], v237 offset:38912
  v_mfma_f32_16x16x32_bf16 v[172:175], v[116:119], v[180:183], v[172:175]
  s_waitcnt lgkmcnt(8)
  ds_read_b128 v[140:143], v235 offset:32768
  v_mfma_f32_16x16x32_bf16 v[200:203], v[4:7], v[120:123], v[200:203]
  s_mov_b64 exec, 0xff
  buffer_load_dword a5, v243, s[44:47], s68 offen
  s_mov_b64 exec, -1
  v_mfma_f32_16x16x32_bf16 v[204:207], v[120:123], v[120:123], v[204:207]
  s_and_b32 s70, s94, -2
  s_mul_i32 s70, s70, 360448
  s_add_u32 s70, s70, 358400
  s_mov_b64 exec, 0x3f
  buffer_load_dword a5, v243, s[16:19], s70 offen
  s_mov_b64 exec, -1
  s_waitcnt lgkmcnt(6)
  v_mfma_f32_16x16x32_bf16 v[144:147], v[184:187], v[124:127], v[144:147]
  s_waitcnt lgkmcnt(4)
  v_mfma_f32_16x16x32_bf16 v[160:163], v[124:127], v[188:191], v[160:163]
  s_waitcnt lgkmcnt(0)
  s_waitcnt vmcnt(15)
  s_barrier
  v_mfma_f32_16x16x32_bf16 v[192:195], v[184:187], v[4:7], v[192:195]
  ds_read_b128 v[104:107], v238 offset:40960
  v_mfma_f32_16x16x32_bf16 v[196:199], v[4:7], v[188:191], v[196:199]
  ds_read_b64_tr_b16 v[176:177], v233 offset:16384
  v_mfma_f32_16x16x32_bf16 v[148:151], v[184:187], v[128:131], v[148:151]
  ds_read_b64_tr_b16 v[178:179], v233 offset:16896
  v_mfma_f32_16x16x32_bf16 v[164:167], v[128:131], v[188:191], v[164:167]
  ds_read_b64_tr_b16 v[180:181], v233 offset:17408
  v_mfma_f32_16x16x32_bf16 v[152:155], v[184:187], v[132:135], v[152:155]
  ds_read_b64_tr_b16 v[182:183], v233 offset:17920
  v_mfma_f32_16x16x32_bf16 v[168:171], v[132:135], v[188:191], v[168:171]
  s_add_u32 m0, s75, 98304
  s_add_u32 s87, 0, s73
  buffer_load_dwordx4 v244, s[8:11], s87 offen lds
  v_mfma_f32_16x16x32_bf16 v[156:159], v[184:187], v[136:139], v[156:159]
  ds_read_b128 v[108:111], v238 offset:43008
  v_mfma_f32_16x16x32_bf16 v[172:175], v[136:139], v[188:191], v[172:175]
  ds_read_b128 v[112:115], v238 offset:45056
  v_mfma_f32_16x16x32_bf16 v[200:203], v[4:7], v[140:143], v[200:203]
  ds_read_b128 v[116:119], v238 offset:47104
  v_mfma_f32_16x16x32_bf16 v[204:207], v[140:143], v[140:143], v[204:207]
  s_waitcnt lgkmcnt(5)
  ds_read_b128 v[120:123], v236 offset:40960
  buffer_load_dwordx4 v245, s[8:11], s87 offen offset:1024 lds
  v_mfma_f32_16x16x32_bf16 v[144:147], v[176:179], v[104:107], v[144:147]
  s_waitcnt lgkmcnt(4)
  ds_read_b128 v[124:127], v237 offset:40960
  v_mfma_f32_16x16x32_bf16 v[160:163], v[104:107], v[180:183], v[160:163]
  ds_read_b64_tr_b16 v[184:185], v233 offset:18432
  v_mfma_f32_16x16x32_bf16 v[192:195], v[176:179], v[4:7], v[192:195]
  ds_read_b64_tr_b16 v[186:187], v233 offset:18944
  v_mfma_f32_16x16x32_bf16 v[196:199], v[4:7], v[180:183], v[196:199]
  s_waitcnt lgkmcnt(6)
  ds_read_b64_tr_b16 v[188:189], v233 offset:19456
  v_mfma_f32_16x16x32_bf16 v[148:151], v[176:179], v[108:111], v[148:151]
  ds_read_b64_tr_b16 v[190:191], v233 offset:19968
  v_mfma_f32_16x16x32_bf16 v[164:167], v[108:111], v[180:183], v[164:167]
  s_add_u32 m0, s75, 100352
  s_sub_u32 s87, 196608, s73
  buffer_load_dwordx4 v244, s[8:11], s87 offen lds
  s_waitcnt lgkmcnt(7)
  v_mfma_f32_16x16x32_bf16 v[152:155], v[176:179], v[112:115], v[152:155]
  ds_read_b128 v[128:131], v237 offset:43008
  v_mfma_f32_16x16x32_bf16 v[168:171], v[112:115], v[180:183], v[168:171]
  s_waitcnt lgkmcnt(7)
  ds_read_b128 v[132:135], v237 offset:45056
  v_mfma_f32_16x16x32_bf16 v[156:159], v[176:179], v[116:119], v[156:159]
  ds_read_b128 v[136:139], v237 offset:47104
  v_mfma_f32_16x16x32_bf16 v[172:175], v[116:119], v[180:183], v[172:175]
  s_waitcnt lgkmcnt(8)
  ds_read_b128 v[140:143], v235 offset:40960
  v_mfma_f32_16x16x32_bf16 v[200:203], v[4:7], v[120:123], v[200:203]
  buffer_load_dwordx4 v245, s[8:11], s87 offen offset:1024 lds
  v_mfma_f32_16x16x32_bf16 v[204:207], v[120:123], v[120:123], v[204:207]
  s_waitcnt vmcnt(12)
  v_readfirstlane_b32 s88, v225
  s_nop 0
  s_cmp_eq_u32 s88, 0
  s_cbranch_scc1 L_nonce_3
L_nret_4:
  s_xor_b32 s84, s84, s88
  s_waitcnt lgkmcnt(6)
  v_mfma_f32_16x16x32_bf16 v[144:147], v[184:187], v[124:127], v[144:147]
  s_waitcnt lgkmcnt(4)
  v_mfma_f32_16x16x32_bf16 v[160:163], v[124:127], v[188:191], v[160:163]
  s_waitcnt lgkmcnt(0)
  s_barrier
  v_mfma_f32_16x16x32_bf16 v[192:195], v[184:187], v[4:7], v[192:195]
  ds_read_b128 v[104:107], v238 offset:49152
  v_mfma_f32_16x16x32_bf16 v[196:199], v[4:7], v[188:191], v[196:199]
  ds_read_b64_tr_b16 v[176:177], v234 offset:0
  v_mfma_f32_16x16x32_bf16 v[148:151], v[184:187], v[128:131], v[148:151]
  ds_read_b64_tr_b16 v[178:179], v234 offset:512
  v_mfma_f32_16x16x32_bf16 v[164:167], v[128:131], v[188:191], v[164:167]
  ds_read_b64_tr_b16 v[180:181], v234 offset:1024
  v_mfma_f32_16x16x32_bf16 v[152:155], v[184:187], v[132:135], v[152:155]
  ds_read_b64_tr_b16 v[182:183], v234 offset:1536
  v_mfma_f32_16x16x32_bf16 v[168:171], v[132:135], v[188:191], v[168:171]
  s_add_u32 m0, s75, 114688
  s_add_u32 s87, 393216, s73
  buffer_load_dwordx4 v244, s[8:11], s87 offen lds
  v_mfma_f32_16x16x32_bf16 v[156:159], v[184:187], v[136:139], v[156:159]
  ds_read_b128 v[108:111], v238 offset:51200
  v_mfma_f32_16x16x32_bf16 v[172:175], v[136:139], v[188:191], v[172:175]
  ds_read_b128 v[112:115], v238 offset:53248
  v_mfma_f32_16x16x32_bf16 v[200:203], v[4:7], v[140:143], v[200:203]
  ds_read_b128 v[116:119], v238 offset:55296
  v_mfma_f32_16x16x32_bf16 v[204:207], v[140:143], v[140:143], v[204:207]
  s_waitcnt lgkmcnt(5)
  ds_read_b128 v[120:123], v236 offset:49152
  buffer_load_dwordx4 v245, s[8:11], s87 offen offset:1024 lds
  v_mfma_f32_16x16x32_bf16 v[144:147], v[176:179], v[104:107], v[144:147]
  s_waitcnt lgkmcnt(4)
  v_mfma_f32_16x16x32_bf16 v[160:163], v[104:107], v[180:183], v[160:163]
  ds_read_b128 v[124:127], v237 offset:49152
  v_mfma_f32_16x16x32_bf16 v[192:195], v[176:179], v[4:7], v[192:195]
  ds_read_b64_tr_b16 v[184:185], v234 offset:2048
  v_mfma_f32_16x16x32_bf16 v[196:199], v[4:7], v[180:183], v[196:199]
  s_waitcnt lgkmcnt(5)
  ds_read_b64_tr_b16 v[186:187], v234 offset:2560
  v_mfma_f32_16x16x32_bf16 v[148:151], v[176:179], v[108:111], v[148:151]
  ds_read_b64_tr_b16 v[188:189], v234 offset:3072
  v_mfma_f32_16x16x32_bf16 v[164:167], v[108:111], v[180:183], v[164:167]
  s_waitcnt lgkmcnt(6)
  ds_read_b64_tr_b16 v[190:191], v234 offset:3584
  v_mfma_f32_16x16x32_bf16 v[152:155], v[176:179], v[112:115], v[152:155]
  s_add_u32 m0, s75, 116736
  s_sub_u32 s87, 589824, s73
  buffer_load_dwordx4 v244, s[8:11], s87 offen lds
  v_mfma_f32_16x16x32_bf16 v[168:171], v[112:115], v[180:183], v[168:171]
  s_waitcnt lgkmcnt(6)
  ds_read_b128 v[128:131], v237 offset:51200
  v_mfma_f32_16x16x32_bf16 v[156:159], v[176:179], v[116:119], v[156:159]
  ds_read_b128 v[132:135], v237 offset:53248
  v_mfma_f32_16x16x32_bf16 v[172:175], v[116:119], v[180:183], v[172:175]
  s_waitcnt lgkmcnt(7)
  ds_read_b128 v[136:139], v237 offset:55296
  v_mfma_f32_16x16x32_bf16 v[200:203], v[4:7], v[120:123], v[200:203]
  ds_read_b128 v[140:143], v235 offset:49152
  v_mfma_f32_16x16x32_bf16 v[204:207], v[120:123], v[120:123], v[204:207]
  s_waitcnt lgkmcnt(6)
  buffer_load_dwordx4 v245, s[8:11], s87 offen offset:1024 lds
  v_mfma_f32_16x16x32_bf16 v[144:147], v[184:187], v[124:127], v[144:147]
  s_waitcnt lgkmcnt(4)
  v_mfma_f32_16x16x32_bf16 v[160:163], v[124:127], v[188:191], v[160:163]
  s_waitcnt lgkmcnt(0)
  s_waitcnt vmcnt(10)
  s_barrier
  v_mfma_f32_16x16x32_bf16 v[192:195], v[184:187], v[4:7], v[192:195]
  ds_read_b128 v[104:107], v238 offset:57344
  v_mfma_f32_16x16x32_bf16 v[196:199], v[4:7], v[188:191], v[196:199]
  ds_read_b64_tr_b16 v[176:177], v234 offset:16384
  v_mfma_f32_16x16x32_bf16 v[148:151], v[184:187], v[128:131], v[148:151]
  ds_read_b64_tr_b16 v[178:179], v234 offset:16896
  v_mfma_f32_16x16x32_bf16 v[164:167], v[128:131], v[188:191], v[164:167]
  s_add_u32 m0, s75, 131072
  s_add_u32 s87, 786432, s73
  buffer_load_dwordx4 v244, s[8:11], s87 offen lds
  ds_read_b64_tr_b16 v[180:181], v234 offset:17408
  v_mfma_f32_16x16x32_bf16 v[152:155], v[184:187], v[132:135], v[152:155]
  ds_read_b64_tr_b16 v[182:183], v234 offset:17920
  v_mfma_f32_16x16x32_bf16 v[168:171], v[132:135], v[188:191], v[168:171]
  buffer_load_dwordx4 v245, s[8:11], s87 offen offset:1024 lds
  v_mfma_f32_16x16x32_bf16 v[156:159], v[184:187], v[136:139], v[156:159]
  ds_read_b128 v[108:111], v238 offset:59392
  ds_read_b128 v[112:115], v238 offset:61440
  v_mfma_f32_16x16x32_bf16 v[172:175], v[136:139], v[188:191], v[172:175]
  s_add_u32 m0, s75, 133120
  s_sub_u32 s87, 983040, s73
  buffer_load_dwordx4 v244, s[8:11], s87 offen lds
  v_mfma_f32_16x16x32_bf16 v[200:203], v[4:7], v[140:143], v[200:203]
  ds_read_b128 v[116:119], v238 offset:63488
  v_mfma_f32_16x16x32_bf16 v[204:207], v[140:143], v[140:143], v[204:207]
  s_waitcnt lgkmcnt(5)
  ds_read_b128 v[120:123], v236 offset:57344
  buffer_load_dwordx4 v245, s[8:11], s87 offen offset:1024 lds
  v_mfma_f32_16x16x32_bf16 v[144:147], v[176:179], v[104:107], v[144:147]
  s_waitcnt lgkmcnt(4)
  ds_read_b128 v[124:127], v237 offset:57344
  v_mfma_f32_16x16x32_bf16 v[160:163], v[104:107], v[180:183], v[160:163]
  ds_read_b64_tr_b16 v[184:185], v234 offset:18432
  v_mfma_f32_16x16x32_bf16 v[192:195], v[176:179], v[4:7], v[192:195]
  ds_read_b64_tr_b16 v[186:187], v234 offset:18944
  v_mfma_f32_16x16x32_bf16 v[196:199], v[4:7], v[180:183], v[196:199]
  s_add_u32 m0, s75, 147456
  s_add_u32 s87, 1179648, s73
  buffer_load_dwordx4 v244, s[8:11], s87 offen lds
  s_waitcnt lgkmcnt(6)
  v_mfma_f32_16x16x32_bf16 v[148:151], v[176:179], v[108:111], v[148:151]
  ds_read_b64_tr_b16 v[188:189], v234 offset:19456
  v_mfma_f32_16x16x32_bf16 v[164:167], v[108:111], v[180:183], v[164:167]
  s_waitcnt lgkmcnt(6)
  ds_read_b64_tr_b16 v[190:191], v234 offset:19968
  v_mfma_f32_16x16x32_bf16 v[152:155], v[176:179], v[112:115], v[152:155]
  buffer_load_dwordx4 v245, s[8:11], s87 offen offset:1024 lds
  v_mfma_f32_16x16x32_bf16 v[168:171], v[112:115], v[180:183], v[168:171]
  s_waitcnt lgkmcnt(6)
  ds_read_b128 v[128:131], v237 offset:59392
  v_mfma_f32_16x16x32_bf16 v[156:159], v[176:179], v[116:119], v[156:159]
  ds_read_b128 v[132:135], v237 offset:61440
  v_mfma_f32_16x16x32_bf16 v[172:175], v[116:119], v[180:183], v[172:175]
  s_add_u32 m0, s75, 149504
  s_sub_u32 s87, 1376256, s73
  buffer_load_dwordx4 v244, s[8:11], s87 offen lds
  s_waitcnt lgkmcnt(7)
  v_mfma_f32_16x16x32_bf16 v[200:203], v[4:7], v[120:123], v[200:203]
  ds_read_b128 v[136:139], v237 offset:63488
  v_mfma_f32_16x16x32_bf16 v[204:207], v[120:123], v[120:123], v[204:207]
  s_waitcnt lgkmcnt(5)
  ds_read_b128 v[140:143], v235 offset:57344
  buffer_load_dwordx4 v245, s[8:11], s87 offen offset:1024 lds
  v_mfma_f32_16x16x32_bf16 v[144:147], v[184:187], v[124:127], v[144:147]
  s_waitcnt lgkmcnt(4)
  v_mfma_f32_16x16x32_bf16 v[160:163], v[124:127], v[188:191], v[160:163]
  v_mfma_f32_16x16x32_bf16 v[192:195], v[184:187], v[4:7], v[192:195]
  v_mfma_f32_16x16x32_bf16 v[196:199], v[4:7], v[188:191], v[196:199]
  s_waitcnt lgkmcnt(3)
  v_mfma_f32_16x16x32_bf16 v[148:151], v[184:187], v[128:131], v[148:151]
  v_mfma_f32_16x16x32_bf16 v[164:167], v[128:131], v[188:191], v[164:167]
  s_waitcnt lgkmcnt(2)
  v_mfma_f32_16x16x32_bf16 v[152:155], v[184:187], v[132:135], v[152:155]
  v_mfma_f32_16x16x32_bf16 v[168:171], v[132:135], v[188:191], v[168:171]
  s_waitcnt lgkmcnt(1)
  v_mfma_f32_16x16x32_bf16 v[156:159], v[184:187], v[136:139], v[156:159]
  v_mfma_f32_16x16x32_bf16 v[172:175], v[136:139], v[188:191], v[172:175]
  s_waitcnt lgkmcnt(0)
  v_mfma_f32_16x16x32_bf16 v[200:203], v[4:7], v[140:143], v[200:203]
  v_mfma_f32_16x16x32_bf16 v[204:207], v[140:143], v[140:143], v[204:207]
  v_and_b32 v250, 3, v0
  v_cmp_eq_u32 vcc, 1, v250
  s_nop 5
  v_cndmask_b32 v248, v204, v205, vcc
  v_cmp_eq_u32 vcc, 2, v250
  s_nop 1
  v_cndmask_b32 v248, v248, v206, vcc
  v_cmp_eq_u32 vcc, 3, v250
  s_nop 1
  v_cndmask_b32 v248, v248, v207, vcc
  v_mul_f32 v247, 0x3b000000, v200
  v_mul_f32 v248, 0x3b000000, v248
  v_fma_f32 v248, -v247, v247, v248
  v_max_f32 v248, 0, v248
  v_add_f32 v248, 0x3727c5ac, v248
  v_rsq_f32 v246, v248
  v_lshrrev_b32 v250, 2, v252
  v_cmp_eq_u32 vcc, v250, v251
  v_mul_f32 v247, -v247, v246
  s_lshr_b32 s91, s76, 4
  s_add_u32 s91, s91, 65536
  v_lshlrev_b32 v250, 3, v252
  v_add_u32 v249, s91, v250
  s_mov_b64 exec, vcc
  ds_write_b64 v249, v[246:247]
  s_mov_b64 exec, -1
  v_add_u32 v250, 65536, v250
  v_lshlrev_b32 v249, 5, v251
  v_add_u32 v249, 65536, v249
  s_waitcnt lgkmcnt(0)
  s_barrier
  ds_read_b64 v[246:247], v250 offset:0
  ds_read_b64 v[228:229], v250 offset:128
  ds_read_b64 v[222:223], v250 offset:256
  ds_read_b64 v[220:221], v250 offset:384
  ds_read_b128 v[104:107], v249 offset:0
  ds_read_b128 v[108:111], v249 offset:16
  ds_read_b128 v[112:115], v249 offset:128
  ds_read_b128 v[116:119], v249 offset:144
  s_waitcnt lgkmcnt(7)
  v_pk_mul_f32 v[120:121], v[192:193], v[246:247] op_sel:[0,1] op_sel_hi:[1,1]
  v_pk_mul_f32 v[122:123], v[194:195], v[246:247] op_sel:[0,1] op_sel_hi:[1,1]
  v_pk_fma_f32 v[120:121], v[144:145], v[246:247], v[120:121] op_sel_hi:[1,0,1]
  v_pk_fma_f32 v[122:123], v[146:147], v[246:247], v[122:123] op_sel_hi:[1,0,1]
  v_cvt_pk_bf16_f32 v180, v120, v121
  v_cvt_pk_bf16_f32 v181, v122, v123
  s_waitcnt lgkmcnt(6)
  v_pk_mul_f32 v[120:121], v[192:193], v[228:229] op_sel:[0,1] op_sel_hi:[1,1]
  v_pk_mul_f32 v[122:123], v[194:195], v[228:229] op_sel:[0,1] op_sel_hi:[1,1]
  v_pk_fma_f32 v[120:121], v[148:149], v[228:229], v[120:121] op_sel_hi:[1,0,1]
  v_pk_fma_f32 v[122:123], v[150:151], v[228:229], v[122:123] op_sel_hi:[1,0,1]
  v_cvt_pk_bf16_f32 v182, v120, v121
  v_cvt_pk_bf16_f32 v183, v122, v123
  s_nop 0
  v_permlane16_swap_b32 v180, v182
  v_permlane16_swap_b32 v181, v183
  buffer_store_dwordx4 v[180:183], v253, s[16:19], s64 offen offset:0 sc1
  s_waitcnt lgkmcnt(5)
  v_pk_mul_f32 v[120:121], v[192:193], v[222:223] op_sel:[0,1] op_sel_hi:[1,1]
  v_pk_mul_f32 v[122:123], v[194:195], v[222:223] op_sel:[0,1] op_sel_hi:[1,1]
  v_pk_fma_f32 v[120:121], v[152:153], v[222:223], v[120:121] op_sel_hi:[1,0,1]
  v_pk_fma_f32 v[122:123], v[154:155], v[222:223], v[122:123] op_sel_hi:[1,0,1]
  v_cvt_pk_bf16_f32 v188, v120, v121
  v_cvt_pk_bf16_f32 v189, v122, v123
  s_waitcnt lgkmcnt(4)
  v_pk_mul_f32 v[120:121], v[192:193], v[220:221] op_sel:[0,1] op_sel_hi:[1,1]
  v_pk_mul_f32 v[122:123], v[194:195], v[220:221] op_sel:[0,1] op_sel_hi:[1,1]
  v_pk_fma_f32 v[120:121], v[156:157], v[220:221], v[120:121] op_sel_hi:[1,0,1]
  v_pk_fma_f32 v[122:123], v[158:159], v[220:221], v[122:123] op_sel_hi:[1,0,1]
  v_cvt_pk_bf16_f32 v190, v120, v121
  v_cvt_pk_bf16_f32 v191, v122, v123
  s_nop 0
  v_permlane16_swap_b32 v188, v190
  v_permlane16_swap_b32 v189, v191
  buffer_store_dwordx4 v[188:191], v253, s[16:19], s64 offen offset:1024 sc1
  s_waitcnt lgkmcnt(3)
  v_mul_f32 v120, v196, v105
  v_mul_f32 v121, v196, v107
  s_waitcnt lgkmcnt(2)
  v_mul_f32 v122, v196, v109
  v_mul_f32 v123, v196, v111
  v_fmac_f32 v120, v160, v104
  v_fmac_f32 v121, v161, v106
  v_fmac_f32 v122, v162, v108
  v_fmac_f32 v123, v163, v110
  ds_read_b128 v[104:107], v249 offset:256
  ds_read_b128 v[108:111], v249 offset:272
  v_cvt_pk_bf16_f32 v200, v120, v121
  v_cvt_pk_bf16_f32 v201, v122, v123
  s_waitcnt lgkmcnt(3)
  v_mul_f32 v120, v196, v113
  v_mul_f32 v121, v196, v115
  s_waitcnt lgkmcnt(2)
  v_mul_f32 v122, v196, v117
  v_mul_f32 v123, v196, v119
  v_fmac_f32 v120, v164, v112
  v_fmac_f32 v121, v165, v114
  v_fmac_f32 v122, v166, v116
  v_fmac_f32 v123, v167, v118
  ds_read_b128 v[112:115], v249 offset:384
  ds_read_b128 v[116:119], v249 offset:400
  v_cvt_pk_bf16_f32 v202, v120, v121
  v_cvt_pk_bf16_f32 v203, v122, v123
  s_nop 0
  v_permlane16_swap_b32 v200, v202
  v_permlane16_swap_b32 v201, v203
  s_nop 0
  v_permlane32_swap_b32 v200, v202
  v_permlane32_swap_b32 v201, v203
  buffer_store_dwordx4 v[200:203], v239, s[16:19], s64 offen offset:0 sc1
  s_waitcnt lgkmcnt(3)
  v_mul_f32 v120, v196, v105
  v_mul_f32 v121, v196, v107
  s_waitcnt lgkmcnt(2)
  v_mul_f32 v122, v196, v109
  v_mul_f32 v123, v196, v111
  v_fmac_f32 v120, v168, v104
  v_fmac_f32 v121, v169, v106
  v_fmac_f32 v122, v170, v108
  v_fmac_f32 v123, v171, v110
  v_cvt_pk_bf16_f32 v204, v120, v121
  v_cvt_pk_bf16_f32 v205, v122, v123
  s_waitcnt lgkmcnt(1)
  v_mul_f32 v120, v196, v113
  v_mul_f32 v121, v196, v115
  s_waitcnt lgkmcnt(0)
  v_mul_f32 v122, v196, v117
  v_mul_f32 v123, v196, v119
  v_fmac_f32 v120, v172, v112
  v_fmac_f32 v121, v173, v114
  v_fmac_f32 v122, v174, v116
  v_fmac_f32 v123, v175, v118
  v_cvt_pk_bf16_f32 v206, v120, v121
  v_cvt_pk_bf16_f32 v207, v122, v123
  s_nop 0
  v_permlane16_swap_b32 v204, v206
  v_permlane16_swap_b32 v205, v207
  s_nop 0
  v_permlane32_swap_b32 v204, v206
  v_permlane32_swap_b32 v205, v207
  buffer_store_dwordx4 v[204:207], v239, s[16:19], s64 offen offset:1024 sc1
  v_mov_b32 v243, v240
  s_add_u32 s97, s60, s57
  s_lshl_b32 s96, s93, 10
  s_add_u32 s96, s96, s60
  s_sub_i32 s76, s94, 1
  s_max_i32 s76, s76, 0
  s_mul_i32 s76, s76, 360448
  s_add_u32 s76, s76, s65
  s_add_u32 s76, s76, 65536
  s_sub_i32 s74, s94, 2
  s_max_i32 s74, s74, 0
  s_mul_i32 s74, s74, 360448
  s_add_u32 s74, s74, s65
  s_add_u32 s74, s74, 65536
  s_sub_i32 s73, s94, 3
  s_max_i32 s73, s73, 0
  s_mul_i32 s73, s73, 360448
  s_add_u32 s73, s73, s65
  s_add_u32 s73, s73, 65536
  s_sub_i32 s70, s94, 4
  s_max_i32 s70, s70, 0
  s_mul_i32 s70, s70, 360448
  s_add_u32 s70, s70, s65
  s_add_u32 s70, s70, 65536
  v_lshrrev_b32 v249, 5, v0
  v_lshlrev_b32 v249, 8, v249
  v_lshl_add_u32 v249, v252, 4, v249
  v_add_u32 v248, 65536, v249
  v_mov_b32 v192, v232
  v_mov_b32 v193, v232
  v_mov_b32 v194, v232
  v_mov_b32 v195, v232
  v_mov_b32 v196, v232
  v_mov_b32 v197, v232
  v_mov_b32 v198, v232
  v_mov_b32 v199, v232
  v_mul_f32 v246, 0x3eb8aa3b, v246
  v_mul_f32 v247, 0x3eb8aa3b, v247
  v_mul_f32 v228, 0x3eb8aa3b, v228
  v_mul_f32 v229, 0x3eb8aa3b, v229
  v_mul_f32 v222, 0x3eb8aa3b, v222
  v_mul_f32 v223, 0x3eb8aa3b, v223
  v_mul_f32 v220, 0x3eb8aa3b, v220
  v_mul_f32 v221, 0x3eb8aa3b, v221
  s_waitcnt vmcnt(4)
  s_barrier
  ds_read_b128 v[104:107], v238 offset:0
  ds_read_b64_tr_b16 v[176:177], v234 offset:32768
  ds_read_b64_tr_b16 v[178:179], v234 offset:33280
  ds_read_b128 v[108:111], v238 offset:2048
  ds_read_b128 v[112:115], v238 offset:4096
  ds_read_b128 v[116:119], v238 offset:6144
  v_permlane16_swap_b32 v200, v192
  v_permlane16_swap_b32 v201, v193
  v_permlane16_swap_b32 v202, v194
  v_permlane16_swap_b32 v203, v195
  v_permlane16_swap_b32 v204, v196
  v_permlane16_swap_b32 v205, v197
  v_permlane16_swap_b32 v206, v198
  v_permlane16_swap_b32 v207, v199
  s_waitcnt lgkmcnt(3)
  v_mfma_f32_16x16x32_bf16 v[144:147], v[176:179], v[104:107], 0
  ds_read_b128 v[124:127], v237 offset:0
  v_mfma_f32_16x16x32_bf16 v[140:143], v[176:179], v[4:7], 0
  s_waitcnt lgkmcnt(3)
  ds_read_b64_tr_b16 v[184:185], v234 offset:33792
  v_mfma_f32_16x16x32_bf16 v[148:151], v[176:179], v[108:111], 0
  s_waitcnt lgkmcnt(3)
  ds_read_b64_tr_b16 v[186:187], v234 offset:34304
  v_mfma_f32_16x16x32_bf16 v[152:155], v[176:179], v[112:115], 0
  s_waitcnt lgkmcnt(3)
  ds_read_b128 v[128:131], v237 offset:2048
  v_mfma_f32_16x16x32_bf16 v[156:159], v[176:179], v[116:119], 0
  ds_read_b128 v[132:135], v237 offset:4096
  ds_read_b128 v[136:139], v237 offset:6144
  s_waitcnt lgkmcnt(3)
  v_mfma_f32_16x16x32_bf16 v[144:147], v[184:187], v[124:127], v[144:147]
  ds_read_b128 v[104:107], v238 offset:8192
  v_mfma_f32_16x16x32_bf16 v[140:143], v[184:187], v[4:7], v[140:143]
  s_waitcnt lgkmcnt(3)
  ds_read_b64_tr_b16 v[176:177], v234 offset:34816
  v_mfma_f32_16x16x32_bf16 v[148:151], v[184:187], v[128:131], v[148:151]
  s_waitcnt lgkmcnt(3)
  ds_read_b64_tr_b16 v[178:179], v234 offset:35328
  v_mfma_f32_16x16x32_bf16 v[152:155], v[184:187], v[132:135], v[152:155]
  s_waitcnt lgkmcnt(3)
  ds_read_b128 v[108:111], v238 offset:10240
  v_mfma_f32_16x16x32_bf16 v[156:159], v[184:187], v[136:139], v[156:159]
  ds_read_b128 v[112:115], v238 offset:12288
  ds_read_b128 v[116:119], v238 offset:14336
  s_waitcnt lgkmcnt(3)
  v_mfma_f32_16x16x32_bf16 v[144:147], v[176:179], v[104:107], v[144:147]
  ds_read_b128 v[124:127], v237 offset:8192
  v_mfma_f32_16x16x32_bf16 v[140:143], v[176:179], v[4:7], v[140:143]
  s_waitcnt lgkmcnt(3)
  ds_read_b64_tr_b16 v[184:185], v234 offset:35840
  v_mfma_f32_16x16x32_bf16 v[148:151], v[176:179], v[108:111], v[148:151]
  s_waitcnt lgkmcnt(3)
  ds_read_b64_tr_b16 v[186:187], v234 offset:36352
  v_mfma_f32_16x16x32_bf16 v[152:155], v[176:179], v[112:115], v[152:155]
  s_waitcnt lgkmcnt(3)
  ds_read_b128 v[128:131], v237 offset:10240
  v_mfma_f32_16x16x32_bf16 v[156:159], v[176:179], v[116:119], v[156:159]
  ds_read_b128 v[132:135], v237 offset:12288
  ds_read_b128 v[136:139], v237 offset:14336
  s_waitcnt lgkmcnt(3)
  v_mfma_f32_16x16x32_bf16 v[144:147], v[184:187], v[124:127], v[144:147]
  ds_read_b128 v[104:107], v238 offset:16384
  v_mfma_f32_16x16x32_bf16 v[140:143], v[184:187], v[4:7], v[140:143]
  s_waitcnt lgkmcnt(3)
  ds_read_b64_tr_b16 v[176:177], v234 offset:49152
  v_mfma_f32_16x16x32_bf16 v[148:151], v[184:187], v[128:131], v[148:151]
  s_waitcnt lgkmcnt(3)
  ds_read_b64_tr_b16 v[178:179], v234 offset:49664
  ds_read_b128 v[108:111], v238 offset:18432
  v_mfma_f32_16x16x32_bf16 v[152:155], v[184:187], v[132:135], v[152:155]
  s_waitcnt lgkmcnt(4)
  ds_read_b128 v[112:115], v238 offset:20480
  v_mfma_f32_16x16x32_bf16 v[156:159], v[184:187], v[136:139], v[156:159]
  ds_read_b128 v[116:119], v238 offset:22528
  s_waitcnt vmcnt(0)
  s_add_u32 s91, s56, s86
  v_mov_b32 v254, s84
  v_lshlrev_b32 v255, 2, v0
  s_mov_b32 exec_hi, 0
  buffer_store_dword v254, v255, s[16:19], s91 offen sc1
  s_mov_b32 exec_hi, -1
  s_waitcnt lgkmcnt(3)
  v_mfma_f32_16x16x32_bf16 v[144:147], v[176:179], v[104:107], v[144:147]
  ds_read_b128 v[124:127], v237 offset:16384
  v_mfma_f32_16x16x32_bf16 v[140:143], v[176:179], v[4:7], v[140:143]
  s_waitcnt lgkmcnt(3)
  ds_read_b64_tr_b16 v[184:185], v234 offset:50176
  v_mfma_f32_16x16x32_bf16 v[148:151], v[176:179], v[108:111], v[148:151]
  s_waitcnt lgkmcnt(3)
  ds_read_b64_tr_b16 v[186:187], v234 offset:50688
  ds_read_b128 v[128:131], v237 offset:18432
  v_mfma_f32_16x16x32_bf16 v[152:155], v[176:179], v[112:115], v[152:155]
  s_waitcnt lgkmcnt(4)
  ds_read_b128 v[132:135], v237 offset:20480
  v_mfma_f32_16x16x32_bf16 v[156:159], v[176:179], v[116:119], v[156:159]
  s_waitcnt lgkmcnt(2)
  ds_read_b128 v[136:139], v237 offset:22528
  buffer_store_dwordx4 a[8:11], v231, s[16:19], s58 offen offset:0 sc1
  v_mfma_f32_16x16x32_bf16 v[144:147], v[184:187], v[124:127], v[144:147]
  ds_read_b128 v[104:107], v238 offset:24576
  v_mfma_f32_16x16x32_bf16 v[140:143], v[184:187], v[4:7], v[140:143]
  s_waitcnt lgkmcnt(3)
  ds_read_b64_tr_b16 v[176:177], v234 offset:51200
  v_mfma_f32_16x16x32_bf16 v[148:151], v[184:187], v[128:131], v[148:151]
  s_waitcnt lgkmcnt(3)
  ds_read_b64_tr_b16 v[178:179], v234 offset:51712
  ds_read_b128 v[108:111], v238 offset:26624
  v_mfma_f32_16x16x32_bf16 v[152:155], v[184:187], v[132:135], v[152:155]
  s_waitcnt lgkmcnt(4)
  ds_read_b128 v[112:115], v238 offset:28672
  v_mfma_f32_16x16x32_bf16 v[156:159], v[184:187], v[136:139], v[156:159]
  s_waitcnt lgkmcnt(2)
  ds_read_b128 v[116:119], v238 offset:30720
  s_add_u32 s91, s58, 32768
  buffer_store_dwordx4 a[8:11], v231, s[16:19], s91 offen offset:0 sc1
  v_mfma_f32_16x16x32_bf16 v[144:147], v[176:179], v[104:107], v[144:147]
  ds_read_b128 v[124:127], v237 offset:24576
  v_mfma_f32_16x16x32_bf16 v[140:143], v[176:179], v[4:7], v[140:143]
  s_waitcnt lgkmcnt(3)
  ds_read_b64_tr_b16 v[184:185], v234 offset:52224
  v_mfma_f32_16x16x32_bf16 v[148:151], v[176:179], v[108:111], v[148:151]
  s_waitcnt lgkmcnt(3)
  ds_read_b64_tr_b16 v[186:187], v234 offset:52736
  v_mfma_f32_16x16x32_bf16 v[152:155], v[176:179], v[112:115], v[152:155]
  s_waitcnt lgkmcnt(3)
  ds_read_b128 v[128:131], v237 offset:26624
  v_mfma_f32_16x16x32_bf16 v[156:159], v[176:179], v[116:119], v[156:159]
  ds_read_b128 v[132:135], v237 offset:28672
  ds_read_b128 v[136:139], v237 offset:30720
  s_waitcnt lgkmcnt(3)
  v_mfma_f32_16x16x32_bf16 v[144:147], v[184:187], v[124:127], v[144:147]
  ds_read_b128 v[104:107], v238 offset:32768
  v_mfma_f32_16x16x32_bf16 v[140:143], v[184:187], v[4:7], v[140:143]
  s_waitcnt lgkmcnt(3)
  ds_read_b64_tr_b16 v[176:177], v233 offset:0
  v_mfma_f32_16x16x32_bf16 v[148:151], v[184:187], v[128:131], v[148:151]
  s_waitcnt lgkmcnt(3)
  ds_read_b64_tr_b16 v[178:179], v233 offset:512
  v_mfma_f32_16x16x32_bf16 v[152:155], v[184:187], v[132:135], v[152:155]
L_page_2:
  s_cbranch_execz L_pageret_0
  s_waitcnt lgkmcnt(3)
  ds_read_b128 v[108:111], v238 offset:34816
  v_mfma_f32_16x16x32_bf16 v[156:159], v[184:187], v[136:139], v[156:159]
  ds_read_b128 v[112:115], v238 offset:36864
  ds_read_b128 v[116:119], v238 offset:38912
  s_waitcnt lgkmcnt(3)
  v_mfma_f32_16x16x32_bf16 v[144:147], v[176:179], v[104:107], v[144:147]
  ds_read_b128 v[124:127], v237 offset:32768
  v_mfma_f32_16x16x32_bf16 v[140:143], v[176:179], v[4:7], v[140:143]
  s_waitcnt lgkmcnt(3)
  ds_read_b64_tr_b16 v[184:185], v233 offset:1024
  v_mfma_f32_16x16x32_bf16 v[148:151], v[176:179], v[108:111], v[148:151]
  s_waitcnt lgkmcnt(3)
  ds_read_b64_tr_b16 v[186:187], v233 offset:1536
  v_mfma_f32_16x16x32_bf16 v[152:155], v[176:179], v[112:115], v[152:155]
  s_waitcnt lgkmcnt(3)
  ds_read_b128 v[128:131], v237 offset:34816
  v_mfma_f32_16x16x32_bf16 v[156:159], v[176:179], v[116:119], v[156:159]
  ds_read_b128 v[132:135], v237 offset:36864
  ds_read_b128 v[136:139], v237 offset:38912
  s_waitcnt lgkmcnt(3)
  v_mfma_f32_16x16x32_bf16 v[144:147], v[184:187], v[124:127], v[144:147]
  ds_read_b128 v[104:107], v238 offset:40960
  v_mfma_f32_16x16x32_bf16 v[140:143], v[184:187], v[4:7], v[140:143]
  s_waitcnt lgkmcnt(3)
  ds_read_b64_tr_b16 v[176:177], v233 offset:2048
  v_mfma_f32_16x16x32_bf16 v[148:151], v[184:187], v[128:131], v[148:151]
  s_waitcnt lgkmcnt(3)
  ds_read_b64_tr_b16 v[178:179], v233 offset:2560
  ds_read_b128 v[108:111], v238 offset:43008
  v_mfma_f32_16x16x32_bf16 v[152:155], v[184:187], v[132:135], v[152:155]
  s_waitcnt lgkmcnt(4)
  ds_read_b128 v[112:115], v238 offset:45056
  v_mfma_f32_16x16x32_bf16 v[156:159], v[184:187], v[136:139], v[156:159]
  s_waitcnt lgkmcnt(2)
  ds_read_b128 v[116:119], v238 offset:47104
  buffer_load_dword v225, v226, s[16:19], s56 offen sc1
  v_mfma_f32_16x16x32_bf16 v[144:147], v[176:179], v[104:107], v[144:147]
  ds_read_b128 v[124:127], v237 offset:40960
  v_mfma_f32_16x16x32_bf16 v[140:143], v[176:179], v[4:7], v[140:143]
  s_waitcnt lgkmcnt(3)
  ds_read_b64_tr_b16 v[184:185], v233 offset:3072
  v_mfma_f32_16x16x32_bf16 v[148:151], v[176:179], v[108:111], v[148:151]
  s_waitcnt lgkmcnt(3)
  ds_read_b64_tr_b16 v[186:187], v233 offset:3584
  ds_read_b128 v[128:131], v237 offset:43008
  v_mfma_f32_16x16x32_bf16 v[152:155], v[176:179], v[112:115], v[152:155]
  s_waitcnt lgkmcnt(4)
  ds_read_b128 v[132:135], v237 offset:45056
  v_mfma_f32_16x16x32_bf16 v[156:159], v[176:179], v[116:119], v[156:159]
  s_waitcnt lgkmcnt(2)
  ds_read_b128 v[136:139], v237 offset:47104
  s_mul_i32 s72, s71, 4096
  s_mov_b64 exec, 0xf
  buffer_load_dword a5, v243, s[20:23], s72 offen
  s_mov_b64 exec, -1
  v_mfma_f32_16x16x32_bf16 v[144:147], v[184:187], v[124:127], v[144:147]
  ds_read_b128 v[104:107], v238 offset:49152
  v_mfma_f32_16x16x32_bf16 v[140:143], v[184:187], v[4:7], v[140:143]
  s_waitcnt lgkmcnt(3)
  ds_read_b64_tr_b16 v[176:177], v233 offset:16384
  v_mfma_f32_16x16x32_bf16 v[148:151], v[184:187], v[128:131], v[148:151]
  s_waitcnt lgkmcnt(3)
  ds_read_b64_tr_b16 v[178:179], v233 offset:16896
  ds_read_b128 v[108:111], v238 offset:51200
  v_mfma_f32_16x16x32_bf16 v[152:155], v[184:187], v[132:135], v[152:155]
  s_waitcnt lgkmcnt(4)
  ds_read_b128 v[112:115], v238 offset:53248
  v_mfma_f32_16x16x32_bf16 v[156:159], v[184:187], v[136:139], v[156:159]
  s_waitcnt lgkmcnt(2)
  ds_read_b128 v[116:119], v238 offset:55296
  s_mul_i32 s72, s71, 4096
  s_mov_b64 exec, 0xf
  buffer_load_dword a5, v243, s[24:27], s72 offen
  s_mov_b64 exec, -1
  v_mfma_f32_16x16x32_bf16 v[144:147], v[176:179], v[104:107], v[144:147]
  ds_read_b128 v[124:127], v237 offset:49152
  v_mfma_f32_16x16x32_bf16 v[140:143], v[176:179], v[4:7], v[140:143]
  s_waitcnt lgkmcnt(3)
  ds_read_b64_tr_b16 v[184:185], v233 offset:17408
  v_mfma_f32_16x16x32_bf16 v[148:151], v[176:179], v[108:111], v[148:151]
  s_waitcnt lgkmcnt(3)
  ds_read_b64_tr_b16 v[186:187], v233 offset:17920
  v_mfma_f32_16x16x32_bf16 v[152:155], v[176:179], v[112:115], v[152:155]
  s_waitcnt lgkmcnt(3)
  ds_read_b128 v[128:131], v237 offset:51200
  v_mfma_f32_16x16x32_bf16 v[156:159], v[176:179], v[116:119], v[156:159]
  ds_read_b128 v[132:135], v237 offset:53248
  ds_read_b128 v[136:139], v237 offset:55296
  s_waitcnt lgkmcnt(3)
  v_mfma_f32_16x16x32_bf16 v[144:147], v[184:187], v[124:127], v[144:147]
  ds_read_b128 v[104:107], v238 offset:57344
  v_mfma_f32_16x16x32_bf16 v[140:143], v[184:187], v[4:7], v[140:143]
  s_waitcnt lgkmcnt(3)
  ds_read_b64_tr_b16 v[176:177], v233 offset:18432
  v_mfma_f32_16x16x32_bf16 v[148:151], v[184:187], v[128:131], v[148:151]
  s_waitcnt lgkmcnt(3)
  ds_read_b64_tr_b16 v[178:179], v233 offset:18944
  v_mfma_f32_16x16x32_bf16 v[152:155], v[184:187], v[132:135], v[152:155]
  s_waitcnt lgkmcnt(3)
  ds_read_b128 v[108:111], v238 offset:59392
  v_mfma_f32_16x16x32_bf16 v[156:159], v[184:187], v[136:139], v[156:159]
  ds_read_b128 v[112:115], v238 offset:61440
  ds_read_b128 v[116:119], v238 offset:63488
  s_waitcnt lgkmcnt(3)
  v_mfma_f32_16x16x32_bf16 v[144:147], v[176:179], v[104:107], v[144:147]
  ds_read_b128 v[124:127], v237 offset:57344
  ds_read_b64_tr_b16 v[184:185], v233 offset:19456
  v_mfma_f32_16x16x32_bf16 v[140:143], v[176:179], v[4:7], v[140:143]
  s_waitcnt vmcnt(2)
  v_xor_b32 v254, s88, v225
  v_cmp_lt_u32 vcc, 31, v254
  s_cbranch_vccnz L_rdy_6
L_rret_7:
  ds_read_b64_tr_b16 v[186:187], v233 offset:19968
  s_waitcnt lgkmcnt(5)
  v_mfma_f32_16x16x32_bf16 v[148:151], v[176:179], v[108:111], v[148:151]
  s_waitcnt lgkmcnt(4)
  buffer_load_dwordx4 a[16:19], v253, s[16:19], s76 offen offset:0 sc1
  ds_read_b128 v[128:131], v237 offset:59392
  v_mfma_f32_16x16x32_bf16 v[152:155], v[176:179], v[112:115], v[152:155]
  s_waitcnt lgkmcnt(4)
  ds_read_b128 v[132:135], v237 offset:61440
  buffer_load_dwordx4 a[20:23], v253, s[16:19], s76 offen offset:1024 sc1
  v_mfma_f32_16x16x32_bf16 v[156:159], v[176:179], v[116:119], v[156:159]
  s_waitcnt lgkmcnt(2)
  ds_read_b128 v[136:139], v237 offset:63488
  s_mov_b64 exec, s[82:83]
  buffer_load_dwordx4 v[8:11], v248, s[16:19], s76 offen offset:0 sc1
  buffer_load_dwordx4 v[12:15], v248, s[16:19], s76 offen offset:512 sc1
  s_mov_b64 exec, -1
  v_mfma_f32_16x16x32_bf16 v[144:147], v[184:187], v[124:127], v[144:147]
  v_mfma_f32_16x16x32_bf16 v[140:143], v[184:187], v[4:7], v[140:143]
  s_mov_b64 exec, s[82:83]
  buffer_load_dwordx4 v[16:19], v248, s[16:19], s76 offen offset:1024 sc1
  buffer_load_dwordx4 v[20:23], v248, s[16:19], s76 offen offset:1536 sc1
  s_mov_b64 exec, -1
  s_waitcnt lgkmcnt(2)
  v_mfma_f32_16x16x32_bf16 v[148:151], v[184:187], v[128:131], v[148:151]
  s_waitcnt lgkmcnt(1)
  v_mfma_f32_16x16x32_bf16 v[152:155], v[184:187], v[132:135], v[152:155]
  buffer_load_dwordx4 a[24:27], v253, s[16:19], s74 offen offset:0 sc1
  s_waitcnt lgkmcnt(0)
  v_mfma_f32_16x16x32_bf16 v[156:159], v[184:187], v[136:139], v[156:159]
  buffer_load_dwordx4 a[28:31], v253, s[16:19], s74 offen offset:1024 sc1
  s_waitcnt lgkmcnt(0)
  s_barrier
  v_pk_mul_f32 v[120:121], v[140:141], v[246:247] op_sel:[0,1] op_sel_hi:[1,1]
  v_pk_mul_f32 v[122:123], v[142:143], v[246:247] op_sel:[0,1] op_sel_hi:[1,1]
  v_pk_fma_f32 v[120:121], v[144:145], v[246:247], v[120:121] op_sel_hi:[1,0,1]
  v_pk_fma_f32 v[122:123], v[146:147], v[246:247], v[122:123] op_sel_hi:[1,0,1]
  v_cvt_pk_bf16_f32 v176, v120, v121
  v_cvt_pk_bf16_f32 v177, v122, v123
  v_pk_mul_f32 v[120:121], v[140:141], v[228:229] op_sel:[0,1] op_sel_hi:[1,1]
  v_pk_mul_f32 v[122:123], v[142:143], v[228:229] op_sel:[0,1] op_sel_hi:[1,1]
  v_pk_fma_f32 v[120:121], v[148:149], v[228:229], v[120:121] op_sel_hi:[1,0,1]
  v_pk_fma_f32 v[122:123], v[150:151], v[228:229], v[122:123] op_sel_hi:[1,0,1]
  v_cvt_pk_bf16_f32 v178, v120, v121
  v_cvt_pk_bf16_f32 v179, v122, v123
  s_nop 0
  v_permlane16_swap_b32 v176, v178
  v_permlane16_swap_b32 v177, v179
  s_mov_b64 exec, s[82:83]
  buffer_load_dwordx4 v[24:27], v248, s[16:19], s74 offen offset:0 sc1
  buffer_load_dwordx4 v[28:31], v248, s[16:19], s74 offen offset:512 sc1
  s_mov_b64 exec, -1
  v_pk_mul_f32 v[120:121], v[140:141], v[222:223] op_sel:[0,1] op_sel_hi:[1,1]
  v_pk_mul_f32 v[122:123], v[142:143], v[222:223] op_sel:[0,1] op_sel_hi:[1,1]
  v_pk_fma_f32 v[120:121], v[152:153], v[222:223], v[120:121] op_sel_hi:[1,0,1]
  v_pk_fma_f32 v[122:123], v[154:155], v[222:223], v[122:123] op_sel_hi:[1,0,1]
  v_cvt_pk_bf16_f32 v184, v120, v121
  v_cvt_pk_bf16_f32 v185, v122, v123
  v_pk_mul_f32 v[120:121], v[140:141], v[220:221] op_sel:[0,1] op_sel_hi:[1,1]
  v_pk_mul_f32 v[122:123], v[142:143], v[220:221] op_sel:[0,1] op_sel_hi:[1,1]
  v_pk_fma_f32 v[120:121], v[156:157], v[220:221], v[120:121] op_sel_hi:[1,0,1]
  v_pk_fma_f32 v[122:123], v[158:159], v[220:221], v[122:123] op_sel_hi:[1,0,1]
  v_cvt_pk_bf16_f32 v186, v120, v121
  v_cvt_pk_bf16_f32 v187, v122, v123
  s_nop 0
  v_permlane16_swap_b32 v184, v186
  v_permlane16_swap_b32 v185, v187
  s_mov_b64 exec, s[82:83]
  buffer_load_dwordx4 v[32:35], v248, s[16:19], s74 offen offset:1024 sc1
  buffer_load_dwordx4 v[36:39], v248, s[16:19], s74 offen offset:1536 sc1
  s_mov_b64 exec, -1
  v_lshrrev_b32 v245, 3, v0
  v_and_b32 v244, 7, v0
  s_mov_b32 s90, s95
  v_bfe_u32 v241, v245, 1, 1
  s_and_b32 s91, s90, 1
  s_lshl_b32 s91, s91, 1
  v_or_b32 v241, s91, v241
  v_lshlrev_b32 v241, 1, v241
  v_xor_b32 v244, v244, v241
  v_lshlrev_b32 v244, 4, v244
  v_and_b32 v242, 3, v245
  v_lshrrev_b32 v241, 2, v245
  v_lshl_add_u32 v242, v241, 3, v242
  s_lshr_b32 s91, s90, 1
  s_lshl_b32 s91, s91, 4
  s_and_b32 s90, s90, 1
  s_lshl_b32 s90, s90, 2
  s_add_u32 s91, s91, s90
  v_add_u32 v242, s91, v242
  s_mov_b32 s91, 1024
  v_mad_u32_u24 v247, v242, s91, v244
  v_add_u32 v247, s85, v247
  v_lshrrev_b32 v245, 3, v0
  v_and_b32 v244, 7, v0
  s_mov_b32 s90, s95
  v_bfe_u32 v241, v245, 1, 1
  s_and_b32 s91, s90, 1
  s_lshl_b32 s91, s91, 1
  v_or_b32 v241, s91, v241
  v_lshlrev_b32 v241, 1, v241
  v_xor_b32 v244, v244, v241
  v_lshlrev_b32 v244, 4, v244
  v_and_b32 v242, 3, v245
  v_lshrrev_b32 v241, 2, v245
  v_lshl_add_u32 v242, v241, 4, v242
  s_lshl_b32 s91, s90, 2
  v_add_u32 v242, s91, v242
  s_mov_b32 s91, 1024
  v_mad_u32_u24 v246, v242, s91, v244
  v_add_u32 v246, s85, v246
  s_add_u32 s69, s94, 0
  s_and_b32 s69, s69, 3
  s_lshl_b32 s69, s69, 14
  s_add_u32 s68, s94, 1
  s_and_b32 s68, s68, 3
  s_lshl_b32 s68, s68, 14
  s_add_u32 s67, s94, 2
  s_and_b32 s67, s67, 3
  s_lshl_b32 s67, s67, 14
  s_add_u32 s66, s94, 3
  s_and_b32 s66, s66, 3
  s_lshl_b32 s66, s66, 14
  v_mfma_f32_32x32x16_bf16 v[104:119], v[180:183], v[176:179], v[72:87]
  s_nop 11
  v_exp_f32 v104, v104
  v_exp_f32 v105, v105
  v_exp_f32 v106, v106
  v_exp_f32 v107, v107
  v_exp_f32 v108, v108
  v_mfma_f32_32x32x16_bf16 v[120:135], v[180:183], v[184:187], 0
  buffer_load_dwordx4 a[32:35], v253, s[16:19], s73 offen offset:0 sc1
  v_exp_f32 v109, v109
  v_exp_f32 v110, v110
  v_exp_f32 v111, v111
  v_cvt_pk_bf16_f32 v168, v104, v105
  v_cvt_pk_bf16_f32 v169, v106, v107
  v_cvt_pk_bf16_f32 v170, v108, v109
  v_cvt_pk_bf16_f32 v171, v110, v111
  buffer_load_dwordx4 a[36:39], v253, s[16:19], s73 offen offset:1024 sc1
  v_exp_f32 v112, v112
  v_exp_f32 v113, v113
  v_mfma_f32_32x32x16_bf16 v[136:151], v[200:203], v[168:171], 0
  s_mov_b64 exec, s[82:83]
  buffer_load_dwordx4 v[40:43], v248, s[16:19], s73 offen offset:0 sc1
  buffer_load_dwordx4 v[44:47], v248, s[16:19], s73 offen offset:512 sc1
  s_mov_b64 exec, -1
  v_exp_f32 v114, v114
  v_exp_f32 v115, v115
  v_exp_f32 v116, v116
  v_exp_f32 v117, v117
  v_exp_f32 v118, v118
  v_exp_f32 v119, v119
  v_cvt_pk_bf16_f32 v172, v112, v113
  v_cvt_pk_bf16_f32 v173, v114, v115
  v_cvt_pk_bf16_f32 v174, v116, v117
  v_cvt_pk_bf16_f32 v175, v118, v119
  s_mov_b64 exec, s[82:83]
  buffer_load_dwordx4 v[48:51], v248, s[16:19], s73 offen offset:1024 sc1
  buffer_load_dwordx4 v[52:55], v248, s[16:19], s73 offen offset:1536 sc1
  s_mov_b64 exec, -1
  v_exp_f32 v120, v120
  v_exp_f32 v121, v121
  v_mfma_f32_32x32x16_bf16 v[136:151], v[192:195], v[172:175], v[136:151]
  v_exp_f32 v122, v122
  v_exp_f32 v123, v123
  v_exp_f32 v124, v124
  v_mfma_f32_32x32x16_bf16 v[104:119], v[188:191], v[184:187], v[72:87]
  buffer_load_dwordx4 a[40:43], v253, s[16:19], s70 offen offset:0 sc1
  v_exp_f32 v125, v125
  v_exp_f32 v126, v126
  v_exp_f32 v127, v127
  v_cvt_pk_bf16_f32 v168, v120, v121
  v_cvt_pk_bf16_f32 v169, v122, v123
  v_cvt_pk_bf16_f32 v170, v124, v125
  v_cvt_pk_bf16_f32 v171, v126, v127
  v_exp_f32 v128, v128
  v_exp_f32 v129, v129
  v_mfma_f32_32x32x16_bf16 v[152:167], v[200:203], v[168:171], 0
  buffer_load_dwordx4 a[44:47], v253, s[16:19], s70 offen offset:1024 sc1
  v_exp_f32 v130, v130
  v_exp_f32 v131, v131
  v_exp_f32 v132, v132
  v_exp_f32 v133, v133
  v_exp_f32 v134, v134
  v_exp_f32 v135, v135
  v_cvt_pk_bf16_f32 v172, v128, v129
  v_cvt_pk_bf16_f32 v173, v130, v131
  v_cvt_pk_bf16_f32 v174, v132, v133
  v_cvt_pk_bf16_f32 v175, v134, v135
  s_mov_b64 exec, s[82:83]
  buffer_load_dwordx4 v[56:59], v248, s[16:19], s70 offen offset:0 sc1
  buffer_load_dwordx4 v[60:63], v248, s[16:19], s70 offen offset:512 sc1
  s_mov_b64 exec, -1
  v_exp_f32 v104, v104
  v_exp_f32 v105, v105
  v_mfma_f32_32x32x16_bf16 v[152:167], v[192:195], v[172:175], v[152:167]
  s_add_u32 s91, s97, 262144
  buffer_store_dwordx4 a[8:11], v253, s[16:19], s91 offen offset:0 sc1
  v_exp_f32 v106, v106
  v_exp_f32 v107, v107
  v_exp_f32 v108, v108
  s_waitcnt vmcnt(22)
  v_mfma_f32_32x32x16_bf16 v[120:135], a[16:19], v[176:179], 0
  s_add_u32 s91, s97, 262144
  buffer_store_dwordx4 a[8:11], v253, s[16:19], s91 offen offset:1024 sc1
  v_exp_f32 v109, v109
  v_exp_f32 v110, v110
  v_exp_f32 v111, v111
  v_cvt_pk_bf16_f32 v168, v104, v105
  v_cvt_pk_bf16_f32 v169, v106, v107
  v_cvt_pk_bf16_f32 v170, v108, v109
  v_cvt_pk_bf16_f32 v171, v110, v111
  v_exp_f32 v112, v112
  v_exp_f32 v113, v113
  v_mfma_f32_32x32x16_bf16 v[152:167], v[204:207], v[168:171], v[152:167]
  s_mov_b64 exec, s[82:83]
  buffer_load_dwordx4 v[64:67], v248, s[16:19], s70 offen offset:1024 sc1
  buffer_load_dwordx4 v[68:71], v248, s[16:19], s70 offen offset:1536 sc1
  s_mov_b64 exec, -1
  v_exp_f32 v114, v114
  v_exp_f32 v115, v115
  v_exp_f32 v116, v116
  v_exp_f32 v117, v117
  v_exp_f32 v118, v118
  v_lshlrev_b32 v250, 10, v252
  v_lshl_add_u32 v250, v251, 5, v250
  s_add_u32 s90, s85, s77
  buffer_load_dwordx4 a[48:51], v250, s[4:7], s90 offen
  buffer_load_dwordx4 a[52:55], v250, s[4:7], s90 offen offset:16
  v_exp_f32 v119, v119
  v_cvt_pk_bf16_f32 v172, v112, v113
  v_cvt_pk_bf16_f32 v173, v114, v115
  v_cvt_pk_bf16_f32 v174, v116, v117
  v_cvt_pk_bf16_f32 v175, v118, v119
  v_mov_b32 v249, s84
  s_lshl_b32 s91, s95, 2
  s_add_u32 s91, s91, 148480
  v_mov_b32 v250, s91
  ds_write_b32 v250, v249
  v_and_b32 v250, 3, v0
  v_lshlrev_b32 v250, 2, v250
  v_add_u32 v250, 148480, v250
  ds_read_b32 v241, v250
  s_waitcnt lgkmcnt(0)
  v_cmp_ne_u32 vcc, s84, v241
  s_add_u32 s91, s86, s85
  s_add_u32 s91, s91, 356352
  s_cmp_eq_u64 vcc, 0
  s_cselect_b32 s91, s91, 0x80000000
  v_mov_b32 v254, s84
  v_lshlrev_b32 v255, 2, v0
  s_mov_b32 exec_hi, 0
  buffer_store_dword v254, v255, s[16:19], s91 offen sc1
  s_mov_b32 exec_hi, -1
  s_cmp_le_u32 s94, 0
  s_cbranch_scc1 L_attn_exit_10
  v_exp_f32 v120, v120
  v_exp_f32 v121, v121
  v_mfma_f32_32x32x16_bf16 v[152:167], v[196:199], v[172:175], v[152:167]
  v_exp_f32 v122, v122
  v_exp_f32 v123, v123
  v_exp_f32 v124, v124
  s_waitcnt vmcnt(27)
  v_mfma_f32_32x32x16_bf16 v[104:119], a[20:23], v[176:179], 0
  s_mov_b32 exec_hi, 0
  buffer_store_dwordx4 a[12:15], v230, s[16:19], s86 offen sc1
  s_mov_b32 exec_hi, -1
  v_exp_f32 v125, v125
  v_exp_f32 v126, v126
  v_exp_f32 v127, v127
  v_cvt_pk_bf16_f32 v168, v120, v121
  v_cvt_pk_bf16_f32 v169, v122, v123
  v_cvt_pk_bf16_f32 v170, v124, v125
  v_cvt_pk_bf16_f32 v171, v126, v127
  s_add_u32 s91, s96, 196608
  buffer_store_dwordx4 a[8:11], v253, s[16:19], s91 offen offset:0 sc1
  v_exp_f32 v128, v128
  v_exp_f32 v129, v129
  s_waitcnt vmcnt(28)
  v_mfma_f32_32x32x16_bf16 v[136:151], v[8:11], v[168:171], v[136:151]
  s_add_u32 m0, s69, s75
  s_mul_i32 s64, s69, 8
  buffer_load_dwordx4 v247, s[20:23], s64 offen lds
  v_exp_f32 v130, v130
  v_exp_f32 v131, v131
  v_exp_f32 v132, v132
  v_exp_f32 v133, v133
  v_add_u32 v245, 31744, v247
  v_exp_f32 v134, v134
  v_exp_f32 v135, v135
  v_cvt_pk_bf16_f32 v172, v128, v129
  v_cvt_pk_bf16_f32 v173, v130, v131
  v_cvt_pk_bf16_f32 v174, v132, v133
  v_cvt_pk_bf16_f32 v175, v134, v135
  buffer_load_dwordx4 v245, s[20:23], s64 offen offset:1024 lds
  v_add_u32 v244, 63488, v247
  v_exp_f32 v104, v104
  v_exp_f32 v105, v105
  s_waitcnt vmcnt(29)
  v_mfma_f32_32x32x16_bf16 v[136:151], v[12:15], v[172:175], v[136:151]
  v_exp_f32 v106, v106
  v_exp_f32 v107, v107
  v_exp_f32 v108, v108
  v_mfma_f32_32x32x16_bf16 v[120:135], a[16:19], v[184:187], 0
  buffer_load_dwordx4 v244, s[20:23], s64 offen offset:2048 lds
  v_exp_f32 v109, v109
  v_exp_f32 v110, v110
  v_exp_f32 v111, v111
  v_cvt_pk_bf16_f32 v168, v104, v105
  v_cvt_pk_bf16_f32 v169, v106, v107
  v_cvt_pk_bf16_f32 v170, v108, v109
  v_cvt_pk_bf16_f32 v171, v110, v111
  v_add_u32 v242, 95232, v247
  v_exp_f32 v112, v112
  v_exp_f32 v113, v113
  s_waitcnt vmcnt(29)
  v_mfma_f32_32x32x16_bf16 v[136:151], v[16:19], v[168:171], v[136:151]
  buffer_load_dwordx4 v242, s[20:23], s64 offen offset:3072 lds
  v_exp_f32 v114, v114
  v_exp_f32 v115, v115
  v_exp_f32 v116, v116
  v_exp_f32 v117, v117
  v_exp_f32 v118, v118
  v_exp_f32 v119, v119
  v_cvt_pk_bf16_f32 v172, v112, v113
  v_cvt_pk_bf16_f32 v173, v114, v115
  v_cvt_pk_bf16_f32 v174, v116, v117
  v_cvt_pk_bf16_f32 v175, v118, v119
  v_exp_f32 v120, v120
  v_exp_f32 v121, v121
  s_waitcnt vmcnt(29)
  v_mfma_f32_32x32x16_bf16 v[136:151], v[20:23], v[172:175], v[136:151]
  v_exp_f32 v122, v122
  v_exp_f32 v123, v123
  v_exp_f32 v124, v124
  v_mfma_f32_32x32x16_bf16 v[104:119], a[20:23], v[184:187], 0
  s_add_u32 m0, s68, s75
  s_mul_i32 s64, s68, 8
  buffer_load_dwordx4 v247, s[20:23], s64 offen lds
  v_exp_f32 v125, v125
  v_exp_f32 v126, v126
  v_exp_f32 v127, v127
  v_cvt_pk_bf16_f32 v168, v120, v121
  v_cvt_pk_bf16_f32 v169, v122, v123
  v_cvt_pk_bf16_f32 v170, v124, v125
  v_cvt_pk_bf16_f32 v171, v126, v127
  v_exp_f32 v128, v128
  v_exp_f32 v129, v129
  v_mfma_f32_32x32x16_bf16 v[152:167], v[8:11], v[168:171], v[152:167]
  buffer_load_dwordx4 v245, s[20:23], s64 offen offset:1024 lds
  v_exp_f32 v130, v130
  v_exp_f32 v131, v131
  v_exp_f32 v132, v132
  v_exp_f32 v133, v133
  v_exp_f32 v134, v134
  v_exp_f32 v135, v135
  v_cvt_pk_bf16_f32 v172, v128, v129
  v_cvt_pk_bf16_f32 v173, v130, v131
  v_cvt_pk_bf16_f32 v174, v132, v133
  v_cvt_pk_bf16_f32 v175, v134, v135
  v_exp_f32 v104, v104
  v_exp_f32 v105, v105
  v_mfma_f32_32x32x16_bf16 v[152:167], v[12:15], v[172:175], v[152:167]
  v_exp_f32 v106, v106
  v_exp_f32 v107, v107
  v_exp_f32 v108, v108
  s_waitcnt vmcnt(30)
  v_mfma_f32_32x32x16_bf16 v[120:135], a[24:27], v[176:179], 0
  buffer_load_dwordx4 v244, s[20:23], s64 offen offset:2048 lds
  v_exp_f32 v109, v109
  v_exp_f32 v110, v110
  v_exp_f32 v111, v111
  v_cvt_pk_bf16_f32 v168, v104, v105
  v_cvt_pk_bf16_f32 v169, v106, v107
  v_cvt_pk_bf16_f32 v170, v108, v109
  v_cvt_pk_bf16_f32 v171, v110, v111
  v_exp_f32 v112, v112
  v_exp_f32 v113, v113
  v_mfma_f32_32x32x16_bf16 v[152:167], v[16:19], v[168:171], v[152:167]
  buffer_load_dwordx4 v242, s[20:23], s64 offen offset:3072 lds
  v_exp_f32 v114, v114
  v_exp_f32 v115, v115
  v_exp_f32 v116, v116
  v_exp_f32 v117, v117
  v_exp_f32 v118, v118
  v_exp_f32 v119, v119
  v_cvt_pk_bf16_f32 v172, v112, v113
  v_cvt_pk_bf16_f32 v173, v114, v115
  v_cvt_pk_bf16_f32 v174, v116, v117
  v_cvt_pk_bf16_f32 v175, v118, v119
  s_cmp_le_u32 s94, 1
  s_cbranch_scc1 L_attn_exit_11
  v_exp_f32 v120, v120
  v_exp_f32 v121, v121
  v_mfma_f32_32x32x16_bf16 v[152:167], v[20:23], v[172:175], v[152:167]
  v_exp_f32 v122, v122
  v_exp_f32 v123, v123
  v_exp_f32 v124, v124
  s_waitcnt vmcnt(31)
  v_mfma_f32_32x32x16_bf16 v[104:119], a[28:31], v[176:179], 0
  s_add_u32 m0, s67, s75
  s_mul_i32 s64, s67, 8
  buffer_load_dwordx4 v247, s[20:23], s64 offen lds
  v_exp_f32 v125, v125
  v_exp_f32 v126, v126
  v_exp_f32 v127, v127
  v_cvt_pk_bf16_f32 v168, v120, v121
  v_cvt_pk_bf16_f32 v169, v122, v123
  v_cvt_pk_bf16_f32 v170, v124, v125
  v_cvt_pk_bf16_f32 v171, v126, v127
  v_exp_f32 v128, v128
  v_exp_f32 v129, v129
  s_waitcnt vmcnt(31)
  v_mfma_f32_32x32x16_bf16 v[136:151], v[24:27], v[168:171], v[136:151]
  buffer_load_dwordx4 v245, s[20:23], s64 offen offset:1024 lds
  v_exp_f32 v130, v130
  v_exp_f32 v131, v131
  v_exp_f32 v132, v132
  v_exp_f32 v133, v133
  v_exp_f32 v134, v134
  v_exp_f32 v135, v135
  v_cvt_pk_bf16_f32 v172, v128, v129
  v_cvt_pk_bf16_f32 v173, v130, v131
  v_cvt_pk_bf16_f32 v174, v132, v133
  v_cvt_pk_bf16_f32 v175, v134, v135
  v_exp_f32 v104, v104
  v_exp_f32 v105, v105
  s_waitcnt vmcnt(31)
  v_mfma_f32_32x32x16_bf16 v[136:151], v[28:31], v[172:175], v[136:151]
  v_exp_f32 v106, v106
  v_exp_f32 v107, v107
  v_exp_f32 v108, v108
  v_mfma_f32_32x32x16_bf16 v[120:135], a[24:27], v[184:187], 0
  buffer_load_dwordx4 v244, s[20:23], s64 offen offset:2048 lds
  v_exp_f32 v109, v109
  v_exp_f32 v110, v110
  v_exp_f32 v111, v111
  v_cvt_pk_bf16_f32 v168, v104, v105
  v_cvt_pk_bf16_f32 v169, v106, v107
  v_cvt_pk_bf16_f32 v170, v108, v109
  v_cvt_pk_bf16_f32 v171, v110, v111
  v_exp_f32 v112, v112
  v_exp_f32 v113, v113
  s_waitcnt vmcnt(31)
  v_mfma_f32_32x32x16_bf16 v[136:151], v[32:35], v[168:171], v[136:151]
  buffer_load_dwordx4 v242, s[20:23], s64 offen offset:3072 lds
  v_exp_f32 v114, v114
  v_exp_f32 v115, v115
  v_exp_f32 v116, v116
  v_exp_f32 v117, v117
  v_exp_f32 v118, v118
  v_exp_f32 v119, v119
  v_cvt_pk_bf16_f32 v172, v112, v113
  v_cvt_pk_bf16_f32 v173, v114, v115
  v_cvt_pk_bf16_f32 v174, v116, v117
  v_cvt_pk_bf16_f32 v175, v118, v119
  v_exp_f32 v120, v120
  v_exp_f32 v121, v121
  s_waitcnt vmcnt(31)
  v_mfma_f32_32x32x16_bf16 v[136:151], v[36:39], v[172:175], v[136:151]
  v_exp_f32 v122, v122
  v_exp_f32 v123, v123
  v_exp_f32 v124, v124
  v_mfma_f32_32x32x16_bf16 v[104:119], a[28:31], v[184:187], 0
  s_add_u32 m0, s66, s75
  s_mul_i32 s64, s66, 8
  buffer_load_dwordx4 v247, s[20:23], s64 offen lds
  v_exp_f32 v125, v125
  v_exp_f32 v126, v126
  v_exp_f32 v127, v127
  v_cvt_pk_bf16_f32 v168, v120, v121
  v_cvt_pk_bf16_f32 v169, v122, v123
  v_cvt_pk_bf16_f32 v170, v124, v125
  v_cvt_pk_bf16_f32 v171, v126, v127
  v_exp_f32 v128, v128
  v_exp_f32 v129, v129
  v_mfma_f32_32x32x16_bf16 v[152:167], v[24:27], v[168:171], v[152:167]
  buffer_load_dwordx4 v245, s[20:23], s64 offen offset:1024 lds
  v_exp_f32 v130, v130
  v_exp_f32 v131, v131
  v_exp_f32 v132, v132
  v_exp_f32 v133, v133
  v_exp_f32 v134, v134
  v_exp_f32 v135, v135
  v_cvt_pk_bf16_f32 v172, v128, v129
  v_cvt_pk_bf16_f32 v173, v130, v131
  v_cvt_pk_bf16_f32 v174, v132, v133
  v_cvt_pk_bf16_f32 v175, v134, v135
  v_exp_f32 v104, v104
  v_exp_f32 v105, v105
  v_mfma_f32_32x32x16_bf16 v[152:167], v[28:31], v[172:175], v[152:167]
  v_exp_f32 v106, v106
  v_exp_f32 v107, v107
  v_exp_f32 v108, v108
  s_waitcnt vmcnt(32)
  v_mfma_f32_32x32x16_bf16 v[120:135], a[32:35], v[176:179], 0
  v_exp_f32 v109, v109
  v_exp_f32 v110, v110
  v_exp_f32 v111, v111
  v_cvt_pk_bf16_f32 v168, v104, v105
  v_cvt_pk_bf16_f32 v169, v106, v107
  v_cvt_pk_bf16_f32 v170, v108, v109
  v_cvt_pk_bf16_f32 v171, v110, v111
  s_lshl_b32 s55, s2, 2
  s_add_u32 s55, s55, s95
  s_mul_i32 s55, s55, 2304
  s_mov_b64 s[44:45], s[32:33]
  s_mov_b32 s46, 1835008
  s_mov_b32 s47, 0x20000
  s_cmp_ge_u32 s55, s46
  s_cselect_b64 s[44:45], s[28:29], s[44:45]
  s_cselect_b32 s91, s46, 0
  s_cselect_b32 s46, 524288, s46
  s_sub_u32 s55, s55, s91
  v_lshlrev_b32 v255, 7, v0
  s_mov_b64 exec, 0x3ffff
  buffer_load_dword a5, v255, s[44:47], s55 offen
  s_mov_b64 exec, -1
  v_exp_f32 v112, v112
  v_exp_f32 v113, v113
  v_mfma_f32_32x32x16_bf16 v[152:167], v[32:35], v[168:171], v[152:167]
  buffer_load_dwordx4 v244, s[20:23], s64 offen offset:2048 lds
  v_exp_f32 v114, v114
  v_exp_f32 v115, v115
  v_exp_f32 v116, v116
  v_exp_f32 v117, v117
  v_exp_f32 v118, v118
  v_exp_f32 v119, v119
  v_cvt_pk_bf16_f32 v172, v112, v113
  v_cvt_pk_bf16_f32 v173, v114, v115
  v_cvt_pk_bf16_f32 v174, v116, v117
  v_cvt_pk_bf16_f32 v175, v118, v119
  s_cmp_le_u32 s94, 2
  s_cbranch_scc1 L_attn_exit_12
  v_exp_f32 v120, v120
  v_exp_f32 v121, v121
  v_mfma_f32_32x32x16_bf16 v[152:167], v[36:39], v[172:175], v[152:167]
  v_exp_f32 v122, v122
  v_exp_f32 v123, v123
  v_exp_f32 v124, v124
  s_waitcnt vmcnt(33)
  v_mfma_f32_32x32x16_bf16 v[104:119], a[36:39], v[176:179], 0
  buffer_load_dwordx4 v242, s[20:23], s64 offen offset:3072 lds
  v_exp_f32 v125, v125
  v_exp_f32 v126, v126
  v_exp_f32 v127, v127
  v_cvt_pk_bf16_f32 v168, v120, v121
  v_cvt_pk_bf16_f32 v169, v122, v123
  v_cvt_pk_bf16_f32 v170, v124, v125
  v_cvt_pk_bf16_f32 v171, v126, v127
  v_exp_f32 v128, v128
  v_exp_f32 v129, v129
  s_waitcnt vmcnt(33)
  v_mfma_f32_32x32x16_bf16 v[136:151], v[40:43], v[168:171], v[136:151]
  s_add_u32 m0, s69, s75
  s_add_u32 m0, m0, 65536
  s_mul_i32 s64, s69, 8
  buffer_load_dwordx4 v246, s[24:27], s64 offen lds
  v_exp_f32 v130, v130
  v_exp_f32 v131, v131
  v_exp_f32 v132, v132
  v_exp_f32 v133, v133
  v_exp_f32 v134, v134
  v_exp_f32 v135, v135
  v_cvt_pk_bf16_f32 v172, v128, v129
  v_cvt_pk_bf16_f32 v173, v130, v131
  v_cvt_pk_bf16_f32 v174, v132, v133
  v_cvt_pk_bf16_f32 v175, v134, v135
  v_add_u32 v245, 31744, v246
  v_exp_f32 v104, v104
  v_exp_f32 v105, v105
  s_waitcnt vmcnt(33)
  v_mfma_f32_32x32x16_bf16 v[136:151], v[44:47], v[172:175], v[136:151]
  v_exp_f32 v106, v106
  v_exp_f32 v107, v107
  v_exp_f32 v108, v108
  v_mfma_f32_32x32x16_bf16 v[120:135], a[32:35], v[184:187], 0
  buffer_load_dwordx4 v245, s[24:27], s64 offen offset:1024 lds
  v_exp_f32 v109, v109
  v_exp_f32 v110, v110
  v_exp_f32 v111, v111
  v_cvt_pk_bf16_f32 v168, v104, v105
L_page_3:
  s_cbranch_execz L_pageret_0
  v_cvt_pk_bf16_f32 v169, v106, v107
  v_cvt_pk_bf16_f32 v170, v108, v109
  v_cvt_pk_bf16_f32 v171, v110, v111
  v_add_u32 v244, 63488, v246
  v_exp_f32 v112, v112
  v_exp_f32 v113, v113
  s_waitcnt vmcnt(33)
  v_mfma_f32_32x32x16_bf16 v[136:151], v[48:51], v[168:171], v[136:151]
  buffer_load_dwordx4 v244, s[24:27], s64 offen offset:2048 lds
  v_exp_f32 v114, v114
  v_exp_f32 v115, v115
  v_exp_f32 v116, v116
  v_exp_f32 v117, v117
  v_exp_f32 v118, v118
  v_exp_f32 v119, v119
  v_cvt_pk_bf16_f32 v172, v112, v113
  v_cvt_pk_bf16_f32 v173, v114, v115
  v_cvt_pk_bf16_f32 v174, v116, v117
  v_cvt_pk_bf16_f32 v175, v118, v119
  v_add_u32 v242, 95232, v246
  v_exp_f32 v120, v120
  v_exp_f32 v121, v121
  s_waitcnt vmcnt(33)
  v_mfma_f32_32x32x16_bf16 v[136:151], v[52:55], v[172:175], v[136:151]
  v_exp_f32 v122, v122
  v_exp_f32 v123, v123
  v_exp_f32 v124, v124
  v_mfma_f32_32x32x16_bf16 v[104:119], a[36:39], v[184:187], 0
  buffer_load_dwordx4 v242, s[24:27], s64 offen offset:3072 lds
  v_exp_f32 v125, v125
  v_exp_f32 v126, v126
  v_exp_f32 v127, v127
  v_cvt_pk_bf16_f32 v168, v120, v121
  v_cvt_pk_bf16_f32 v169, v122, v123
  v_cvt_pk_bf16_f32 v170, v124, v125
  v_cvt_pk_bf16_f32 v171, v126, v127
  v_exp_f32 v128, v128
  v_exp_f32 v129, v129
  v_mfma_f32_32x32x16_bf16 v[152:167], v[40:43], v[168:171], v[152:167]
  s_add_u32 m0, s68, s75
  s_add_u32 m0, m0, 65536
  s_mul_i32 s64, s68, 8
  buffer_load_dwordx4 v246, s[24:27], s64 offen lds
  v_exp_f32 v130, v130
  v_exp_f32 v131, v131
  v_exp_f32 v132, v132
  v_exp_f32 v133, v133
  v_exp_f32 v134, v134
  v_exp_f32 v135, v135
  v_cvt_pk_bf16_f32 v172, v128, v129
  v_cvt_pk_bf16_f32 v173, v130, v131
  v_cvt_pk_bf16_f32 v174, v132, v133
  v_cvt_pk_bf16_f32 v175, v134, v135
  v_exp_f32 v104, v104
  v_exp_f32 v105, v105
  v_mfma_f32_32x32x16_bf16 v[152:167], v[44:47], v[172:175], v[152:167]
  v_exp_f32 v106, v106
  v_exp_f32 v107, v107
  v_exp_f32 v108, v108
  s_waitcnt vmcnt(34)
  v_mfma_f32_32x32x16_bf16 v[120:135], a[40:43], v[176:179], v[88:103]
  buffer_load_dwordx4 v245, s[24:27], s64 offen offset:1024 lds
  v_exp_f32 v109, v109
  v_exp_f32 v110, v110
  v_exp_f32 v111, v111
  v_cvt_pk_bf16_f32 v168, v104, v105
  v_cvt_pk_bf16_f32 v169, v106, v107
  v_cvt_pk_bf16_f32 v170, v108, v109
  v_cvt_pk_bf16_f32 v171, v110, v111
  v_exp_f32 v112, v112
  v_exp_f32 v113, v113
  v_mfma_f32_32x32x16_bf16 v[152:167], v[48:51], v[168:171], v[152:167]
  v_exp_f32 v114, v114
  v_exp_f32 v115, v115
  v_exp_f32 v116, v116
  v_exp_f32 v117, v117
  v_exp_f32 v118, v118
  v_exp_f32 v119, v119
  v_cvt_pk_bf16_f32 v172, v112, v113
  v_cvt_pk_bf16_f32 v173, v114, v115
  v_cvt_pk_bf16_f32 v174, v116, v117
  v_cvt_pk_bf16_f32 v175, v118, v119
  s_bitcmp1_b32 s94, 0
  s_cselect_b32 s91, 1, -1
  s_add_i32 s91, s91, s94
  s_max_i32 s91, s91, 0
  s_min_i32 s91, s91, 31
  s_and_b32 s90, s94, -2
  v_bfe_u32 v240, v0, 3, 1
  v_add_u32 v240, s90, v240
  v_mov_b32 v250, s91
  v_cndmask_b32 v240, v250, v240, s[82:83]
  s_mov_b32 s91, 360448
  v_mul_lo_u32 v240, v240, s91
  v_and_b32 v250, 7, v0
  v_lshl_add_u32 v240, v250, 7, v240
  v_add_u32 v240, 356352, v240
  buffer_load_dword v241, v240, s[16:19], 0 offen sc1
  s_cmp_le_u32 s94, 3
  s_cbranch_scc1 L_attn_exit_13
  v_exp_f32 v120, v120
  v_exp_f32 v121, v121
  v_mfma_f32_32x32x16_bf16 v[152:167], v[52:55], v[172:175], v[152:167]
  v_exp_f32 v122, v122
  v_exp_f32 v123, v123
  v_exp_f32 v124, v124
  s_waitcnt vmcnt(35)
  v_mfma_f32_32x32x16_bf16 v[104:119], a[44:47], v[176:179], 0
  buffer_load_dwordx4 v244, s[24:27], s64 offen offset:2048 lds
  v_exp_f32 v125, v125
  v_exp_f32 v126, v126
  v_exp_f32 v127, v127
  v_cvt_pk_bf16_f32 v168, v120, v121
  v_cvt_pk_bf16_f32 v169, v122, v123
  v_cvt_pk_bf16_f32 v170, v124, v125
  v_cvt_pk_bf16_f32 v171, v126, v127
  v_exp_f32 v128, v128
  v_exp_f32 v129, v129
  s_waitcnt vmcnt(35)
  v_mfma_f32_32x32x16_bf16 v[136:151], v[56:59], v[168:171], v[136:151]
  buffer_load_dwordx4 v242, s[24:27], s64 offen offset:3072 lds
  v_exp_f32 v130, v130
  v_exp_f32 v131, v131
  v_exp_f32 v132, v132
  v_exp_f32 v133, v133
  v_exp_f32 v134, v134
  v_exp_f32 v135, v135
  v_cvt_pk_bf16_f32 v172, v128, v129
  v_cvt_pk_bf16_f32 v173, v130, v131
  v_cvt_pk_bf16_f32 v174, v132, v133
  v_cvt_pk_bf16_f32 v175, v134, v135
  v_exp_f32 v104, v104
  v_exp_f32 v105, v105
  s_waitcnt vmcnt(35)
  v_mfma_f32_32x32x16_bf16 v[136:151], v[60:63], v[172:175], v[136:151]
  v_exp_f32 v106, v106
  v_exp_f32 v107, v107
  v_exp_f32 v108, v108
  v_mfma_f32_32x32x16_bf16 v[120:135], a[44:47], v[184:187], v[88:103]
  v_exp_f32 v109, v109
  v_exp_f32 v110, v110
  v_exp_f32 v111, v111
  v_cvt_pk_bf16_f32 v168, v104, v105
  v_cvt_pk_bf16_f32 v169, v106, v107
  v_cvt_pk_bf16_f32 v170, v108, v109
  v_cvt_pk_bf16_f32 v171, v110, v111
  v_exp_f32 v112, v112
  v_exp_f32 v113, v113
  s_waitcnt vmcnt(32)
  v_mfma_f32_32x32x16_bf16 v[136:151], v[64:67], v[168:171], v[136:151]
  v_exp_f32 v114, v114
  v_exp_f32 v115, v115
  v_exp_f32 v116, v116
  v_exp_f32 v117, v117
  v_exp_f32 v118, v118
  v_exp_f32 v119, v119
  v_cvt_pk_bf16_f32 v172, v112, v113
  v_cvt_pk_bf16_f32 v173, v114, v115
  v_cvt_pk_bf16_f32 v174, v116, v117
  v_cvt_pk_bf16_f32 v175, v118, v119
  v_exp_f32 v120, v120
  v_exp_f32 v121, v121
  s_waitcnt vmcnt(31)
  v_mfma_f32_32x32x16_bf16 v[136:151], v[68:71], v[172:175], v[136:151]
  v_exp_f32 v122, v122
  v_exp_f32 v123, v123
  v_exp_f32 v124, v124
  v_exp_f32 v125, v125
  v_exp_f32 v126, v126
  v_exp_f32 v127, v127
  v_cvt_pk_bf16_f32 v168, v120, v121
  v_cvt_pk_bf16_f32 v169, v122, v123
  v_cvt_pk_bf16_f32 v170, v124, v125
  v_cvt_pk_bf16_f32 v171, v126, v127
  v_exp_f32 v128, v128
  v_exp_f32 v129, v129
  v_mfma_f32_32x32x16_bf16 v[152:167], v[64:67], v[168:171], v[152:167]
  v_exp_f32 v130, v130
  v_exp_f32 v131, v131
  v_exp_f32 v132, v132
  v_exp_f32 v133, v133
  v_exp_f32 v134, v134
  v_exp_f32 v135, v135
  v_cvt_pk_bf16_f32 v172, v128, v129
  v_cvt_pk_bf16_f32 v173, v130, v131
  v_cvt_pk_bf16_f32 v174, v132, v133
  v_cvt_pk_bf16_f32 v175, v134, v135
  s_nop 1
  v_mfma_f32_32x32x16_bf16 v[152:167], v[68:71], v[172:175], v[152:167]
L_attn_done_9:
  v_subrev_u32 v250, 0x2b800000, v144
  s_nop 10
  v_subrev_u32 v249, 0x2b800000, v160
  v_max_u32 v250, v250, v249
  v_cmp_le_u32 vcc, 0x28000000, v250
  s_cbranch_vccnz L_attn_truemax_14
L_attn_norm_15:
  v_rcp_f32 v250, v144
  v_rcp_f32 v249, v160
  v_accvgpr_read_b32 v239, a0
  v_mul_f32 v136, v136, v250
  v_mul_f32 v137, v137, v250
  v_mul_f32 v138, v138, v250
  v_mul_f32 v139, v139, v250
  v_mul_f32 v140, v140, v250
  v_mul_f32 v141, v141, v250
  v_mul_f32 v142, v142, v250
  v_mul_f32 v143, v143, v250
  v_cvt_pk_bf16_f32 v168, v136, v137
  v_cvt_pk_bf16_f32 v169, v138, v139
  v_cvt_pk_bf16_f32 v170, v140, v141
  v_cvt_pk_bf16_f32 v171, v142, v143
  v_and_b32 v168, -2, v168
  v_mul_f32 v152, v152, v249
  v_mul_f32 v153, v153, v249
  v_mul_f32 v154, v154, v249
  v_mul_f32 v155, v155, v249
  v_mul_f32 v156, v156, v249
  v_mul_f32 v157, v157, v249
  v_mul_f32 v158, v158, v249
  v_mul_f32 v159, v159, v249
  v_cvt_pk_bf16_f32 v172, v152, v153
  v_cvt_pk_bf16_f32 v173, v154, v155
  v_cvt_pk_bf16_f32 v174, v156, v157
  v_cvt_pk_bf16_f32 v175, v158, v159
  v_and_b32 v172, -2, v172
  s_waitcnt vmcnt(2)
  v_xor_b32 v254, s88, v241
  v_cmp_lt_u32 vcc, 31, v254
  s_cbranch_vccnz L_rdy_18
L_rret_19:
  v_cmp_ne_u32 vcc, s84, v241
  v_accvgpr_write_b32 a0, v240
  s_and_b64 vcc, vcc, s[82:83]
  s_cbranch_scc1 L_slow
  buffer_store_dwordx4 v[168:171], v239, s[16:19], s58 offen
  s_add_u32 s91, s58, 32768
  buffer_store_dwordx4 v[172:175], v239, s[16:19], s91 offen
  v_bfe_u32 v221, v0, 2, 2
  v_lshrrev_b32 v220, 1, v221
  v_and_b32 v229, 1, v251
  v_lshl_or_b32 v220, v229, 1, v220
  v_xor_b32 v220, 0, v220
  v_lshlrev_b32 v220, 5, v220
  v_lshl_add_u32 v220, v221, 7, v220
  v_lshl_add_u32 v220, v251, 12, v220
  v_and_b32 v221, 3, v0
  v_lshl_add_u32 v229, v221, 3, v220
  v_add_u32 v225, 65536, v229
  v_xor_b32 v228, 32, v229
  v_add_u32 v224, 65536, v228
  v_xor_b32 v227, 64, v229
  v_add_u32 v223, 65536, v227
  v_xor_b32 v226, 96, v229
  v_add_u32 v222, 65536, v226
  s_waitcnt vmcnt(2)
  s_barrier
  s_add_u32 s91, s86, s85
  s_add_u32 s91, s91, 357376
  s_cmp_eq_u32 s95, 0
  s_cselect_b32 s91, s91, 0x80000000
  v_mov_b32 v254, s84
  v_lshlrev_b32 v255, 2, v0
  s_mov_b32 exec_hi, 0
  buffer_store_dword v254, v255, s[16:19], s91 offen sc1
  s_mov_b32 exec_hi, -1
  v_accvgpr_read_b32 v220, a0
  s_add_u32 s97, s60, 0
  s_add_u32 s96, s60, 4096
  s_add_u32 s77, s60, 8192
  s_add_u32 s76, s60, 12288
  v_mov_b32 v20, 0x3f803f80
  v_mov_b32 v21, 0x3f803f80
  v_mov_b32 v22, 0x3f803f80
  v_mov_b32 v23, 0x3f803f80
  s_add_u32 m0, s67, s75
  s_add_u32 m0, m0, 65536
  s_mul_i32 s64, s67, 8
  buffer_load_dwordx4 v246, s[24:27], s64 offen lds
  s_lshl_b32 s91, s95, 5
  v_xor_b32 v217, s91, v225
  v_lshlrev_b32 v218, 4, v251
  s_add_u32 s87, s64, 31744
  buffer_load_dwordx4 v246, s[24:27], s87 offen offset:1024 lds
  v_add_u32 v218, 147456, v218
  s_lshl_b32 s91, s95, 6
  v_add_u32 v230, s91, v218
  s_add_u32 s87, s64, 63488
  buffer_load_dwordx4 v246, s[24:27], s87 offen offset:2048 lds
  v_add_u32 v250, s69, v217
  ds_read_b64_tr_b16 a[176:177], v250 offset:0
  ds_read_b64_tr_b16 a[178:179], v250 offset:512
  ds_read_b64_tr_b16 a[180:181], v250 offset:1024
  s_add_u32 s87, s64, 95232
  buffer_load_dwordx4 v246, s[24:27], s87 offen offset:3072 lds
  ds_read_b64_tr_b16 a[182:183], v250 offset:1536
  ds_read_b64_tr_b16 a[184:185], v250 offset:2048
  ds_read_b64_tr_b16 a[186:187], v250 offset:2560
  ds_read_b64_tr_b16 a[188:189], v250 offset:3072
  s_add_u32 m0, s66, s75
  s_add_u32 m0, m0, 65536
  s_mul_i32 s64, s66, 8
  buffer_load_dwordx4 v246, s[24:27], s64 offen lds
  ds_read_b64_tr_b16 a[190:191], v250 offset:3584
  v_add_u32 v250, s68, v217
  ds_read_b64_tr_b16 a[192:193], v250 offset:0
  ds_read_b64_tr_b16 a[194:195], v250 offset:512
  s_add_u32 s87, s64, 31744
  buffer_load_dwordx4 v246, s[24:27], s87 offen offset:1024 lds
  ds_read_b64_tr_b16 a[196:197], v250 offset:1024
  ds_read_b64_tr_b16 a[198:199], v250 offset:1536
  ds_read_b64_tr_b16 a[200:201], v250 offset:2048
  s_add_u32 s87, s64, 63488
  buffer_load_dwordx4 v246, s[24:27], s87 offen offset:2048 lds
  ds_read_b64_tr_b16 a[202:203], v250 offset:2560
  ds_read_b64_tr_b16 a[204:205], v250 offset:3072
  ds_read_b64_tr_b16 a[206:207], v250 offset:3584
  s_add_u32 s87, s64, 95232
  buffer_load_dwordx4 v246, s[24:27], s87 offen offset:3072 lds
  ds_read_b64_tr_b16 a[8:9], v229 offset:0
  ds_read_b64_tr_b16 a[10:11], v229 offset:512
  ds_read_b64_tr_b16 a[12:13], v228 offset:0
  ds_read_b64_tr_b16 a[14:15], v228 offset:512
  ds_read_b64_tr_b16 a[16:17], v227 offset:0
  ds_read_b64_tr_b16 a[18:19], v227 offset:512
  ds_read_b64_tr_b16 a[20:21], v226 offset:0
  ds_read_b64_tr_b16 a[22:23], v226 offset:512
  ds_read_b64_tr_b16 a[24:25], v229 offset:1024
  ds_read_b64_tr_b16 a[26:27], v229 offset:1536
  ds_read_b64_tr_b16 a[28:29], v228 offset:1024
  ds_read_b64_tr_b16 a[30:31], v228 offset:1536
  ds_read_b64_tr_b16 a[32:33], v227 offset:1024
  ds_read_b64_tr_b16 a[34:35], v227 offset:1536
  ds_read_b64_tr_b16 a[36:37], v226 offset:1024
  ds_read_b64_tr_b16 a[38:39], v226 offset:1536
  ds_read_b64_tr_b16 a[40:41], v229 offset:2048
  s_waitcnt lgkmcnt(14)
  v_mfma_f32_16x16x32_bf16 v[116:119], a[176:179], v[20:23], 0
  ds_read_b64_tr_b16 a[42:43], v229 offset:2560
  ds_read_b64_tr_b16 a[44:45], v228 offset:2048
  ds_read_b64_tr_b16 a[46:47], v228 offset:2560
  buffer_load_dwordx4 v[28:31], v253, s[16:19], s97 offen offset:0 sc1
  ds_read_b64_tr_b16 a[56:57], v227 offset:2048
  ds_read_b64_tr_b16 a[58:59], v227 offset:2560
  ds_read_b64_tr_b16 a[60:61], v226 offset:2048
  ds_read_b64_tr_b16 a[62:63], v226 offset:2560
  ds_read_b64_tr_b16 a[64:65], v229 offset:3072
  ds_read_b64_tr_b16 a[66:67], v229 offset:3584
  buffer_load_dwordx4 v[32:35], v253, s[16:19], s97 offen offset:1024 sc1
  v_mfma_f32_16x16x32_bf16 v[116:119], a[180:183], v[20:23], v[116:119]
  ds_read_b64_tr_b16 a[68:69], v228 offset:3072
  ds_read_b64_tr_b16 a[70:71], v228 offset:3584
  ds_read_b64_tr_b16 a[72:73], v227 offset:3072
  ds_read_b64_tr_b16 a[74:75], v227 offset:3584
  ds_read_b64_tr_b16 a[76:77], v226 offset:3072
  buffer_load_dwordx4 v[36:39], v253, s[16:19], s97 offen offset:2048 sc1
  ds_read_b64_tr_b16 a[78:79], v226 offset:3584
  ds_read_b64_tr_b16 a[80:81], v229 offset:16384
  ds_read_b64_tr_b16 a[82:83], v229 offset:16896
  ds_read_b64_tr_b16 a[84:85], v228 offset:16384
  v_mfma_f32_16x16x32_bf16 v[116:119], a[184:187], v[20:23], v[116:119]
  ds_read_b64_tr_b16 a[86:87], v228 offset:16896
  buffer_load_dwordx4 v[40:43], v253, s[16:19], s97 offen offset:3072 sc1
  ds_read_b64_tr_b16 a[88:89], v227 offset:16384
  ds_read_b64_tr_b16 a[90:91], v227 offset:16896
  ds_read_b64_tr_b16 a[92:93], v226 offset:16384
  ds_read_b64_tr_b16 a[94:95], v226 offset:16896
  ds_read_b64_tr_b16 a[96:97], v229 offset:17408
  ds_read_b64_tr_b16 a[98:99], v229 offset:17920
  buffer_load_dwordx4 v[44:47], v253, s[16:19], s96 offen offset:0 sc1
  ds_read_b64_tr_b16 a[100:101], v228 offset:17408
  ds_read_b64_tr_b16 a[102:103], v228 offset:17920
  v_mfma_f32_16x16x32_bf16 v[116:119], a[188:191], v[20:23], v[116:119]
  ds_read_b64_tr_b16 a[104:105], v227 offset:17408
  ds_read_b64_tr_b16 a[106:107], v227 offset:17920
  ds_read_b64_tr_b16 a[108:109], v226 offset:17408
  buffer_load_dwordx4 v[48:51], v253, s[16:19], s96 offen offset:1024 sc1
  ds_read_b64_tr_b16 a[110:111], v226 offset:17920
  ds_read_b64_tr_b16 a[112:113], v229 offset:18432
  ds_read_b64_tr_b16 a[114:115], v229 offset:18944
  ds_read_b64_tr_b16 a[116:117], v228 offset:18432
  ds_read_b64_tr_b16 a[118:119], v228 offset:18944
  ds_read_b64_tr_b16 a[120:121], v227 offset:18432
  buffer_load_dwordx4 v[52:55], v253, s[16:19], s96 offen offset:2048 sc1
  v_mfma_f32_16x16x32_bf16 v[116:119], a[192:195], v[20:23], v[116:119]
  ds_read_b64_tr_b16 a[122:123], v227 offset:18944
  ds_read_b64_tr_b16 a[124:125], v226 offset:18432
  ds_read_b64_tr_b16 a[126:127], v226 offset:18944
  ds_read_b64_tr_b16 a[128:129], v229 offset:19456
  ds_read_b64_tr_b16 a[130:131], v229 offset:19968
  buffer_load_dwordx4 v[56:59], v253, s[16:19], s96 offen offset:3072 sc1
  ds_read_b64_tr_b16 a[132:133], v228 offset:19456
  ds_read_b64_tr_b16 a[134:135], v228 offset:19968
  ds_read_b64_tr_b16 a[136:137], v227 offset:19456
  ds_read_b64_tr_b16 a[138:139], v227 offset:19968
  v_mfma_f32_16x16x32_bf16 v[116:119], a[196:199], v[20:23], v[116:119]
  ds_read_b64_tr_b16 a[140:141], v226 offset:19456
  buffer_load_dwordx4 v[60:63], v253, s[16:19], s77 offen offset:0 sc1
  ds_read_b64_tr_b16 a[142:143], v226 offset:19968
  ds_read_b64_tr_b16 a[144:145], v229 offset:32768
  ds_read_b64_tr_b16 a[146:147], v229 offset:33280
  ds_read_b64_tr_b16 a[148:149], v228 offset:32768
  ds_read_b64_tr_b16 a[150:151], v228 offset:33280
  ds_read_b64_tr_b16 a[152:153], v227 offset:32768
  ds_read_b64_tr_b16 a[154:155], v227 offset:33280
  ds_read_b64_tr_b16 a[156:157], v226 offset:32768
  v_mfma_f32_16x16x32_bf16 v[116:119], a[200:203], v[20:23], v[116:119]
  ds_read_b64_tr_b16 a[158:159], v226 offset:33280
  ds_read_b64_tr_b16 a[160:161], v229 offset:33792
  ds_read_b64_tr_b16 a[162:163], v229 offset:34304
  ds_read_b64_tr_b16 a[164:165], v228 offset:33792
  ds_read_b64_tr_b16 a[166:167], v228 offset:34304
  ds_read_b64_tr_b16 a[168:169], v227 offset:33792
  ds_read_b64_tr_b16 a[170:171], v227 offset:34304
  ds_read_b64_tr_b16 a[172:173], v226 offset:33792
  ds_read_b64_tr_b16 a[174:175], v226 offset:34304
  v_mfma_f32_16x16x32_bf16 v[116:119], a[204:207], v[20:23], v[116:119]
  v_accvgpr_read_b32 v92, a48
  v_accvgpr_read_b32 v93, a49
  v_accvgpr_read_b32 v94, a50
  v_accvgpr_read_b32 v95, a51
  v_accvgpr_read_b32 v96, a52
  v_accvgpr_read_b32 v97, a53
  v_accvgpr_read_b32 v98, a54
  v_accvgpr_read_b32 v99, a55
  v_accvgpr_read_b32 v219, a1
  v_permlane16_swap_b32 v92, v94
  v_permlane16_swap_b32 v96, v98
  v_permlane16_swap_b32 v93, v95
  v_permlane16_swap_b32 v97, v99
  v_permlane32_swap_b32 v92, v96
  v_permlane32_swap_b32 v94, v98
  v_permlane32_swap_b32 v93, v97
  v_permlane32_swap_b32 v95, v99
  v_lshlrev_b32 v100, 16, v92
  v_and_b32 v101, 0xffff0000, v92
  v_lshlrev_b32 v102, 16, v93
  v_and_b32 v103, 0xffff0000, v93
  v_lshlrev_b32 v104, 16, v94
  v_and_b32 v105, 0xffff0000, v94
  v_lshlrev_b32 v106, 16, v95
  v_and_b32 v107, 0xffff0000, v95
  v_lshlrev_b32 v108, 16, v96
  v_and_b32 v109, 0xffff0000, v96
  v_lshlrev_b32 v110, 16, v97
  v_and_b32 v111, 0xffff0000, v97
  v_lshlrev_b32 v112, 16, v98
  v_and_b32 v113, 0xffff0000, v98
  v_lshlrev_b32 v114, 16, v99
  v_and_b32 v115, 0xffff0000, v99
  s_add_u32 s74, s60, s57
  s_add_u32 s74, s74, 262144
  v_accvgpr_read_b32 v216, a2
  v_accvgpr_read_b32 v215, a3
  v_lshlrev_b32 v214, 8, v251
  v_lshl_add_u32 v214, v252, 3, v214
  s_add_u32 s70, s59, 327680
  s_add_u32 s73, s86, s57
  s_add_u32 s73, s73, 0
  s_waitcnt vmcnt(7)
  v_bitop3_b32 v254, v28, v32, 1 bitop3:0xa8
  v_cmp_ne_u32 vcc, 0, v254
  s_cbranch_vccnz L_retry_21
L_ret_22:
  v_mfma_f32_16x16x32_bf16 v[4:7], a[8:11], v[28:31], 0
  s_waitcnt lgkmcnt(12)
  ds_read_b64_tr_b16 a[8:9], v229 offset:34816
  ds_read_b64_tr_b16 a[10:11], v229 offset:35328
  buffer_load_dwordx4 v[64:67], v253, s[16:19], s77 offen offset:1024 sc1
  v_mfma_f32_16x16x32_bf16 v[8:11], a[12:15], v[28:31], 0
  ds_read_b64_tr_b16 a[12:13], v228 offset:34816
  ds_read_b64_tr_b16 a[14:15], v228 offset:35328
  v_mfma_f32_16x16x32_bf16 v[12:15], a[16:19], v[28:31], 0
  ds_read_b64_tr_b16 a[16:17], v227 offset:34816
  ds_read_b64_tr_b16 a[18:19], v227 offset:35328
  v_mfma_f32_16x16x32_bf16 v[16:19], a[20:23], v[28:31], 0
  ds_read_b64_tr_b16 a[20:21], v226 offset:34816
  ds_read_b64_tr_b16 a[22:23], v226 offset:35328
  v_mfma_f32_16x16x32_bf16 v[4:7], a[24:27], v[32:35], v[4:7]
  ds_read_b64_tr_b16 a[24:25], v229 offset:35840
  ds_read_b64_tr_b16 a[26:27], v229 offset:36352
  buffer_load_dwordx4 v[68:71], v253, s[16:19], s77 offen offset:2048 sc1
  s_waitcnt vmcnt(7)
  v_bitop3_b32 v254, v36, v40, 1 bitop3:0xa8
  v_mfma_f32_16x16x32_bf16 v[8:11], a[28:31], v[32:35], v[8:11]
  ds_read_b64_tr_b16 a[28:29], v228 offset:35840
  ds_read_b64_tr_b16 a[30:31], v228 offset:36352
  v_cmp_ne_u32 vcc, 0, v254
  v_mfma_f32_16x16x32_bf16 v[12:15], a[32:35], v[32:35], v[12:15]
  ds_read_b64_tr_b16 a[32:33], v227 offset:35840
  ds_read_b64_tr_b16 a[34:35], v227 offset:36352
  v_mfma_f32_16x16x32_bf16 v[16:19], a[36:39], v[32:35], v[16:19]
  ds_read_b64_tr_b16 a[36:37], v226 offset:35840
  ds_read_b64_tr_b16 a[38:39], v226 offset:36352
  s_cbranch_vccnz L_retry_24
L_ret_25:
  v_mfma_f32_16x16x32_bf16 v[4:7], a[40:43], v[36:39], v[4:7]
  ds_read_b64_tr_b16 a[40:41], v229 offset:49152
  ds_read_b64_tr_b16 a[42:43], v229 offset:49664
  buffer_load_dwordx4 v[72:75], v253, s[16:19], s77 offen offset:3072 sc1
  v_mfma_f32_16x16x32_bf16 v[8:11], a[44:47], v[36:39], v[8:11]
  ds_read_b64_tr_b16 a[44:45], v228 offset:49152
  ds_read_b64_tr_b16 a[46:47], v228 offset:49664
  v_mfma_f32_16x16x32_bf16 v[12:15], a[56:59], v[36:39], v[12:15]
  ds_read_b64_tr_b16 a[56:57], v227 offset:49152
  ds_read_b64_tr_b16 a[58:59], v227 offset:49664
  v_mfma_f32_16x16x32_bf16 v[16:19], a[60:63], v[36:39], v[16:19]
  ds_read_b64_tr_b16 a[60:61], v226 offset:49152
  ds_read_b64_tr_b16 a[62:63], v226 offset:49664
  v_mfma_f32_16x16x32_bf16 v[4:7], a[64:67], v[40:43], v[4:7]
  ds_read_b64_tr_b16 a[64:65], v229 offset:50176
  ds_read_b64_tr_b16 a[66:67], v229 offset:50688
  buffer_load_dwordx4 v[76:79], v253, s[16:19], s76 offen offset:0 sc1
  s_waitcnt vmcnt(7)
  v_bitop3_b32 v254, v44, v48, 1 bitop3:0xa8
  v_mfma_f32_16x16x32_bf16 v[8:11], a[68:71], v[40:43], v[8:11]
  ds_read_b64_tr_b16 a[68:69], v228 offset:50176
  ds_read_b64_tr_b16 a[70:71], v228 offset:50688
  v_cmp_ne_u32 vcc, 0, v254
  v_mfma_f32_16x16x32_bf16 v[12:15], a[72:75], v[40:43], v[12:15]
  ds_read_b64_tr_b16 a[72:73], v227 offset:50176
  ds_read_b64_tr_b16 a[74:75], v227 offset:50688
  v_mfma_f32_16x16x32_bf16 v[16:19], a[76:79], v[40:43], v[16:19]
  ds_read_b64_tr_b16 a[76:77], v226 offset:50176
  ds_read_b64_tr_b16 a[78:79], v226 offset:50688
  s_cbranch_vccnz L_retry_27
L_ret_28:
  v_mfma_f32_16x16x32_bf16 v[4:7], a[80:83], v[44:47], v[4:7]
  ds_read_b64_tr_b16 a[80:81], v229 offset:51200
  ds_read_b64_tr_b16 a[82:83], v229 offset:51712
  buffer_load_dwordx4 v[80:83], v253, s[16:19], s76 offen offset:1024 sc1
  v_mfma_f32_16x16x32_bf16 v[8:11], a[84:87], v[44:47], v[8:11]
  ds_read_b64_tr_b16 a[84:85], v228 offset:51200
  ds_read_b64_tr_b16 a[86:87], v228 offset:51712
  v_mfma_f32_16x16x32_bf16 v[12:15], a[88:91], v[44:47], v[12:15]
  ds_read_b64_tr_b16 a[88:89], v227 offset:51200
  ds_read_b64_tr_b16 a[90:91], v227 offset:51712
  v_mfma_f32_16x16x32_bf16 v[16:19], a[92:95], v[44:47], v[16:19]
  ds_read_b64_tr_b16 a[92:93], v226 offset:51200
  ds_read_b64_tr_b16 a[94:95], v226 offset:51712
  v_mfma_f32_16x16x32_bf16 v[4:7], a[96:99], v[48:51], v[4:7]
  ds_read_b64_tr_b16 a[96:97], v229 offset:52224
  ds_read_b64_tr_b16 a[98:99], v229 offset:52736
  buffer_load_dwordx4 v[84:87], v253, s[16:19], s76 offen offset:2048 sc1
  s_waitcnt vmcnt(7)
  v_bitop3_b32 v254, v52, v56, 1 bitop3:0xa8
  v_mfma_f32_16x16x32_bf16 v[8:11], a[100:103], v[48:51], v[8:11]
  ds_read_b64_tr_b16 a[100:101], v228 offset:52224
  ds_read_b64_tr_b16 a[102:103], v228 offset:52736
  v_cmp_ne_u32 vcc, 0, v254
  v_mfma_f32_16x16x32_bf16 v[12:15], a[104:107], v[48:51], v[12:15]
  ds_read_b64_tr_b16 a[104:105], v227 offset:52224
  ds_read_b64_tr_b16 a[106:107], v227 offset:52736
  v_mfma_f32_16x16x32_bf16 v[16:19], a[108:111], v[48:51], v[16:19]
  ds_read_b64_tr_b16 a[108:109], v226 offset:52224
  ds_read_b64_tr_b16 a[110:111], v226 offset:52736
  s_cbranch_vccnz L_retry_30
L_ret_31:
  v_mfma_f32_16x16x32_bf16 v[4:7], a[112:115], v[52:55], v[4:7]
  buffer_load_dwordx4 v[88:91], v253, s[16:19], s76 offen offset:3072 sc1
  v_mfma_f32_16x16x32_bf16 v[8:11], a[116:119], v[52:55], v[8:11]
  v_mfma_f32_16x16x32_bf16 v[12:15], a[120:123], v[52:55], v[12:15]
  v_mfma_f32_16x16x32_bf16 v[16:19], a[124:127], v[52:55], v[16:19]
  v_mfma_f32_16x16x32_bf16 v[4:7], a[128:131], v[56:59], v[4:7]
  s_waitcnt lgkmcnt(0)
  s_barrier
  buffer_load_dword v221, v220, s[16:19], 0 offen offset:1024 sc1
  s_mul_i32 s72, s71, 4096
  s_mov_b64 exec, 0xf
  buffer_load_dword a5, v243, s[28:31], s72 offen
  s_mov_b64 exec, -1
  s_waitcnt vmcnt(8)
  v_bitop3_b32 v254, v60, v64, 1 bitop3:0xa8
  v_mfma_f32_16x16x32_bf16 v[8:11], a[132:135], v[56:59], v[8:11]
  v_cmp_ne_u32 vcc, 0, v254
  v_mfma_f32_16x16x32_bf16 v[12:15], a[136:139], v[56:59], v[12:15]
  s_add_u32 m0, s69, s75
  s_mul_i32 s64, s69, 8
  buffer_load_dwordx4 v246, s[28:31], s64 offen lds
  v_mfma_f32_16x16x32_bf16 v[16:19], a[140:143], v[56:59], v[16:19]
  s_cbranch_vccnz L_retry_33
L_ret_34:
  v_mfma_f32_16x16x32_bf16 v[4:7], a[144:147], v[60:63], v[4:7]
  v_mfma_f32_16x16x32_bf16 v[8:11], a[148:151], v[60:63], v[8:11]
  v_mfma_f32_16x16x32_bf16 v[12:15], a[152:155], v[60:63], v[12:15]
  s_add_u32 s87, s64, 31744
  buffer_load_dwordx4 v246, s[28:31], s87 offen offset:1024 lds
  v_mfma_f32_16x16x32_bf16 v[16:19], a[156:159], v[60:63], v[16:19]
  v_mfma_f32_16x16x32_bf16 v[4:7], a[160:163], v[64:67], v[4:7]
  s_waitcnt vmcnt(8)
  v_bitop3_b32 v254, v68, v72, 1 bitop3:0xa8
  v_mfma_f32_16x16x32_bf16 v[8:11], a[164:167], v[64:67], v[8:11]
  v_cmp_ne_u32 vcc, 0, v254
  v_mfma_f32_16x16x32_bf16 v[12:15], a[168:171], v[64:67], v[12:15]
  s_add_u32 s87, s64, 63488
  buffer_load_dwordx4 v246, s[28:31], s87 offen offset:2048 lds
  v_mfma_f32_16x16x32_bf16 v[16:19], a[172:175], v[64:67], v[16:19]
  s_cbranch_vccnz L_retry_36
L_ret_37:
  v_mfma_f32_16x16x32_bf16 v[4:7], a[8:11], v[68:71], v[4:7]
  v_mfma_f32_16x16x32_bf16 v[8:11], a[12:15], v[68:71], v[8:11]
  v_mfma_f32_16x16x32_bf16 v[12:15], a[16:19], v[68:71], v[12:15]
  s_add_u32 s87, s64, 95232
  buffer_load_dwordx4 v246, s[28:31], s87 offen offset:3072 lds
  v_mfma_f32_16x16x32_bf16 v[16:19], a[20:23], v[68:71], v[16:19]
  v_mfma_f32_16x16x32_bf16 v[4:7], a[24:27], v[72:75], v[4:7]
  s_waitcnt vmcnt(8)
  v_bitop3_b32 v254, v76, v80, 1 bitop3:0xa8
  v_mfma_f32_16x16x32_bf16 v[8:11], a[28:31], v[72:75], v[8:11]
  v_cmp_ne_u32 vcc, 0, v254
  v_mfma_f32_16x16x32_bf16 v[12:15], a[32:35], v[72:75], v[12:15]
  s_add_u32 m0, s68, s75
  s_mul_i32 s64, s68, 8
  buffer_load_dwordx4 v246, s[28:31], s64 offen lds
  v_mfma_f32_16x16x32_bf16 v[16:19], a[36:39], v[72:75], v[16:19]
  s_cbranch_vccnz L_retry_39
L_ret_40:
  v_mfma_f32_16x16x32_bf16 v[4:7], a[40:43], v[76:79], v[4:7]
  v_mfma_f32_16x16x32_bf16 v[8:11], a[44:47], v[76:79], v[8:11]
  v_mfma_f32_16x16x32_bf16 v[12:15], a[56:59], v[76:79], v[12:15]
  s_add_u32 s87, s64, 31744
  buffer_load_dwordx4 v246, s[28:31], s87 offen offset:1024 lds
  v_mfma_f32_16x16x32_bf16 v[16:19], a[60:63], v[76:79], v[16:19]
  v_mfma_f32_16x16x32_bf16 v[4:7], a[64:67], v[80:83], v[4:7]
  s_waitcnt vmcnt(8)
  v_bitop3_b32 v254, v84, v88, 1 bitop3:0xa8
  v_mfma_f32_16x16x32_bf16 v[8:11], a[68:71], v[80:83], v[8:11]
  v_cmp_ne_u32 vcc, 0, v254
  v_mfma_f32_16x16x32_bf16 v[12:15], a[72:75], v[80:83], v[12:15]
  s_add_u32 s87, s64, 63488
  buffer_load_dwordx4 v246, s[28:31], s87 offen offset:2048 lds
L_page_4:
  s_cbranch_execz L_pageret_0
  v_mfma_f32_16x16x32_bf16 v[16:19], a[76:79], v[80:83], v[16:19]
  s_cbranch_vccnz L_retry_42
L_ret_43:
  v_mfma_f32_16x16x32_bf16 v[4:7], a[80:83], v[84:87], v[4:7]
  v_mfma_f32_16x16x32_bf16 v[8:11], a[84:87], v[84:87], v[8:11]
  v_mfma_f32_16x16x32_bf16 v[12:15], a[88:91], v[84:87], v[12:15]
  s_add_u32 s87, s64, 95232
  buffer_load_dwordx4 v246, s[28:31], s87 offen offset:3072 lds
  v_mfma_f32_16x16x32_bf16 v[16:19], a[92:95], v[84:87], v[16:19]
  v_mfma_f32_16x16x32_bf16 v[4:7], a[96:99], v[88:91], v[4:7]
  s_add_u32 m0, s67, s75
  s_mul_i32 s64, s67, 8
  buffer_load_dwordx4 v246, s[28:31], s64 offen lds
  v_mfma_f32_16x16x32_bf16 v[8:11], a[100:103], v[88:91], v[8:11]
  v_mfma_f32_16x16x32_bf16 v[12:15], a[104:107], v[88:91], v[12:15]
  v_mfma_f32_16x16x32_bf16 v[16:19], a[108:111], v[88:91], v[16:19]
  s_nop 1
  v_pk_add_f32 v[4:5], v[4:5], v[100:101]
  v_pk_add_f32 v[6:7], v[6:7], v[102:103]
  s_nop 1
  v_pk_add_f32 v[8:9], v[8:9], v[104:105]
  v_pk_add_f32 v[10:11], v[10:11], v[106:107]
  v_pk_add_f32 v[12:13], v[12:13], v[108:109]
  v_pk_add_f32 v[14:15], v[14:15], v[110:111]
  v_pk_add_f32 v[16:17], v[16:17], v[112:113]
  v_pk_add_f32 v[18:19], v[18:19], v[114:115]
  v_cvt_pk_bf16_f32 v168, v4, v5
  v_cvt_pk_bf16_f32 v169, v6, v7
  v_and_b32 v168, -2, v168
  v_cvt_pk_bf16_f32 v170, v8, v9
  v_cvt_pk_bf16_f32 v171, v10, v11
  buffer_store_dwordx4 v[168:171], v253, s[16:19], s74 offen offset:0
  v_cvt_pk_bf16_f32 v172, v12, v13
  v_cvt_pk_bf16_f32 v173, v14, v15
  v_and_b32 v172, -2, v172
  v_cvt_pk_bf16_f32 v174, v16, v17
  v_cvt_pk_bf16_f32 v175, v18, v19
  buffer_store_dwordx4 v[172:175], v253, s[16:19], s74 offen offset:1024
  v_pk_add_f32 v[210:211], v[4:5], v[6:7]
  v_pk_mul_f32 v[208:209], v[4:5], v[4:5]
  v_pk_fma_f32 v[208:209], v[6:7], v[6:7], v[208:209]
  v_pk_add_f32 v[210:211], v[210:211], v[8:9]
  v_pk_fma_f32 v[208:209], v[8:9], v[8:9], v[208:209]
  v_pk_add_f32 v[210:211], v[210:211], v[10:11]
  v_pk_fma_f32 v[208:209], v[10:11], v[10:11], v[208:209]
  v_pk_add_f32 v[210:211], v[210:211], v[12:13]
  v_pk_fma_f32 v[208:209], v[12:13], v[12:13], v[208:209]
  v_pk_add_f32 v[210:211], v[210:211], v[14:15]
  v_pk_fma_f32 v[208:209], v[14:15], v[14:15], v[208:209]
  v_pk_add_f32 v[210:211], v[210:211], v[16:17]
  v_pk_fma_f32 v[208:209], v[16:17], v[16:17], v[208:209]
  s_add_u32 s87, s64, 31744
  buffer_load_dwordx4 v246, s[28:31], s87 offen offset:1024 lds
  v_pk_add_f32 v[210:211], v[210:211], v[18:19]
  v_pk_fma_f32 v[208:209], v[18:19], v[18:19], v[208:209]
  v_add_f32 v210, v210, v211
  v_add_f32 v208, v208, v209
  s_add_u32 s90, s59, s85
  s_add_u32 s90, s90, 327680
  v_permlane32_swap_b32 v210, v208
  v_add_f32 v210, v210, v208
  v_mov_b32 v208, v210
  s_nop 1
  v_permlane16_swap_b32 v210, v208
  v_add_f32 v210, v210, v208
  buffer_store_dword v210, v219, s[16:19], s90 offen
  s_add_u32 s87, s64, 63488
  buffer_load_dwordx4 v246, s[28:31], s87 offen offset:2048 lds
  s_add_u32 s97, s60, 262144
  s_add_u32 s96, s60, 266240
  s_add_u32 s77, s60, 270336
  s_add_u32 s76, s60, 274432
  s_lshl_b32 s65, s92, 8
  s_cmp_lt_u32 s92, 14
  s_cselect_b32 s65, s65, 0x80000000
  v_lshrrev_b32 v212, 3, v0
  v_and_b32 v211, 7, v0
  s_mov_b32 s90, s95
  v_bfe_u32 v209, v212, 1, 1
  v_lshlrev_b32 v209, 1, v209
  v_lshlrev_b32 v209, 1, v209
  v_xor_b32 v211, v211, v209
  s_add_u32 s87, s64, 95232
  buffer_load_dwordx4 v246, s[28:31], s87 offen offset:3072 lds
  v_lshlrev_b32 v211, 4, v211
  v_and_b32 v210, 3, v212
  v_lshrrev_b32 v209, 2, v212
  v_lshl_add_u32 v210, v209, 4, v210
  s_lshl_b32 s91, s90, 2
  v_add_u32 v210, s91, v210
  s_mov_b32 s91, 3584
  v_mad_u32_u24 v213, v210, s91, v211
  s_add_u32 m0, s66, s75
  s_mul_i32 s64, s66, 8
  buffer_load_dwordx4 v246, s[28:31], s64 offen lds
  ds_read_b64_tr_b16 a[8:9], v225 offset:0
  ds_read_b64_tr_b16 a[10:11], v225 offset:512
  ds_read_b64_tr_b16 a[12:13], v224 offset:0
  ds_read_b64_tr_b16 a[14:15], v224 offset:512
  ds_read_b64_tr_b16 a[16:17], v223 offset:0
  ds_read_b64_tr_b16 a[18:19], v223 offset:512
  ds_read_b64_tr_b16 a[20:21], v222 offset:0
  ds_read_b64_tr_b16 a[22:23], v222 offset:512
  s_add_u32 s87, s64, 31744
  buffer_load_dwordx4 v246, s[28:31], s87 offen offset:1024 lds
  ds_read_b64_tr_b16 a[24:25], v225 offset:1024
  ds_read_b64_tr_b16 a[26:27], v225 offset:1536
  ds_read_b64_tr_b16 a[28:29], v224 offset:1024
  ds_read_b64_tr_b16 a[30:31], v224 offset:1536
  ds_read_b64_tr_b16 a[32:33], v223 offset:1024
  ds_read_b64_tr_b16 a[34:35], v223 offset:1536
  ds_read_b64_tr_b16 a[36:37], v222 offset:1024
  ds_read_b64_tr_b16 a[38:39], v222 offset:1536
  s_add_u32 s87, s64, 63488
  buffer_load_dwordx4 v246, s[28:31], s87 offen offset:2048 lds
  ds_read_b64_tr_b16 a[40:41], v225 offset:2048
  ds_read_b64_tr_b16 a[42:43], v225 offset:2560
  ds_read_b64_tr_b16 a[44:45], v224 offset:2048
  ds_read_b64_tr_b16 a[46:47], v224 offset:2560
  ds_read_b64_tr_b16 a[56:57], v223 offset:2048
  ds_read_b64_tr_b16 a[58:59], v223 offset:2560
  ds_read_b64_tr_b16 a[60:61], v222 offset:2048
  ds_read_b64_tr_b16 a[62:63], v222 offset:2560
  s_add_u32 s87, s64, 95232
  buffer_load_dwordx4 v246, s[28:31], s87 offen offset:3072 lds
  ds_read_b64_tr_b16 a[64:65], v225 offset:3072
  ds_read_b64_tr_b16 a[66:67], v225 offset:3584
  ds_read_b64_tr_b16 a[68:69], v224 offset:3072
  ds_read_b64_tr_b16 a[70:71], v224 offset:3584
  ds_read_b64_tr_b16 a[72:73], v223 offset:3072
  ds_read_b64_tr_b16 a[74:75], v223 offset:3584
  ds_read_b64_tr_b16 a[76:77], v222 offset:3072
  ds_read_b64_tr_b16 a[78:79], v222 offset:3584
  ds_read_b64_tr_b16 a[80:81], v225 offset:16384
  ds_read_b64_tr_b16 a[82:83], v225 offset:16896
  ds_read_b64_tr_b16 a[84:85], v224 offset:16384
  ds_read_b64_tr_b16 a[86:87], v224 offset:16896
  ds_read_b64_tr_b16 a[88:89], v223 offset:16384
  ds_read_b64_tr_b16 a[90:91], v223 offset:16896
  ds_read_b64_tr_b16 a[92:93], v222 offset:16384
  ds_read_b64_tr_b16 a[94:95], v222 offset:16896
  ds_read_b64_tr_b16 a[96:97], v225 offset:17408
  ds_read_b64_tr_b16 a[98:99], v225 offset:17920
  buffer_load_dwordx4 v[28:31], v253, s[16:19], s97 offen offset:0 sc1
  ds_read_b64_tr_b16 a[100:101], v224 offset:17408
  ds_read_b64_tr_b16 a[102:103], v224 offset:17920
  ds_read_b64_tr_b16 a[104:105], v223 offset:17408
  ds_read_b64_tr_b16 a[106:107], v223 offset:17920
  ds_read_b64_tr_b16 a[108:109], v222 offset:17408
  ds_read_b64_tr_b16 a[110:111], v222 offset:17920
  buffer_load_dwordx4 v[32:35], v253, s[16:19], s97 offen offset:1024 sc1
  v_add_u32 v213, s65, v213
  v_add_u32 v212, s67, v217
  ds_read_b64_tr_b16 a[48:49], v212 offset:0
  ds_read_b64_tr_b16 a[50:51], v212 offset:512
  ds_read_b64_tr_b16 a[52:53], v212 offset:1024
  ds_read_b64_tr_b16 a[54:55], v212 offset:1536
  ds_read_b64_tr_b16 a[176:177], v212 offset:2048
  ds_read_b64_tr_b16 a[178:179], v212 offset:2560
  buffer_load_dwordx4 v[36:39], v253, s[16:19], s97 offen offset:2048 sc1
  ds_read_b64_tr_b16 a[180:181], v212 offset:3072
  ds_read_b64_tr_b16 a[182:183], v212 offset:3584
  v_add_u32 v212, s66, v217
  ds_read_b64_tr_b16 a[184:185], v212 offset:0
  ds_read_b64_tr_b16 a[186:187], v212 offset:512
  ds_read_b64_tr_b16 a[188:189], v212 offset:1024
  ds_read_b64_tr_b16 a[190:191], v212 offset:1536
  buffer_load_dwordx4 v[40:43], v253, s[16:19], s97 offen offset:3072 sc1
  ds_read_b64_tr_b16 a[192:193], v212 offset:2048
  ds_read_b64_tr_b16 a[194:195], v212 offset:2560
  ds_read_b64_tr_b16 a[196:197], v212 offset:3072
  ds_read_b64_tr_b16 a[198:199], v212 offset:3584
  ds_read_b64_tr_b16 a[112:113], v225 offset:18432
  ds_read_b64_tr_b16 a[114:115], v225 offset:18944
  buffer_load_dwordx4 v[44:47], v253, s[16:19], s96 offen offset:0 sc1
  ds_read_b64_tr_b16 a[116:117], v224 offset:18432
  ds_read_b64_tr_b16 a[118:119], v224 offset:18944
  s_waitcnt lgkmcnt(14)
  v_mfma_f32_16x16x32_bf16 v[116:119], a[48:51], v[20:23], v[116:119]
  ds_read_b64_tr_b16 a[120:121], v223 offset:18432
  ds_read_b64_tr_b16 a[122:123], v223 offset:18944
  ds_read_b64_tr_b16 a[124:125], v222 offset:18432
  buffer_load_dwordx4 v[48:51], v253, s[16:19], s96 offen offset:1024 sc1
  ds_read_b64_tr_b16 a[126:127], v222 offset:18944
  v_mfma_f32_16x16x32_bf16 v[116:119], a[52:55], v[20:23], v[116:119]
  ds_read_b64_tr_b16 a[128:129], v225 offset:19456
  ds_read_b64_tr_b16 a[130:131], v225 offset:19968
  ds_read_b64_tr_b16 a[132:133], v224 offset:19456
  v_mfma_f32_16x16x32_bf16 v[116:119], a[176:179], v[20:23], v[116:119]
  s_waitcnt lgkmcnt(10)
  buffer_load_dwordx4 v[52:55], v253, s[16:19], s96 offen offset:2048 sc1
  ds_read_b64_tr_b16 a[134:135], v224 offset:19968
  ds_read_b64_tr_b16 a[136:137], v223 offset:19456
  ds_read_b64_tr_b16 a[138:139], v223 offset:19968
  ds_read_b64_tr_b16 a[140:141], v222 offset:19456
  v_mfma_f32_16x16x32_bf16 v[116:119], a[180:183], v[20:23], v[116:119]
  ds_read_b64_tr_b16 a[142:143], v222 offset:19968
  buffer_load_dwordx4 v[56:59], v253, s[16:19], s96 offen offset:3072 sc1
  ds_read_b64_tr_b16 a[144:145], v225 offset:32768
  ds_read_b64_tr_b16 a[146:147], v225 offset:33280
  v_mfma_f32_16x16x32_bf16 v[116:119], a[184:187], v[20:23], v[116:119]
  ds_read_b64_tr_b16 a[148:149], v224 offset:32768
  ds_read_b64_tr_b16 a[150:151], v224 offset:33280
  ds_read_b64_tr_b16 a[152:153], v223 offset:32768
  buffer_load_dwordx4 v[60:63], v253, s[16:19], s77 offen offset:0 sc1
  ds_read_b64_tr_b16 a[154:155], v223 offset:33280
  v_mfma_f32_16x16x32_bf16 v[116:119], a[188:191], v[20:23], v[116:119]
  ds_read_b64_tr_b16 a[156:157], v222 offset:32768
  ds_read_b64_tr_b16 a[158:159], v222 offset:33280
  ds_read_b64_tr_b16 a[160:161], v225 offset:33792
  v_mfma_f32_16x16x32_bf16 v[116:119], a[192:195], v[20:23], v[116:119]
  ds_read_b64_tr_b16 a[162:163], v225 offset:34304
  ds_read_b64_tr_b16 a[164:165], v224 offset:33792
  ds_read_b64_tr_b16 a[166:167], v224 offset:34304
  ds_read_b64_tr_b16 a[168:169], v223 offset:33792
  v_mfma_f32_16x16x32_bf16 v[116:119], a[196:199], v[20:23], v[116:119]
  ds_read_b64_tr_b16 a[170:171], v223 offset:34304
  ds_read_b64_tr_b16 a[172:173], v222 offset:33792
  ds_read_b64_tr_b16 a[174:175], v222 offset:34304
  s_mov_b64 exec, s[80:81]
  s_nop 3
  ds_write_b128 v230, v[116:119] offset:0
  s_mov_b64 exec, -1
  s_waitcnt vmcnt(7)
  v_bitop3_b32 v254, v28, v32, 1 bitop3:0xa8
  v_cmp_ne_u32 vcc, 0, v254
  s_cbranch_vccnz L_retry_51
L_ret_52:
  v_mfma_f32_16x16x32_bf16 v[92:95], a[8:11], v[28:31], 0
  ds_read_b64_tr_b16 a[8:9], v225 offset:34816
  ds_read_b64_tr_b16 a[10:11], v225 offset:35328
  buffer_load_dwordx4 v[64:67], v253, s[16:19], s77 offen offset:1024 sc1
  v_mfma_f32_16x16x32_bf16 v[96:99], a[12:15], v[28:31], 0
  ds_read_b64_tr_b16 a[12:13], v224 offset:34816
  ds_read_b64_tr_b16 a[14:15], v224 offset:35328
  v_mfma_f32_16x16x32_bf16 v[100:103], a[16:19], v[28:31], 0
  ds_read_b64_tr_b16 a[16:17], v223 offset:34816
  ds_read_b64_tr_b16 a[18:19], v223 offset:35328
  v_mfma_f32_16x16x32_bf16 v[104:107], a[20:23], v[28:31], 0
  ds_read_b64_tr_b16 a[20:21], v222 offset:34816
  ds_read_b64_tr_b16 a[22:23], v222 offset:35328
  v_mfma_f32_16x16x32_bf16 v[92:95], a[24:27], v[32:35], v[92:95]
  ds_read_b64_tr_b16 a[24:25], v225 offset:35840
  ds_read_b64_tr_b16 a[26:27], v225 offset:36352
  buffer_load_dwordx4 v[68:71], v253, s[16:19], s77 offen offset:2048 sc1
  s_waitcnt vmcnt(7)
  v_bitop3_b32 v254, v36, v40, 1 bitop3:0xa8
  v_mfma_f32_16x16x32_bf16 v[96:99], a[28:31], v[32:35], v[96:99]
  ds_read_b64_tr_b16 a[28:29], v224 offset:35840
  ds_read_b64_tr_b16 a[30:31], v224 offset:36352
  v_cmp_ne_u32 vcc, 0, v254
  v_mfma_f32_16x16x32_bf16 v[100:103], a[32:35], v[32:35], v[100:103]
  ds_read_b64_tr_b16 a[32:33], v223 offset:35840
  ds_read_b64_tr_b16 a[34:35], v223 offset:36352
  v_mfma_f32_16x16x32_bf16 v[104:107], a[36:39], v[32:35], v[104:107]
  ds_read_b64_tr_b16 a[36:37], v222 offset:35840
  ds_read_b64_tr_b16 a[38:39], v222 offset:36352
  s_cbranch_vccnz L_retry_54
L_ret_55:
  v_mfma_f32_16x16x32_bf16 v[92:95], a[40:43], v[36:39], v[92:95]
  ds_read_b64_tr_b16 a[40:41], v225 offset:49152
  ds_read_b64_tr_b16 a[42:43], v225 offset:49664
  buffer_load_dwordx4 v[72:75], v253, s[16:19], s77 offen offset:3072 sc1
  v_mfma_f32_16x16x32_bf16 v[96:99], a[44:47], v[36:39], v[96:99]
  ds_read_b64_tr_b16 a[44:45], v224 offset:49152
  ds_read_b64_tr_b16 a[46:47], v224 offset:49664
  v_mfma_f32_16x16x32_bf16 v[100:103], a[56:59], v[36:39], v[100:103]
  ds_read_b64_tr_b16 a[56:57], v223 offset:49152
  ds_read_b64_tr_b16 a[58:59], v223 offset:49664
  v_mfma_f32_16x16x32_bf16 v[104:107], a[60:63], v[36:39], v[104:107]
  ds_read_b64_tr_b16 a[60:61], v222 offset:49152
  ds_read_b64_tr_b16 a[62:63], v222 offset:49664
  v_mfma_f32_16x16x32_bf16 v[92:95], a[64:67], v[40:43], v[92:95]
  ds_read_b64_tr_b16 a[64:65], v225 offset:50176
  ds_read_b64_tr_b16 a[66:67], v225 offset:50688
  buffer_load_dwordx4 v[76:79], v253, s[16:19], s76 offen offset:0 sc1
  s_waitcnt vmcnt(7)
  v_bitop3_b32 v254, v44, v48, 1 bitop3:0xa8
  v_mfma_f32_16x16x32_bf16 v[96:99], a[68:71], v[40:43], v[96:99]
  ds_read_b64_tr_b16 a[68:69], v224 offset:50176
  ds_read_b64_tr_b16 a[70:71], v224 offset:50688
  v_cmp_ne_u32 vcc, 0, v254
  v_mfma_f32_16x16x32_bf16 v[100:103], a[72:75], v[40:43], v[100:103]
  ds_read_b64_tr_b16 a[72:73], v223 offset:50176
  ds_read_b64_tr_b16 a[74:75], v223 offset:50688
  v_mfma_f32_16x16x32_bf16 v[104:107], a[76:79], v[40:43], v[104:107]
  ds_read_b64_tr_b16 a[76:77], v222 offset:50176
  ds_read_b64_tr_b16 a[78:79], v222 offset:50688
  s_cbranch_vccnz L_retry_57
L_ret_58:
  v_mfma_f32_16x16x32_bf16 v[92:95], a[80:83], v[44:47], v[92:95]
  ds_read_b64_tr_b16 a[80:81], v225 offset:51200
  ds_read_b64_tr_b16 a[82:83], v225 offset:51712
  buffer_load_dwordx4 v[80:83], v253, s[16:19], s76 offen offset:1024 sc1
  v_mfma_f32_16x16x32_bf16 v[96:99], a[84:87], v[44:47], v[96:99]
  ds_read_b64_tr_b16 a[84:85], v224 offset:51200
  ds_read_b64_tr_b16 a[86:87], v224 offset:51712
  v_mfma_f32_16x16x32_bf16 v[100:103], a[88:91], v[44:47], v[100:103]
  ds_read_b64_tr_b16 a[88:89], v223 offset:51200
  ds_read_b64_tr_b16 a[90:91], v223 offset:51712
  v_mfma_f32_16x16x32_bf16 v[104:107], a[92:95], v[44:47], v[104:107]
  ds_read_b64_tr_b16 a[92:93], v222 offset:51200
  ds_read_b64_tr_b16 a[94:95], v222 offset:51712
  v_mfma_f32_16x16x32_bf16 v[92:95], a[96:99], v[48:51], v[92:95]
  ds_read_b64_tr_b16 a[96:97], v225 offset:52224
  ds_read_b64_tr_b16 a[98:99], v225 offset:52736
  buffer_load_dwordx4 v[84:87], v253, s[16:19], s76 offen offset:2048 sc1
  s_waitcnt vmcnt(7)
  v_bitop3_b32 v254, v52, v56, 1 bitop3:0xa8
  v_mfma_f32_16x16x32_bf16 v[96:99], a[100:103], v[48:51], v[96:99]
  ds_read_b64_tr_b16 a[100:101], v224 offset:52224
  ds_read_b64_tr_b16 a[102:103], v224 offset:52736
  v_cmp_ne_u32 vcc, 0, v254
  v_mfma_f32_16x16x32_bf16 v[100:103], a[104:107], v[48:51], v[100:103]
  ds_read_b64_tr_b16 a[104:105], v223 offset:52224
  ds_read_b64_tr_b16 a[106:107], v223 offset:52736
  v_mfma_f32_16x16x32_bf16 v[104:107], a[108:111], v[48:51], v[104:107]
  ds_read_b64_tr_b16 a[108:109], v222 offset:52224
  ds_read_b64_tr_b16 a[110:111], v222 offset:52736
  s_cbranch_vccnz L_retry_60
L_ret_61:
  s_waitcnt lgkmcnt(14)
  v_mfma_f32_16x16x32_bf16 v[92:95], a[112:115], v[52:55], v[92:95]
  buffer_load_dwordx4 v[88:91], v253, s[16:19], s76 offen offset:3072 sc1
  v_lshlrev_b32 v198, 5, v251
  v_mfma_f32_16x16x32_bf16 v[96:99], a[116:119], v[52:55], v[96:99]
  v_mfma_f32_16x16x32_bf16 v[100:103], a[120:123], v[52:55], v[100:103]
  v_and_b32 v199, 1, v252
  v_mfma_f32_16x16x32_bf16 v[104:107], a[124:127], v[52:55], v[104:107]
  v_mfma_f32_16x16x32_bf16 v[92:95], a[128:131], v[56:59], v[92:95]
  s_waitcnt lgkmcnt(0)
  s_barrier
  buffer_load_dwordx2 v[108:109], v214, s[16:19], s70 offen sc1
  buffer_load_dwordx2 v[110:111], v214, s[16:19], s70 offen offset:128 sc1
  v_lshl_add_u32 v198, v199, 4, v198
  s_waitcnt vmcnt(8)
  v_bitop3_b32 v254, v60, v64, 1 bitop3:0xa8
  v_mfma_f32_16x16x32_bf16 v[96:99], a[132:135], v[56:59], v[96:99]
  v_cmp_ne_u32 vcc, 0, v254
  v_mfma_f32_16x16x32_bf16 v[100:103], a[136:139], v[56:59], v[100:103]
  s_lshl_b32 s91, s95, 14
  s_sub_u32 s91, 335872, s91
  v_add_u32 v199, s91, v198
  s_cmp_eq_u32 s95, 0
  s_cselect_b32 s58, 4096, 0
  s_cselect_b32 s91, 0, 15
  v_xor_b32 v198, s91, v252
  v_mfma_f32_16x16x32_bf16 v[104:107], a[140:143], v[56:59], v[104:107]
  s_cbranch_vccnz L_retry_63
L_ret_64:
  v_mfma_f32_16x16x32_bf16 v[92:95], a[144:147], v[60:63], v[92:95]
  s_add_u32 s91, s95, 1
  s_bitcmp0_b32 s91, 1
  s_cselect_b32 s91, 1, 0
  v_cmp_gt_u32 s[78:79], s91, v198
  v_mfma_f32_16x16x32_bf16 v[96:99], a[148:151], v[60:63], v[96:99]
  v_mfma_f32_16x16x32_bf16 v[100:103], a[152:155], v[60:63], v[100:103]
  v_cndmask_b32 v201, v253, v199, s[78:79]
  v_mfma_f32_16x16x32_bf16 v[104:107], a[156:159], v[60:63], v[104:107]
  v_mfma_f32_16x16x32_bf16 v[92:95], a[160:163], v[64:67], v[92:95]
  s_add_u32 s91, s95, 1
  s_bitcmp0_b32 s91, 1
  s_cselect_b32 s91, 2, 0
  v_cmp_gt_u32 s[78:79], s91, v198
  s_waitcnt vmcnt(6)
  v_bitop3_b32 v254, v68, v72, 1 bitop3:0xa8
  v_mfma_f32_16x16x32_bf16 v[96:99], a[164:167], v[64:67], v[96:99]
  v_cmp_ne_u32 vcc, 0, v254
  v_mfma_f32_16x16x32_bf16 v[100:103], a[168:171], v[64:67], v[100:103]
  v_mfma_f32_16x16x32_bf16 v[104:107], a[172:175], v[64:67], v[104:107]
  s_cbranch_vccnz L_retry_66
L_ret_67:
  v_mfma_f32_16x16x32_bf16 v[92:95], a[8:11], v[68:71], v[92:95]
  v_cndmask_b32 v200, v253, v199, s[78:79]
  v_mfma_f32_16x16x32_bf16 v[96:99], a[12:15], v[68:71], v[96:99]
  v_mfma_f32_16x16x32_bf16 v[100:103], a[16:19], v[68:71], v[100:103]
  s_add_u32 m0, s69, s75
  s_add_u32 m0, m0, 65536
  s_mul_i32 s64, s69, 28
  buffer_load_dwordx4 v213, s[32:35], s64 offen lds
  v_mfma_f32_16x16x32_bf16 v[104:107], a[20:23], v[68:71], v[104:107]
  v_mfma_f32_16x16x32_bf16 v[92:95], a[24:27], v[72:75], v[92:95]
  s_lshl_b32 s90, s58, 2
  v_subrev_u32 v225, s90, v229
  v_add_u32 v229, s90, v229
  v_subrev_u32 v224, s90, v228
  v_add_u32 v228, s90, v228
  v_subrev_u32 v223, s90, v227
  v_add_u32 v227, s90, v227
  v_subrev_u32 v222, s90, v226
  v_add_u32 v226, s90, v226
  s_waitcnt vmcnt(5)
  v_bitop3_b32 v254, v76, v80, 1 bitop3:0xa8
  v_mfma_f32_16x16x32_bf16 v[96:99], a[28:31], v[72:75], v[96:99]
  v_cmp_ne_u32 vcc, 0, v254
  v_mfma_f32_16x16x32_bf16 v[100:103], a[32:35], v[72:75], v[100:103]
  s_add_u32 s87, s64, 113664
  buffer_load_dwordx4 v213, s[32:35], s87 offen offset:1024 lds
  v_mfma_f32_16x16x32_bf16 v[104:107], a[36:39], v[72:75], v[104:107]
  s_cbranch_vccnz L_retry_69
L_ret_70:
  v_mfma_f32_16x16x32_bf16 v[92:95], a[40:43], v[76:79], v[92:95]
  ds_read_b128 v[120:123], v218 offset:0
  v_mfma_f32_16x16x32_bf16 v[96:99], a[44:47], v[76:79], v[96:99]
  v_mfma_f32_16x16x32_bf16 v[100:103], a[56:59], v[76:79], v[100:103]
  s_add_u32 s87, s64, 227328
  buffer_load_dwordx4 v213, s[32:35], s87 offen offset:2048 lds
  v_mfma_f32_16x16x32_bf16 v[104:107], a[60:63], v[76:79], v[104:107]
  v_mfma_f32_16x16x32_bf16 v[92:95], a[64:67], v[80:83], v[92:95]
  ds_read_b128 v[124:127], v218 offset:64
  s_waitcnt vmcnt(5)
  v_bitop3_b32 v254, v84, v88, 1 bitop3:0xa8
  v_mfma_f32_16x16x32_bf16 v[96:99], a[68:71], v[80:83], v[96:99]
  v_cmp_ne_u32 vcc, 0, v254
  v_mfma_f32_16x16x32_bf16 v[100:103], a[72:75], v[80:83], v[100:103]
  s_add_u32 s87, s64, 340992
  buffer_load_dwordx4 v213, s[32:35], s87 offen offset:3072 lds
  v_mfma_f32_16x16x32_bf16 v[104:107], a[76:79], v[80:83], v[104:107]
  s_cbranch_vccnz L_retry_72
L_ret_73:
  v_mfma_f32_16x16x32_bf16 v[92:95], a[80:83], v[84:87], v[92:95]
  ds_read_b128 v[128:131], v218 offset:128
  v_mfma_f32_16x16x32_bf16 v[96:99], a[84:87], v[84:87], v[96:99]
  v_mfma_f32_16x16x32_bf16 v[100:103], a[88:91], v[84:87], v[100:103]
  s_add_u32 m0, s68, s75
  s_add_u32 m0, m0, 65536
  s_mul_i32 s64, s68, 28
  buffer_load_dwordx4 v213, s[32:35], s64 offen lds
  v_mfma_f32_16x16x32_bf16 v[104:107], a[92:95], v[84:87], v[104:107]
  s_barrier
  v_mfma_f32_16x16x32_bf16 v[92:95], a[96:99], v[88:91], v[92:95]
  s_add_u32 s87, s64, 113664
  buffer_load_dwordx4 v213, s[32:35], s87 offen offset:1024 lds
  ds_read_b128 v[132:135], v218 offset:192
  v_mfma_f32_16x16x32_bf16 v[96:99], a[100:103], v[88:91], v[96:99]
  v_mfma_f32_16x16x32_bf16 v[100:103], a[104:107], v[88:91], v[100:103]
  v_mfma_f32_16x16x32_bf16 v[104:107], a[108:111], v[88:91], v[104:107]
  v_xor_b32 v254, s88, v221
  v_cmp_lt_u32 vcc, 31, v254
  s_cbranch_vccnz L_rdy_48
L_rret_49:
  s_waitcnt vmcnt(6)
  v_max3_u32 v254, v108, v109, v110
  v_max_u32 v254, v254, v111
  v_cmp_eq_u32 vcc, -1, v254
  s_cbranch_vccnz L_retry_45
L_ret_46:
  v_pk_add_f32 v[108:109], v[108:109], v[110:111]
  s_nop 1
  v_permlane32_swap_b32 v108, v109
  v_add_f32 v108, v108, v109
  v_mov_b32 v109, v108
  s_nop 1
  v_permlane16_swap_b32 v108, v109
  v_add_f32 v108, v108, v109
  v_mov_b32 v109, v108
  s_nop 1
  v_permlane32_swap_b32 v108, v109
  v_mul_f32 v210, 0xbb000000, v108
  v_mul_f32 v250, 0x3b000000, v109
  v_fma_f32 v250, -v210, v210, v250
  v_max_f32 v250, 0, v250
  v_add_f32 v249, 0x3727c5ac, v250
  v_rsq_f32 v208, v249
  v_mov_b32 v249, 0x3727c5ac
  v_mul_f32 v250, v250, v208
  v_fmac_f32 v249, v250, v208
  v_rsq_f32 v249, v249
  s_nop 0
  v_mul_f32 v249, v249, v208
  v_mul_f32 v206, 0xc0135761, v249
  v_mul_f32 v204, v249, v249
  v_rcp_f32 v202, v249
  v_mul_f32 v204, v204, v249
  v_mul_f32 v204, 0xbdd2d3e8, v204
  s_add_u32 s87, s64, 227328
  buffer_load_dwordx4 v213, s[32:35], s87 offen offset:2048 lds
  s_waitcnt lgkmcnt(3)
  v_pk_fma_f32 v[92:93], v[120:121], v[210:211], v[92:93] op_sel_hi:[1,0,1]
  v_pk_fma_f32 v[94:95], v[122:123], v[210:211], v[94:95] op_sel_hi:[1,0,1]
  s_waitcnt lgkmcnt(2)
  v_pk_fma_f32 v[96:97], v[124:125], v[210:211], v[96:97] op_sel_hi:[1,0,1]
  v_pk_fma_f32 v[98:99], v[126:127], v[210:211], v[98:99] op_sel_hi:[1,0,1]
  s_waitcnt lgkmcnt(1)
  v_pk_fma_f32 v[100:101], v[128:129], v[210:211], v[100:101] op_sel_hi:[1,0,1]
  v_pk_fma_f32 v[102:103], v[130:131], v[210:211], v[102:103] op_sel_hi:[1,0,1]
  s_waitcnt lgkmcnt(0)
  v_pk_fma_f32 v[104:105], v[132:133], v[210:211], v[104:105] op_sel_hi:[1,0,1]
  v_pk_fma_f32 v[106:107], v[134:135], v[210:211], v[106:107] op_sel_hi:[1,0,1]
  v_pk_mul_f32 v[108:109], v[92:93], v[92:93]
  v_pk_mul_f32 v[110:111], v[94:95], v[94:95]
  v_pk_fma_f32 v[108:109], v[108:109], v[204:205], v[206:207] op_sel_hi:[1,0,0]
  v_pk_fma_f32 v[110:111], v[110:111], v[204:205], v[206:207] op_sel_hi:[1,0,0]
  v_pk_mul_f32 v[108:109], v[108:109], v[92:93]
  v_pk_mul_f32 v[110:111], v[110:111], v[94:95]
  v_exp_f32 v108, v108
  v_exp_f32 v110, v110
  v_exp_f32 v109, v109
  v_exp_f32 v111, v111
  v_pk_fma_f32 v[108:109], v[108:109], v[202:203], v[202:203] op_sel_hi:[1,0,0]
  v_pk_fma_f32 v[110:111], v[110:111], v[202:203], v[202:203] op_sel_hi:[1,0,0]
  v_rcp_f32 v108, v108
  v_rcp_f32 v110, v110
  v_rcp_f32 v109, v109
  v_rcp_f32 v111, v111
  v_pk_mul_f32 v[108:109], v[108:109], v[92:93]
  v_pk_mul_f32 v[110:111], v[110:111], v[94:95]
  v_cvt_pk_bf16_f32 v168, v108, v109
  v_cvt_pk_bf16_f32 v169, v110, v111
  s_add_u32 s87, s64, 340992
  buffer_load_dwordx4 v213, s[32:35], s87 offen offset:3072 lds
  v_pk_mul_f32 v[108:109], v[96:97], v[96:97]
  v_pk_mul_f32 v[110:111], v[98:99], v[98:99]
  v_pk_fma_f32 v[108:109], v[108:109], v[204:205], v[206:207] op_sel_hi:[1,0,0]
  v_pk_fma_f32 v[110:111], v[110:111], v[204:205], v[206:207] op_sel_hi:[1,0,0]
  v_pk_mul_f32 v[108:109], v[108:109], v[96:97]
  v_pk_mul_f32 v[110:111], v[110:111], v[98:99]
  v_exp_f32 v108, v108
  v_exp_f32 v110, v110
  v_exp_f32 v109, v109
  v_exp_f32 v111, v111
  v_pk_fma_f32 v[108:109], v[108:109], v[202:203], v[202:203] op_sel_hi:[1,0,0]
  v_pk_fma_f32 v[110:111], v[110:111], v[202:203], v[202:203] op_sel_hi:[1,0,0]
  v_rcp_f32 v108, v108
  v_rcp_f32 v110, v110
  v_rcp_f32 v109, v109
  v_rcp_f32 v111, v111
  v_pk_mul_f32 v[108:109], v[108:109], v[96:97]
  v_pk_mul_f32 v[110:111], v[110:111], v[98:99]
  v_cvt_pk_bf16_f32 v170, v108, v109
  v_cvt_pk_bf16_f32 v171, v110, v111
  s_add_u32 m0, s67, s75
  s_add_u32 m0, m0, 65536
  s_mul_i32 s64, s67, 28
  buffer_load_dwordx4 v213, s[32:35], s64 offen lds
  v_or_b32 v168, 1, v168
  buffer_store_dwordx4 v[168:171], v215, s[16:19], s57 offen offset:0 sc1
  buffer_store_dwordx4 v[168:171], v216, s[16:19], s73 offen offset:0
  v_pk_mul_f32 v[108:109], v[100:101], v[100:101]
  v_pk_mul_f32 v[110:111], v[102:103], v[102:103]
  v_pk_fma_f32 v[108:109], v[108:109], v[204:205], v[206:207] op_sel_hi:[1,0,0]
  v_pk_fma_f32 v[110:111], v[110:111], v[204:205], v[206:207] op_sel_hi:[1,0,0]
  v_pk_mul_f32 v[108:109], v[108:109], v[100:101]
  v_pk_mul_f32 v[110:111], v[110:111], v[102:103]
  v_exp_f32 v108, v108
  v_exp_f32 v110, v110
  v_exp_f32 v109, v109
  v_exp_f32 v111, v111
  v_pk_fma_f32 v[108:109], v[108:109], v[202:203], v[202:203] op_sel_hi:[1,0,0]
  v_pk_fma_f32 v[110:111], v[110:111], v[202:203], v[202:203] op_sel_hi:[1,0,0]
  v_rcp_f32 v108, v108
  v_rcp_f32 v110, v110
  v_rcp_f32 v109, v109
  v_rcp_f32 v111, v111
  v_pk_mul_f32 v[108:109], v[108:109], v[100:101]
  v_pk_mul_f32 v[110:111], v[110:111], v[102:103]
  v_cvt_pk_bf16_f32 v172, v108, v109
  v_cvt_pk_bf16_f32 v173, v110, v111
  s_add_u32 s87, s64, 113664
  buffer_load_dwordx4 v213, s[32:35], s87 offen offset:1024 lds
  v_pk_mul_f32 v[108:109], v[104:105], v[104:105]
  v_pk_mul_f32 v[110:111], v[106:107], v[106:107]
  v_pk_fma_f32 v[108:109], v[108:109], v[204:205], v[206:207] op_sel_hi:[1,0,0]
  v_pk_fma_f32 v[110:111], v[110:111], v[204:205], v[206:207] op_sel_hi:[1,0,0]
  v_pk_mul_f32 v[108:109], v[108:109], v[104:105]
  v_pk_mul_f32 v[110:111], v[110:111], v[106:107]
  v_exp_f32 v108, v108
  v_exp_f32 v110, v110
  v_exp_f32 v109, v109
  v_exp_f32 v111, v111
  v_pk_fma_f32 v[108:109], v[108:109], v[202:203], v[202:203] op_sel_hi:[1,0,0]
  v_pk_fma_f32 v[110:111], v[110:111], v[202:203], v[202:203] op_sel_hi:[1,0,0]
  v_rcp_f32 v108, v108
  v_rcp_f32 v110, v110
  v_rcp_f32 v109, v109
  v_rcp_f32 v111, v111
  v_pk_mul_f32 v[108:109], v[108:109], v[104:105]
  v_pk_mul_f32 v[110:111], v[110:111], v[106:107]
  v_cvt_pk_bf16_f32 v174, v108, v109
  v_cvt_pk_bf16_f32 v175, v110, v111
  s_add_u32 s87, s64, 227328
  buffer_load_dwordx4 v213, s[32:35], s87 offen offset:2048 lds
  v_or_b32 v172, 1, v172
  buffer_store_dwordx4 v[172:175], v215, s[16:19], s57 offen offset:1024 sc1
  buffer_store_dwordx4 v[172:175], v216, s[16:19], s73 offen offset:1024
  s_xor_b32 s97, s58, 0
  s_add_u32 s97, s97, s60
  s_xor_b32 s96, s58, 8192
  s_add_u32 s96, s96, s60
  s_xor_b32 s77, s58, 4096
  s_add_u32 s77, s77, s60
  s_xor_b32 s76, s58, 12288
  s_add_u32 s76, s76, s60
  v_pk_add_f32 v[92:93], v[4:5], v[210:211] op_sel_hi:[1,0]
  v_pk_add_f32 v[94:95], v[6:7], v[210:211] op_sel_hi:[1,0]
  v_pk_add_f32 v[96:97], v[8:9], v[210:211] op_sel_hi:[1,0]
  v_pk_add_f32 v[98:99], v[10:11], v[210:211] op_sel_hi:[1,0]
  v_pk_add_f32 v[100:101], v[12:13], v[210:211] op_sel_hi:[1,0]
  v_pk_add_f32 v[102:103], v[14:15], v[210:211] op_sel_hi:[1,0]
  s_add_u32 s87, s64, 340992
  buffer_load_dwordx4 v213, s[32:35], s87 offen offset:3072 lds
  v_pk_add_f32 v[104:105], v[16:17], v[210:211] op_sel_hi:[1,0]
  v_pk_add_f32 v[106:107], v[18:19], v[210:211] op_sel_hi:[1,0]
  v_pk_mul_f32 v[92:93], v[92:93], v[208:209] op_sel_hi:[1,0]
  v_pk_mul_f32 v[94:95], v[94:95], v[208:209] op_sel_hi:[1,0]
L_page_5:
  s_cbranch_execz L_pageret_1
  v_pk_mul_f32 v[96:97], v[96:97], v[208:209] op_sel_hi:[1,0]
  s_add_u32 m0, s66, s75
  s_add_u32 m0, m0, 65536
  s_mul_i32 s64, s66, 28
  buffer_load_dwordx4 v213, s[32:35], s64 offen lds
  v_pk_mul_f32 v[98:99], v[98:99], v[208:209] op_sel_hi:[1,0]
  v_pk_mul_f32 v[100:101], v[100:101], v[208:209] op_sel_hi:[1,0]
  v_pk_mul_f32 v[102:103], v[102:103], v[208:209] op_sel_hi:[1,0]
  v_pk_mul_f32 v[104:105], v[104:105], v[208:209] op_sel_hi:[1,0]
  v_pk_mul_f32 v[106:107], v[106:107], v[208:209] op_sel_hi:[1,0]
  s_add_u32 s87, s64, 113664
  buffer_load_dwordx4 v213, s[32:35], s87 offen offset:1024 lds
  s_add_u32 s74, s60, s57
  s_add_u32 s74, s74, 262144
  ds_read_b64_tr_b16 a[8:9], v229 offset:0
  ds_read_b64_tr_b16 a[10:11], v229 offset:512
  ds_read_b64_tr_b16 a[12:13], v228 offset:0
  s_add_u32 s87, s64, 227328
  buffer_load_dwordx4 v213, s[32:35], s87 offen offset:2048 lds
  ds_read_b64_tr_b16 a[14:15], v228 offset:512
  ds_read_b64_tr_b16 a[16:17], v227 offset:0
  ds_read_b64_tr_b16 a[18:19], v227 offset:512
  ds_read_b64_tr_b16 a[20:21], v226 offset:0
  ds_read_b64_tr_b16 a[22:23], v226 offset:512
  s_add_u32 s87, s64, 340992
  buffer_load_dwordx4 v213, s[32:35], s87 offen offset:3072 lds
  ds_read_b64_tr_b16 a[24:25], v229 offset:1024
  ds_read_b64_tr_b16 a[26:27], v229 offset:1536
  ds_read_b64_tr_b16 a[28:29], v228 offset:1024
  ds_read_b64_tr_b16 a[30:31], v228 offset:1536
  ds_read_b64_tr_b16 a[32:33], v227 offset:1024
  ds_read_b64_tr_b16 a[34:35], v227 offset:1536
  ds_read_b64_tr_b16 a[36:37], v226 offset:1024
  ds_read_b64_tr_b16 a[38:39], v226 offset:1536
  ds_read_b64_tr_b16 a[40:41], v229 offset:2048
  ds_read_b64_tr_b16 a[42:43], v229 offset:2560
  ds_read_b64_tr_b16 a[44:45], v228 offset:2048
  ds_read_b64_tr_b16 a[46:47], v228 offset:2560
  ds_read_b64_tr_b16 a[56:57], v227 offset:2048
  ds_read_b64_tr_b16 a[58:59], v227 offset:2560
  ds_read_b64_tr_b16 a[60:61], v226 offset:2048
  ds_read_b64_tr_b16 a[62:63], v226 offset:2560
  ds_read_b64_tr_b16 a[64:65], v229 offset:3072
  ds_read_b64_tr_b16 a[66:67], v229 offset:3584
  ds_read_b64_tr_b16 a[68:69], v228 offset:3072
  ds_read_b64_tr_b16 a[70:71], v228 offset:3584
  ds_read_b64_tr_b16 a[72:73], v227 offset:3072
  ds_read_b64_tr_b16 a[74:75], v227 offset:3584
  ds_read_b64_tr_b16 a[76:77], v226 offset:3072
  ds_read_b64_tr_b16 a[78:79], v226 offset:3584
  ds_read_b64_tr_b16 a[80:81], v229 offset:32768
  ds_read_b64_tr_b16 a[82:83], v229 offset:33280
  ds_read_b64_tr_b16 a[84:85], v228 offset:32768
  ds_read_b64_tr_b16 a[86:87], v228 offset:33280
  ds_read_b64_tr_b16 a[88:89], v227 offset:32768
  ds_read_b64_tr_b16 a[90:91], v227 offset:33280
  ds_read_b64_tr_b16 a[92:93], v226 offset:32768
  ds_read_b64_tr_b16 a[94:95], v226 offset:33280
  ds_read_b64_tr_b16 a[96:97], v229 offset:33792
  ds_read_b64_tr_b16 a[98:99], v229 offset:34304
  buffer_load_dwordx4 v[28:31], v253, s[16:19], s97 offen offset:0 sc1
  ds_read_b64_tr_b16 a[100:101], v228 offset:33792
  ds_read_b64_tr_b16 a[102:103], v228 offset:34304
  ds_read_b64_tr_b16 a[104:105], v227 offset:33792
  ds_read_b64_tr_b16 a[106:107], v227 offset:34304
  ds_read_b64_tr_b16 a[108:109], v226 offset:33792
  ds_read_b64_tr_b16 a[110:111], v226 offset:34304
  buffer_load_dwordx4 v[32:35], v253, s[16:19], s97 offen offset:1024 sc1
  ds_read_b64_tr_b16 a[112:113], v229 offset:34816
  ds_read_b64_tr_b16 a[114:115], v229 offset:35328
  ds_read_b64_tr_b16 a[116:117], v228 offset:34816
  ds_read_b64_tr_b16 a[118:119], v228 offset:35328
  ds_read_b64_tr_b16 a[120:121], v227 offset:34816
  ds_read_b64_tr_b16 a[122:123], v227 offset:35328
  buffer_load_dwordx4 v[36:39], v253, s[16:19], s97 offen offset:2048 sc1
  ds_read_b64_tr_b16 a[124:125], v226 offset:34816
  ds_read_b64_tr_b16 a[126:127], v226 offset:35328
  ds_read_b64_tr_b16 a[128:129], v229 offset:35840
  ds_read_b64_tr_b16 a[130:131], v229 offset:36352
  ds_read_b64_tr_b16 a[132:133], v228 offset:35840
  ds_read_b64_tr_b16 a[134:135], v228 offset:36352
  buffer_load_dwordx4 v[40:43], v253, s[16:19], s97 offen offset:3072 sc1
  ds_read_b64_tr_b16 a[136:137], v227 offset:35840
  ds_read_b64_tr_b16 a[138:139], v227 offset:36352
  ds_read_b64_tr_b16 a[140:141], v226 offset:35840
  ds_read_b64_tr_b16 a[142:143], v226 offset:36352
  ds_read_b64_tr_b16 a[144:145], v225 offset:16384
  ds_read_b64_tr_b16 a[146:147], v225 offset:16896
  buffer_load_dwordx4 v[44:47], v253, s[16:19], s96 offen offset:0 sc1
  ds_read_b64_tr_b16 a[148:149], v224 offset:16384
  ds_read_b64_tr_b16 a[150:151], v224 offset:16896
  ds_read_b64_tr_b16 a[152:153], v223 offset:16384
  ds_read_b64_tr_b16 a[154:155], v223 offset:16896
  ds_read_b64_tr_b16 a[156:157], v222 offset:16384
  ds_read_b64_tr_b16 a[158:159], v222 offset:16896
  buffer_load_dwordx4 v[48:51], v253, s[16:19], s96 offen offset:1024 sc1
  ds_read_b64_tr_b16 a[160:161], v225 offset:17408
  ds_read_b64_tr_b16 a[162:163], v225 offset:17920
  ds_read_b64_tr_b16 a[164:165], v224 offset:17408
  ds_read_b64_tr_b16 a[166:167], v224 offset:17920
  ds_read_b64_tr_b16 a[168:169], v223 offset:17408
  ds_read_b64_tr_b16 a[170:171], v223 offset:17920
  buffer_load_dwordx4 v[52:55], v253, s[16:19], s96 offen offset:2048 sc1
  ds_read_b64_tr_b16 a[172:173], v222 offset:17408
  ds_read_b64_tr_b16 a[174:175], v222 offset:17920
  buffer_load_dwordx4 v[56:59], v253, s[16:19], s96 offen offset:3072 sc1
  v_and_b32 v250, 1, v251
  v_add_u32 v250, s62, v250
  v_lshrrev_b32 v249, 5, v0
  v_lshlrev_b32 v245, 14, v250
  v_lshl_add_u32 v245, v249, 8, v245
  v_lshl_add_u32 v245, v252, 4, v245
  v_lshlrev_b32 v241, 10, v250
  v_lshl_add_u32 v241, v249, 9, v241
  v_lshl_add_u32 v241, v252, 3, v241
  v_lshlrev_b32 v239, 4, v249
  buffer_load_dwordx4 v[60:63], v201, s[16:19], s77 offen offset:0 sc1
  v_add_u32 v239, 147712, v239
  v_bfe_u32 v250, v0, 2, 2
  v_and_b32 v249, 1, v251
  v_and_b32 v242, 2, v250
  v_xor_b32 v249, v249, v242
  s_waitcnt vmcnt(7)
  v_bitop3_b32 v254, v28, v32, 1 bitop3:0x2a
  v_cmp_ne_u32 vcc, 0, v254
  s_cbranch_vccnz L_retry_75
L_ret_76:
  s_waitcnt lgkmcnt(14)
  v_mfma_f32_16x16x32_bf16 v[92:95], a[8:11], v[28:31], v[92:95]
  ds_read_b64_tr_b16 a[8:9], v225 offset:18432
  ds_read_b64_tr_b16 a[10:11], v225 offset:18944
  buffer_load_dwordx4 v[64:67], v201, s[16:19], s77 offen offset:1024 sc1
  v_mfma_f32_16x16x32_bf16 v[96:99], a[12:15], v[28:31], v[96:99]
  ds_read_b64_tr_b16 a[12:13], v224 offset:18432
  ds_read_b64_tr_b16 a[14:15], v224 offset:18944
  v_mfma_f32_16x16x32_bf16 v[100:103], a[16:19], v[28:31], v[100:103]
  ds_read_b64_tr_b16 a[16:17], v223 offset:18432
  ds_read_b64_tr_b16 a[18:19], v223 offset:18944
  v_mfma_f32_16x16x32_bf16 v[104:107], a[20:23], v[28:31], v[104:107]
  ds_read_b64_tr_b16 a[20:21], v222 offset:18432
  ds_read_b64_tr_b16 a[22:23], v222 offset:18944
  v_mfma_f32_16x16x32_bf16 v[92:95], a[24:27], v[32:35], v[92:95]
  ds_read_b64_tr_b16 a[24:25], v225 offset:19456
  ds_read_b64_tr_b16 a[26:27], v225 offset:19968
  buffer_load_dwordx4 v[68:71], v201, s[16:19], s77 offen offset:2048 sc1
  s_waitcnt vmcnt(7)
  v_bitop3_b32 v254, v36, v40, 1 bitop3:0x2a
  v_mfma_f32_16x16x32_bf16 v[96:99], a[28:31], v[32:35], v[96:99]
  ds_read_b64_tr_b16 a[28:29], v224 offset:19456
  ds_read_b64_tr_b16 a[30:31], v224 offset:19968
  v_cmp_ne_u32 vcc, 0, v254
  v_mfma_f32_16x16x32_bf16 v[100:103], a[32:35], v[32:35], v[100:103]
  ds_read_b64_tr_b16 a[32:33], v223 offset:19456
  ds_read_b64_tr_b16 a[34:35], v223 offset:19968
  v_mfma_f32_16x16x32_bf16 v[104:107], a[36:39], v[32:35], v[104:107]
  ds_read_b64_tr_b16 a[36:37], v222 offset:19456
  ds_read_b64_tr_b16 a[38:39], v222 offset:19968
  s_cbranch_vccnz L_retry_78
L_ret_79:
  v_mfma_f32_16x16x32_bf16 v[92:95], a[40:43], v[36:39], v[92:95]
  ds_read_b64_tr_b16 a[40:41], v225 offset:49152
  ds_read_b64_tr_b16 a[42:43], v225 offset:49664
  buffer_load_dwordx4 v[72:75], v201, s[16:19], s77 offen offset:3072 sc1
  v_mfma_f32_16x16x32_bf16 v[96:99], a[44:47], v[36:39], v[96:99]
  ds_read_b64_tr_b16 a[44:45], v224 offset:49152
  ds_read_b64_tr_b16 a[46:47], v224 offset:49664
  v_mfma_f32_16x16x32_bf16 v[100:103], a[56:59], v[36:39], v[100:103]
  ds_read_b64_tr_b16 a[56:57], v223 offset:49152
  ds_read_b64_tr_b16 a[58:59], v223 offset:49664
  v_mfma_f32_16x16x32_bf16 v[104:107], a[60:63], v[36:39], v[104:107]
  ds_read_b64_tr_b16 a[60:61], v222 offset:49152
  ds_read_b64_tr_b16 a[62:63], v222 offset:49664
  v_mfma_f32_16x16x32_bf16 v[92:95], a[64:67], v[40:43], v[92:95]
  ds_read_b64_tr_b16 a[64:65], v225 offset:50176
  ds_read_b64_tr_b16 a[66:67], v225 offset:50688
  buffer_load_dwordx4 v[76:79], v200, s[16:19], s76 offen offset:0 sc1
  s_waitcnt vmcnt(7)
  v_bitop3_b32 v254, v44, v48, 1 bitop3:0x2a
  v_mfma_f32_16x16x32_bf16 v[96:99], a[68:71], v[40:43], v[96:99]
  ds_read_b64_tr_b16 a[68:69], v224 offset:50176
  ds_read_b64_tr_b16 a[70:71], v224 offset:50688
  v_cmp_ne_u32 vcc, 0, v254
  v_mfma_f32_16x16x32_bf16 v[100:103], a[72:75], v[40:43], v[100:103]
  ds_read_b64_tr_b16 a[72:73], v223 offset:50176
  ds_read_b64_tr_b16 a[74:75], v223 offset:50688
  v_mfma_f32_16x16x32_bf16 v[104:107], a[76:79], v[40:43], v[104:107]
  ds_read_b64_tr_b16 a[76:77], v222 offset:50176
  ds_read_b64_tr_b16 a[78:79], v222 offset:50688
  s_cbranch_vccnz L_retry_81
L_ret_82:
  v_mfma_f32_16x16x32_bf16 v[92:95], a[80:83], v[44:47], v[92:95]
  ds_read_b64_tr_b16 a[80:81], v225 offset:51200
  ds_read_b64_tr_b16 a[82:83], v225 offset:51712
  buffer_load_dwordx4 v[80:83], v200, s[16:19], s76 offen offset:1024 sc1
  v_mfma_f32_16x16x32_bf16 v[96:99], a[84:87], v[44:47], v[96:99]
  ds_read_b64_tr_b16 a[84:85], v224 offset:51200
  ds_read_b64_tr_b16 a[86:87], v224 offset:51712
  v_mfma_f32_16x16x32_bf16 v[100:103], a[88:91], v[44:47], v[100:103]
  ds_read_b64_tr_b16 a[88:89], v223 offset:51200
  ds_read_b64_tr_b16 a[90:91], v223 offset:51712
  v_mfma_f32_16x16x32_bf16 v[104:107], a[92:95], v[44:47], v[104:107]
  ds_read_b64_tr_b16 a[92:93], v222 offset:51200
  ds_read_b64_tr_b16 a[94:95], v222 offset:51712
  v_mfma_f32_16x16x32_bf16 v[92:95], a[96:99], v[48:51], v[92:95]
  ds_read_b64_tr_b16 a[96:97], v225 offset:52224
  ds_read_b64_tr_b16 a[98:99], v225 offset:52736
  buffer_load_dwordx4 v[84:87], v200, s[16:19], s76 offen offset:2048 sc1
  s_waitcnt vmcnt(7)
  v_bitop3_b32 v254, v52, v56, 1 bitop3:0x2a
  v_mfma_f32_16x16x32_bf16 v[96:99], a[100:103], v[48:51], v[96:99]
  ds_read_b64_tr_b16 a[100:101], v224 offset:52224
  ds_read_b64_tr_b16 a[102:103], v224 offset:52736
  v_cmp_ne_u32 vcc, 0, v254
  v_mfma_f32_16x16x32_bf16 v[100:103], a[104:107], v[48:51], v[100:103]
  ds_read_b64_tr_b16 a[104:105], v223 offset:52224
  ds_read_b64_tr_b16 a[106:107], v223 offset:52736
  v_mfma_f32_16x16x32_bf16 v[104:107], a[108:111], v[48:51], v[104:107]
  ds_read_b64_tr_b16 a[108:109], v222 offset:52224
  ds_read_b64_tr_b16 a[110:111], v222 offset:52736
  s_cbranch_vccnz L_retry_84
L_ret_85:
  v_mfma_f32_16x16x32_bf16 v[92:95], a[112:115], v[52:55], v[92:95]
  buffer_load_dwordx4 v[88:91], v200, s[16:19], s76 offen offset:3072 sc1
  s_lshl_b32 s91, s58, 2
  v_subrev_u32 v229, s91, v229
  v_lshlrev_b32 v249, 5, v249
  v_lshl_add_u32 v249, v250, 7, v249
  v_mfma_f32_16x16x32_bf16 v[96:99], a[116:119], v[52:55], v[96:99]
  v_lshrrev_b32 v250, 5, v0
  v_lshl_add_u32 v249, v250, 12, v249
  v_and_b32 v250, 3, v0
  v_mfma_f32_16x16x32_bf16 v[100:103], a[120:123], v[52:55], v[100:103]
  v_lshl_add_u32 v242, v250, 3, v249
  v_xor_b32 v235, 64, v242
  v_add_u32 v248, 65536, v242
  v_mfma_f32_16x16x32_bf16 v[104:107], a[124:127], v[52:55], v[104:107]
  v_add_u32 v247, 65536, v235
  v_bfe_u32 v221, v0, 2, 2
  v_and_b32 v220, 2, v221
  v_mfma_f32_16x16x32_bf16 v[92:95], a[128:131], v[56:59], v[92:95]
  s_waitcnt lgkmcnt(0)
  s_barrier
  s_mul_i32 s72, s71, 14336
  s_mov_b64 exec, 0x3fff
  buffer_load_dword a5, v243, s[32:35], s72 offen
  s_mov_b64 exec, -1
  v_xor_b32 v220, s95, v220
  v_lshlrev_b32 v220, 5, v220
  v_lshl_add_u32 v220, v221, 7, v220
  s_waitcnt vmcnt(7)
  v_bitop3_b32 v254, v60, v64, 1 bitop3:0x2a
  v_mfma_f32_16x16x32_bf16 v[96:99], a[132:135], v[56:59], v[96:99]
  v_lshl_add_u32 v220, v251, 12, v220
  v_and_b32 v221, 3, v0
  v_lshl_add_u32 v237, v221, 3, v220
  v_cmp_ne_u32 vcc, 0, v254
  v_mfma_f32_16x16x32_bf16 v[100:103], a[136:139], v[56:59], v[100:103]
  s_add_u32 m0, s69, s75
  s_mul_i32 s64, s69, 28
  s_add_u32 s87, s64, 128
  buffer_load_dwordx4 v213, s[32:35], s87 offen lds
  v_add_u32 v24, 65536, v237
  v_lshrrev_b32 v221, 3, v0
  v_and_b32 v220, 7, v0
  s_mov_b32 s90, 0
  v_bfe_u32 v216, v221, 1, 1
  v_mfma_f32_16x16x32_bf16 v[104:107], a[140:143], v[56:59], v[104:107]
  s_cbranch_vccnz L_retry_87
L_ret_88:
  v_mfma_f32_16x16x32_bf16 v[92:95], a[144:147], v[60:63], v[92:95]
  s_and_b32 s91, s90, 1
  s_lshl_b32 s91, s91, 1
  v_or_b32 v216, s91, v216
  v_mfma_f32_16x16x32_bf16 v[96:99], a[148:151], v[60:63], v[96:99]
  v_lshlrev_b32 v216, 1, v216
  v_xor_b32 v220, v220, v216
  v_lshlrev_b32 v220, 4, v220
  v_mfma_f32_16x16x32_bf16 v[100:103], a[152:155], v[60:63], v[100:103]
  s_add_u32 s87, s64, 113792
  buffer_load_dwordx4 v213, s[32:35], s87 offen offset:1024 lds
  v_and_b32 v217, 3, v221
  v_lshrrev_b32 v216, 2, v221
  v_lshl_add_u32 v217, v216, 3, v217
  v_mfma_f32_16x16x32_bf16 v[104:107], a[156:159], v[60:63], v[104:107]
  s_lshr_b32 s91, s90, 1
  s_lshl_b32 s91, s91, 4
  v_mfma_f32_16x16x32_bf16 v[92:95], a[160:163], v[64:67], v[92:95]
  s_and_b32 s90, s90, 1
  s_lshl_b32 s90, s90, 2
  s_add_u32 s91, s91, s90
  s_waitcnt vmcnt(7)
  v_bitop3_b32 v254, v68, v72, 1 bitop3:0x2a
  v_mfma_f32_16x16x32_bf16 v[96:99], a[164:167], v[64:67], v[96:99]
  v_add_u32 v217, s91, v217
  s_mov_b32 s91, 1024
  v_mad_u32_u24 v234, v217, s91, v220
  v_cmp_ne_u32 vcc, 0, v254
  v_mfma_f32_16x16x32_bf16 v[100:103], a[168:171], v[64:67], v[100:103]
  s_add_u32 s87, s64, 227456
  buffer_load_dwordx4 v213, s[32:35], s87 offen offset:2048 lds
  v_lshrrev_b32 v221, 3, v0
  v_and_b32 v220, 7, v0
  s_mov_b32 s90, 1
  v_bfe_u32 v216, v221, 1, 1
  s_and_b32 s91, s90, 1
  v_mfma_f32_16x16x32_bf16 v[104:107], a[172:175], v[64:67], v[104:107]
  s_cbranch_vccnz L_retry_90
L_ret_91:
  v_mfma_f32_16x16x32_bf16 v[92:95], a[8:11], v[68:71], v[92:95]
  s_lshl_b32 s91, s91, 1
  v_or_b32 v216, s91, v216
  v_lshlrev_b32 v216, 1, v216
  v_mfma_f32_16x16x32_bf16 v[96:99], a[12:15], v[68:71], v[96:99]
  v_xor_b32 v220, v220, v216
  v_lshlrev_b32 v220, 4, v220
  v_and_b32 v217, 3, v221
  v_mfma_f32_16x16x32_bf16 v[100:103], a[16:19], v[68:71], v[100:103]
  s_add_u32 s87, s64, 341120
  buffer_load_dwordx4 v213, s[32:35], s87 offen offset:3072 lds
  v_lshrrev_b32 v216, 2, v221
  v_lshl_add_u32 v217, v216, 3, v217
  s_lshr_b32 s91, s90, 1
  v_mfma_f32_16x16x32_bf16 v[104:107], a[20:23], v[68:71], v[104:107]
  s_lshl_b32 s91, s91, 4
  s_and_b32 s90, s90, 1
  v_mfma_f32_16x16x32_bf16 v[92:95], a[24:27], v[72:75], v[92:95]
  s_lshl_b32 s90, s90, 2
  s_add_u32 s91, s91, s90
  v_add_u32 v217, s91, v217
  s_waitcnt vmcnt(7)
  v_bitop3_b32 v254, v76, v80, 1 bitop3:0x2a
  v_mfma_f32_16x16x32_bf16 v[96:99], a[28:31], v[72:75], v[96:99]
  s_mov_b32 s91, 1024
  v_mad_u32_u24 v233, v217, s91, v220
  v_add_u32 v232, 14336, v234
  v_cmp_ne_u32 vcc, 0, v254
  v_mfma_f32_16x16x32_bf16 v[100:103], a[32:35], v[72:75], v[100:103]
  s_add_u32 m0, s68, s75
  s_mul_i32 s64, s68, 28
  s_add_u32 s87, s64, 128
  buffer_load_dwordx4 v213, s[32:35], s87 offen lds
  v_add_u32 v231, 13312, v233
  v_subrev_u32 v233, 1024, v233
  s_and_b32 s70, s94, 3
  s_mul_i32 s70, s70, 3
  s_add_u32 s70, s70, s95
  v_mfma_f32_16x16x32_bf16 v[104:107], a[36:39], v[72:75], v[104:107]
  s_cbranch_vccnz L_retry_93
L_ret_94:
  v_mfma_f32_16x16x32_bf16 v[92:95], a[40:43], v[76:79], v[92:95]
  s_add_u32 s70, s70, 0
  s_cmp_ge_u32 s70, 12
  s_cselect_b32 s91, 12, 0
  s_sub_u32 s70, s70, s91
  v_mfma_f32_16x16x32_bf16 v[96:99], a[44:47], v[76:79], v[96:99]
  s_lshl_b32 s70, s70, 17
  s_add_u32 s70, s70, s85
  s_and_b32 s65, s94, 3
  v_mfma_f32_16x16x32_bf16 v[100:103], a[56:59], v[76:79], v[100:103]
  s_add_u32 s87, s64, 113792
  buffer_load_dwordx4 v213, s[32:35], s87 offen offset:1024 lds
  s_mul_i32 s65, s65, 3
  s_add_u32 s65, s65, s95
  s_add_u32 s65, s65, 4
  v_mfma_f32_16x16x32_bf16 v[104:107], a[60:63], v[76:79], v[104:107]
  s_cmp_ge_u32 s65, 12
  s_cselect_b32 s91, 12, 0
  s_sub_u32 s65, s65, s91
  v_mfma_f32_16x16x32_bf16 v[92:95], a[64:67], v[80:83], v[92:95]
  s_lshl_b32 s65, s65, 17
  s_add_u32 s65, s65, s85
  s_and_b32 s56, s94, 3
  s_waitcnt vmcnt(7)
  v_bitop3_b32 v254, v84, v88, 1 bitop3:0x2a
  v_mfma_f32_16x16x32_bf16 v[96:99], a[68:71], v[80:83], v[96:99]
  s_mul_i32 s56, s56, 3
  s_add_u32 s56, s56, s95
  s_add_u32 s56, s56, 8
  v_cmp_ne_u32 vcc, 0, v254
  v_mfma_f32_16x16x32_bf16 v[100:103], a[72:75], v[80:83], v[100:103]
  s_add_u32 s87, s64, 227456
  buffer_load_dwordx4 v213, s[32:35], s87 offen offset:2048 lds
  s_cmp_ge_u32 s56, 12
  s_cselect_b32 s91, 12, 0
  s_sub_u32 s56, s56, s91
  s_lshl_b32 s56, s56, 17
  s_add_u32 s56, s56, s85
  s_lshr_b32 s55, s95, 1
  v_mfma_f32_16x16x32_bf16 v[104:107], a[76:79], v[80:83], v[104:107]
  s_cbranch_vccnz L_retry_96
L_ret_97:
  v_mfma_f32_16x16x32_bf16 v[92:95], a[80:83], v[84:87], v[92:95]
  s_lshl_b32 s55, s55, 2
  s_and_b32 s91, s95, 1
  s_add_u32 s55, s55, s91
  v_mfma_f32_16x16x32_bf16 v[96:99], a[84:87], v[84:87], v[96:99]
  s_add_u32 s55, s55, 48
  s_lshl_b32 s55, s55, 15
  s_add_u32 s55, s55, s85
  v_mfma_f32_16x16x32_bf16 v[100:103], a[88:91], v[84:87], v[100:103]
  s_add_u32 s87, s64, 341120
  buffer_load_dwordx4 v213, s[32:35], s87 offen offset:3072 lds
  s_lshl_b32 s73, s95, 12
  s_add_u32 s73, s73, 66560
  s_and_b32 s54, s94, -2
  v_mfma_f32_16x16x32_bf16 v[104:107], a[92:95], v[84:87], v[104:107]
  s_mul_i32 s54, s54, 360448
  s_add_u32 s54, s54, 358400
  v_mfma_f32_16x16x32_bf16 v[92:95], a[96:99], v[88:91], v[92:95]
  s_add_u32 m0, s67, s75
  s_mul_i32 s64, s67, 28
  s_add_u32 s87, s64, 128
  buffer_load_dwordx4 v213, s[32:35], s87 offen lds
  s_lshl_b32 s53, s92, 2
  s_add_u32 s53, s53, s95
  s_lshl_b32 s53, s53, 2
  v_mfma_f32_16x16x32_bf16 v[96:99], a[100:103], v[88:91], v[96:99]
  s_add_u32 s53, s53, s54
  v_lshlrev_b32 v250, 12, v251
  v_sub_u32 v250, v229, v250
  v_mfma_f32_16x16x32_bf16 v[100:103], a[104:107], v[88:91], v[100:103]
  v_lshl_add_u32 v250, v251, 10, v250
  v_add_u32 v229, s73, v250
  v_xor_b32 v1, 32, v229
  v_mfma_f32_16x16x32_bf16 v[104:107], a[108:111], v[88:91], v[104:107]
  v_xor_b32 v2, 64, v229
  v_xor_b32 v3, 96, v229
  s_mov_b32 s91, 0xfffefffe
  v_cvt_pk_bf16_f32 v168, v92, v93
  v_cvt_pk_bf16_f32 v169, v94, v95
  v_and_or_b32 v168, v168, s91, 1
  v_cvt_pk_bf16_f32 v170, v96, v97
  v_cvt_pk_bf16_f32 v171, v98, v99
  buffer_store_dwordx4 v[168:171], v253, s[16:19], s74 offen offset:0
  v_cvt_pk_bf16_f32 v172, v100, v101
  v_cvt_pk_bf16_f32 v173, v102, v103
  v_and_or_b32 v172, v172, s91, 1
  v_cvt_pk_bf16_f32 v174, v104, v105
  v_cvt_pk_bf16_f32 v175, v106, v107
  buffer_store_dwordx4 v[172:175], v253, s[16:19], s74 offen offset:1024
  v_pk_add_f32 v[220:221], v[92:93], v[94:95]
  v_pk_mul_f32 v[216:217], v[92:93], v[92:93]
  v_pk_fma_f32 v[216:217], v[94:95], v[94:95], v[216:217]
  v_pk_add_f32 v[220:221], v[220:221], v[96:97]
  v_pk_fma_f32 v[216:217], v[96:97], v[96:97], v[216:217]
  v_pk_add_f32 v[220:221], v[220:221], v[98:99]
  v_pk_fma_f32 v[216:217], v[98:99], v[98:99], v[216:217]
  v_pk_add_f32 v[220:221], v[220:221], v[100:101]
  v_pk_fma_f32 v[216:217], v[100:101], v[100:101], v[216:217]
  v_pk_add_f32 v[220:221], v[220:221], v[102:103]
  v_pk_fma_f32 v[216:217], v[102:103], v[102:103], v[216:217]
  v_pk_add_f32 v[220:221], v[220:221], v[104:105]
  v_pk_fma_f32 v[216:217], v[104:105], v[104:105], v[216:217]
  s_add_u32 s87, s64, 113792
  buffer_load_dwordx4 v213, s[32:35], s87 offen offset:1024 lds
  v_pk_add_f32 v[220:221], v[220:221], v[106:107]
  v_pk_fma_f32 v[216:217], v[106:107], v[106:107], v[216:217]
  v_add_f32 v220, v220, v221
  v_add_f32 v216, v216, v217
  s_add_u32 s90, s59, s85
  s_add_u32 s90, s90, 331776
  v_permlane32_swap_b32 v220, v216
  v_add_f32 v220, v220, v216
  v_mov_b32 v216, v220
  s_nop 1
  v_permlane16_swap_b32 v220, v216
  v_add_f32 v220, v220, v216
  buffer_store_dword v220, v219, s[16:19], s90 offen
  s_add_u32 s87, s64, 227456
  buffer_load_dwordx4 v213, s[32:35], s87 offen offset:2048 lds
  v_pk_add_f32 v[4:5], v[4:5], v[92:93]
  v_pk_add_f32 v[6:7], v[6:7], v[94:95]
  s_add_u32 s87, s64, 341120
  buffer_load_dwordx4 v213, s[32:35], s87 offen offset:3072 lds
  v_pk_add_f32 v[8:9], v[8:9], v[96:97]
  v_pk_add_f32 v[10:11], v[10:11], v[98:99]
  s_add_u32 m0, s66, s75
  s_mul_i32 s64, s66, 28
  s_add_u32 s87, s64, 128
  buffer_load_dwordx4 v213, s[32:35], s87 offen lds
  v_pk_add_f32 v[12:13], v[12:13], v[100:101]
  s_add_u32 s87, s64, 113792
  buffer_load_dwordx4 v213, s[32:35], s87 offen offset:1024 lds
  v_pk_add_f32 v[14:15], v[14:15], v[102:103]
  v_pk_add_f32 v[16:17], v[16:17], v[104:105]
  s_add_u32 s87, s64, 227456
  buffer_load_dwordx4 v213, s[32:35], s87 offen offset:2048 lds
  v_pk_add_f32 v[18:19], v[18:19], v[106:107]
  s_add_u32 s87, s64, 341120
  buffer_load_dwordx4 v213, s[32:35], s87 offen offset:3072 lds
  s_cmp_ge_u32 s92, 14
  s_cbranch_scc1 L_p6idle_99
  s_add_u32 s97, s63, 262144
  s_add_u32 s96, s63, 266240
  s_add_u32 s77, s63, 270336
  s_add_u32 s76, s63, 274432
  s_and_b32 s91, s94, -2
  s_add_u32 s91, s91, s95
  s_add_u32 s91, s91, 2
  s_min_u32 s91, s91, 31
  s_mul_i32 s91, s91, 360448
  s_add_u32 s91, s91, 357376
  v_and_b32 v221, 7, v0
  v_lshlrev_b32 v221, 7, v221
  v_add_u32 v221, s91, v221
  buffer_load_dword v220, v221, s[16:19], 0 offen sc1
  ds_read_b64_tr_b16 a[168:169], v24 offset:0
  ds_read_b64_tr_b16 a[170:171], v24 offset:512
  ds_read_b64_tr_b16 a[172:173], v24 offset:1024
  ds_read_b64_tr_b16 a[174:175], v24 offset:1536
  ds_read_b64_tr_b16 a[176:177], v24 offset:2048
  ds_read_b64_tr_b16 a[178:179], v24 offset:2560
  ds_read_b64_tr_b16 a[180:181], v24 offset:3072
  ds_read_b64_tr_b16 a[182:183], v24 offset:3584
  ds_read_b64_tr_b16 a[184:185], v24 offset:16384
  ds_read_b64_tr_b16 a[186:187], v24 offset:16896
  ds_read_b64_tr_b16 a[188:189], v24 offset:17408
  ds_read_b64_tr_b16 a[190:191], v24 offset:17920
  ds_read_b64_tr_b16 a[192:193], v24 offset:18432
  ds_read_b64_tr_b16 a[194:195], v24 offset:18944
  ds_read_b64_tr_b16 a[196:197], v24 offset:19456
  ds_read_b64_tr_b16 a[198:199], v24 offset:19968
  ds_read_b64_tr_b16 a[200:201], v24 offset:32768
  ds_read_b64_tr_b16 a[202:203], v24 offset:33280
  ds_read_b64_tr_b16 a[204:205], v24 offset:33792
  ds_read_b64_tr_b16 a[206:207], v24 offset:34304
  ds_read_b64_tr_b16 a[208:209], v24 offset:34816
  ds_read_b64_tr_b16 a[210:211], v24 offset:35328
  ds_read_b64_tr_b16 a[212:213], v24 offset:35840
  ds_read_b64_tr_b16 a[214:215], v24 offset:36352
  ds_read_b64_tr_b16 a[216:217], v24 offset:49152
  ds_read_b64_tr_b16 a[218:219], v24 offset:49664
  ds_read_b64_tr_b16 a[220:221], v24 offset:50176
  ds_read_b64_tr_b16 a[222:223], v24 offset:50688
  buffer_load_dwordx4 v[28:31], v245, s[16:19], s97 offen offset:0 sc1
  ds_read_b64_tr_b16 a[224:225], v24 offset:51200
  ds_read_b64_tr_b16 a[226:227], v24 offset:51712
  ds_read_b64_tr_b16 a[228:229], v24 offset:52224
  ds_read_b64_tr_b16 a[230:231], v24 offset:52736
  ds_read_b64_tr_b16 a[232:233], v248 offset:0
  ds_read_b64_tr_b16 a[234:235], v248 offset:512
  buffer_load_dwordx4 v[32:35], v245, s[16:19], s97 offen offset:512 sc1
  ds_read_b64_tr_b16 a[236:237], v247 offset:0
  ds_read_b64_tr_b16 a[238:239], v247 offset:512
  ds_read_b64_tr_b16 a[240:241], v248 offset:8192
  ds_read_b64_tr_b16 a[242:243], v248 offset:8704
  ds_read_b64_tr_b16 a[244:245], v247 offset:8192
  ds_read_b64_tr_b16 a[246:247], v247 offset:8704
  buffer_load_dwordx4 v[36:39], v245, s[16:19], s97 offen offset:1024 sc1
  ds_read_b64_tr_b16 a[248:249], v248 offset:1024
  ds_read_b64_tr_b16 a[250:251], v248 offset:1536
  s_waitcnt lgkmcnt(14)
  v_mfma_f32_16x16x32_bf16 v[204:207], a[168:171], v[20:23], 0
  v_mfma_f32_16x16x32_bf16 v[204:207], a[172:175], v[20:23], v[204:207]
  v_mfma_f32_16x16x32_bf16 v[204:207], a[176:179], v[20:23], v[204:207]
  v_mfma_f32_16x16x32_bf16 v[204:207], a[180:183], v[20:23], v[204:207]
  buffer_load_dwordx4 v[40:43], v245, s[16:19], s97 offen offset:1536 sc1
  v_mfma_f32_16x16x32_bf16 v[204:207], a[184:187], v[20:23], v[204:207]
  v_mfma_f32_16x16x32_bf16 v[204:207], a[188:191], v[20:23], v[204:207]
  v_mfma_f32_16x16x32_bf16 v[204:207], a[192:195], v[20:23], v[204:207]
  v_mfma_f32_16x16x32_bf16 v[204:207], a[196:199], v[20:23], v[204:207]
  v_mfma_f32_16x16x32_bf16 v[204:207], a[200:203], v[20:23], v[204:207]
  v_mfma_f32_16x16x32_bf16 v[204:207], a[204:207], v[20:23], v[204:207]
  buffer_load_dwordx4 v[44:47], v245, s[16:19], s97 offen offset:2048 sc1
  v_mfma_f32_16x16x32_bf16 v[204:207], a[208:211], v[20:23], v[204:207]
  v_mfma_f32_16x16x32_bf16 v[204:207], a[212:215], v[20:23], v[204:207]
  v_mfma_f32_16x16x32_bf16 v[204:207], a[216:219], v[20:23], v[204:207]
  v_mfma_f32_16x16x32_bf16 v[204:207], a[220:223], v[20:23], v[204:207]
  s_waitcnt lgkmcnt(12)
  v_mfma_f32_16x16x32_bf16 v[204:207], a[224:227], v[20:23], v[204:207]
  s_waitcnt lgkmcnt(10)
  v_mfma_f32_16x16x32_bf16 v[204:207], a[228:231], v[20:23], v[204:207]
  buffer_load_dwordx4 v[48:51], v245, s[16:19], s97 offen offset:2560 sc1
  s_mov_b64 exec, s[80:81]
  s_nop 5
  ds_write_b128 v230, v[204:207] offset:256
  s_mov_b64 exec, -1
  buffer_load_dwordx4 v[52:55], v245, s[16:19], s97 offen offset:3072 sc1
  buffer_load_dwordx4 v[56:59], v245, s[16:19], s97 offen offset:3584 sc1
  buffer_load_dwordx4 v[60:63], v245, s[16:19], s96 offen offset:0 sc1
  buffer_load_dwordx4 v[64:67], v245, s[16:19], s96 offen offset:512 sc1
  s_waitcnt vmcnt(8)
  v_bitop3_b32 v254, v28, v32, 1 bitop3:0x7e
  v_and_b32 v254, 0x10001, v254
  v_cmp_ne_u32 vcc, 0, v254
  s_cbranch_vccnz L_retry_107
L_ret_108:
  ds_read_b64_tr_b16 a[252:253], v247 offset:1024
  ds_read_b64_tr_b16 a[254:255], v247 offset:1536
  s_waitcnt lgkmcnt(11)
  v_mfma_f32_32x32x16_bf16 v[156:171], a[232:235], v[28:31], 0
  s_waitcnt lgkmcnt(9)
  buffer_load_dwordx4 v[68:71], v245, s[16:19], s96 offen offset:1024 sc1
  ds_read_b64_tr_b16 a[232:233], v248 offset:9216
  ds_read_b64_tr_b16 a[234:235], v248 offset:9728
  v_mfma_f32_32x32x16_bf16 v[172:187], a[236:239], v[28:31], 0
  s_waitcnt lgkmcnt(9)
  ds_read_b64_tr_b16 a[236:237], v247 offset:9216
  ds_read_b64_tr_b16 a[238:239], v247 offset:9728
  v_mfma_f32_32x32x16_bf16 v[156:171], a[240:243], v[32:35], v[156:171]
  buffer_load_dwordx4 v[72:75], v245, s[16:19], s96 offen offset:1536 sc1
  ds_read_b64_tr_b16 a[240:241], v248 offset:2048
  ds_read_b64_tr_b16 a[242:243], v248 offset:2560
  s_waitcnt vmcnt(8)
  v_bitop3_b32 v254, v36, v40, 1 bitop3:0x7e
L_page_6:
  s_cbranch_execz L_pageret_1
  v_and_b32 v254, 0x10001, v254
  v_cmp_ne_u32 vcc, 0, v254
  s_waitcnt lgkmcnt(11)
  v_mfma_f32_32x32x16_bf16 v[172:187], a[244:247], v[32:35], v[172:187]
  s_cbranch_vccnz L_retry_110
L_ret_111:
  ds_read_b64_tr_b16 a[244:245], v247 offset:2048
  ds_read_b64_tr_b16 a[246:247], v247 offset:2560
  s_waitcnt lgkmcnt(11)
  v_mfma_f32_32x32x16_bf16 v[156:171], a[248:251], v[36:39], v[156:171]
  s_waitcnt lgkmcnt(8)
  buffer_load_dwordx4 v[76:79], v245, s[16:19], s96 offen offset:2048 sc1
  ds_read_b64_tr_b16 a[248:249], v248 offset:10240
  ds_read_b64_tr_b16 a[250:251], v248 offset:10752
  v_mfma_f32_32x32x16_bf16 v[172:187], a[252:255], v[36:39], v[172:187]
  s_waitcnt lgkmcnt(8)
  ds_read_b64_tr_b16 a[252:253], v247 offset:10240
  ds_read_b64_tr_b16 a[254:255], v247 offset:10752
  v_mfma_f32_32x32x16_bf16 v[156:171], a[232:235], v[40:43], v[156:171]
  buffer_load_dwordx4 v[80:83], v245, s[16:19], s96 offen offset:2560 sc1
  ds_read_b64_tr_b16 a[232:233], v248 offset:3072
  ds_read_b64_tr_b16 a[234:235], v248 offset:3584
  s_waitcnt vmcnt(8)
  v_bitop3_b32 v254, v44, v48, 1 bitop3:0x7e
  v_and_b32 v254, 0x10001, v254
  v_cmp_ne_u32 vcc, 0, v254
  s_waitcnt lgkmcnt(10)
  v_mfma_f32_32x32x16_bf16 v[172:187], a[236:239], v[40:43], v[172:187]
  s_cbranch_vccnz L_retry_113
L_ret_114:
  ds_read_b64_tr_b16 a[236:237], v247 offset:3072
  ds_read_b64_tr_b16 a[238:239], v247 offset:3584
  s_waitcnt lgkmcnt(10)
  v_mfma_f32_32x32x16_bf16 v[156:171], a[240:243], v[44:47], v[156:171]
  buffer_load_dwordx4 v[84:87], v245, s[16:19], s96 offen offset:3072 sc1
  v_xor_b32 v254, s88, v220
  v_cmp_lt_u32 vcc, 31, v254
  s_cbranch_vccnz L_rdy_116
L_rret_117:
  ds_read_b64_tr_b16 a[240:241], v248 offset:11264
  ds_read_b64_tr_b16 a[242:243], v248 offset:11776
  s_waitcnt lgkmcnt(10)
  v_mfma_f32_32x32x16_bf16 v[172:187], a[244:247], v[44:47], v[172:187]
  s_waitcnt lgkmcnt(8)
  ds_read_b64_tr_b16 a[244:245], v247 offset:11264
  ds_read_b64_tr_b16 a[246:247], v247 offset:11776
  v_mfma_f32_32x32x16_bf16 v[156:171], a[248:251], v[48:51], v[156:171]
  buffer_load_dwordx4 v[88:91], v245, s[16:19], s96 offen offset:3584 sc1
  ds_read_b64_tr_b16 a[248:249], v248 offset:16384
  ds_read_b64_tr_b16 a[250:251], v248 offset:16896
  s_waitcnt vmcnt(8)
  v_bitop3_b32 v254, v52, v56, 1 bitop3:0x7e
  v_and_b32 v254, 0x10001, v254
  v_cmp_ne_u32 vcc, 0, v254
  s_waitcnt lgkmcnt(10)
  v_mfma_f32_32x32x16_bf16 v[172:187], a[252:255], v[48:51], v[172:187]
  s_cbranch_vccnz L_retry_119
L_ret_120:
  ds_read_b64_tr_b16 a[252:253], v247 offset:16384
  ds_read_b64_tr_b16 a[254:255], v247 offset:16896
  s_waitcnt lgkmcnt(10)
  v_mfma_f32_32x32x16_bf16 v[156:171], a[232:235], v[52:55], v[156:171]
  s_waitcnt lgkmcnt(8)
  buffer_load_dwordx4 v[92:95], v245, s[16:19], s77 offen offset:0 sc1
  ds_read_b64_tr_b16 a[232:233], v248 offset:24576
  ds_read_b64_tr_b16 a[234:235], v248 offset:25088
  v_mfma_f32_32x32x16_bf16 v[172:187], a[236:239], v[52:55], v[172:187]
  s_waitcnt lgkmcnt(8)
  ds_read_b64_tr_b16 a[236:237], v247 offset:24576
  ds_read_b64_tr_b16 a[238:239], v247 offset:25088
  v_mfma_f32_32x32x16_bf16 v[156:171], a[240:243], v[56:59], v[156:171]
  buffer_load_dwordx4 v[96:99], v245, s[16:19], s77 offen offset:512 sc1
  ds_read_b64_tr_b16 a[240:241], v248 offset:17408
  ds_read_b64_tr_b16 a[242:243], v248 offset:17920
  s_waitcnt vmcnt(8)
  v_bitop3_b32 v254, v60, v64, 1 bitop3:0x7e
  v_and_b32 v254, 0x10001, v254
  v_cmp_ne_u32 vcc, 0, v254
  s_waitcnt lgkmcnt(10)
  v_mfma_f32_32x32x16_bf16 v[172:187], a[244:247], v[56:59], v[172:187]
  s_cbranch_vccnz L_retry_122
L_ret_123:
  ds_read_b64_tr_b16 a[244:245], v247 offset:17408
  ds_read_b64_tr_b16 a[246:247], v247 offset:17920
  s_waitcnt lgkmcnt(10)
  v_mfma_f32_32x32x16_bf16 v[156:171], a[248:251], v[60:63], v[156:171]
  s_waitcnt lgkmcnt(8)
  buffer_load_dwordx4 v[100:103], v245, s[16:19], s77 offen offset:1024 sc1
  ds_read_b64_tr_b16 a[248:249], v248 offset:25600
  ds_read_b64_tr_b16 a[250:251], v248 offset:26112
  v_mfma_f32_32x32x16_bf16 v[172:187], a[252:255], v[60:63], v[172:187]
  s_waitcnt lgkmcnt(8)
  ds_read_b64_tr_b16 a[252:253], v247 offset:25600
  ds_read_b64_tr_b16 a[254:255], v247 offset:26112
  v_mfma_f32_32x32x16_bf16 v[156:171], a[232:235], v[64:67], v[156:171]
  buffer_load_dwordx4 v[104:107], v245, s[16:19], s77 offen offset:1536 sc1
  ds_read_b64_tr_b16 a[232:233], v248 offset:18432
  ds_read_b64_tr_b16 a[234:235], v248 offset:18944
  s_waitcnt vmcnt(8)
  v_bitop3_b32 v254, v68, v72, 1 bitop3:0x7e
  v_and_b32 v254, 0x10001, v254
  v_cmp_ne_u32 vcc, 0, v254
  s_waitcnt lgkmcnt(10)
  v_mfma_f32_32x32x16_bf16 v[172:187], a[236:239], v[64:67], v[172:187]
  s_cbranch_vccnz L_retry_125
L_ret_126:
  ds_read_b64_tr_b16 a[236:237], v247 offset:18432
  ds_read_b64_tr_b16 a[238:239], v247 offset:18944
  s_waitcnt lgkmcnt(10)
  v_mfma_f32_32x32x16_bf16 v[156:171], a[240:243], v[68:71], v[156:171]
  s_waitcnt lgkmcnt(8)
  buffer_load_dwordx4 v[108:111], v245, s[16:19], s77 offen offset:2048 sc1
  s_add_u32 s67, s63, 331776
  buffer_load_dwordx2 v[220:221], v241, s[16:19], s67 offen offset:0 sc1
  buffer_load_dwordx2 v[222:223], v241, s[16:19], s67 offen offset:128 sc1
  buffer_load_dwordx2 v[224:225], v241, s[16:19], s67 offen offset:256 sc1
  buffer_load_dwordx2 v[226:227], v241, s[16:19], s67 offen offset:384 sc1
  ds_read_b64_tr_b16 a[240:241], v248 offset:26624
  ds_read_b64_tr_b16 a[242:243], v248 offset:27136
  v_mfma_f32_32x32x16_bf16 v[172:187], a[244:247], v[68:71], v[172:187]
  s_waitcnt lgkmcnt(8)
  ds_read_b64_tr_b16 a[244:245], v247 offset:26624
  ds_read_b64_tr_b16 a[246:247], v247 offset:27136
  v_mfma_f32_32x32x16_bf16 v[156:171], a[248:251], v[72:75], v[156:171]
  buffer_load_dwordx4 v[112:115], v245, s[16:19], s77 offen offset:2560 sc1
  ds_read_b64_tr_b16 a[248:249], v248 offset:19456
  ds_read_b64_tr_b16 a[250:251], v248 offset:19968
  s_waitcnt vmcnt(12)
  v_bitop3_b32 v254, v76, v80, 1 bitop3:0x7e
  v_and_b32 v254, 0x10001, v254
  v_cmp_ne_u32 vcc, 0, v254
  s_waitcnt lgkmcnt(10)
  v_mfma_f32_32x32x16_bf16 v[172:187], a[252:255], v[72:75], v[172:187]
  s_cbranch_vccnz L_retry_128
L_ret_129:
  ds_read_b64_tr_b16 a[252:253], v247 offset:19456
  ds_read_b64_tr_b16 a[254:255], v247 offset:19968
  s_waitcnt lgkmcnt(10)
  v_mfma_f32_32x32x16_bf16 v[156:171], a[232:235], v[76:79], v[156:171]
  s_waitcnt lgkmcnt(8)
  buffer_load_dwordx4 v[116:119], v245, s[16:19], s77 offen offset:3072 sc1
  ds_read_b64_tr_b16 a[232:233], v248 offset:27648
  ds_read_b64_tr_b16 a[234:235], v248 offset:28160
  v_mfma_f32_32x32x16_bf16 v[172:187], a[236:239], v[76:79], v[172:187]
  s_waitcnt lgkmcnt(8)
  ds_read_b64_tr_b16 a[236:237], v247 offset:27648
  ds_read_b64_tr_b16 a[238:239], v247 offset:28160
  v_mfma_f32_32x32x16_bf16 v[156:171], a[240:243], v[80:83], v[156:171]
  buffer_load_dwordx4 v[120:123], v245, s[16:19], s77 offen offset:3584 sc1
  ds_read_b64_tr_b16 a[240:241], v248 offset:32768
  ds_read_b64_tr_b16 a[242:243], v248 offset:33280
  s_waitcnt vmcnt(12)
  v_bitop3_b32 v254, v84, v88, 1 bitop3:0x7e
  v_and_b32 v254, 0x10001, v254
  v_cmp_ne_u32 vcc, 0, v254
  s_waitcnt lgkmcnt(10)
  v_mfma_f32_32x32x16_bf16 v[172:187], a[244:247], v[80:83], v[172:187]
  s_cbranch_vccnz L_retry_131
L_ret_132:
  s_barrier
  ds_read_b64_tr_b16 a[244:245], v247 offset:32768
  ds_read_b64_tr_b16 a[246:247], v247 offset:33280
  s_waitcnt lgkmcnt(10)
  v_mfma_f32_32x32x16_bf16 v[156:171], a[248:251], v[84:87], v[156:171]
  s_waitcnt lgkmcnt(8)
  buffer_load_dwordx4 v[124:127], v245, s[16:19], s76 offen offset:0 sc1
  ds_read_b64_tr_b16 a[168:169], v237 offset:0
  ds_read_b64_tr_b16 a[170:171], v237 offset:512
  ds_read_b64_tr_b16 a[172:173], v237 offset:1024
  ds_read_b64_tr_b16 a[174:175], v237 offset:1536
  ds_read_b64_tr_b16 a[248:249], v248 offset:40960
  ds_read_b64_tr_b16 a[250:251], v248 offset:41472
  v_mfma_f32_32x32x16_bf16 v[172:187], a[252:255], v[84:87], v[172:187]
  s_waitcnt lgkmcnt(12)
  ds_read_b64_tr_b16 a[252:253], v247 offset:40960
  ds_read_b64_tr_b16 a[254:255], v247 offset:41472
  v_mfma_f32_32x32x16_bf16 v[156:171], a[232:235], v[88:91], v[156:171]
  buffer_load_dwordx4 v[128:131], v245, s[16:19], s76 offen offset:512 sc1
  ds_read_b64_tr_b16 a[176:177], v237 offset:2048
  ds_read_b64_tr_b16 a[178:179], v237 offset:2560
  ds_read_b64_tr_b16 a[180:181], v237 offset:3072
  ds_read_b64_tr_b16 a[182:183], v237 offset:3584
  ds_read_b64_tr_b16 a[232:233], v248 offset:33792
  ds_read_b64_tr_b16 a[234:235], v248 offset:34304
  s_waitcnt vmcnt(12)
  v_bitop3_b32 v254, v92, v96, 1 bitop3:0x7e
  v_and_b32 v254, 0x10001, v254
  v_cmp_ne_u32 vcc, 0, v254
  s_waitcnt lgkmcnt(14)
  v_mfma_f32_32x32x16_bf16 v[172:187], a[236:239], v[88:91], v[172:187]
  s_cbranch_vccnz L_retry_134
L_ret_135:
  ds_read_b64_tr_b16 a[236:237], v247 offset:33792
  ds_read_b64_tr_b16 a[238:239], v247 offset:34304
  v_mfma_f32_32x32x16_bf16 v[156:171], a[240:243], v[92:95], v[156:171]
  buffer_load_dwordx4 v[132:135], v245, s[16:19], s76 offen offset:1024 sc1
  ds_read_b64_tr_b16 a[184:185], v237 offset:16384
  ds_read_b64_tr_b16 a[186:187], v237 offset:16896
  ds_read_b64_tr_b16 a[188:189], v237 offset:17408
  ds_read_b64_tr_b16 a[190:191], v237 offset:17920
  ds_read_b64_tr_b16 a[240:241], v248 offset:41984
  ds_read_b64_tr_b16 a[242:243], v248 offset:42496
  v_mfma_f32_32x32x16_bf16 v[172:187], a[244:247], v[92:95], v[172:187]
  s_waitcnt lgkmcnt(14)
  v_mfma_f32_16x16x32_bf16 v[204:207], a[168:171], v[20:23], 0
  v_mfma_f32_16x16x32_bf16 v[204:207], a[172:175], v[20:23], v[204:207]
  ds_read_b64_tr_b16 a[244:245], v247 offset:41984
  ds_read_b64_tr_b16 a[246:247], v247 offset:42496
  v_mfma_f32_32x32x16_bf16 v[156:171], a[248:251], v[96:99], v[156:171]
  buffer_load_dwordx4 v[136:139], v245, s[16:19], s76 offen offset:1536 sc1
  ds_read_b64_tr_b16 a[192:193], v237 offset:18432
  ds_read_b64_tr_b16 a[194:195], v237 offset:18944
  ds_read_b64_tr_b16 a[196:197], v237 offset:19456
  ds_read_b64_tr_b16 a[198:199], v237 offset:19968
  ds_read_b64_tr_b16 a[248:249], v248 offset:34816
  ds_read_b64_tr_b16 a[250:251], v248 offset:35328
  s_waitcnt vmcnt(12)
  v_bitop3_b32 v254, v100, v104, 1 bitop3:0x7e
  v_and_b32 v254, 0x10001, v254
  v_cmp_ne_u32 vcc, 0, v254
  v_mfma_f32_32x32x16_bf16 v[172:187], a[252:255], v[96:99], v[172:187]
  s_cbranch_vccnz L_retry_137
L_ret_138:
  s_waitcnt lgkmcnt(14)
  v_mfma_f32_16x16x32_bf16 v[204:207], a[176:179], v[20:23], v[204:207]
  ds_read_b64_tr_b16 a[252:253], v247 offset:34816
  ds_read_b64_tr_b16 a[254:255], v247 offset:35328
  v_mfma_f32_32x32x16_bf16 v[156:171], a[232:235], v[100:103], v[156:171]
  buffer_load_dwordx4 v[140:143], v245, s[16:19], s76 offen offset:2048 sc1
  ds_read_b64_tr_b16 a[200:201], v237 offset:32768
  ds_read_b64_tr_b16 a[202:203], v237 offset:33280
  ds_read_b64_tr_b16 a[204:205], v237 offset:33792
  ds_read_b64_tr_b16 a[206:207], v237 offset:34304
  ds_read_b64_tr_b16 a[232:233], v248 offset:43008
  ds_read_b64_tr_b16 a[234:235], v248 offset:43520
  v_mfma_f32_32x32x16_bf16 v[172:187], a[236:239], v[100:103], v[172:187]
  v_mfma_f32_16x16x32_bf16 v[204:207], a[180:183], v[20:23], v[204:207]
  s_waitcnt lgkmcnt(12)
  ds_read_b64_tr_b16 a[236:237], v247 offset:43008
  ds_read_b64_tr_b16 a[238:239], v247 offset:43520
  v_mfma_f32_32x32x16_bf16 v[156:171], a[240:243], v[104:107], v[156:171]
  buffer_load_dwordx4 v[144:147], v245, s[16:19], s76 offen offset:2560 sc1
  ds_read_b64_tr_b16 a[208:209], v237 offset:34816
  ds_read_b64_tr_b16 a[210:211], v237 offset:35328
  ds_read_b64_tr_b16 a[212:213], v237 offset:35840
  ds_read_b64_tr_b16 a[214:215], v237 offset:36352
  ds_read_b64_tr_b16 a[240:241], v248 offset:35840
  ds_read_b64_tr_b16 a[242:243], v248 offset:36352
  s_waitcnt vmcnt(8)
  v_bitop3_b32 v254, v108, v112, 1 bitop3:0x7e
  v_and_b32 v254, 0x10001, v254
  v_cmp_ne_u32 vcc, 0, v254
  v_mfma_f32_32x32x16_bf16 v[172:187], a[244:247], v[104:107], v[172:187]
  s_cbranch_vccnz L_retry_140
L_ret_141:
  v_mfma_f32_16x16x32_bf16 v[204:207], a[184:187], v[20:23], v[204:207]
  s_waitcnt lgkmcnt(12)
  ds_read_b64_tr_b16 a[244:245], v247 offset:35840
  ds_read_b64_tr_b16 a[246:247], v247 offset:36352
  v_mfma_f32_32x32x16_bf16 v[156:171], a[248:251], v[108:111], v[156:171]
  buffer_load_dwordx4 v[148:151], v245, s[16:19], s76 offen offset:3072 sc1
  ds_read_b64_tr_b16 a[216:217], v237 offset:49152
  ds_read_b64_tr_b16 a[218:219], v237 offset:49664
  ds_read_b64_tr_b16 a[220:221], v237 offset:50176
  ds_read_b64_tr_b16 a[222:223], v237 offset:50688
  ds_read_b64_tr_b16 a[248:249], v248 offset:44032
  ds_read_b64_tr_b16 a[250:251], v248 offset:44544
  v_mfma_f32_32x32x16_bf16 v[172:187], a[252:255], v[108:111], v[172:187]
  v_mfma_f32_16x16x32_bf16 v[204:207], a[188:191], v[20:23], v[204:207]
  s_waitcnt lgkmcnt(12)
  ds_read_b64_tr_b16 a[252:253], v247 offset:44032
  ds_read_b64_tr_b16 a[254:255], v247 offset:44544
  v_mfma_f32_32x32x16_bf16 v[156:171], a[232:235], v[112:115], v[156:171]
  buffer_load_dwordx4 v[152:155], v245, s[16:19], s76 offen offset:3584 sc1
  ds_read_b64_tr_b16 a[224:225], v237 offset:51200
  ds_read_b64_tr_b16 a[226:227], v237 offset:51712
  ds_read_b64_tr_b16 a[228:229], v237 offset:52224
  ds_read_b64_tr_b16 a[230:231], v237 offset:52736
  ds_read_b64_tr_b16 a[232:233], v248 offset:49152
  ds_read_b64_tr_b16 a[234:235], v248 offset:49664
  s_waitcnt vmcnt(8)
  v_bitop3_b32 v254, v116, v120, 1 bitop3:0x7e
  v_and_b32 v254, 0x10001, v254
  v_cmp_ne_u32 vcc, 0, v254
  v_mfma_f32_32x32x16_bf16 v[172:187], a[236:239], v[112:115], v[172:187]
  s_cbranch_vccnz L_retry_143
L_ret_144:
  v_mfma_f32_16x16x32_bf16 v[204:207], a[192:195], v[20:23], v[204:207]
  s_waitcnt lgkmcnt(12)
  ds_read_b64_tr_b16 a[236:237], v247 offset:49152
  ds_read_b64_tr_b16 a[238:239], v247 offset:49664
  v_mfma_f32_32x32x16_bf16 v[156:171], a[240:243], v[116:119], v[156:171]
  s_mul_i32 s72, s71, 14336
  s_mov_b64 exec, 0x3fff
  buffer_load_dword a5, v243, s[36:39], s72 offen
  s_mov_b64 exec, -1
  v_max3_u32 v254, v220, v221, v222
  v_max3_u32 v254, v254, v223, v224
  v_max3_u32 v254, v254, v225, v226
  v_max_u32 v254, v254, v227
  v_cmp_eq_u32 vcc, -1, v254
  s_cbranch_vccnz L_retry_104
L_ret_105:
  ds_read_b64_tr_b16 a[240:241], v248 offset:57344
  ds_read_b64_tr_b16 a[242:243], v248 offset:57856
  v_mfma_f32_32x32x16_bf16 v[172:187], a[244:247], v[116:119], v[172:187]
  v_mfma_f32_16x16x32_bf16 v[204:207], a[196:199], v[20:23], v[204:207]
  s_waitcnt lgkmcnt(12)
  ds_read_b64_tr_b16 a[244:245], v247 offset:57344
  ds_read_b64_tr_b16 a[246:247], v247 offset:57856
  v_mfma_f32_32x32x16_bf16 v[156:171], a[248:251], v[120:123], v[156:171]
  ds_read_b64_tr_b16 a[248:249], v248 offset:50176
  ds_read_b64_tr_b16 a[250:251], v248 offset:50688
  s_waitcnt vmcnt(7)
  v_bitop3_b32 v254, v124, v128, 1 bitop3:0x7e
  v_and_b32 v254, 0x10001, v254
  v_cmp_ne_u32 vcc, 0, v254
  s_waitcnt lgkmcnt(14)
  v_mfma_f32_32x32x16_bf16 v[172:187], a[252:255], v[120:123], v[172:187]
  s_cbranch_vccnz L_retry_146
L_ret_147:
  v_mfma_f32_16x16x32_bf16 v[204:207], a[200:203], v[20:23], v[204:207]
  s_waitcnt lgkmcnt(8)
  ds_read_b64_tr_b16 a[252:253], v247 offset:50176
  ds_read_b64_tr_b16 a[254:255], v247 offset:50688
  v_mfma_f32_32x32x16_bf16 v[156:171], a[232:235], v[124:127], v[156:171]
  s_waitcnt lgkmcnt(8)
  ds_read_b64_tr_b16 a[232:233], v248 offset:58368
  ds_read_b64_tr_b16 a[234:235], v248 offset:58880
  v_add_f32 v220, v220, v222
  v_add_f32 v221, v221, v223
  v_add_f32 v224, v224, v226
  v_add_f32 v225, v225, v227
  v_add_f32 v220, v220, v224
  v_add_f32 v221, v221, v225
  v_mov_b32 v222, v220
  v_mfma_f32_32x32x16_bf16 v[172:187], a[236:239], v[124:127], v[172:187]
  v_mfma_f32_16x16x32_bf16 v[204:207], a[204:207], v[20:23], v[204:207]
  s_waitcnt lgkmcnt(8)
  ds_read_b64_tr_b16 a[236:237], v247 offset:58368
  ds_read_b64_tr_b16 a[238:239], v247 offset:58880
  v_mfma_f32_32x32x16_bf16 v[156:171], a[240:243], v[128:131], v[156:171]
  ds_read_b64_tr_b16 a[240:241], v248 offset:51200
  ds_read_b64_tr_b16 a[242:243], v248 offset:51712
  s_waitcnt vmcnt(5)
  v_bitop3_b32 v254, v132, v136, 1 bitop3:0x7e
  v_and_b32 v254, 0x10001, v254
  v_cmp_ne_u32 vcc, 0, v254
  s_waitcnt lgkmcnt(10)
  v_mfma_f32_32x32x16_bf16 v[172:187], a[244:247], v[128:131], v[172:187]
  s_cbranch_vccnz L_retry_149
L_ret_150:
  v_mfma_f32_16x16x32_bf16 v[204:207], a[208:211], v[20:23], v[204:207]
  s_waitcnt lgkmcnt(8)
  ds_read_b64_tr_b16 a[244:245], v247 offset:51200
  ds_read_b64_tr_b16 a[246:247], v247 offset:51712
  v_mfma_f32_32x32x16_bf16 v[156:171], a[248:251], v[132:135], v[156:171]
  s_waitcnt lgkmcnt(8)
  ds_read_b64_tr_b16 a[248:249], v248 offset:59392
  ds_read_b64_tr_b16 a[250:251], v248 offset:59904
  v_mov_b32 v223, v221
  v_permlane32_swap_b32 v220, v222
  s_nop 0
  v_permlane32_swap_b32 v221, v223
  v_add_f32 v220, v220, v222
  v_add_f32 v221, v221, v223
  v_mul_f32 v244, 0xbb000000, v220
  v_mul_f32 v250, 0x3b000000, v221
  v_mfma_f32_32x32x16_bf16 v[172:187], a[252:255], v[132:135], v[172:187]
  v_mfma_f32_16x16x32_bf16 v[204:207], a[212:215], v[20:23], v[204:207]
  s_waitcnt lgkmcnt(8)
  ds_read_b64_tr_b16 a[252:253], v247 offset:59392
  ds_read_b64_tr_b16 a[254:255], v247 offset:59904
  v_mfma_f32_32x32x16_bf16 v[156:171], a[232:235], v[136:139], v[156:171]
  ds_read_b64_tr_b16 a[232:233], v248 offset:52224
  ds_read_b64_tr_b16 a[234:235], v248 offset:52736
  s_waitcnt vmcnt(3)
  v_bitop3_b32 v254, v140, v144, 1 bitop3:0x7e
  v_and_b32 v254, 0x10001, v254
  v_cmp_ne_u32 vcc, 0, v254
  s_waitcnt lgkmcnt(10)
  v_mfma_f32_32x32x16_bf16 v[172:187], a[236:239], v[136:139], v[172:187]
  s_cbranch_vccnz L_retry_152
L_ret_153:
  v_mfma_f32_16x16x32_bf16 v[204:207], a[216:219], v[20:23], v[204:207]
  s_waitcnt lgkmcnt(8)
  ds_read_b64_tr_b16 a[236:237], v247 offset:52224
  ds_read_b64_tr_b16 a[238:239], v247 offset:52736
  v_mfma_f32_32x32x16_bf16 v[156:171], a[240:243], v[140:143], v[156:171]
  s_waitcnt lgkmcnt(8)
  ds_read_b64_tr_b16 a[240:241], v248 offset:60416
  ds_read_b64_tr_b16 a[242:243], v248 offset:60928
  v_fma_f32 v250, -v244, v244, v250
  v_max_f32 v250, 0, v250
  v_add_f32 v250, 0x3727c5ac, v250
  v_rsq_f32 v250, v250
  s_nop 0
  v_mul_f32 v240, 0xc0135761, v250
  v_mul_f32 v238, v250, v250
  v_mfma_f32_32x32x16_bf16 v[172:187], a[244:247], v[140:143], v[172:187]
  v_mfma_f32_16x16x32_bf16 v[204:207], a[220:223], v[20:23], v[204:207]
  s_waitcnt lgkmcnt(8)
  ds_read_b64_tr_b16 a[244:245], v247 offset:60416
  ds_read_b64_tr_b16 a[246:247], v247 offset:60928
  v_mfma_f32_32x32x16_bf16 v[156:171], a[248:251], v[144:147], v[156:171]
  ds_read_b64_tr_b16 a[248:249], v242 offset:0
  ds_read_b64_tr_b16 a[250:251], v242 offset:512
  s_waitcnt vmcnt(1)
  v_bitop3_b32 v254, v148, v152, 1 bitop3:0x7e
  v_and_b32 v254, 0x10001, v254
  v_cmp_ne_u32 vcc, 0, v254
  s_waitcnt lgkmcnt(10)
  v_mfma_f32_32x32x16_bf16 v[172:187], a[252:255], v[144:147], v[172:187]
  s_cbranch_vccnz L_retry_155
L_ret_156:
  v_mfma_f32_16x16x32_bf16 v[204:207], a[224:227], v[20:23], v[204:207]
  s_waitcnt lgkmcnt(8)
  ds_read_b64_tr_b16 a[252:253], v242 offset:8192
  ds_read_b64_tr_b16 a[254:255], v242 offset:8704
  v_mfma_f32_32x32x16_bf16 v[156:171], a[232:235], v[148:151], v[156:171]
  s_waitcnt lgkmcnt(8)
  ds_read_b128 v[220:223], v239 offset:0
  ds_read_b128 v[224:227], v239 offset:32
  ds_read_b64_tr_b16 a[232:233], v242 offset:1024
  ds_read_b64_tr_b16 a[234:235], v242 offset:1536
  v_rcp_f32 v236, v250
  v_mul_f32 v238, v238, v250
  v_mul_f32 v238, 0xbdd2d3e8, v238
  v_accvgpr_read_b32 v241, a4
  v_mfma_f32_32x32x16_bf16 v[172:187], a[236:239], v[148:151], v[172:187]
  v_mfma_f32_16x16x32_bf16 v[204:207], a[228:231], v[20:23], v[204:207]
  s_waitcnt lgkmcnt(10)
  ds_read_b64_tr_b16 a[236:237], v242 offset:9216
  ds_read_b64_tr_b16 a[238:239], v242 offset:9728
  v_mfma_f32_32x32x16_bf16 v[156:171], a[240:243], v[152:155], v[156:171]
  s_waitcnt lgkmcnt(10)
  ds_read_b64_tr_b16 a[240:241], v242 offset:2048
  ds_read_b64_tr_b16 a[242:243], v242 offset:2560
  v_mfma_f32_32x32x16_bf16 v[172:187], a[244:247], v[152:155], v[172:187]
  s_mov_b64 exec, s[80:81]
  ds_write_b128 v230, v[204:207] offset:512
  s_mov_b64 exec, -1
  s_waitcnt lgkmcnt(0)
  s_barrier
  s_nop 2
  v_pk_fma_f32 v[156:157], v[220:221], v[244:245], v[156:157] op_sel_hi:[1,0,1]
  v_pk_fma_f32 v[158:159], v[222:223], v[244:245], v[158:159] op_sel_hi:[1,0,1]
  v_pk_fma_f32 v[160:161], v[224:225], v[244:245], v[160:161] op_sel_hi:[1,0,1]
  v_pk_fma_f32 v[162:163], v[226:227], v[244:245], v[162:163] op_sel_hi:[1,0,1]
  ds_read_b128 v[220:223], v239 offset:64
  ds_read_b128 v[224:227], v239 offset:96
  s_add_u32 m0, s73, 64512
  s_add_u32 s87, s70, 0
  buffer_load_dwordx4 v234, s[36:39], s87 offen lds
  v_pk_mul_f32 v[24:25], v[156:157], v[156:157]
  v_pk_mul_f32 v[26:27], v[158:159], v[158:159]
  v_pk_fma_f32 v[24:25], v[24:25], v[238:239], v[240:241] op_sel_hi:[1,0,0]
  v_pk_fma_f32 v[26:27], v[26:27], v[238:239], v[240:241] op_sel_hi:[1,0,0]
  v_pk_mul_f32 v[24:25], v[24:25], v[156:157]
  v_pk_mul_f32 v[26:27], v[26:27], v[158:159]
  v_mfma_f32_32x32x16_bf16 v[188:203], a[248:251], v[28:31], 0
  ds_read_b64_tr_b16 a[244:245], v242 offset:10240
  ds_read_b64_tr_b16 a[246:247], v242 offset:10752
  buffer_load_dwordx4 v233, s[36:39], s87 offen offset:1024 lds
  v_exp_f32 v24, v24
  v_exp_f32 v26, v26
  v_exp_f32 v25, v25
  v_exp_f32 v27, v27
  v_pk_fma_f32 v[24:25], v[24:25], v[236:237], v[236:237] op_sel_hi:[1,0,0]
  v_pk_fma_f32 v[26:27], v[26:27], v[236:237], v[236:237] op_sel_hi:[1,0,0]
  v_mfma_f32_32x32x16_bf16 v[188:203], a[252:255], v[32:35], v[188:203]
  ds_read_b64_tr_b16 a[248:249], v242 offset:3072
  ds_read_b64_tr_b16 a[250:251], v242 offset:3584
  buffer_load_dwordx4 v232, s[36:39], s87 offen offset:2048 lds
  v_rcp_f32 v24, v24
  v_rcp_f32 v26, v26
  v_rcp_f32 v25, v25
  v_rcp_f32 v27, v27
  v_pk_mul_f32 v[24:25], v[24:25], v[156:157]
  v_pk_mul_f32 v[26:27], v[26:27], v[158:159]
  v_cvt_pk_bf16_f32 v156, v24, v25
  v_cvt_pk_bf16_f32 v157, v26, v27
  v_pk_mul_f32 v[24:25], v[160:161], v[160:161]
  v_pk_mul_f32 v[26:27], v[162:163], v[162:163]
  v_pk_fma_f32 v[24:25], v[24:25], v[238:239], v[240:241] op_sel_hi:[1,0,0]
  v_pk_fma_f32 v[26:27], v[26:27], v[238:239], v[240:241] op_sel_hi:[1,0,0]
  v_pk_mul_f32 v[24:25], v[24:25], v[160:161]
  v_pk_mul_f32 v[26:27], v[26:27], v[162:163]
  v_mfma_f32_32x32x16_bf16 v[188:203], a[232:235], v[36:39], v[188:203]
  ds_read_b64_tr_b16 a[252:253], v242 offset:11264
  buffer_load_dwordx4 v231, s[36:39], s87 offen offset:3072 lds
  ds_read_b64_tr_b16 a[254:255], v242 offset:11776
  v_exp_f32 v24, v24
  v_exp_f32 v26, v26
  v_exp_f32 v25, v25
  v_exp_f32 v27, v27
  v_pk_fma_f32 v[24:25], v[24:25], v[236:237], v[236:237] op_sel_hi:[1,0,0]
  v_pk_fma_f32 v[26:27], v[26:27], v[236:237], v[236:237] op_sel_hi:[1,0,0]
  v_mfma_f32_32x32x16_bf16 v[188:203], a[236:239], v[40:43], v[188:203]
  ds_read_b64_tr_b16 a[232:233], v242 offset:16384
  ds_read_b64_tr_b16 a[234:235], v242 offset:16896
  s_add_u32 m0, s73, 0
  s_add_u32 s87, s65, 0
  buffer_load_dwordx4 v234, s[36:39], s87 offen lds
  v_rcp_f32 v24, v24
  v_rcp_f32 v26, v26
  v_rcp_f32 v25, v25
  v_rcp_f32 v27, v27
  v_pk_mul_f32 v[24:25], v[24:25], v[160:161]
  v_pk_mul_f32 v[26:27], v[26:27], v[162:163]
  v_cvt_pk_bf16_f32 v158, v24, v25
  v_cvt_pk_bf16_f32 v159, v26, v27
  buffer_store_dwordx4 v[156:159], v241, s[16:19], s61 offen offset:0
  buffer_load_dwordx4 v233, s[36:39], s87 offen offset:1024 lds
  s_waitcnt lgkmcnt(9)
  v_pk_fma_f32 v[164:165], v[220:221], v[244:245], v[164:165] op_sel_hi:[1,0,1]
  v_pk_fma_f32 v[166:167], v[222:223], v[244:245], v[166:167] op_sel_hi:[1,0,1]
  s_waitcnt lgkmcnt(8)
  v_pk_fma_f32 v[168:169], v[224:225], v[244:245], v[168:169] op_sel_hi:[1,0,1]
  v_pk_fma_f32 v[170:171], v[226:227], v[244:245], v[170:171] op_sel_hi:[1,0,1]
  ds_read_b128 v[220:223], v239 offset:128
  ds_read_b128 v[224:227], v239 offset:160
  buffer_load_dwordx4 v232, s[36:39], s87 offen offset:2048 lds
  v_pk_mul_f32 v[24:25], v[164:165], v[164:165]
  v_pk_mul_f32 v[26:27], v[166:167], v[166:167]
  v_pk_fma_f32 v[24:25], v[24:25], v[238:239], v[240:241] op_sel_hi:[1,0,0]
  v_pk_fma_f32 v[26:27], v[26:27], v[238:239], v[240:241] op_sel_hi:[1,0,0]
  v_pk_mul_f32 v[24:25], v[24:25], v[164:165]
  v_pk_mul_f32 v[26:27], v[26:27], v[166:167]
  v_mfma_f32_32x32x16_bf16 v[188:203], a[240:243], v[44:47], v[188:203]
  s_waitcnt lgkmcnt(8)
  ds_read_b64_tr_b16 a[236:237], v242 offset:24576
  ds_read_b64_tr_b16 a[238:239], v242 offset:25088
  buffer_load_dwordx4 v231, s[36:39], s87 offen offset:3072 lds
  v_exp_f32 v24, v24
  v_exp_f32 v26, v26
  v_exp_f32 v25, v25
  v_exp_f32 v27, v27
  v_pk_fma_f32 v[24:25], v[24:25], v[236:237], v[236:237] op_sel_hi:[1,0,0]
  v_pk_fma_f32 v[26:27], v[26:27], v[236:237], v[236:237] op_sel_hi:[1,0,0]
  v_mfma_f32_32x32x16_bf16 v[188:203], a[244:247], v[48:51], v[188:203]
  ds_read_b64_tr_b16 a[240:241], v242 offset:17408
  ds_read_b64_tr_b16 a[242:243], v242 offset:17920
  s_add_u32 m0, s73, 16384
  s_add_u32 s87, s56, 0
  buffer_load_dwordx4 v234, s[36:39], s87 offen lds
  v_rcp_f32 v24, v24
  v_rcp_f32 v26, v26
  v_rcp_f32 v25, v25
  v_rcp_f32 v27, v27
  v_pk_mul_f32 v[24:25], v[24:25], v[164:165]
  v_pk_mul_f32 v[26:27], v[26:27], v[166:167]
  v_cvt_pk_bf16_f32 v164, v24, v25
  v_cvt_pk_bf16_f32 v165, v26, v27
  v_pk_mul_f32 v[24:25], v[168:169], v[168:169]
  v_pk_mul_f32 v[26:27], v[170:171], v[170:171]
  v_pk_fma_f32 v[24:25], v[24:25], v[238:239], v[240:241] op_sel_hi:[1,0,0]
  v_pk_fma_f32 v[26:27], v[26:27], v[238:239], v[240:241] op_sel_hi:[1,0,0]
  v_pk_mul_f32 v[24:25], v[24:25], v[168:169]
  v_pk_mul_f32 v[26:27], v[26:27], v[170:171]
  s_waitcnt lgkmcnt(10)
  v_mfma_f32_32x32x16_bf16 v[188:203], a[248:251], v[52:55], v[188:203]
  s_waitcnt lgkmcnt(8)
  ds_read_b64_tr_b16 a[244:245], v242 offset:25600
  buffer_load_dwordx4 v233, s[36:39], s87 offen offset:1024 lds
  ds_read_b64_tr_b16 a[246:247], v242 offset:26112
  v_exp_f32 v24, v24
  v_exp_f32 v26, v26
  v_exp_f32 v25, v25
  v_exp_f32 v27, v27
  v_pk_fma_f32 v[24:25], v[24:25], v[236:237], v[236:237] op_sel_hi:[1,0,0]
  v_pk_fma_f32 v[26:27], v[26:27], v[236:237], v[236:237] op_sel_hi:[1,0,0]
  v_mfma_f32_32x32x16_bf16 v[188:203], a[252:255], v[56:59], v[188:203]
  ds_read_b64_tr_b16 a[248:249], v242 offset:18432
  ds_read_b64_tr_b16 a[250:251], v242 offset:18944
  buffer_load_dwordx4 v232, s[36:39], s87 offen offset:2048 lds
  v_rcp_f32 v24, v24
  v_rcp_f32 v26, v26
  v_rcp_f32 v25, v25
  v_rcp_f32 v27, v27
  v_pk_mul_f32 v[24:25], v[24:25], v[168:169]
  v_pk_mul_f32 v[26:27], v[26:27], v[170:171]
  v_cvt_pk_bf16_f32 v166, v24, v25
  v_cvt_pk_bf16_f32 v167, v26, v27
  buffer_store_dwordx4 v[164:167], v241, s[16:19], s61 offen offset:512
  buffer_load_dwordx4 v231, s[36:39], s87 offen offset:3072 lds
  s_waitcnt lgkmcnt(9)
  v_pk_fma_f32 v[172:173], v[220:221], v[244:245], v[172:173] op_sel_hi:[1,0,1]
  v_pk_fma_f32 v[174:175], v[222:223], v[244:245], v[174:175] op_sel_hi:[1,0,1]
  s_waitcnt lgkmcnt(8)
  v_pk_fma_f32 v[176:177], v[224:225], v[244:245], v[176:177] op_sel_hi:[1,0,1]
  v_pk_fma_f32 v[178:179], v[226:227], v[244:245], v[178:179] op_sel_hi:[1,0,1]
  ds_read_b128 v[220:223], v239 offset:192
  ds_read_b128 v[224:227], v239 offset:224
  s_add_u32 m0, s73, 32768
  s_add_u32 s87, s70, 32768
  buffer_load_dwordx4 v234, s[36:39], s87 offen lds
  v_pk_mul_f32 v[24:25], v[172:173], v[172:173]
  v_pk_mul_f32 v[26:27], v[174:175], v[174:175]
  v_pk_fma_f32 v[24:25], v[24:25], v[238:239], v[240:241] op_sel_hi:[1,0,0]
  v_pk_fma_f32 v[26:27], v[26:27], v[238:239], v[240:241] op_sel_hi:[1,0,0]
  v_pk_mul_f32 v[24:25], v[24:25], v[172:173]
  v_pk_mul_f32 v[26:27], v[26:27], v[174:175]
  v_mfma_f32_32x32x16_bf16 v[188:203], a[232:235], v[60:63], v[188:203]
  s_waitcnt lgkmcnt(8)
  ds_read_b64_tr_b16 a[252:253], v242 offset:26624
  ds_read_b64_tr_b16 a[254:255], v242 offset:27136
  buffer_load_dwordx4 v233, s[36:39], s87 offen offset:1024 lds
  v_exp_f32 v24, v24
  v_exp_f32 v26, v26
  v_exp_f32 v25, v25
  v_exp_f32 v27, v27
  v_pk_fma_f32 v[24:25], v[24:25], v[236:237], v[236:237] op_sel_hi:[1,0,0]
  v_pk_fma_f32 v[26:27], v[26:27], v[236:237], v[236:237] op_sel_hi:[1,0,0]
  v_mfma_f32_32x32x16_bf16 v[188:203], a[236:239], v[64:67], v[188:203]
  ds_read_b64_tr_b16 a[232:233], v242 offset:19456
  ds_read_b64_tr_b16 a[234:235], v242 offset:19968
L_page_7:
  s_cbranch_execz L_pageret_1
  buffer_load_dwordx4 v232, s[36:39], s87 offen offset:2048 lds
  v_rcp_f32 v24, v24
  v_rcp_f32 v26, v26
  v_rcp_f32 v25, v25
  v_rcp_f32 v27, v27
  v_pk_mul_f32 v[24:25], v[24:25], v[172:173]
  v_pk_mul_f32 v[26:27], v[26:27], v[174:175]
  v_cvt_pk_bf16_f32 v172, v24, v25
  v_cvt_pk_bf16_f32 v173, v26, v27
  v_pk_mul_f32 v[24:25], v[176:177], v[176:177]
  v_pk_mul_f32 v[26:27], v[178:179], v[178:179]
  v_pk_fma_f32 v[24:25], v[24:25], v[238:239], v[240:241] op_sel_hi:[1,0,0]
  v_pk_fma_f32 v[26:27], v[26:27], v[238:239], v[240:241] op_sel_hi:[1,0,0]
  v_pk_mul_f32 v[24:25], v[24:25], v[176:177]
  v_pk_mul_f32 v[26:27], v[26:27], v[178:179]
  s_waitcnt lgkmcnt(10)
  v_mfma_f32_32x32x16_bf16 v[188:203], a[240:243], v[68:71], v[188:203]
  s_waitcnt lgkmcnt(8)
  ds_read_b64_tr_b16 a[236:237], v242 offset:27648
  buffer_load_dwordx4 v231, s[36:39], s87 offen offset:3072 lds
  ds_read_b64_tr_b16 a[238:239], v242 offset:28160
  v_exp_f32 v24, v24
  v_exp_f32 v26, v26
  v_exp_f32 v25, v25
  v_exp_f32 v27, v27
  v_pk_fma_f32 v[24:25], v[24:25], v[236:237], v[236:237] op_sel_hi:[1,0,0]
  v_pk_fma_f32 v[26:27], v[26:27], v[236:237], v[236:237] op_sel_hi:[1,0,0]
  v_mfma_f32_32x32x16_bf16 v[188:203], a[244:247], v[72:75], v[188:203]
  ds_read_b64_tr_b16 a[240:241], v242 offset:32768
  ds_read_b64_tr_b16 a[242:243], v242 offset:33280
  s_waitcnt vmcnt(14)
  ds_read_b64_tr_b16 a[8:9], v229 offset:64512
  ds_read_b64_tr_b16 a[10:11], v229 offset:65024
  v_rcp_f32 v24, v24
  v_rcp_f32 v26, v26
  v_rcp_f32 v25, v25
  v_rcp_f32 v27, v27
  v_pk_mul_f32 v[24:25], v[24:25], v[176:177]
  v_pk_mul_f32 v[26:27], v[26:27], v[178:179]
  v_cvt_pk_bf16_f32 v174, v24, v25
  v_cvt_pk_bf16_f32 v175, v26, v27
  buffer_store_dwordx4 v[172:175], v241, s[16:19], s61 offen offset:1024
  ds_read_b64_tr_b16 a[12:13], v1 offset:64512
  ds_read_b64_tr_b16 a[14:15], v1 offset:65024
  s_waitcnt lgkmcnt(13)
  v_pk_fma_f32 v[180:181], v[220:221], v[244:245], v[180:181] op_sel_hi:[1,0,1]
  v_pk_fma_f32 v[182:183], v[222:223], v[244:245], v[182:183] op_sel_hi:[1,0,1]
  s_waitcnt lgkmcnt(12)
  v_pk_fma_f32 v[184:185], v[224:225], v[244:245], v[184:185] op_sel_hi:[1,0,1]
  v_pk_fma_f32 v[186:187], v[226:227], v[244:245], v[186:187] op_sel_hi:[1,0,1]
  ds_read_b128 v[220:223], v239 offset:256
  ds_read_b128 v[224:227], v239 offset:288
  ds_read_b64_tr_b16 a[16:17], v2 offset:64512
  ds_read_b64_tr_b16 a[18:19], v2 offset:65024
  v_pk_mul_f32 v[24:25], v[180:181], v[180:181]
  v_pk_mul_f32 v[26:27], v[182:183], v[182:183]
  v_pk_fma_f32 v[24:25], v[24:25], v[238:239], v[240:241] op_sel_hi:[1,0,0]
  v_pk_fma_f32 v[26:27], v[26:27], v[238:239], v[240:241] op_sel_hi:[1,0,0]
  v_pk_mul_f32 v[24:25], v[24:25], v[180:181]
  v_pk_mul_f32 v[26:27], v[26:27], v[182:183]
  v_mfma_f32_32x32x16_bf16 v[188:203], a[248:251], v[76:79], v[188:203]
  s_waitcnt lgkmcnt(10)
  ds_read_b64_tr_b16 a[244:245], v242 offset:40960
  ds_read_b64_tr_b16 a[246:247], v242 offset:41472
  ds_read_b64_tr_b16 a[20:21], v3 offset:64512
  ds_read_b64_tr_b16 a[22:23], v3 offset:65024
  v_exp_f32 v24, v24
  v_exp_f32 v26, v26
  v_exp_f32 v25, v25
  v_exp_f32 v27, v27
  v_pk_fma_f32 v[24:25], v[24:25], v[236:237], v[236:237] op_sel_hi:[1,0,0]
  v_pk_fma_f32 v[26:27], v[26:27], v[236:237], v[236:237] op_sel_hi:[1,0,0]
  v_mfma_f32_32x32x16_bf16 v[188:203], a[252:255], v[80:83], v[188:203]
  ds_read_b64_tr_b16 a[248:249], v242 offset:33792
  ds_read_b64_tr_b16 a[250:251], v242 offset:34304
  v_rcp_f32 v24, v24
  v_rcp_f32 v26, v26
  v_rcp_f32 v25, v25
  v_rcp_f32 v27, v27
  v_pk_mul_f32 v[24:25], v[24:25], v[180:181]
  v_pk_mul_f32 v[26:27], v[26:27], v[182:183]
  s_waitcnt vmcnt(10)
  ds_read_b64_tr_b16 a[24:25], v229 offset:0
  ds_read_b64_tr_b16 a[26:27], v229 offset:512
  v_cvt_pk_bf16_f32 v180, v24, v25
  v_cvt_pk_bf16_f32 v181, v26, v27
  v_pk_mul_f32 v[24:25], v[184:185], v[184:185]
  v_pk_mul_f32 v[26:27], v[186:187], v[186:187]
  v_pk_fma_f32 v[24:25], v[24:25], v[238:239], v[240:241] op_sel_hi:[1,0,0]
  v_pk_fma_f32 v[26:27], v[26:27], v[238:239], v[240:241] op_sel_hi:[1,0,0]
  v_pk_mul_f32 v[24:25], v[24:25], v[184:185]
  v_pk_mul_f32 v[26:27], v[26:27], v[186:187]
  v_mfma_f32_32x32x16_bf16 v[188:203], a[232:235], v[84:87], v[188:203]
  s_waitcnt lgkmcnt(4)
  ds_read_b64_tr_b16 a[252:253], v242 offset:41984
  s_add_u32 m0, s73, 64512
  s_add_u32 s87, s65, 32768
  buffer_load_dwordx4 v234, s[36:39], s87 offen lds
  ds_read_b64_tr_b16 a[254:255], v242 offset:42496
  v_exp_f32 v24, v24
  v_exp_f32 v26, v26
  v_exp_f32 v25, v25
  v_exp_f32 v27, v27
  v_pk_fma_f32 v[24:25], v[24:25], v[236:237], v[236:237] op_sel_hi:[1,0,0]
  v_pk_fma_f32 v[26:27], v[26:27], v[236:237], v[236:237] op_sel_hi:[1,0,0]
  v_mfma_f32_32x32x16_bf16 v[188:203], a[236:239], v[88:91], v[188:203]
  ds_read_b64_tr_b16 a[232:233], v242 offset:34816
  ds_read_b64_tr_b16 a[234:235], v242 offset:35328
  ds_read_b64_tr_b16 a[28:29], v1 offset:0
  ds_read_b64_tr_b16 a[30:31], v1 offset:512
  v_rcp_f32 v24, v24
  v_rcp_f32 v26, v26
  v_rcp_f32 v25, v25
  v_rcp_f32 v27, v27
  v_pk_mul_f32 v[24:25], v[24:25], v[184:185]
  v_pk_mul_f32 v[26:27], v[26:27], v[186:187]
  v_cvt_pk_bf16_f32 v182, v24, v25
  v_cvt_pk_bf16_f32 v183, v26, v27
  buffer_store_dwordx4 v[180:183], v241, s[16:19], s61 offen offset:1536
  buffer_load_dwordx4 v233, s[36:39], s87 offen offset:1024 lds
  ds_read_b64_tr_b16 a[236:237], v242 offset:43008
  ds_read_b64_tr_b16 a[238:239], v242 offset:43520
  v_mfma_f32_32x32x16_bf16 v[188:203], a[240:243], v[92:95], v[188:203]
  ds_read_b64_tr_b16 a[32:33], v2 offset:0
  ds_read_b64_tr_b16 a[34:35], v2 offset:512
  ds_read_b64_tr_b16 a[240:241], v242 offset:35840
  ds_read_b64_tr_b16 a[242:243], v242 offset:36352
  v_mfma_f32_32x32x16_bf16 v[188:203], a[244:247], v[96:99], v[188:203]
  s_waitcnt lgkmcnt(12)
  buffer_load_dwordx4 v232, s[36:39], s87 offen offset:2048 lds
  s_lshr_b32 s97, s70, 19
  ds_read_b64_tr_b16 a[244:245], v242 offset:44032
  ds_read_b64_tr_b16 a[246:247], v242 offset:44544
  v_mfma_f32_32x32x16_bf16 v[188:203], a[248:251], v[100:103], v[188:203]
  s_waitcnt lgkmcnt(10)
  ds_read_b64_tr_b16 a[36:37], v3 offset:0
  ds_read_b64_tr_b16 a[38:39], v3 offset:512
  s_lshl_b32 s97, s97, 16
  ds_read_b64_tr_b16 a[248:249], v242 offset:49152
  ds_read_b64_tr_b16 a[250:251], v242 offset:49664
  v_mfma_f32_32x32x16_bf16 v[188:203], a[252:255], v[104:107], v[188:203]
  buffer_load_dwordx4 v231, s[36:39], s87 offen offset:3072 lds
  s_waitcnt vmcnt(10)
  ds_read_b64_tr_b16 a[40:41], v229 offset:16384
  ds_read_b64_tr_b16 a[42:43], v229 offset:16896
  ds_read_b64_tr_b16 a[252:253], v242 offset:57344
  ds_read_b64_tr_b16 a[254:255], v242 offset:57856
  v_mfma_f32_32x32x16_bf16 v[188:203], a[232:235], v[108:111], v[188:203]
  s_bfe_u32 s74, s70, 262159
  s_waitcnt lgkmcnt(6)
  s_add_u32 m0, s73, 0
  s_add_u32 s87, s56, 32768
  buffer_load_dwordx4 v234, s[36:39], s87 offen lds
  ds_read_b64_tr_b16 a[232:233], v242 offset:50176
  ds_read_b64_tr_b16 a[234:235], v242 offset:50688
  v_mfma_f32_32x32x16_bf16 v[188:203], a[236:239], v[112:115], v[188:203]
  s_lshl_b32 s74, s74, 10
  ds_read_b64_tr_b16 a[236:237], v242 offset:58368
  ds_read_b64_tr_b16 a[238:239], v242 offset:58880
  v_mfma_f32_32x32x16_bf16 v[188:203], a[240:243], v[116:119], v[188:203]
  ds_read_b64_tr_b16 a[44:45], v1 offset:16384
  ds_read_b64_tr_b16 a[46:47], v1 offset:16896
  buffer_load_dwordx4 v233, s[36:39], s87 offen offset:1024 lds
  ds_read_b64_tr_b16 a[240:241], v242 offset:51200
  ds_read_b64_tr_b16 a[242:243], v242 offset:51712
  v_mfma_f32_32x32x16_bf16 v[188:203], a[244:247], v[120:123], v[188:203]
  s_add_u32 s97, s97, s74
  ds_read_b64_tr_b16 a[48:49], v2 offset:16384
  ds_read_b64_tr_b16 a[50:51], v2 offset:16896
  ds_read_b64_tr_b16 a[244:245], v242 offset:59392
  ds_read_b64_tr_b16 a[246:247], v242 offset:59904
  s_waitcnt lgkmcnt(14)
  v_mfma_f32_32x32x16_bf16 v[188:203], a[248:251], v[124:127], v[188:203]
  s_lshr_b32 s96, s65, 19
  buffer_load_dwordx4 v232, s[36:39], s87 offen offset:2048 lds
  ds_read_b64_tr_b16 a[248:249], v242 offset:52224
  ds_read_b64_tr_b16 a[250:251], v242 offset:52736
  s_waitcnt lgkmcnt(14)
  v_mfma_f32_32x32x16_bf16 v[188:203], a[252:255], v[128:131], v[188:203]
  s_waitcnt lgkmcnt(10)
  ds_read_b64_tr_b16 a[52:53], v3 offset:16384
  ds_read_b64_tr_b16 a[54:55], v3 offset:16896
  s_lshl_b32 s96, s96, 16
  ds_read_b64_tr_b16 a[252:253], v242 offset:60416
  ds_read_b64_tr_b16 a[254:255], v242 offset:60928
  v_mfma_f32_32x32x16_bf16 v[188:203], a[232:235], v[132:135], v[188:203]
  buffer_load_dwordx4 v231, s[36:39], s87 offen offset:3072 lds
  ds_read_b64_tr_b16 a[232:233], v235 offset:0
  ds_read_b64_tr_b16 a[234:235], v235 offset:512
  v_mfma_f32_32x32x16_bf16 v[188:203], a[236:239], v[136:139], v[188:203]
  s_bfe_u32 s74, s65, 262159
  s_waitcnt vmcnt(10)
  ds_read_b64_tr_b16 a[56:57], v229 offset:32768
  ds_read_b64_tr_b16 a[58:59], v229 offset:33280
  ds_read_b64_tr_b16 a[236:237], v235 offset:8192
  ds_read_b64_tr_b16 a[238:239], v235 offset:8704
  s_waitcnt lgkmcnt(14)
  v_mfma_f32_32x32x16_bf16 v[188:203], a[240:243], v[140:143], v[188:203]
  s_waitcnt lgkmcnt(8)
  s_add_u32 m0, s73, 16384
  s_add_u32 s87, s55, 0
  buffer_load_dwordx4 v234, s[36:39], s87 offen lds
  s_lshl_b32 s74, s74, 10
  ds_read_b64_tr_b16 a[240:241], v235 offset:1024
  ds_read_b64_tr_b16 a[242:243], v235 offset:1536
  v_mfma_f32_32x32x16_bf16 v[188:203], a[244:247], v[144:147], v[188:203]
  ds_read_b64_tr_b16 a[60:61], v1 offset:32768
  ds_read_b64_tr_b16 a[62:63], v1 offset:33280
  s_add_u32 s96, s96, s74
  ds_read_b64_tr_b16 a[244:245], v235 offset:9216
  ds_read_b64_tr_b16 a[246:247], v235 offset:9728
  v_mfma_f32_32x32x16_bf16 v[188:203], a[248:251], v[148:151], v[188:203]
  s_waitcnt lgkmcnt(10)
  buffer_load_dwordx4 v233, s[36:39], s87 offen offset:1024 lds
  ds_read_b64_tr_b16 a[64:65], v2 offset:32768
  ds_read_b64_tr_b16 a[66:67], v2 offset:33280
  ds_read_b64_tr_b16 a[248:249], v235 offset:2048
  ds_read_b64_tr_b16 a[250:251], v235 offset:2560
  v_mfma_f32_32x32x16_bf16 v[188:203], a[252:255], v[152:155], v[188:203]
  s_lshr_b32 s77, s56, 19
  buffer_load_dwordx4 v232, s[36:39], s87 offen offset:2048 lds
  ds_read_b64_tr_b16 a[252:253], v235 offset:10240
  ds_read_b64_tr_b16 a[254:255], v235 offset:10752
  v_mfma_f32_32x32x16_bf16 v[204:219], a[232:235], v[28:31], 0
  s_lshl_b32 s77, s77, 16
  ds_read_b64_tr_b16 a[232:233], v235 offset:3072
  ds_read_b64_tr_b16 a[234:235], v235 offset:3584
  s_waitcnt lgkmcnt(14)
  v_mfma_f32_32x32x16_bf16 v[204:219], a[236:239], v[32:35], v[204:219]
  s_waitcnt lgkmcnt(10)
  ds_read_b64_tr_b16 a[68:69], v3 offset:32768
  ds_read_b64_tr_b16 a[70:71], v3 offset:33280
  buffer_load_dwordx4 v231, s[36:39], s87 offen offset:3072 lds
  ds_read_b64_tr_b16 a[236:237], v235 offset:11264
  ds_read_b64_tr_b16 a[238:239], v235 offset:11776
  v_mfma_f32_32x32x16_bf16 v[204:219], a[240:243], v[36:39], v[204:219]
  s_waitcnt vmcnt(11)
  v_mov_b32 v255, s84
  s_mov_b64 exec, 1
  buffer_store_dword v255, off, s[16:19], s53 offset:0
  s_mov_b64 exec, -1
  s_bfe_u32 s74, s56, 262159
  s_waitcnt vmcnt(9)
  ds_read_b64_tr_b16 a[72:73], v229 offset:64512
  ds_read_b64_tr_b16 a[74:75], v229 offset:65024
  ds_read_b64_tr_b16 a[240:241], v235 offset:16384
  ds_read_b64_tr_b16 a[242:243], v235 offset:16896
  s_waitcnt lgkmcnt(14)
  v_mfma_f32_32x32x16_bf16 v[204:219], a[244:247], v[40:43], v[204:219]
  s_waitcnt lgkmcnt(6)
  v_bfe_u32 v29, v0, 1, 2
  v_mov_b32 v28, s70
  s_lshl_b32 s74, s74, 10
  s_add_u32 m0, s73, 32768
  s_add_u32 s87, s70, 65536
  buffer_load_dwordx4 v234, s[36:39], s87 offen lds
  ds_read_b64_tr_b16 a[244:245], v235 offset:24576
  ds_read_b64_tr_b16 a[246:247], v235 offset:25088
  v_mfma_f32_32x32x16_bf16 v[204:219], a[248:251], v[44:47], v[204:219]
  ds_read_b64_tr_b16 a[76:77], v1 offset:64512
  ds_read_b64_tr_b16 a[78:79], v1 offset:65024
  ds_read_b64_tr_b16 a[248:249], v235 offset:17408
  ds_read_b64_tr_b16 a[250:251], v235 offset:17920
  v_cmp_eq_u32 vcc, 1, v29
  v_mov_b32 v255, s65
  s_add_u32 s77, s77, s74
  v_mfma_f32_32x32x16_bf16 v[204:219], a[252:255], v[48:51], v[204:219]
  buffer_load_dwordx4 v233, s[36:39], s87 offen offset:1024 lds
  ds_read_b64_tr_b16 a[252:253], v235 offset:25600
  ds_read_b64_tr_b16 a[254:255], v235 offset:26112
  v_cndmask_b32 v28, v28, v255, vcc
  v_mfma_f32_32x32x16_bf16 v[204:219], a[232:235], v[52:55], v[204:219]
  s_waitcnt lgkmcnt(10)
  ds_read_b64_tr_b16 a[80:81], v2 offset:64512
  ds_read_b64_tr_b16 a[82:83], v2 offset:65024
  ds_read_b64_tr_b16 a[232:233], v235 offset:18432
  ds_read_b64_tr_b16 a[234:235], v235 offset:18944
  v_cmp_eq_u32 vcc, 2, v29
  v_mov_b32 v255, s56
  s_lshr_b32 s76, s55, 19
  v_mfma_f32_32x32x16_bf16 v[204:219], a[236:239], v[56:59], v[204:219]
  s_waitcnt lgkmcnt(12)
  buffer_load_dwordx4 v232, s[36:39], s87 offen offset:2048 lds
  ds_read_b64_tr_b16 a[236:237], v235 offset:26624
  ds_read_b64_tr_b16 a[238:239], v235 offset:27136
  v_cndmask_b32 v28, v28, v255, vcc
  s_lshl_b32 s76, s76, 16
  v_mfma_f32_32x32x16_bf16 v[204:219], a[240:243], v[60:63], v[204:219]
  s_waitcnt lgkmcnt(10)
  ds_read_b64_tr_b16 a[84:85], v3 offset:64512
  ds_read_b64_tr_b16 a[86:87], v3 offset:65024
  ds_read_b64_tr_b16 a[240:241], v235 offset:19456
  ds_read_b64_tr_b16 a[242:243], v235 offset:19968
  v_cmp_eq_u32 vcc, 3, v29
  v_mov_b32 v255, s55
  s_bfe_u32 s74, s55, 262159
  v_mfma_f32_32x32x16_bf16 v[204:219], a[244:247], v[64:67], v[204:219]
  buffer_load_dwordx4 v231, s[36:39], s87 offen offset:3072 lds
  v_cndmask_b32 v28, v28, v255, vcc
  s_waitcnt vmcnt(9)
  ds_read_b64_tr_b16 a[88:89], v229 offset:0
  ds_read_b64_tr_b16 a[90:91], v229 offset:512
  ds_read_b64_tr_b16 a[244:245], v235 offset:27648
  ds_read_b64_tr_b16 a[246:247], v235 offset:28160
  s_waitcnt lgkmcnt(14)
  v_mfma_f32_32x32x16_bf16 v[204:219], a[248:251], v[68:71], v[204:219]
  ds_read_b64_tr_b16 a[248:249], v235 offset:32768
  ds_read_b64_tr_b16 a[250:251], v235 offset:33280
  v_lshrrev_b32 v28, 17, v28
  v_and_b32 v29, 1, v0
  s_lshl_b32 s74, s74, 10
  v_mfma_f32_32x32x16_bf16 v[204:219], a[252:255], v[72:75], v[204:219]
  s_waitcnt lgkmcnt(8)
  v_lshl_add_u32 v28, v28, 2, v29
  s_add_u32 m0, s73, 64512
  s_add_u32 s87, s65, 65536
  buffer_load_dwordx4 v234, s[36:39], s87 offen lds
  s_add_u32 s76, s76, s74
  ds_read_b64_tr_b16 a[252:253], v235 offset:40960
  ds_read_b64_tr_b16 a[254:255], v235 offset:41472
  v_mfma_f32_32x32x16_bf16 v[204:219], a[232:235], v[76:79], v[204:219]
  ds_read_b64_tr_b16 a[92:93], v1 offset:0
  ds_read_b64_tr_b16 a[94:95], v1 offset:512
  buffer_load_dwordx4 v233, s[36:39], s87 offen offset:1024 lds
  ds_read_b64_tr_b16 a[232:233], v235 offset:33792
  ds_read_b64_tr_b16 a[234:235], v235 offset:34304
  s_and_b32 s91, s94, 1
  s_lshl_b32 s91, s91, 1
  v_add_u32 v28, s91, v28
  v_mfma_f32_32x32x16_bf16 v[204:219], a[236:239], v[80:83], v[204:219]
  s_waitcnt lgkmcnt(10)
  ds_read_b64_tr_b16 a[96:97], v2 offset:0
  ds_read_b64_tr_b16 a[98:99], v2 offset:512
  ds_read_b64_tr_b16 a[236:237], v235 offset:41984
  ds_read_b64_tr_b16 a[238:239], v235 offset:42496
  v_lshlrev_b32 v28, 2, v28
  v_add_u32 v32, s97, v253
  v_add_u32 v33, s96, v253
  v_add_u32 v34, s77, v253
  v_add_u32 v35, s76, v253
  v_mfma_f32_32x32x16_bf16 v[204:219], a[240:243], v[84:87], v[204:219]
  s_add_u32 s74, s95, 1
  buffer_load_dwordx4 v232, s[36:39], s87 offen offset:2048 lds
  ds_read_b64_tr_b16 a[240:241], v235 offset:34816
  ds_read_b64_tr_b16 a[242:243], v235 offset:35328
  s_waitcnt lgkmcnt(14)
  v_mfma_f32_32x32x16_bf16 v[204:219], a[244:247], v[88:91], v[204:219]
  s_waitcnt lgkmcnt(10)
  ds_read_b64_tr_b16 a[100:101], v3 offset:0
  ds_read_b64_tr_b16 a[102:103], v3 offset:512
  s_and_b32 s74, s74, 3
  ds_read_b64_tr_b16 a[244:245], v235 offset:43008
  ds_read_b64_tr_b16 a[246:247], v235 offset:43520
  v_mfma_f32_32x32x16_bf16 v[204:219], a[248:251], v[92:95], v[204:219]
  buffer_load_dwordx4 v231, s[36:39], s87 offen offset:3072 lds
  ds_read_b64_tr_b16 a[248:249], v235 offset:35840
  ds_read_b64_tr_b16 a[250:251], v235 offset:36352
  v_mfma_f32_32x32x16_bf16 v[204:219], a[252:255], v[96:99], v[204:219]
  s_lshl_b32 s74, s74, 14
  s_waitcnt vmcnt(9)
  ds_read_b64_tr_b16 a[104:105], v229 offset:16384
  ds_read_b64_tr_b16 a[106:107], v229 offset:16896
  ds_read_b64_tr_b16 a[252:253], v235 offset:44032
  ds_read_b64_tr_b16 a[254:255], v235 offset:44544
  s_waitcnt lgkmcnt(14)
  v_mfma_f32_32x32x16_bf16 v[204:219], a[232:235], v[100:103], v[204:219]
  s_waitcnt lgkmcnt(8)
  buffer_load_dword v29, v28, s[16:19], s54 offen offset:0 sc1
  s_add_u32 m0, s73, 0
  s_add_u32 s87, s56, 65536
  buffer_load_dwordx4 v234, s[36:39], s87 offen lds
  s_add_u32 s97, s74, s86
  ds_read_b64_tr_b16 a[232:233], v235 offset:49152
  ds_read_b64_tr_b16 a[234:235], v235 offset:49664
  v_mfma_f32_32x32x16_bf16 v[204:219], a[236:239], v[104:107], v[204:219]
  ds_read_b64_tr_b16 a[108:109], v1 offset:16384
  ds_read_b64_tr_b16 a[110:111], v1 offset:16896
  s_add_u32 s69, s95, 2
  ds_read_b64_tr_b16 a[236:237], v235 offset:57344
  ds_read_b64_tr_b16 a[238:239], v235 offset:57856
  v_mfma_f32_32x32x16_bf16 v[204:219], a[240:243], v[108:111], v[204:219]
  s_waitcnt lgkmcnt(10)
  buffer_load_dwordx4 v233, s[36:39], s87 offen offset:1024 lds
  ds_read_b64_tr_b16 a[112:113], v2 offset:16384
  ds_read_b64_tr_b16 a[114:115], v2 offset:16896
  ds_read_b64_tr_b16 a[240:241], v235 offset:50176
  ds_read_b64_tr_b16 a[242:243], v235 offset:50688
  v_mfma_f32_32x32x16_bf16 v[204:219], a[244:247], v[112:115], v[204:219]
  s_and_b32 s69, s69, 3
  ds_read_b64_tr_b16 a[244:245], v235 offset:58368
  ds_read_b64_tr_b16 a[246:247], v235 offset:58880
  v_mfma_f32_32x32x16_bf16 v[204:219], a[248:251], v[116:119], v[204:219]
  s_waitcnt lgkmcnt(12)
  buffer_load_dwordx4 v232, s[36:39], s87 offen offset:2048 lds
  s_lshl_b32 s69, s69, 14
  ds_read_b64_tr_b16 a[248:249], v235 offset:51200
  ds_read_b64_tr_b16 a[250:251], v235 offset:51712
  v_mfma_f32_32x32x16_bf16 v[204:219], a[252:255], v[120:123], v[204:219]
  s_waitcnt lgkmcnt(10)
  ds_read_b64_tr_b16 a[116:117], v3 offset:16384
  ds_read_b64_tr_b16 a[118:119], v3 offset:16896
  buffer_load_dwordx4 v231, s[36:39], s87 offen offset:3072 lds
  ds_read_b64_tr_b16 a[252:253], v235 offset:59392
  ds_read_b64_tr_b16 a[254:255], v235 offset:59904
  v_mfma_f32_32x32x16_bf16 v[204:219], a[232:235], v[124:127], v[204:219]
  s_add_u32 s96, s69, s86
  s_waitcnt vmcnt(9)
  ds_read_b64_tr_b16 a[120:121], v229 offset:32768
  ds_read_b64_tr_b16 a[122:123], v229 offset:33280
  ds_read_b64_tr_b16 a[232:233], v235 offset:52224
  ds_read_b64_tr_b16 a[234:235], v235 offset:52736
  s_waitcnt lgkmcnt(14)
  v_mfma_f32_32x32x16_bf16 v[204:219], a[236:239], v[128:131], v[204:219]
  s_add_u32 s68, s95, 3
  s_waitcnt lgkmcnt(6)
  s_add_u32 m0, s73, 16384
  s_add_u32 s87, s55, 65536
  buffer_load_dwordx4 v234, s[36:39], s87 offen lds
  ds_read_b64_tr_b16 a[236:237], v235 offset:60416
  ds_read_b64_tr_b16 a[238:239], v235 offset:60928
  v_mfma_f32_32x32x16_bf16 v[204:219], a[240:243], v[132:135], v[204:219]
  ds_read_b64_tr_b16 a[124:125], v1 offset:32768
  ds_read_b64_tr_b16 a[126:127], v1 offset:33280
  v_mfma_f32_32x32x16_bf16 v[204:219], a[244:247], v[136:139], v[204:219]
  s_and_b32 s68, s68, 3
  buffer_load_dwordx4 v233, s[36:39], s87 offen offset:1024 lds
  v_mfma_f32_32x32x16_bf16 v[204:219], a[248:251], v[140:143], v[204:219]
  s_lshl_b32 s68, s68, 14
  ds_read_b64_tr_b16 a[128:129], v2 offset:32768
  ds_read_b64_tr_b16 a[130:131], v2 offset:33280
  s_waitcnt lgkmcnt(10)
  v_mfma_f32_32x32x16_bf16 v[204:219], a[252:255], v[144:147], v[204:219]
  s_waitcnt lgkmcnt(6)
  buffer_load_dwordx4 v232, s[36:39], s87 offen offset:2048 lds
  s_add_u32 s77, s68, s86
  v_mfma_f32_32x32x16_bf16 v[204:219], a[232:235], v[148:151], v[204:219]
  s_waitcnt lgkmcnt(4)
  ds_read_b64_tr_b16 a[132:133], v3 offset:32768
  ds_read_b64_tr_b16 a[134:135], v3 offset:33280
  s_lshl_b32 s76, s95, 14
  v_mfma_f32_32x32x16_bf16 v[204:219], a[236:239], v[152:155], v[204:219]
  buffer_load_dwordx4 v231, s[36:39], s87 offen offset:3072 lds
  s_add_u32 s76, s76, s86
  v_pk_fma_f32 v[188:189], v[220:221], v[244:245], v[188:189] op_sel_hi:[1,0,1]
  v_pk_fma_f32 v[190:191], v[222:223], v[244:245], v[190:191] op_sel_hi:[1,0,1]
  v_pk_fma_f32 v[192:193], v[224:225], v[244:245], v[192:193] op_sel_hi:[1,0,1]
  v_pk_fma_f32 v[194:195], v[226:227], v[244:245], v[194:195] op_sel_hi:[1,0,1]
  ds_read_b128 v[220:223], v239 offset:320
  ds_read_b128 v[224:227], v239 offset:352
  v_pk_mul_f32 v[24:25], v[188:189], v[188:189]
  v_pk_mul_f32 v[26:27], v[190:191], v[190:191]
  v_pk_fma_f32 v[24:25], v[24:25], v[238:239], v[240:241] op_sel_hi:[1,0,0]
  v_pk_fma_f32 v[26:27], v[26:27], v[238:239], v[240:241] op_sel_hi:[1,0,0]
  s_waitcnt vmcnt(8)
  v_xor_b32 v254, s88, v29
  v_cmp_lt_u32 vcc, 31, v254
  s_cbranch_vccnz L_rdy_158
L_rret_159:
  v_pk_mul_f32 v[24:25], v[24:25], v[188:189]
  buffer_load_dwordx4 v[44:47], v32, s[16:19], s97 offen offset:0 sc1
  v_pk_mul_f32 v[26:27], v[26:27], v[190:191]
  v_exp_f32 v24, v24
  v_exp_f32 v26, v26
  v_exp_f32 v25, v25
  v_exp_f32 v27, v27
  v_pk_fma_f32 v[24:25], v[24:25], v[236:237], v[236:237] op_sel_hi:[1,0,0]
  v_pk_fma_f32 v[26:27], v[26:27], v[236:237], v[236:237] op_sel_hi:[1,0,0]
  v_rcp_f32 v24, v24
  buffer_load_dwordx4 v[48:51], v33, s[16:19], s97 offen offset:0 sc1
  v_rcp_f32 v26, v26
  v_rcp_f32 v25, v25
  v_rcp_f32 v27, v27
  v_pk_mul_f32 v[24:25], v[24:25], v[188:189]
  v_pk_mul_f32 v[26:27], v[26:27], v[190:191]
  v_cvt_pk_bf16_f32 v188, v24, v25
  v_cvt_pk_bf16_f32 v189, v26, v27
  v_pk_mul_f32 v[24:25], v[192:193], v[192:193]
  buffer_load_dwordx4 v[52:55], v34, s[16:19], s97 offen offset:0 sc1
  v_pk_mul_f32 v[26:27], v[194:195], v[194:195]
  v_pk_fma_f32 v[24:25], v[24:25], v[238:239], v[240:241] op_sel_hi:[1,0,0]
  v_pk_fma_f32 v[26:27], v[26:27], v[238:239], v[240:241] op_sel_hi:[1,0,0]
  v_pk_mul_f32 v[24:25], v[24:25], v[192:193]
  v_pk_mul_f32 v[26:27], v[26:27], v[194:195]
  v_exp_f32 v24, v24
  v_exp_f32 v26, v26
  v_exp_f32 v25, v25
  buffer_load_dwordx4 v[56:59], v32, s[16:19], s97 offen offset:1024 sc1
  v_exp_f32 v27, v27
  v_pk_fma_f32 v[24:25], v[24:25], v[236:237], v[236:237] op_sel_hi:[1,0,0]
  v_pk_fma_f32 v[26:27], v[26:27], v[236:237], v[236:237] op_sel_hi:[1,0,0]
  v_rcp_f32 v24, v24
  v_rcp_f32 v26, v26
  v_rcp_f32 v25, v25
  v_rcp_f32 v27, v27
  v_pk_mul_f32 v[24:25], v[24:25], v[192:193]
  buffer_load_dwordx4 v[60:63], v33, s[16:19], s97 offen offset:1024 sc1
  v_pk_mul_f32 v[26:27], v[26:27], v[194:195]
  v_cvt_pk_bf16_f32 v190, v24, v25
  v_cvt_pk_bf16_f32 v191, v26, v27
  buffer_store_dwordx4 v[188:191], v241, s[16:19], s61 offen offset:2048
  s_waitcnt lgkmcnt(1)
  v_pk_fma_f32 v[196:197], v[220:221], v[244:245], v[196:197] op_sel_hi:[1,0,1]
  v_pk_fma_f32 v[198:199], v[222:223], v[244:245], v[198:199] op_sel_hi:[1,0,1]
  s_waitcnt lgkmcnt(0)
  v_pk_fma_f32 v[200:201], v[224:225], v[244:245], v[200:201] op_sel_hi:[1,0,1]
  v_pk_fma_f32 v[202:203], v[226:227], v[244:245], v[202:203] op_sel_hi:[1,0,1]
  buffer_load_dwordx4 v[64:67], v34, s[16:19], s97 offen offset:1024 sc1
  ds_read_b128 v[220:223], v239 offset:384
  ds_read_b128 v[224:227], v239 offset:416
  buffer_load_dwordx4 v[68:71], v35, s[16:19], s97 offen offset:0 sc1
  v_pk_mul_f32 v[24:25], v[196:197], v[196:197]
  v_pk_mul_f32 v[26:27], v[198:199], v[198:199]
  v_pk_fma_f32 v[24:25], v[24:25], v[238:239], v[240:241] op_sel_hi:[1,0,0]
  v_pk_fma_f32 v[26:27], v[26:27], v[238:239], v[240:241] op_sel_hi:[1,0,0]
  v_pk_mul_f32 v[24:25], v[24:25], v[196:197]
  v_pk_mul_f32 v[26:27], v[26:27], v[198:199]
  v_exp_f32 v24, v24
  v_exp_f32 v26, v26
  v_exp_f32 v25, v25
  v_exp_f32 v27, v27
  v_pk_fma_f32 v[24:25], v[24:25], v[236:237], v[236:237] op_sel_hi:[1,0,0]
  v_pk_fma_f32 v[26:27], v[26:27], v[236:237], v[236:237] op_sel_hi:[1,0,0]
  v_rcp_f32 v24, v24
  v_rcp_f32 v26, v26
  buffer_load_dwordx4 v[72:75], v32, s[16:19], s96 offen offset:0 sc1
  v_rcp_f32 v25, v25
  v_rcp_f32 v27, v27
  v_pk_mul_f32 v[24:25], v[24:25], v[196:197]
  v_pk_mul_f32 v[26:27], v[26:27], v[198:199]
  v_cvt_pk_bf16_f32 v196, v24, v25
  v_cvt_pk_bf16_f32 v197, v26, v27
  v_pk_mul_f32 v[24:25], v[200:201], v[200:201]
  v_pk_mul_f32 v[26:27], v[202:203], v[202:203]
  buffer_load_dwordx4 v[76:79], v33, s[16:19], s96 offen offset:0 sc1
  v_pk_fma_f32 v[24:25], v[24:25], v[238:239], v[240:241] op_sel_hi:[1,0,0]
  v_pk_fma_f32 v[26:27], v[26:27], v[238:239], v[240:241] op_sel_hi:[1,0,0]
  v_pk_mul_f32 v[24:25], v[24:25], v[200:201]
  v_pk_mul_f32 v[26:27], v[26:27], v[202:203]
  v_exp_f32 v24, v24
  v_exp_f32 v26, v26
  v_exp_f32 v25, v25
  v_exp_f32 v27, v27
  buffer_load_dwordx4 v[80:83], v34, s[16:19], s96 offen offset:0 sc1
  v_pk_fma_f32 v[24:25], v[24:25], v[236:237], v[236:237] op_sel_hi:[1,0,0]
  v_pk_fma_f32 v[26:27], v[26:27], v[236:237], v[236:237] op_sel_hi:[1,0,0]
  v_rcp_f32 v24, v24
  v_rcp_f32 v26, v26
  v_rcp_f32 v25, v25
  v_rcp_f32 v27, v27
  v_pk_mul_f32 v[24:25], v[24:25], v[200:201]
  v_pk_mul_f32 v[26:27], v[26:27], v[202:203]
  buffer_load_dwordx4 v[84:87], v32, s[16:19], s96 offen offset:1024 sc1
  v_cvt_pk_bf16_f32 v198, v24, v25
  v_cvt_pk_bf16_f32 v199, v26, v27
  buffer_store_dwordx4 v[196:199], v241, s[16:19], s61 offen offset:2560
  s_waitcnt lgkmcnt(1)
  v_pk_fma_f32 v[204:205], v[220:221], v[244:245], v[204:205] op_sel_hi:[1,0,1]
  v_pk_fma_f32 v[206:207], v[222:223], v[244:245], v[206:207] op_sel_hi:[1,0,1]
  s_waitcnt lgkmcnt(0)
  v_pk_fma_f32 v[208:209], v[224:225], v[244:245], v[208:209] op_sel_hi:[1,0,1]
  v_pk_fma_f32 v[210:211], v[226:227], v[244:245], v[210:211] op_sel_hi:[1,0,1]
  ds_read_b128 v[220:223], v239 offset:448
  buffer_load_dwordx4 v[88:91], v33, s[16:19], s96 offen offset:1024 sc1
  ds_read_b128 v[224:227], v239 offset:480
  buffer_load_dwordx4 v[92:95], v34, s[16:19], s96 offen offset:1024 sc1
  v_pk_mul_f32 v[24:25], v[204:205], v[204:205]
  v_pk_mul_f32 v[26:27], v[206:207], v[206:207]
  v_pk_fma_f32 v[24:25], v[24:25], v[238:239], v[240:241] op_sel_hi:[1,0,0]
  v_pk_fma_f32 v[26:27], v[26:27], v[238:239], v[240:241] op_sel_hi:[1,0,0]
  v_pk_mul_f32 v[24:25], v[24:25], v[204:205]
  v_pk_mul_f32 v[26:27], v[26:27], v[206:207]
  v_exp_f32 v24, v24
  v_exp_f32 v26, v26
  v_exp_f32 v25, v25
  v_exp_f32 v27, v27
  v_pk_fma_f32 v[24:25], v[24:25], v[236:237], v[236:237] op_sel_hi:[1,0,0]
  v_pk_fma_f32 v[26:27], v[26:27], v[236:237], v[236:237] op_sel_hi:[1,0,0]
  v_rcp_f32 v24, v24
  v_rcp_f32 v26, v26
  v_rcp_f32 v25, v25
  buffer_load_dwordx4 v[96:99], v35, s[16:19], s96 offen offset:0 sc1
  v_rcp_f32 v27, v27
  v_pk_mul_f32 v[24:25], v[24:25], v[204:205]
  v_pk_mul_f32 v[26:27], v[26:27], v[206:207]
  v_cvt_pk_bf16_f32 v204, v24, v25
  v_cvt_pk_bf16_f32 v205, v26, v27
  v_pk_mul_f32 v[24:25], v[208:209], v[208:209]
  v_pk_mul_f32 v[26:27], v[210:211], v[210:211]
  v_pk_fma_f32 v[24:25], v[24:25], v[238:239], v[240:241] op_sel_hi:[1,0,0]
  buffer_load_dwordx4 v[100:103], v32, s[16:19], s77 offen offset:0 sc1
  v_pk_fma_f32 v[26:27], v[26:27], v[238:239], v[240:241] op_sel_hi:[1,0,0]
  v_pk_mul_f32 v[24:25], v[24:25], v[208:209]
  v_pk_mul_f32 v[26:27], v[26:27], v[210:211]
  v_exp_f32 v24, v24
  v_exp_f32 v26, v26
  v_exp_f32 v25, v25
  v_exp_f32 v27, v27
  v_pk_fma_f32 v[24:25], v[24:25], v[236:237], v[236:237] op_sel_hi:[1,0,0]
  buffer_load_dwordx4 v[104:107], v33, s[16:19], s77 offen offset:0 sc1
  v_pk_fma_f32 v[26:27], v[26:27], v[236:237], v[236:237] op_sel_hi:[1,0,0]
  v_rcp_f32 v24, v24
  s_waitcnt vmcnt(5)
  v_mov_b32 v255, s84
  s_mov_b64 exec, 1
  buffer_store_dword v255, off, s[16:19], s53 offset:256
L_page_8:
  s_cbranch_execz L_pageret_1
  s_mov_b64 exec, -1
  v_rcp_f32 v26, v26
  v_rcp_f32 v25, v25
  v_rcp_f32 v27, v27
  v_pk_mul_f32 v[24:25], v[24:25], v[208:209]
  v_pk_mul_f32 v[26:27], v[26:27], v[210:211]
  v_cvt_pk_bf16_f32 v206, v24, v25
  buffer_load_dwordx4 v[108:111], v34, s[16:19], s77 offen offset:0 sc1
  v_cvt_pk_bf16_f32 v207, v26, v27
  buffer_store_dwordx4 v[204:207], v241, s[16:19], s61 offen offset:3072
  s_waitcnt lgkmcnt(1)
  v_pk_fma_f32 v[212:213], v[220:221], v[244:245], v[212:213] op_sel_hi:[1,0,1]
  v_pk_fma_f32 v[214:215], v[222:223], v[244:245], v[214:215] op_sel_hi:[1,0,1]
  s_waitcnt lgkmcnt(0)
  v_pk_fma_f32 v[216:217], v[224:225], v[244:245], v[216:217] op_sel_hi:[1,0,1]
  v_pk_fma_f32 v[218:219], v[226:227], v[244:245], v[218:219] op_sel_hi:[1,0,1]
  v_pk_mul_f32 v[24:25], v[212:213], v[212:213]
  v_pk_mul_f32 v[26:27], v[214:215], v[214:215]
  buffer_load_dwordx4 v[112:115], v32, s[16:19], s77 offen offset:1024 sc1
  v_pk_fma_f32 v[24:25], v[24:25], v[238:239], v[240:241] op_sel_hi:[1,0,0]
  v_pk_fma_f32 v[26:27], v[26:27], v[238:239], v[240:241] op_sel_hi:[1,0,0]
  v_pk_mul_f32 v[24:25], v[24:25], v[212:213]
  v_pk_mul_f32 v[26:27], v[26:27], v[214:215]
  v_exp_f32 v24, v24
  v_exp_f32 v26, v26
  v_exp_f32 v25, v25
  v_exp_f32 v27, v27
  buffer_load_dwordx4 v[116:119], v33, s[16:19], s77 offen offset:1024 sc1
  v_pk_fma_f32 v[24:25], v[24:25], v[236:237], v[236:237] op_sel_hi:[1,0,0]
  v_pk_fma_f32 v[26:27], v[26:27], v[236:237], v[236:237] op_sel_hi:[1,0,0]
  v_rcp_f32 v24, v24
  v_rcp_f32 v26, v26
  v_rcp_f32 v25, v25
  v_rcp_f32 v27, v27
  v_pk_mul_f32 v[24:25], v[24:25], v[212:213]
  v_pk_mul_f32 v[26:27], v[26:27], v[214:215]
  buffer_load_dwordx4 v[120:123], v34, s[16:19], s77 offen offset:1024 sc1
  v_cvt_pk_bf16_f32 v212, v24, v25
  v_cvt_pk_bf16_f32 v213, v26, v27
  v_pk_mul_f32 v[24:25], v[216:217], v[216:217]
  v_pk_mul_f32 v[26:27], v[218:219], v[218:219]
  v_pk_fma_f32 v[24:25], v[24:25], v[238:239], v[240:241] op_sel_hi:[1,0,0]
  v_pk_fma_f32 v[26:27], v[26:27], v[238:239], v[240:241] op_sel_hi:[1,0,0]
  v_pk_mul_f32 v[24:25], v[24:25], v[216:217]
  v_pk_mul_f32 v[26:27], v[26:27], v[218:219]
  buffer_load_dwordx4 v[124:127], v35, s[16:19], s77 offen offset:0 sc1
  v_exp_f32 v24, v24
  v_exp_f32 v26, v26
  v_exp_f32 v25, v25
  v_exp_f32 v27, v27
  v_pk_fma_f32 v[24:25], v[24:25], v[236:237], v[236:237] op_sel_hi:[1,0,0]
  v_pk_fma_f32 v[26:27], v[26:27], v[236:237], v[236:237] op_sel_hi:[1,0,0]
  v_rcp_f32 v24, v24
  v_rcp_f32 v26, v26
  buffer_load_dwordx4 v[128:131], v32, s[16:19], s76 offen offset:0 sc1
  v_rcp_f32 v25, v25
  v_rcp_f32 v27, v27
  v_pk_mul_f32 v[24:25], v[24:25], v[216:217]
  v_pk_mul_f32 v[26:27], v[26:27], v[218:219]
  v_cvt_pk_bf16_f32 v214, v24, v25
  v_cvt_pk_bf16_f32 v215, v26, v27
  buffer_store_dwordx4 v[212:215], v241, s[16:19], s61 offen offset:3584
  buffer_load_dwordx4 v[132:135], v33, s[16:19], s76 offen offset:0 sc1
  buffer_load_dwordx4 v[136:139], v34, s[16:19], s76 offen offset:0 sc1
L_p6join_100:
  v_mfma_f32_16x16x32_bf16 v[156:159], a[8:11], v[44:47], 0
  v_mfma_f32_16x16x32_bf16 v[160:163], a[12:15], v[44:47], 0
  v_mfma_f32_16x16x32_bf16 v[164:167], a[16:19], v[44:47], 0
  v_mfma_f32_16x16x32_bf16 v[168:171], a[20:23], v[44:47], 0
  v_mfma_f32_16x16x32_bf16 v[156:159], a[24:27], v[48:51], v[156:159]
  v_mfma_f32_16x16x32_bf16 v[160:163], a[28:31], v[48:51], v[160:163]
  v_mfma_f32_16x16x32_bf16 v[164:167], a[32:35], v[48:51], v[164:167]
  v_mfma_f32_16x16x32_bf16 v[168:171], a[36:39], v[48:51], v[168:171]
  v_mfma_f32_16x16x32_bf16 v[156:159], a[40:43], v[52:55], v[156:159]
  v_mfma_f32_16x16x32_bf16 v[160:163], a[44:47], v[52:55], v[160:163]
  v_mfma_f32_16x16x32_bf16 v[164:167], a[48:51], v[52:55], v[164:167]
  v_mfma_f32_16x16x32_bf16 v[168:171], a[52:55], v[52:55], v[168:171]
  v_mfma_f32_16x16x32_bf16 v[156:159], a[56:59], v[56:59], v[156:159]
  v_mfma_f32_16x16x32_bf16 v[160:163], a[60:63], v[56:59], v[160:163]
  ds_read_b64_tr_b16 a[136:137], v229 offset:64512
  ds_read_b64_tr_b16 a[138:139], v229 offset:65024
  v_mfma_f32_16x16x32_bf16 v[164:167], a[64:67], v[56:59], v[164:167]
  v_mfma_f32_16x16x32_bf16 v[168:171], a[68:71], v[56:59], v[168:171]
  s_add_u32 m0, s73, 32768
  s_add_u32 s87, s70, 98304
  buffer_load_dwordx4 v234, s[36:39], s87 offen lds
  v_mfma_f32_16x16x32_bf16 v[156:159], a[72:75], v[60:63], v[156:159]
  v_mfma_f32_16x16x32_bf16 v[160:163], a[76:79], v[60:63], v[160:163]
  ds_read_b64_tr_b16 a[140:141], v1 offset:64512
  ds_read_b64_tr_b16 a[142:143], v1 offset:65024
  v_mfma_f32_16x16x32_bf16 v[164:167], a[80:83], v[60:63], v[164:167]
  v_mfma_f32_16x16x32_bf16 v[168:171], a[84:87], v[60:63], v[168:171]
  buffer_load_dwordx4 v233, s[36:39], s87 offen offset:1024 lds
  v_mfma_f32_16x16x32_bf16 v[156:159], a[88:91], v[64:67], v[156:159]
  v_mfma_f32_16x16x32_bf16 v[160:163], a[92:95], v[64:67], v[160:163]
  ds_read_b64_tr_b16 a[144:145], v2 offset:64512
  ds_read_b64_tr_b16 a[146:147], v2 offset:65024
  v_mfma_f32_16x16x32_bf16 v[164:167], a[96:99], v[64:67], v[164:167]
  v_mfma_f32_16x16x32_bf16 v[168:171], a[100:103], v[64:67], v[168:171]
  buffer_load_dwordx4 v232, s[36:39], s87 offen offset:2048 lds
  v_mfma_f32_16x16x32_bf16 v[156:159], a[104:107], v[68:71], v[156:159]
  v_mfma_f32_16x16x32_bf16 v[160:163], a[108:111], v[68:71], v[160:163]
  ds_read_b64_tr_b16 a[148:149], v3 offset:64512
  ds_read_b64_tr_b16 a[150:151], v3 offset:65024
  v_mfma_f32_16x16x32_bf16 v[164:167], a[112:115], v[68:71], v[164:167]
  v_mfma_f32_16x16x32_bf16 v[168:171], a[116:119], v[68:71], v[168:171]
  buffer_load_dwordx4 v231, s[36:39], s87 offen offset:3072 lds
  v_mfma_f32_16x16x32_bf16 v[172:175], a[8:11], v[72:75], 0
  v_mfma_f32_16x16x32_bf16 v[176:179], a[12:15], v[72:75], 0
  ds_read_b64_tr_b16 a[152:153], v229 offset:0
  ds_read_b64_tr_b16 a[154:155], v229 offset:512
  buffer_load_dword v29, v28, s[16:19], s54 offen offset:256 sc1
  v_mfma_f32_16x16x32_bf16 v[180:183], a[16:19], v[72:75], 0
  v_mfma_f32_16x16x32_bf16 v[184:187], a[20:23], v[72:75], 0
  s_waitcnt lgkmcnt(2)
  s_add_u32 m0, s73, 64512
  s_add_u32 s87, s65, 98304
  buffer_load_dwordx4 v234, s[36:39], s87 offen lds
  v_mfma_f32_16x16x32_bf16 v[172:175], a[24:27], v[76:79], v[172:175]
  v_mfma_f32_16x16x32_bf16 v[176:179], a[28:31], v[76:79], v[176:179]
  ds_read_b64_tr_b16 a[156:157], v1 offset:0
  ds_read_b64_tr_b16 a[158:159], v1 offset:512
  v_mfma_f32_16x16x32_bf16 v[180:183], a[32:35], v[76:79], v[180:183]
  s_waitcnt vmcnt(8)
  v_mov_b32 v255, s84
  s_mov_b64 exec, 1
  buffer_store_dword v255, off, s[16:19], s53 offset:512
  s_mov_b64 exec, -1
  v_mfma_f32_16x16x32_bf16 v[184:187], a[36:39], v[76:79], v[184:187]
  buffer_load_dwordx4 v233, s[36:39], s87 offen offset:1024 lds
  v_mfma_f32_16x16x32_bf16 v[172:175], a[40:43], v[80:83], v[172:175]
  v_mfma_f32_16x16x32_bf16 v[176:179], a[44:47], v[80:83], v[176:179]
  ds_read_b64_tr_b16 a[160:161], v2 offset:0
  ds_read_b64_tr_b16 a[162:163], v2 offset:512
  v_mfma_f32_16x16x32_bf16 v[180:183], a[48:51], v[80:83], v[180:183]
  v_mfma_f32_16x16x32_bf16 v[184:187], a[52:55], v[80:83], v[184:187]
  buffer_load_dwordx4 v232, s[36:39], s87 offen offset:2048 lds
  v_mfma_f32_16x16x32_bf16 v[172:175], a[56:59], v[84:87], v[172:175]
  v_mfma_f32_16x16x32_bf16 v[176:179], a[60:63], v[84:87], v[176:179]
  ds_read_b64_tr_b16 a[164:165], v3 offset:0
  ds_read_b64_tr_b16 a[166:167], v3 offset:512
  v_mfma_f32_16x16x32_bf16 v[180:183], a[64:67], v[84:87], v[180:183]
  v_mfma_f32_16x16x32_bf16 v[184:187], a[68:71], v[84:87], v[184:187]
  buffer_load_dwordx4 v231, s[36:39], s87 offen offset:3072 lds
  v_mfma_f32_16x16x32_bf16 v[172:175], a[72:75], v[88:91], v[172:175]
  v_mfma_f32_16x16x32_bf16 v[176:179], a[76:79], v[88:91], v[176:179]
  ds_read_b64_tr_b16 a[168:169], v229 offset:16384
  ds_read_b64_tr_b16 a[170:171], v229 offset:16896
  v_mfma_f32_16x16x32_bf16 v[180:183], a[80:83], v[88:91], v[180:183]
  v_mfma_f32_16x16x32_bf16 v[184:187], a[84:87], v[88:91], v[184:187]
  s_waitcnt lgkmcnt(2)
  s_add_u32 m0, s73, 0
  s_add_u32 s87, s56, 98304
  buffer_load_dwordx4 v234, s[36:39], s87 offen lds
  v_mfma_f32_16x16x32_bf16 v[172:175], a[88:91], v[92:95], v[172:175]
  v_mfma_f32_16x16x32_bf16 v[176:179], a[92:95], v[92:95], v[176:179]
  ds_read_b64_tr_b16 a[172:173], v1 offset:16384
  ds_read_b64_tr_b16 a[174:175], v1 offset:16896
  v_mfma_f32_16x16x32_bf16 v[180:183], a[96:99], v[92:95], v[180:183]
  v_mfma_f32_16x16x32_bf16 v[184:187], a[100:103], v[92:95], v[184:187]
  buffer_load_dwordx4 v233, s[36:39], s87 offen offset:1024 lds
  v_mfma_f32_16x16x32_bf16 v[172:175], a[104:107], v[96:99], v[172:175]
  s_waitcnt vmcnt(7)
  v_xor_b32 v254, s88, v29
  v_mfma_f32_16x16x32_bf16 v[176:179], a[108:111], v[96:99], v[176:179]
  ds_read_b64_tr_b16 a[176:177], v2 offset:16384
  ds_read_b64_tr_b16 a[178:179], v2 offset:16896
  v_cmp_lt_u32 vcc, 31, v254
  v_mfma_f32_16x16x32_bf16 v[180:183], a[112:115], v[96:99], v[180:183]
  v_mfma_f32_16x16x32_bf16 v[184:187], a[116:119], v[96:99], v[184:187]
  buffer_load_dwordx4 v232, s[36:39], s87 offen offset:2048 lds
  s_cbranch_vccnz L_rdy_161
L_rret_162:
  v_mfma_f32_16x16x32_bf16 v[188:191], a[8:11], v[100:103], 0
  buffer_load_dwordx4 v[140:143], v32, s[16:19], s97 offen offset:2048 sc1
  v_mfma_f32_16x16x32_bf16 v[192:195], a[12:15], v[100:103], 0
  ds_read_b64_tr_b16 a[180:181], v3 offset:16384
  ds_read_b64_tr_b16 a[182:183], v3 offset:16896
  v_mfma_f32_16x16x32_bf16 v[196:199], a[16:19], v[100:103], 0
  v_mfma_f32_16x16x32_bf16 v[200:203], a[20:23], v[100:103], 0
  buffer_load_dwordx4 v231, s[36:39], s87 offen offset:3072 lds
  v_mfma_f32_16x16x32_bf16 v[188:191], a[24:27], v[104:107], v[188:191]
  buffer_load_dwordx4 v[144:147], v33, s[16:19], s97 offen offset:2048 sc1
  v_mfma_f32_16x16x32_bf16 v[192:195], a[28:31], v[104:107], v[192:195]
  ds_read_b64_tr_b16 a[184:185], v229 offset:32768
  ds_read_b64_tr_b16 a[186:187], v229 offset:33280
  v_mfma_f32_16x16x32_bf16 v[196:199], a[32:35], v[104:107], v[196:199]
  v_mfma_f32_16x16x32_bf16 v[200:203], a[36:39], v[104:107], v[200:203]
  ds_read_b64_tr_b16 a[188:189], v1 offset:32768
  ds_read_b64_tr_b16 a[190:191], v1 offset:33280
  v_mfma_f32_16x16x32_bf16 v[188:191], a[40:43], v[108:111], v[188:191]
  buffer_load_dwordx4 v[148:151], v34, s[16:19], s97 offen offset:2048 sc1
  v_mfma_f32_16x16x32_bf16 v[192:195], a[44:47], v[108:111], v[192:195]
  ds_read_b64_tr_b16 a[192:193], v2 offset:32768
  ds_read_b64_tr_b16 a[194:195], v2 offset:33280
  v_mfma_f32_16x16x32_bf16 v[196:199], a[48:51], v[108:111], v[196:199]
  v_mfma_f32_16x16x32_bf16 v[200:203], a[52:55], v[108:111], v[200:203]
  ds_read_b64_tr_b16 a[196:197], v3 offset:32768
  ds_read_b64_tr_b16 a[198:199], v3 offset:33280
  v_mfma_f32_16x16x32_bf16 v[188:191], a[56:59], v[112:115], v[188:191]
  buffer_load_dwordx4 v[152:155], v32, s[16:19], s96 offen offset:2048 sc1
  v_mfma_f32_16x16x32_bf16 v[192:195], a[60:63], v[112:115], v[192:195]
  s_waitcnt vmcnt(8)
  ds_read_b64_tr_b16 a[200:201], v229 offset:64512
  ds_read_b64_tr_b16 a[202:203], v229 offset:65024
  v_mfma_f32_16x16x32_bf16 v[196:199], a[64:67], v[112:115], v[196:199]
  v_mfma_f32_16x16x32_bf16 v[200:203], a[68:71], v[112:115], v[200:203]
  ds_read_b64_tr_b16 a[204:205], v1 offset:64512
  ds_read_b64_tr_b16 a[206:207], v1 offset:65024
  v_mfma_f32_16x16x32_bf16 v[188:191], a[72:75], v[116:119], v[188:191]
  buffer_load_dwordx4 v[44:47], v33, s[16:19], s96 offen offset:2048 sc1
  v_mfma_f32_16x16x32_bf16 v[192:195], a[76:79], v[116:119], v[192:195]
  ds_read_b64_tr_b16 a[208:209], v2 offset:64512
  ds_read_b64_tr_b16 a[210:211], v2 offset:65024
  buffer_load_dword v29, v28, s[16:19], s54 offen offset:512 sc1
  v_mfma_f32_16x16x32_bf16 v[196:199], a[80:83], v[116:119], v[196:199]
  v_mfma_f32_16x16x32_bf16 v[200:203], a[84:87], v[116:119], v[200:203]
  ds_read_b64_tr_b16 a[212:213], v3 offset:64512
  ds_read_b64_tr_b16 a[214:215], v3 offset:65024
  v_mfma_f32_16x16x32_bf16 v[188:191], a[88:91], v[120:123], v[188:191]
  buffer_load_dwordx4 v[48:51], v34, s[16:19], s96 offen offset:2048 sc1
  v_mfma_f32_16x16x32_bf16 v[192:195], a[92:95], v[120:123], v[192:195]
  s_waitcnt vmcnt(6)
  ds_read_b64_tr_b16 a[216:217], v229 offset:0
  ds_read_b64_tr_b16 a[218:219], v229 offset:512
  v_mfma_f32_16x16x32_bf16 v[196:199], a[96:99], v[120:123], v[196:199]
  v_mfma_f32_16x16x32_bf16 v[200:203], a[100:103], v[120:123], v[200:203]
  ds_read_b64_tr_b16 a[220:221], v1 offset:0
  ds_read_b64_tr_b16 a[222:223], v1 offset:512
  v_mfma_f32_16x16x32_bf16 v[188:191], a[104:107], v[124:127], v[188:191]
  buffer_load_dwordx4 v[52:55], v32, s[16:19], s77 offen offset:2048 sc1
  v_mfma_f32_16x16x32_bf16 v[192:195], a[108:111], v[124:127], v[192:195]
  ds_read_b64_tr_b16 a[224:225], v2 offset:0
  ds_read_b64_tr_b16 a[226:227], v2 offset:512
  v_mfma_f32_16x16x32_bf16 v[196:199], a[112:115], v[124:127], v[196:199]
  v_mfma_f32_16x16x32_bf16 v[200:203], a[116:119], v[124:127], v[200:203]
  ds_read_b64_tr_b16 a[228:229], v3 offset:0
  ds_read_b64_tr_b16 a[230:231], v3 offset:512
  v_mfma_f32_16x16x32_bf16 v[4:7], a[8:11], v[128:131], v[4:7]
  buffer_load_dwordx4 v[56:59], v33, s[16:19], s77 offen offset:2048 sc1
  v_mfma_f32_16x16x32_bf16 v[8:11], a[12:15], v[128:131], v[8:11]
  v_mfma_f32_16x16x32_bf16 v[12:15], a[16:19], v[128:131], v[12:15]
  v_mfma_f32_16x16x32_bf16 v[16:19], a[20:23], v[128:131], v[16:19]
  v_mfma_f32_16x16x32_bf16 v[4:7], a[24:27], v[132:135], v[4:7]
  buffer_load_dwordx4 v[60:63], v34, s[16:19], s77 offen offset:2048 sc1
  v_mfma_f32_16x16x32_bf16 v[8:11], a[28:31], v[132:135], v[8:11]
  v_mfma_f32_16x16x32_bf16 v[12:15], a[32:35], v[132:135], v[12:15]
  v_mfma_f32_16x16x32_bf16 v[16:19], a[36:39], v[132:135], v[16:19]
  v_mfma_f32_16x16x32_bf16 v[4:7], a[40:43], v[136:139], v[4:7]
  v_mfma_f32_16x16x32_bf16 v[8:11], a[44:47], v[136:139], v[8:11]
  v_mfma_f32_16x16x32_bf16 v[12:15], a[48:51], v[136:139], v[12:15]
  v_mfma_f32_16x16x32_bf16 v[16:19], a[52:55], v[136:139], v[16:19]
  v_mfma_f32_16x16x32_bf16 v[156:159], a[120:123], v[140:143], v[156:159]
  s_waitcnt vmcnt(4)
  v_xor_b32 v254, s88, v29
  v_mfma_f32_16x16x32_bf16 v[160:163], a[124:127], v[140:143], v[160:163]
  v_cmp_lt_u32 vcc, 31, v254
  v_mfma_f32_16x16x32_bf16 v[164:167], a[128:131], v[140:143], v[164:167]
  v_mfma_f32_16x16x32_bf16 v[168:171], a[132:135], v[140:143], v[168:171]
  s_cbranch_vccnz L_rdy_164
L_rret_165:
  v_mfma_f32_16x16x32_bf16 v[156:159], a[136:139], v[144:147], v[156:159]
  buffer_load_dwordx4 v[64:67], v35, s[16:19], s97 offen offset:2048 sc1
  v_mfma_f32_16x16x32_bf16 v[160:163], a[140:143], v[144:147], v[160:163]
  v_mfma_f32_16x16x32_bf16 v[164:167], a[144:147], v[144:147], v[164:167]
  v_mfma_f32_16x16x32_bf16 v[168:171], a[148:151], v[144:147], v[168:171]
  v_mfma_f32_16x16x32_bf16 v[156:159], a[152:155], v[148:151], v[156:159]
  buffer_load_dwordx4 v[68:71], v32, s[16:19], s97 offen offset:3072 sc1
  v_mfma_f32_16x16x32_bf16 v[160:163], a[156:159], v[148:151], v[160:163]
  v_mfma_f32_16x16x32_bf16 v[164:167], a[160:163], v[148:151], v[164:167]
  v_mfma_f32_16x16x32_bf16 v[168:171], a[164:167], v[148:151], v[168:171]
  v_mfma_f32_16x16x32_bf16 v[172:175], a[120:123], v[152:155], v[172:175]
  buffer_load_dwordx4 v[72:75], v33, s[16:19], s97 offen offset:3072 sc1
  v_mfma_f32_16x16x32_bf16 v[176:179], a[124:127], v[152:155], v[176:179]
  s_sub_u32 s91, s95, 1
  s_and_b32 s91, s91, 3
  v_mfma_f32_16x16x32_bf16 v[180:183], a[128:131], v[152:155], v[180:183]
  s_lshl_b32 s91, s91, 12
  v_mfma_f32_16x16x32_bf16 v[184:187], a[132:135], v[152:155], v[184:187]
  s_add_u32 s91, s91, 66560
  v_mfma_f32_16x16x32_bf16 v[172:175], a[136:139], v[44:47], v[172:175]
  buffer_load_dwordx4 v[76:79], v34, s[16:19], s97 offen offset:3072 sc1
  v_mfma_f32_16x16x32_bf16 v[176:179], a[140:143], v[44:47], v[176:179]
  v_add_u32 v28, s91, v253
  v_mfma_f32_16x16x32_bf16 v[180:183], a[144:147], v[44:47], v[180:183]
  v_mfma_f32_16x16x32_bf16 v[184:187], a[148:151], v[44:47], v[184:187]
  s_waitcnt vmcnt(7)
  v_mfma_f32_16x16x32_bf16 v[172:175], a[152:155], v[48:51], v[172:175]
  buffer_load_dwordx4 v[80:83], v35, s[16:19], s96 offen offset:2048 sc1
  v_mfma_f32_16x16x32_bf16 v[176:179], a[156:159], v[48:51], v[176:179]
  s_sub_u32 s91, s95, 2
  s_and_b32 s91, s91, 3
  v_mfma_f32_16x16x32_bf16 v[180:183], a[160:163], v[48:51], v[180:183]
  s_lshl_b32 s91, s91, 12
  v_mfma_f32_16x16x32_bf16 v[184:187], a[164:167], v[48:51], v[184:187]
  s_add_u32 s91, s91, 66560
  s_waitcnt vmcnt(7)
  v_mfma_f32_16x16x32_bf16 v[188:191], a[120:123], v[52:55], v[188:191]
  buffer_load_dwordx4 v[84:87], v32, s[16:19], s96 offen offset:3072 sc1
  v_mfma_f32_16x16x32_bf16 v[192:195], a[124:127], v[52:55], v[192:195]
  v_add_u32 v29, s91, v253
  v_mfma_f32_16x16x32_bf16 v[196:199], a[128:131], v[52:55], v[196:199]
  v_mfma_f32_16x16x32_bf16 v[200:203], a[132:135], v[52:55], v[200:203]
  s_waitcnt vmcnt(7)
  v_mfma_f32_16x16x32_bf16 v[188:191], a[136:139], v[56:59], v[188:191]
  buffer_load_dwordx4 v[88:91], v33, s[16:19], s96 offen offset:3072 sc1
  v_mfma_f32_16x16x32_bf16 v[192:195], a[140:143], v[56:59], v[192:195]
  s_sub_u32 s91, s95, 3
  s_and_b32 s91, s91, 3
  v_mfma_f32_16x16x32_bf16 v[196:199], a[144:147], v[56:59], v[196:199]
  s_lshl_b32 s91, s91, 12
  v_mfma_f32_16x16x32_bf16 v[200:203], a[148:151], v[56:59], v[200:203]
  s_add_u32 s91, s91, 66560
  s_waitcnt vmcnt(7)
  v_mfma_f32_16x16x32_bf16 v[188:191], a[152:155], v[60:63], v[188:191]
  buffer_load_dwordx4 v[92:95], v34, s[16:19], s96 offen offset:3072 sc1
  v_mfma_f32_16x16x32_bf16 v[192:195], a[156:159], v[60:63], v[192:195]
  v_add_u32 v249, s91, v253
  v_mfma_f32_16x16x32_bf16 v[196:199], a[160:163], v[60:63], v[196:199]
  v_mfma_f32_16x16x32_bf16 v[200:203], a[164:167], v[60:63], v[200:203]
  s_waitcnt vmcnt(7) lgkmcnt(14)
  v_mfma_f32_16x16x32_bf16 v[156:159], a[168:171], v[64:67], v[156:159]
  buffer_load_dwordx4 v[96:99], v35, s[16:19], s77 offen offset:2048 sc1
  v_mfma_f32_16x16x32_bf16 v[160:163], a[172:175], v[64:67], v[160:163]
  v_mfma_f32_16x16x32_bf16 v[164:167], a[176:179], v[64:67], v[164:167]
  v_mfma_f32_16x16x32_bf16 v[168:171], a[180:183], v[64:67], v[168:171]
  s_waitcnt vmcnt(7)
  v_mfma_f32_16x16x32_bf16 v[156:159], a[184:187], v[68:71], v[156:159]
  buffer_load_dwordx4 v[100:103], v32, s[16:19], s77 offen offset:3072 sc1
  v_mfma_f32_16x16x32_bf16 v[160:163], a[188:191], v[68:71], v[160:163]
  s_lshl_b32 s74, s94, 2
  v_lshlrev_b32 v250, 10, v252
  s_add_u32 s74, s74, s95
  v_mfma_f32_16x16x32_bf16 v[164:167], a[192:195], v[68:71], v[164:167]
  v_mfma_f32_16x16x32_bf16 v[168:171], a[196:199], v[68:71], v[168:171]
  s_lshl_b32 s74, s74, 14
  v_lshl_add_u32 v250, v251, 5, v250
  s_add_u32 s74, s74, s85
  s_waitcnt vmcnt(7)
  v_mfma_f32_16x16x32_bf16 v[156:159], a[200:203], v[72:75], v[156:159]
  s_waitcnt lgkmcnt(12)
  buffer_load_dwordx4 v[104:107], v33, s[16:19], s77 offen offset:3072 sc1
  v_mfma_f32_16x16x32_bf16 v[160:163], a[204:207], v[72:75], v[160:163]
  s_waitcnt lgkmcnt(10)
  v_mfma_f32_16x16x32_bf16 v[164:167], a[208:211], v[72:75], v[164:167]
  s_waitcnt lgkmcnt(8)
  v_mfma_f32_16x16x32_bf16 v[168:171], a[212:215], v[72:75], v[168:171]
  s_waitcnt vmcnt(7) lgkmcnt(6)
  v_mfma_f32_16x16x32_bf16 v[156:159], a[216:219], v[76:79], v[156:159]
  s_waitcnt lgkmcnt(4)
  buffer_load_dwordx4 v[108:111], v34, s[16:19], s77 offen offset:3072 sc1
  v_mfma_f32_16x16x32_bf16 v[160:163], a[220:223], v[76:79], v[160:163]
  s_waitcnt lgkmcnt(2)
  v_mfma_f32_16x16x32_bf16 v[164:167], a[224:227], v[76:79], v[164:167]
  s_waitcnt lgkmcnt(0)
  v_mfma_f32_16x16x32_bf16 v[168:171], a[228:231], v[76:79], v[168:171]
  s_waitcnt vmcnt(7)
  v_mfma_f32_16x16x32_bf16 v[172:175], a[168:171], v[80:83], v[172:175]
  buffer_load_dwordx4 v[112:115], v32, s[16:19], s76 offen offset:1024 sc1
  v_mfma_f32_16x16x32_bf16 v[176:179], a[172:175], v[80:83], v[176:179]
  v_mfma_f32_16x16x32_bf16 v[180:183], a[176:179], v[80:83], v[180:183]
  v_add_u32 v30, s73, v253
  v_mfma_f32_16x16x32_bf16 v[184:187], a[180:183], v[80:83], v[184:187]
  s_waitcnt vmcnt(7)
  v_mfma_f32_16x16x32_bf16 v[172:175], a[184:187], v[84:87], v[172:175]
  buffer_load_dwordx4 v[116:119], v33, s[16:19], s76 offen offset:1024 sc1
  v_mfma_f32_16x16x32_bf16 v[176:179], a[188:191], v[84:87], v[176:179]
  v_mfma_f32_16x16x32_bf16 v[180:183], a[192:195], v[84:87], v[180:183]
  ds_write_b128 v30, v[156:159] offset:0
  v_mfma_f32_16x16x32_bf16 v[184:187], a[196:199], v[84:87], v[184:187]
  s_waitcnt vmcnt(7)
  v_mfma_f32_16x16x32_bf16 v[172:175], a[200:203], v[88:91], v[172:175]
  buffer_load_dwordx4 v[120:123], v34, s[16:19], s76 offen offset:1024 sc1
  v_mfma_f32_16x16x32_bf16 v[176:179], a[204:207], v[88:91], v[176:179]
  ds_write_b128 v30, v[160:163] offset:1024
  v_mfma_f32_16x16x32_bf16 v[180:183], a[208:211], v[88:91], v[180:183]
  ds_write_b128 v30, v[164:167] offset:2048
  v_mfma_f32_16x16x32_bf16 v[184:187], a[212:215], v[88:91], v[184:187]
  s_waitcnt vmcnt(7)
  v_mfma_f32_16x16x32_bf16 v[172:175], a[216:219], v[92:95], v[172:175]
  buffer_load_dwordx4 v[124:127], v35, s[16:19], s76 offen offset:0 sc1
  v_mfma_f32_16x16x32_bf16 v[176:179], a[220:223], v[92:95], v[176:179]
  ds_write_b128 v30, v[168:171] offset:3072
  v_mfma_f32_16x16x32_bf16 v[180:183], a[224:227], v[92:95], v[180:183]
  v_mfma_f32_16x16x32_bf16 v[184:187], a[228:231], v[92:95], v[184:187]
  s_waitcnt vmcnt(7)
  v_mfma_f32_16x16x32_bf16 v[188:191], a[168:171], v[96:99], v[188:191]
  buffer_load_dwordx4 v[128:131], v32, s[16:19], s76 offen offset:2048 sc1
  v_mfma_f32_16x16x32_bf16 v[192:195], a[172:175], v[96:99], v[192:195]
  v_mfma_f32_16x16x32_bf16 v[196:199], a[176:179], v[96:99], v[196:199]
  v_mfma_f32_16x16x32_bf16 v[200:203], a[180:183], v[96:99], v[200:203]
  s_waitcnt vmcnt(7)
  v_mfma_f32_16x16x32_bf16 v[188:191], a[184:187], v[100:103], v[188:191]
  buffer_load_dwordx4 v[132:135], v33, s[16:19], s76 offen offset:2048 sc1
  v_mfma_f32_16x16x32_bf16 v[192:195], a[188:191], v[100:103], v[192:195]
  v_mfma_f32_16x16x32_bf16 v[196:199], a[192:195], v[100:103], v[196:199]
  ds_write_b128 v30, v[172:175] offset:16384
  v_mfma_f32_16x16x32_bf16 v[200:203], a[196:199], v[100:103], v[200:203]
  s_waitcnt vmcnt(7)
  v_mfma_f32_16x16x32_bf16 v[188:191], a[200:203], v[104:107], v[188:191]
  buffer_load_dwordx4 v[136:139], v34, s[16:19], s76 offen offset:2048 sc1
  v_mfma_f32_16x16x32_bf16 v[192:195], a[204:207], v[104:107], v[192:195]
  ds_write_b128 v30, v[176:179] offset:17408
  v_mfma_f32_16x16x32_bf16 v[196:199], a[208:211], v[104:107], v[196:199]
  ds_write_b128 v30, v[180:183] offset:18432
  v_mfma_f32_16x16x32_bf16 v[200:203], a[212:215], v[104:107], v[200:203]
  s_waitcnt vmcnt(7)
  v_mfma_f32_16x16x32_bf16 v[188:191], a[216:219], v[108:111], v[188:191]
  buffer_load_dwordx4 v[140:143], v35, s[16:19], s76 offen offset:2048 sc1
  v_mfma_f32_16x16x32_bf16 v[192:195], a[220:223], v[108:111], v[192:195]
  ds_write_b128 v30, v[184:187] offset:19456
  v_mfma_f32_16x16x32_bf16 v[196:199], a[224:227], v[108:111], v[196:199]
  v_mfma_f32_16x16x32_bf16 v[200:203], a[228:231], v[108:111], v[200:203]
  s_waitcnt vmcnt(7)
  v_mfma_f32_16x16x32_bf16 v[4:7], a[56:59], v[112:115], v[4:7]
  buffer_load_dwordx4 v[144:147], v32, s[16:19], s76 offen offset:3072 sc1
  v_mfma_f32_16x16x32_bf16 v[8:11], a[60:63], v[112:115], v[8:11]
  v_mfma_f32_16x16x32_bf16 v[12:15], a[64:67], v[112:115], v[12:15]
  v_mfma_f32_16x16x32_bf16 v[16:19], a[68:71], v[112:115], v[16:19]
  s_waitcnt vmcnt(7)
  v_mfma_f32_16x16x32_bf16 v[4:7], a[72:75], v[116:119], v[4:7]
  buffer_load_dwordx4 v[148:151], v33, s[16:19], s76 offen offset:3072 sc1
  ds_write_b128 v30, v[188:191] offset:32768
  v_mfma_f32_16x16x32_bf16 v[8:11], a[76:79], v[116:119], v[8:11]
  ds_write_b128 v30, v[192:195] offset:33792
  v_mfma_f32_16x16x32_bf16 v[12:15], a[80:83], v[116:119], v[12:15]
  ds_write_b128 v30, v[196:199] offset:34816
  v_mfma_f32_16x16x32_bf16 v[16:19], a[84:87], v[116:119], v[16:19]
  s_waitcnt vmcnt(7)
  v_mfma_f32_16x16x32_bf16 v[4:7], a[88:91], v[120:123], v[4:7]
  buffer_load_dwordx4 v[152:155], v34, s[16:19], s76 offen offset:3072 sc1
  ds_write_b128 v30, v[200:203] offset:35840
  v_mfma_f32_16x16x32_bf16 v[8:11], a[92:95], v[120:123], v[8:11]
  v_mfma_f32_16x16x32_bf16 v[12:15], a[96:99], v[120:123], v[12:15]
  v_mfma_f32_16x16x32_bf16 v[16:19], a[100:103], v[120:123], v[16:19]
  s_waitcnt vmcnt(7)
  v_mfma_f32_16x16x32_bf16 v[4:7], a[104:107], v[124:127], v[4:7]
  s_waitcnt lgkmcnt(0)
  s_barrier
  ds_read_b128 v[156:159], v28 offset:0
  ds_read_b128 v[172:175], v29 offset:16384
  ds_read_b128 v[188:191], v249 offset:32768
  v_mfma_f32_16x16x32_bf16 v[8:11], a[108:111], v[124:127], v[8:11]
  ds_read_b128 v[160:163], v28 offset:1024
  ds_read_b128 v[176:179], v29 offset:17408
  ds_read_b128 v[192:195], v249 offset:33792
  v_mfma_f32_16x16x32_bf16 v[12:15], a[112:115], v[124:127], v[12:15]
  ds_read_b128 v[164:167], v28 offset:2048
  ds_read_b128 v[180:183], v29 offset:18432
  ds_read_b128 v[196:199], v249 offset:34816
  v_mfma_f32_16x16x32_bf16 v[16:19], a[116:119], v[124:127], v[16:19]
  ds_read_b128 v[168:171], v28 offset:3072
  ds_read_b128 v[184:187], v29 offset:19456
  ds_read_b128 v[200:203], v249 offset:35840
  s_waitcnt vmcnt(6)
  v_mfma_f32_16x16x32_bf16 v[4:7], a[120:123], v[128:131], v[4:7]
  v_mfma_f32_16x16x32_bf16 v[8:11], a[124:127], v[128:131], v[8:11]
  v_mfma_f32_16x16x32_bf16 v[12:15], a[128:131], v[128:131], v[12:15]
  v_mfma_f32_16x16x32_bf16 v[16:19], a[132:135], v[128:131], v[16:19]
  s_waitcnt vmcnt(5)
  v_mfma_f32_16x16x32_bf16 v[4:7], a[136:139], v[132:135], v[4:7]
  v_mfma_f32_16x16x32_bf16 v[8:11], a[140:143], v[132:135], v[8:11]
  v_mfma_f32_16x16x32_bf16 v[12:15], a[144:147], v[132:135], v[12:15]
  v_mfma_f32_16x16x32_bf16 v[16:19], a[148:151], v[132:135], v[16:19]
  s_waitcnt vmcnt(4)
  v_mfma_f32_16x16x32_bf16 v[4:7], a[152:155], v[136:139], v[4:7]
  s_waitcnt lgkmcnt(10)
  v_add_f32 v156, v156, v172
  v_add_f32 v157, v157, v173
  v_mfma_f32_16x16x32_bf16 v[8:11], a[156:159], v[136:139], v[8:11]
  v_add_f32 v158, v158, v174
  v_add_f32 v159, v159, v175
  v_mfma_f32_16x16x32_bf16 v[12:15], a[160:163], v[136:139], v[12:15]
  s_waitcnt lgkmcnt(9)
  v_add_f32 v156, v156, v188
  v_add_f32 v157, v157, v189
  v_mfma_f32_16x16x32_bf16 v[16:19], a[164:167], v[136:139], v[16:19]
  v_add_f32 v158, v158, v190
  s_waitcnt vmcnt(3)
  v_mfma_f32_16x16x32_bf16 v[4:7], a[168:171], v[140:143], v[4:7]
  s_waitcnt lgkmcnt(7)
  v_add_f32 v159, v159, v191
  v_add_f32 v160, v160, v176
  v_mfma_f32_16x16x32_bf16 v[8:11], a[172:175], v[140:143], v[8:11]
  v_add_f32 v161, v161, v177
  v_add_f32 v162, v162, v178
  v_mfma_f32_16x16x32_bf16 v[12:15], a[176:179], v[140:143], v[12:15]
  s_waitcnt lgkmcnt(6)
  v_add_f32 v163, v163, v179
  v_add_f32 v160, v160, v192
  v_mfma_f32_16x16x32_bf16 v[16:19], a[180:183], v[140:143], v[16:19]
  v_add_f32 v161, v161, v193
  s_waitcnt vmcnt(2)
  v_mfma_f32_16x16x32_bf16 v[4:7], a[184:187], v[144:147], v[4:7]
  v_add_f32 v162, v162, v194
  v_add_f32 v163, v163, v195
  v_mfma_f32_16x16x32_bf16 v[8:11], a[188:191], v[144:147], v[8:11]
  s_waitcnt lgkmcnt(4)
  v_add_f32 v164, v164, v180
  v_add_f32 v165, v165, v181
  v_mfma_f32_16x16x32_bf16 v[12:15], a[192:195], v[144:147], v[12:15]
  v_add_f32 v166, v166, v182
  v_add_f32 v167, v167, v183
  v_mfma_f32_16x16x32_bf16 v[16:19], a[196:199], v[144:147], v[16:19]
  s_waitcnt lgkmcnt(3)
  v_add_f32 v164, v164, v196
  s_waitcnt vmcnt(1)
  v_mfma_f32_16x16x32_bf16 v[4:7], a[200:203], v[148:151], v[4:7]
  v_add_f32 v165, v165, v197
  v_add_f32 v166, v166, v198
  v_mfma_f32_16x16x32_bf16 v[8:11], a[204:207], v[148:151], v[8:11]
  v_add_f32 v167, v167, v199
  s_waitcnt lgkmcnt(1)
  v_add_f32 v168, v168, v184
  v_mfma_f32_16x16x32_bf16 v[12:15], a[208:211], v[148:151], v[12:15]
  v_add_f32 v169, v169, v185
  v_add_f32 v170, v170, v186
  v_mfma_f32_16x16x32_bf16 v[16:19], a[212:215], v[148:151], v[16:19]
  v_add_f32 v171, v171, v187
  s_waitcnt vmcnt(0)
  v_mfma_f32_16x16x32_bf16 v[4:7], a[216:219], v[152:155], v[4:7]
  s_waitcnt lgkmcnt(0)
  v_add_f32 v168, v168, v200
  v_add_f32 v169, v169, v201
  v_mfma_f32_16x16x32_bf16 v[8:11], a[220:223], v[152:155], v[8:11]
  v_add_f32 v170, v170, v202
  v_add_f32 v171, v171, v203
  v_mfma_f32_16x16x32_bf16 v[12:15], a[224:227], v[152:155], v[12:15]
  v_mfma_f32_16x16x32_bf16 v[16:19], a[228:231], v[152:155], v[16:19]
  v_pk_add_f32 v[4:5], v[4:5], v[156:157]
  v_pk_add_f32 v[6:7], v[6:7], v[158:159]
  s_nop 1
  v_pk_add_f32 v[8:9], v[8:9], v[160:161]
  v_pk_add_f32 v[10:11], v[10:11], v[162:163]
  s_nop 0
  v_pk_add_f32 v[12:13], v[12:13], v[164:165]
  v_pk_add_f32 v[14:15], v[14:15], v[166:167]
  v_pk_add_f32 v[16:17], v[16:17], v[168:169]
  v_pk_add_f32 v[18:19], v[18:19], v[170:171]
  v_cvt_pk_bf16_f32 v20, v4, v5
  v_cvt_pk_bf16_f32 v21, v6, v7
  v_cvt_pk_bf16_f32 v22, v8, v9
  v_cvt_pk_bf16_f32 v23, v10, v11
  v_cvt_pk_bf16_f32 v24, v12, v13
  v_cvt_pk_bf16_f32 v25, v14, v15
  v_cvt_pk_bf16_f32 v26, v16, v17
  v_cvt_pk_bf16_f32 v27, v18, v19
  v_permlane16_swap_b32 v20, v22
  v_permlane16_swap_b32 v24, v26
  v_permlane16_swap_b32 v21, v23
  v_permlane16_swap_b32 v25, v27
  v_permlane32_swap_b32 v20, v24
  v_permlane32_swap_b32 v22, v26
  v_permlane32_swap_b32 v21, v25
  v_permlane32_swap_b32 v23, v27
  buffer_store_dwordx4 v[20:23], v250, s[40:43], s74 offen
  buffer_store_dwordx4 v[24:27], v250, s[40:43], s74 offen offset:16
L_end:
  s_endpgm
L_draw_1:
  s_memrealtime s[96:97]
  s_waitcnt lgkmcnt(0)
  v_mov_b32 v255, s96
  v_or_b32 v255, 1, v255
  s_lshl_b32 s97, s2, 5
  s_mov_b64 exec, 1
  buffer_store_dword v255, off, s[12:15], s97 sc1
  s_mov_b64 exec, -1
  s_branch L_drawn_2
L_nonce_3:
  s_sub_u32 s89, s89, 1
  s_cbranch_scc1 L_ngo_5
  buffer_load_dword v225, off, s[12:15], 0 sc1
  s_waitcnt vmcnt(0)
  v_readfirstlane_b32 s88, v225
  s_nop 0
  s_cmp_eq_u32 s88, 0
  s_cbranch_scc1 L_nonce_3
  s_branch L_nret_4
L_ngo_5:
  s_mov_b32 s89, 0
  s_waitcnt vmcnt(0)
  s_branch L_nret_4
L_rdy_6:
  s_sub_u32 s89, s89, 1
  s_cbranch_scc1 L_rgo_8
  buffer_load_dword v225, v226, s[16:19], s56 offen sc1
  s_waitcnt vmcnt(0)
  v_xor_b32 v254, s88, v225
  v_cmp_lt_u32 vcc, 31, v254
  s_cbranch_vccnz L_rdy_6
  s_branch L_rret_7
L_rgo_8:
  s_mov_b32 s89, 0
  s_waitcnt vmcnt(0)
  s_branch L_rret_7
L_attn_exit_10:
  v_mfma_f32_32x32x16_bf16 v[152:167], v[196:199], v[172:175], v[152:167]
  s_mov_b32 exec_hi, 0
  buffer_store_dwordx4 a[12:15], v230, s[16:19], s86 offen sc1
  s_mov_b32 exec_hi, -1
  s_add_u32 s91, s96, 196608
  buffer_store_dwordx4 a[8:11], v253, s[16:19], s91 offen offset:0 sc1
  s_add_u32 m0, s69, s75
  s_mul_i32 s64, s69, 8
  buffer_load_dwordx4 v247, s[20:23], s64 offen lds
  v_add_u32 v245, 31744, v247
  buffer_load_dwordx4 v245, s[20:23], s64 offen offset:1024 lds
  v_add_u32 v244, 63488, v247
  buffer_load_dwordx4 v244, s[20:23], s64 offen offset:2048 lds
  v_add_u32 v242, 95232, v247
  buffer_load_dwordx4 v242, s[20:23], s64 offen offset:3072 lds
  s_add_u32 m0, s68, s75
  s_mul_i32 s64, s68, 8
  buffer_load_dwordx4 v247, s[20:23], s64 offen lds
  buffer_load_dwordx4 v245, s[20:23], s64 offen offset:1024 lds
  buffer_load_dwordx4 v244, s[20:23], s64 offen offset:2048 lds
  buffer_load_dwordx4 v242, s[20:23], s64 offen offset:3072 lds
  s_add_u32 m0, s67, s75
  s_mul_i32 s64, s67, 8
  buffer_load_dwordx4 v247, s[20:23], s64 offen lds
  buffer_load_dwordx4 v245, s[20:23], s64 offen offset:1024 lds
  buffer_load_dwordx4 v244, s[20:23], s64 offen offset:2048 lds
  buffer_load_dwordx4 v242, s[20:23], s64 offen offset:3072 lds
  s_add_u32 m0, s66, s75
  s_mul_i32 s64, s66, 8
  buffer_load_dwordx4 v247, s[20:23], s64 offen lds
  buffer_load_dwordx4 v245, s[20:23], s64 offen offset:1024 lds
  s_lshl_b32 s55, s2, 2
  s_add_u32 s55, s55, s95
  s_mul_i32 s55, s55, 2304
  s_mov_b64 s[44:45], s[32:33]
  s_mov_b32 s46, 1835008
  s_mov_b32 s47, 0x20000
  s_cmp_ge_u32 s55, s46
  s_cselect_b64 s[44:45], s[28:29], s[44:45]
  s_cselect_b32 s91, s46, 0
  s_cselect_b32 s46, 524288, s46
  s_sub_u32 s55, s55, s91
  v_lshlrev_b32 v255, 7, v0
  s_mov_b64 exec, 0x3ffff
  buffer_load_dword a5, v255, s[44:47], s55 offen
  s_mov_b64 exec, -1
  buffer_load_dwordx4 v244, s[20:23], s64 offen offset:2048 lds
  buffer_load_dwordx4 v242, s[20:23], s64 offen offset:3072 lds
  s_add_u32 m0, s69, s75
  s_add_u32 m0, m0, 65536
  s_mul_i32 s64, s69, 8
  buffer_load_dwordx4 v246, s[24:27], s64 offen lds
  v_add_u32 v245, 31744, v246
  buffer_load_dwordx4 v245, s[24:27], s64 offen offset:1024 lds
  v_add_u32 v244, 63488, v246
  buffer_load_dwordx4 v244, s[24:27], s64 offen offset:2048 lds
  v_add_u32 v242, 95232, v246
  buffer_load_dwordx4 v242, s[24:27], s64 offen offset:3072 lds
  s_add_u32 m0, s68, s75
  s_add_u32 m0, m0, 65536
  s_mul_i32 s64, s68, 8
  buffer_load_dwordx4 v246, s[24:27], s64 offen lds
  buffer_load_dwordx4 v245, s[24:27], s64 offen offset:1024 lds
  s_bitcmp1_b32 s94, 0
  s_cselect_b32 s91, 1, -1
  s_add_i32 s91, s91, s94
  s_max_i32 s91, s91, 0
  s_min_i32 s91, s91, 31
  s_and_b32 s90, s94, -2
  v_bfe_u32 v240, v0, 3, 1
  v_add_u32 v240, s90, v240
  v_mov_b32 v250, s91
  v_cndmask_b32 v240, v250, v240, s[82:83]
  s_mov_b32 s91, 360448
  v_mul_lo_u32 v240, v240, s91
  v_and_b32 v250, 7, v0
  v_lshl_add_u32 v240, v250, 7, v240
  v_add_u32 v240, 356352, v240
  buffer_load_dword v241, v240, s[16:19], 0 offen sc1
  buffer_load_dwordx4 v244, s[24:27], s64 offen offset:2048 lds
  buffer_load_dwordx4 v242, s[24:27], s64 offen offset:3072 lds
  s_waitcnt vmcnt(0)
  s_branch L_attn_done_9
L_attn_exit_11:
  v_mfma_f32_32x32x16_bf16 v[152:167], v[20:23], v[172:175], v[152:167]
  s_add_u32 m0, s67, s75
  s_mul_i32 s64, s67, 8
  buffer_load_dwordx4 v247, s[20:23], s64 offen lds
  buffer_load_dwordx4 v245, s[20:23], s64 offen offset:1024 lds
  buffer_load_dwordx4 v244, s[20:23], s64 offen offset:2048 lds
  buffer_load_dwordx4 v242, s[20:23], s64 offen offset:3072 lds
  s_add_u32 m0, s66, s75
  s_mul_i32 s64, s66, 8
  buffer_load_dwordx4 v247, s[20:23], s64 offen lds
  buffer_load_dwordx4 v245, s[20:23], s64 offen offset:1024 lds
  s_lshl_b32 s55, s2, 2
  s_add_u32 s55, s55, s95
  s_mul_i32 s55, s55, 2304
  s_mov_b64 s[44:45], s[32:33]
  s_mov_b32 s46, 1835008
  s_mov_b32 s47, 0x20000
  s_cmp_ge_u32 s55, s46
  s_cselect_b64 s[44:45], s[28:29], s[44:45]
  s_cselect_b32 s91, s46, 0
  s_cselect_b32 s46, 524288, s46
  s_sub_u32 s55, s55, s91
  v_lshlrev_b32 v255, 7, v0
  s_mov_b64 exec, 0x3ffff
  buffer_load_dword a5, v255, s[44:47], s55 offen
  s_mov_b64 exec, -1
  buffer_load_dwordx4 v244, s[20:23], s64 offen offset:2048 lds
  buffer_load_dwordx4 v242, s[20:23], s64 offen offset:3072 lds
  s_add_u32 m0, s69, s75
  s_add_u32 m0, m0, 65536
  s_mul_i32 s64, s69, 8
  buffer_load_dwordx4 v246, s[24:27], s64 offen lds
  v_add_u32 v245, 31744, v246
  buffer_load_dwordx4 v245, s[24:27], s64 offen offset:1024 lds
  v_add_u32 v244, 63488, v246
  buffer_load_dwordx4 v244, s[24:27], s64 offen offset:2048 lds
  v_add_u32 v242, 95232, v246
  buffer_load_dwordx4 v242, s[24:27], s64 offen offset:3072 lds
  s_add_u32 m0, s68, s75
  s_add_u32 m0, m0, 65536
  s_mul_i32 s64, s68, 8
  buffer_load_dwordx4 v246, s[24:27], s64 offen lds
  buffer_load_dwordx4 v245, s[24:27], s64 offen offset:1024 lds
  s_bitcmp1_b32 s94, 0
  s_cselect_b32 s91, 1, -1
  s_add_i32 s91, s91, s94
  s_max_i32 s91, s91, 0
  s_min_i32 s91, s91, 31
  s_and_b32 s90, s94, -2
  v_bfe_u32 v240, v0, 3, 1
  v_add_u32 v240, s90, v240
  v_mov_b32 v250, s91
  v_cndmask_b32 v240, v250, v240, s[82:83]
  s_mov_b32 s91, 360448
  v_mul_lo_u32 v240, v240, s91
  v_and_b32 v250, 7, v0
  v_lshl_add_u32 v240, v250, 7, v240
  v_add_u32 v240, 356352, v240
  buffer_load_dword v241, v240, s[16:19], 0 offen sc1
  buffer_load_dwordx4 v244, s[24:27], s64 offen offset:2048 lds
  buffer_load_dwordx4 v242, s[24:27], s64 offen offset:3072 lds
  s_waitcnt vmcnt(0)
  s_branch L_attn_done_9
L_attn_exit_12:
  v_mfma_f32_32x32x16_bf16 v[152:167], v[36:39], v[172:175], v[152:167]
  buffer_load_dwordx4 v242, s[20:23], s64 offen offset:3072 lds
  s_add_u32 m0, s69, s75
  s_add_u32 m0, m0, 65536
  s_mul_i32 s64, s69, 8
  buffer_load_dwordx4 v246, s[24:27], s64 offen lds
  v_add_u32 v245, 31744, v246
  buffer_load_dwordx4 v245, s[24:27], s64 offen offset:1024 lds
  v_add_u32 v244, 63488, v246
  buffer_load_dwordx4 v244, s[24:27], s64 offen offset:2048 lds
  v_add_u32 v242, 95232, v246
  buffer_load_dwordx4 v242, s[24:27], s64 offen offset:3072 lds
  s_add_u32 m0, s68, s75
  s_add_u32 m0, m0, 65536
  s_mul_i32 s64, s68, 8
  buffer_load_dwordx4 v246, s[24:27], s64 offen lds
  buffer_load_dwordx4 v245, s[24:27], s64 offen offset:1024 lds
  s_bitcmp1_b32 s94, 0
  s_cselect_b32 s91, 1, -1
  s_add_i32 s91, s91, s94
  s_max_i32 s91, s91, 0
  s_min_i32 s91, s91, 31
  s_and_b32 s90, s94, -2
  v_bfe_u32 v240, v0, 3, 1
  v_add_u32 v240, s90, v240
  v_mov_b32 v250, s91
  v_cndmask_b32 v240, v250, v240, s[82:83]
  s_mov_b32 s91, 360448
  v_mul_lo_u32 v240, v240, s91
  v_and_b32 v250, 7, v0
  v_lshl_add_u32 v240, v250, 7, v240
  v_add_u32 v240, 356352, v240
  buffer_load_dword v241, v240, s[16:19], 0 offen sc1
  buffer_load_dwordx4 v244, s[24:27], s64 offen offset:2048 lds
  buffer_load_dwordx4 v242, s[24:27], s64 offen offset:3072 lds
  s_waitcnt vmcnt(0)
  s_branch L_attn_done_9
L_attn_exit_13:
  v_mfma_f32_32x32x16_bf16 v[152:167], v[52:55], v[172:175], v[152:167]
  buffer_load_dwordx4 v244, s[24:27], s64 offen offset:2048 lds
  buffer_load_dwordx4 v242, s[24:27], s64 offen offset:3072 lds
  s_waitcnt vmcnt(0)
  s_branch L_attn_done_9
L_attn_truemax_14:
  s_waitcnt vmcnt(0)
  v_mfma_f32_32x32x16_bf16 v[104:119], v[180:183], v[176:179], v[72:87]
  s_nop 11
  v_max_f32 v239, v104, v105
  v_max3_f32 v239, v106, v107, v239
  v_max3_f32 v239, v108, v109, v239
  v_max3_f32 v239, v110, v111, v239
  v_max3_f32 v239, v112, v113, v239
  v_max3_f32 v239, v114, v115, v239
  v_max3_f32 v239, v116, v117, v239
  v_max3_f32 v239, v118, v119, v239
  v_mfma_f32_32x32x16_bf16 v[120:135], v[180:183], v[184:187], 0
  s_nop 11
  v_max_f32 v238, v120, v121
  v_max3_f32 v238, v122, v123, v238
  v_max3_f32 v238, v124, v125, v238
  v_max3_f32 v238, v126, v127, v238
  v_max3_f32 v238, v128, v129, v238
  v_max3_f32 v238, v130, v131, v238
  v_max3_f32 v238, v132, v133, v238
  v_max3_f32 v238, v134, v135, v238
  v_mfma_f32_32x32x16_bf16 v[104:119], v[188:191], v[184:187], v[72:87]
  s_nop 11
  v_max3_f32 v238, v104, v105, v238
  v_max3_f32 v238, v106, v107, v238
  v_max3_f32 v238, v108, v109, v238
  v_max3_f32 v238, v110, v111, v238
  v_max3_f32 v238, v112, v113, v238
  v_max3_f32 v238, v114, v115, v238
  v_max3_f32 v238, v116, v117, v238
  v_max3_f32 v238, v118, v119, v238
  s_cmp_le_u32 s94, 0
  s_cbranch_scc1 L_fb_p2_16
  v_mfma_f32_32x32x16_bf16 v[120:135], a[16:19], v[176:179], 0
  s_nop 11
  v_max3_f32 v239, v120, v121, v239
  v_max3_f32 v239, v122, v123, v239
  v_max3_f32 v239, v124, v125, v239
  v_max3_f32 v239, v126, v127, v239
  v_max3_f32 v239, v128, v129, v239
  v_max3_f32 v239, v130, v131, v239
  v_max3_f32 v239, v132, v133, v239
  v_max3_f32 v239, v134, v135, v239
  v_mfma_f32_32x32x16_bf16 v[104:119], a[20:23], v[176:179], 0
  s_nop 11
  v_max3_f32 v239, v104, v105, v239
  v_max3_f32 v239, v106, v107, v239
  v_max3_f32 v239, v108, v109, v239
  v_max3_f32 v239, v110, v111, v239
  v_max3_f32 v239, v112, v113, v239
  v_max3_f32 v239, v114, v115, v239
  v_max3_f32 v239, v116, v117, v239
  v_max3_f32 v239, v118, v119, v239
  v_mfma_f32_32x32x16_bf16 v[120:135], a[16:19], v[184:187], 0
  s_nop 11
  v_max3_f32 v238, v120, v121, v238
  v_max3_f32 v238, v122, v123, v238
  v_max3_f32 v238, v124, v125, v238
  v_max3_f32 v238, v126, v127, v238
  v_max3_f32 v238, v128, v129, v238
  v_max3_f32 v238, v130, v131, v238
  v_max3_f32 v238, v132, v133, v238
  v_max3_f32 v238, v134, v135, v238
  v_mfma_f32_32x32x16_bf16 v[104:119], a[20:23], v[184:187], 0
  s_nop 11
  v_max3_f32 v238, v104, v105, v238
  v_max3_f32 v238, v106, v107, v238
  v_max3_f32 v238, v108, v109, v238
  v_max3_f32 v238, v110, v111, v238
  v_max3_f32 v238, v112, v113, v238
  v_max3_f32 v238, v114, v115, v238
  v_max3_f32 v238, v116, v117, v238
  v_max3_f32 v238, v118, v119, v238
  s_cmp_le_u32 s94, 1
  s_cbranch_scc1 L_fb_p2_16
  v_mfma_f32_32x32x16_bf16 v[120:135], a[24:27], v[176:179], 0
  s_nop 11
  v_max3_f32 v239, v120, v121, v239
  v_max3_f32 v239, v122, v123, v239
  v_max3_f32 v239, v124, v125, v239
  v_max3_f32 v239, v126, v127, v239
  v_max3_f32 v239, v128, v129, v239
  v_max3_f32 v239, v130, v131, v239
  v_max3_f32 v239, v132, v133, v239
  v_max3_f32 v239, v134, v135, v239
  v_mfma_f32_32x32x16_bf16 v[104:119], a[28:31], v[176:179], 0
  s_nop 11
  v_max3_f32 v239, v104, v105, v239
  v_max3_f32 v239, v106, v107, v239
  v_max3_f32 v239, v108, v109, v239
  v_max3_f32 v239, v110, v111, v239
  v_max3_f32 v239, v112, v113, v239
  v_max3_f32 v239, v114, v115, v239
  v_max3_f32 v239, v116, v117, v239
  v_max3_f32 v239, v118, v119, v239
  v_mfma_f32_32x32x16_bf16 v[120:135], a[24:27], v[184:187], 0
  s_nop 11
  v_max3_f32 v238, v120, v121, v238
  v_max3_f32 v238, v122, v123, v238
  v_max3_f32 v238, v124, v125, v238
  v_max3_f32 v238, v126, v127, v238
  v_max3_f32 v238, v128, v129, v238
  v_max3_f32 v238, v130, v131, v238
  v_max3_f32 v238, v132, v133, v238
  v_max3_f32 v238, v134, v135, v238
  v_mfma_f32_32x32x16_bf16 v[104:119], a[28:31], v[184:187], 0
  s_nop 11
  v_max3_f32 v238, v104, v105, v238
  v_max3_f32 v238, v106, v107, v238
  v_max3_f32 v238, v108, v109, v238
  v_max3_f32 v238, v110, v111, v238
  v_max3_f32 v238, v112, v113, v238
  v_max3_f32 v238, v114, v115, v238
  v_max3_f32 v238, v116, v117, v238
  v_max3_f32 v238, v118, v119, v238
  s_cmp_le_u32 s94, 2
  s_cbranch_scc1 L_fb_p2_16
  v_mfma_f32_32x32x16_bf16 v[120:135], a[32:35], v[176:179], 0
  s_nop 11
  v_max3_f32 v239, v120, v121, v239
  v_max3_f32 v239, v122, v123, v239
  v_max3_f32 v239, v124, v125, v239
  v_max3_f32 v239, v126, v127, v239
  v_max3_f32 v239, v128, v129, v239
  v_max3_f32 v239, v130, v131, v239
  v_max3_f32 v239, v132, v133, v239
  v_max3_f32 v239, v134, v135, v239
  v_mfma_f32_32x32x16_bf16 v[104:119], a[36:39], v[176:179], 0
  s_nop 11
  v_max3_f32 v239, v104, v105, v239
  v_max3_f32 v239, v106, v107, v239
  v_max3_f32 v239, v108, v109, v239
  v_max3_f32 v239, v110, v111, v239
  v_max3_f32 v239, v112, v113, v239
  v_max3_f32 v239, v114, v115, v239
  v_max3_f32 v239, v116, v117, v239
  v_max3_f32 v239, v118, v119, v239
  v_mfma_f32_32x32x16_bf16 v[120:135], a[32:35], v[184:187], 0
  s_nop 11
  v_max3_f32 v238, v120, v121, v238
  v_max3_f32 v238, v122, v123, v238
  v_max3_f32 v238, v124, v125, v238
  v_max3_f32 v238, v126, v127, v238
  v_max3_f32 v238, v128, v129, v238
  v_max3_f32 v238, v130, v131, v238
  v_max3_f32 v238, v132, v133, v238
  v_max3_f32 v238, v134, v135, v238
  v_mfma_f32_32x32x16_bf16 v[104:119], a[36:39], v[184:187], 0
  s_nop 11
  v_max3_f32 v238, v104, v105, v238
  v_max3_f32 v238, v106, v107, v238
  v_max3_f32 v238, v108, v109, v238
  v_max3_f32 v238, v110, v111, v238
  v_max3_f32 v238, v112, v113, v238
  v_max3_f32 v238, v114, v115, v238
  v_max3_f32 v238, v116, v117, v238
  v_max3_f32 v238, v118, v119, v238
  s_cmp_le_u32 s94, 3
  s_cbranch_scc1 L_fb_p2_16
  v_mfma_f32_32x32x16_bf16 v[120:135], a[40:43], v[176:179], v[88:103]
  s_nop 11
  v_max3_f32 v239, v120, v121, v239
  v_max3_f32 v239, v122, v123, v239
  v_max3_f32 v239, v124, v125, v239
  v_max3_f32 v239, v126, v127, v239
  v_max3_f32 v239, v128, v129, v239
  v_max3_f32 v239, v130, v131, v239
  v_max3_f32 v239, v132, v133, v239
  v_max3_f32 v239, v134, v135, v239
  v_mfma_f32_32x32x16_bf16 v[104:119], a[44:47], v[176:179], 0
  s_nop 11
  v_max3_f32 v239, v104, v105, v239
  v_max3_f32 v239, v106, v107, v239
  v_max3_f32 v239, v108, v109, v239
  v_max3_f32 v239, v110, v111, v239
  v_max3_f32 v239, v112, v113, v239
  v_max3_f32 v239, v114, v115, v239
  v_max3_f32 v239, v116, v117, v239
  v_max3_f32 v239, v118, v119, v239
  v_mfma_f32_32x32x16_bf16 v[120:135], a[44:47], v[184:187], v[88:103]
  s_nop 11
  v_max3_f32 v238, v120, v121, v238
  v_max3_f32 v238, v122, v123, v238
  v_max3_f32 v238, v124, v125, v238
  v_max3_f32 v238, v126, v127, v238
  v_max3_f32 v238, v128, v129, v238
  v_max3_f32 v238, v130, v131, v238
  v_max3_f32 v238, v132, v133, v238
  v_max3_f32 v238, v134, v135, v238
L_fb_p2_16:
  v_mov_b32 v250, v239
  s_nop 1
  v_permlane32_swap_b32 v239, v250
  v_max_f32 v239, v239, v250
  v_mov_b32 v250, v238
  s_nop 1
  v_permlane32_swap_b32 v238, v250
  v_max_f32 v238, v238, v250
  v_mfma_f32_32x32x16_bf16 v[104:119], v[180:183], v[176:179], v[72:87]
  s_nop 11
  v_sub_f32 v104, v104, v239
  v_exp_f32 v104, v104
  v_sub_f32 v105, v105, v239
  v_exp_f32 v105, v105
  v_sub_f32 v106, v106, v239
  v_exp_f32 v106, v106
  v_sub_f32 v107, v107, v239
  v_exp_f32 v107, v107
  v_sub_f32 v108, v108, v239
  v_exp_f32 v108, v108
  v_sub_f32 v109, v109, v239
  v_exp_f32 v109, v109
  v_sub_f32 v110, v110, v239
  v_exp_f32 v110, v110
  v_sub_f32 v111, v111, v239
  v_exp_f32 v111, v111
  v_cvt_pk_bf16_f32 v168, v104, v105
  v_cvt_pk_bf16_f32 v169, v106, v107
  v_cvt_pk_bf16_f32 v170, v108, v109
  v_cvt_pk_bf16_f32 v171, v110, v111
  v_sub_f32 v112, v112, v239
  v_exp_f32 v112, v112
  v_sub_f32 v113, v113, v239
  v_exp_f32 v113, v113
  v_mfma_f32_32x32x16_bf16 v[136:151], v[200:203], v[168:171], 0
  v_sub_f32 v114, v114, v239
  v_exp_f32 v114, v114
  v_sub_f32 v115, v115, v239
  v_exp_f32 v115, v115
  v_sub_f32 v116, v116, v239
  v_exp_f32 v116, v116
  v_sub_f32 v117, v117, v239
  v_exp_f32 v117, v117
  v_sub_f32 v118, v118, v239
  v_exp_f32 v118, v118
  v_sub_f32 v119, v119, v239
  v_exp_f32 v119, v119
  v_cvt_pk_bf16_f32 v172, v112, v113
  v_cvt_pk_bf16_f32 v173, v114, v115
  v_cvt_pk_bf16_f32 v174, v116, v117
  v_cvt_pk_bf16_f32 v175, v118, v119
  s_nop 1
  v_mfma_f32_32x32x16_bf16 v[136:151], v[192:195], v[172:175], v[136:151]
  v_mfma_f32_32x32x16_bf16 v[120:135], v[180:183], v[184:187], 0
  s_nop 11
  v_sub_f32 v120, v120, v238
  v_exp_f32 v120, v120
  v_sub_f32 v121, v121, v238
  v_exp_f32 v121, v121
  v_sub_f32 v122, v122, v238
  v_exp_f32 v122, v122
  v_sub_f32 v123, v123, v238
  v_exp_f32 v123, v123
  v_sub_f32 v124, v124, v238
  v_exp_f32 v124, v124
  v_sub_f32 v125, v125, v238
  v_exp_f32 v125, v125
  v_sub_f32 v126, v126, v238
  v_exp_f32 v126, v126
  v_sub_f32 v127, v127, v238
  v_exp_f32 v127, v127
  v_cvt_pk_bf16_f32 v168, v120, v121
  v_cvt_pk_bf16_f32 v169, v122, v123
  v_cvt_pk_bf16_f32 v170, v124, v125
  v_cvt_pk_bf16_f32 v171, v126, v127
  v_sub_f32 v128, v128, v238
  v_exp_f32 v128, v128
  v_sub_f32 v129, v129, v238
  v_exp_f32 v129, v129
  v_mfma_f32_32x32x16_bf16 v[152:167], v[200:203], v[168:171], 0
  v_sub_f32 v130, v130, v238
  v_exp_f32 v130, v130
  v_sub_f32 v131, v131, v238
  v_exp_f32 v131, v131
  v_sub_f32 v132, v132, v238
  v_exp_f32 v132, v132
  v_sub_f32 v133, v133, v238
  v_exp_f32 v133, v133
  v_sub_f32 v134, v134, v238
  v_exp_f32 v134, v134
  v_sub_f32 v135, v135, v238
  v_exp_f32 v135, v135
  v_cvt_pk_bf16_f32 v172, v128, v129
  v_cvt_pk_bf16_f32 v173, v130, v131
  v_cvt_pk_bf16_f32 v174, v132, v133
  v_cvt_pk_bf16_f32 v175, v134, v135
  s_nop 1
  v_mfma_f32_32x32x16_bf16 v[152:167], v[192:195], v[172:175], v[152:167]
  v_mfma_f32_32x32x16_bf16 v[104:119], v[188:191], v[184:187], v[72:87]
  s_nop 11
  v_sub_f32 v104, v104, v238
  v_exp_f32 v104, v104
  v_sub_f32 v105, v105, v238
  v_exp_f32 v105, v105
  v_sub_f32 v106, v106, v238
  v_exp_f32 v106, v106
  v_sub_f32 v107, v107, v238
  v_exp_f32 v107, v107
  v_sub_f32 v108, v108, v238
  v_exp_f32 v108, v108
  v_sub_f32 v109, v109, v238
  v_exp_f32 v109, v109
  v_sub_f32 v110, v110, v238
  v_exp_f32 v110, v110
  v_sub_f32 v111, v111, v238
  v_exp_f32 v111, v111
  v_cvt_pk_bf16_f32 v168, v104, v105
  v_cvt_pk_bf16_f32 v169, v106, v107
  v_cvt_pk_bf16_f32 v170, v108, v109
  v_cvt_pk_bf16_f32 v171, v110, v111
  v_sub_f32 v112, v112, v238
  v_exp_f32 v112, v112
  v_sub_f32 v113, v113, v238
  v_exp_f32 v113, v113
  v_mfma_f32_32x32x16_bf16 v[152:167], v[204:207], v[168:171], v[152:167]
  v_sub_f32 v114, v114, v238
  v_exp_f32 v114, v114
  v_sub_f32 v115, v115, v238
  v_exp_f32 v115, v115
  v_sub_f32 v116, v116, v238
  v_exp_f32 v116, v116
  v_sub_f32 v117, v117, v238
  v_exp_f32 v117, v117
  v_sub_f32 v118, v118, v238
  v_exp_f32 v118, v118
  v_sub_f32 v119, v119, v238
  v_exp_f32 v119, v119
  v_cvt_pk_bf16_f32 v172, v112, v113
  v_cvt_pk_bf16_f32 v173, v114, v115
  v_cvt_pk_bf16_f32 v174, v116, v117
  v_cvt_pk_bf16_f32 v175, v118, v119
  s_nop 1
  v_mfma_f32_32x32x16_bf16 v[152:167], v[196:199], v[172:175], v[152:167]
  s_cmp_le_u32 s94, 0
  s_cbranch_scc1 L_fb_done_17
  v_mfma_f32_32x32x16_bf16 v[120:135], a[16:19], v[176:179], 0
  s_nop 11
  v_sub_f32 v120, v120, v239
  v_exp_f32 v120, v120
  v_sub_f32 v121, v121, v239
  v_exp_f32 v121, v121
  v_sub_f32 v122, v122, v239
  v_exp_f32 v122, v122
  v_sub_f32 v123, v123, v239
  v_exp_f32 v123, v123
  v_sub_f32 v124, v124, v239
  v_exp_f32 v124, v124
  v_sub_f32 v125, v125, v239
  v_exp_f32 v125, v125
  v_sub_f32 v126, v126, v239
  v_exp_f32 v126, v126
  v_sub_f32 v127, v127, v239
  v_exp_f32 v127, v127
  v_cvt_pk_bf16_f32 v168, v120, v121
  v_cvt_pk_bf16_f32 v169, v122, v123
  v_cvt_pk_bf16_f32 v170, v124, v125
  v_cvt_pk_bf16_f32 v171, v126, v127
  v_sub_f32 v128, v128, v239
  v_exp_f32 v128, v128
  v_sub_f32 v129, v129, v239
  v_exp_f32 v129, v129
  v_mfma_f32_32x32x16_bf16 v[136:151], v[8:11], v[168:171], v[136:151]
  v_sub_f32 v130, v130, v239
  v_exp_f32 v130, v130
  v_sub_f32 v131, v131, v239
  v_exp_f32 v131, v131
  v_sub_f32 v132, v132, v239
  v_exp_f32 v132, v132
  v_sub_f32 v133, v133, v239
  v_exp_f32 v133, v133
  v_sub_f32 v134, v134, v239
  v_exp_f32 v134, v134
  v_sub_f32 v135, v135, v239
  v_exp_f32 v135, v135
  v_cvt_pk_bf16_f32 v172, v128, v129
  v_cvt_pk_bf16_f32 v173, v130, v131
  v_cvt_pk_bf16_f32 v174, v132, v133
  v_cvt_pk_bf16_f32 v175, v134, v135
  s_nop 1
  v_mfma_f32_32x32x16_bf16 v[136:151], v[12:15], v[172:175], v[136:151]
  v_mfma_f32_32x32x16_bf16 v[104:119], a[20:23], v[176:179], 0
  s_nop 11
  v_sub_f32 v104, v104, v239
  v_exp_f32 v104, v104
  v_sub_f32 v105, v105, v239
  v_exp_f32 v105, v105
  v_sub_f32 v106, v106, v239
  v_exp_f32 v106, v106
  v_sub_f32 v107, v107, v239
  v_exp_f32 v107, v107
  v_sub_f32 v108, v108, v239
  v_exp_f32 v108, v108
  v_sub_f32 v109, v109, v239
  v_exp_f32 v109, v109
  v_sub_f32 v110, v110, v239
  v_exp_f32 v110, v110
  v_sub_f32 v111, v111, v239
  v_exp_f32 v111, v111
  v_cvt_pk_bf16_f32 v168, v104, v105
  v_cvt_pk_bf16_f32 v169, v106, v107
  v_cvt_pk_bf16_f32 v170, v108, v109
  v_cvt_pk_bf16_f32 v171, v110, v111
  v_sub_f32 v112, v112, v239
  v_exp_f32 v112, v112
  v_sub_f32 v113, v113, v239
  v_exp_f32 v113, v113
  v_mfma_f32_32x32x16_bf16 v[136:151], v[16:19], v[168:171], v[136:151]
  v_sub_f32 v114, v114, v239
  v_exp_f32 v114, v114
  v_sub_f32 v115, v115, v239
  v_exp_f32 v115, v115
  v_sub_f32 v116, v116, v239
  v_exp_f32 v116, v116
  v_sub_f32 v117, v117, v239
  v_exp_f32 v117, v117
  v_sub_f32 v118, v118, v239
  v_exp_f32 v118, v118
  v_sub_f32 v119, v119, v239
  v_exp_f32 v119, v119
  v_cvt_pk_bf16_f32 v172, v112, v113
  v_cvt_pk_bf16_f32 v173, v114, v115
  v_cvt_pk_bf16_f32 v174, v116, v117
  v_cvt_pk_bf16_f32 v175, v118, v119
  s_nop 1
  v_mfma_f32_32x32x16_bf16 v[136:151], v[20:23], v[172:175], v[136:151]
  v_mfma_f32_32x32x16_bf16 v[120:135], a[16:19], v[184:187], 0
  s_nop 11
  v_sub_f32 v120, v120, v238
  v_exp_f32 v120, v120
  v_sub_f32 v121, v121, v238
  v_exp_f32 v121, v121
  v_sub_f32 v122, v122, v238
  v_exp_f32 v122, v122
  v_sub_f32 v123, v123, v238
  v_exp_f32 v123, v123
  v_sub_f32 v124, v124, v238
  v_exp_f32 v124, v124
  v_sub_f32 v125, v125, v238
  v_exp_f32 v125, v125
  v_sub_f32 v126, v126, v238
  v_exp_f32 v126, v126
  v_sub_f32 v127, v127, v238
  v_exp_f32 v127, v127
  v_cvt_pk_bf16_f32 v168, v120, v121
  v_cvt_pk_bf16_f32 v169, v122, v123
  v_cvt_pk_bf16_f32 v170, v124, v125
  v_cvt_pk_bf16_f32 v171, v126, v127
  v_sub_f32 v128, v128, v238
  v_exp_f32 v128, v128
  v_sub_f32 v129, v129, v238
  v_exp_f32 v129, v129
  v_mfma_f32_32x32x16_bf16 v[152:167], v[8:11], v[168:171], v[152:167]
  v_sub_f32 v130, v130, v238
  v_exp_f32 v130, v130
  v_sub_f32 v131, v131, v238
  v_exp_f32 v131, v131
  v_sub_f32 v132, v132, v238
  v_exp_f32 v132, v132
  v_sub_f32 v133, v133, v238
  v_exp_f32 v133, v133
  v_sub_f32 v134, v134, v238
  v_exp_f32 v134, v134
  v_sub_f32 v135, v135, v238
  v_exp_f32 v135, v135
  v_cvt_pk_bf16_f32 v172, v128, v129
  v_cvt_pk_bf16_f32 v173, v130, v131
  v_cvt_pk_bf16_f32 v174, v132, v133
  v_cvt_pk_bf16_f32 v175, v134, v135
  s_nop 1
  v_mfma_f32_32x32x16_bf16 v[152:167], v[12:15], v[172:175], v[152:167]
  v_mfma_f32_32x32x16_bf16 v[104:119], a[20:23], v[184:187], 0
  s_nop 11
  v_sub_f32 v104, v104, v238
  v_exp_f32 v104, v104
  v_sub_f32 v105, v105, v238
  v_exp_f32 v105, v105
  v_sub_f32 v106, v106, v238
  v_exp_f32 v106, v106
  v_sub_f32 v107, v107, v238
  v_exp_f32 v107, v107
  v_sub_f32 v108, v108, v238
  v_exp_f32 v108, v108
  v_sub_f32 v109, v109, v238
  v_exp_f32 v109, v109
  v_sub_f32 v110, v110, v238
  v_exp_f32 v110, v110
  v_sub_f32 v111, v111, v238
  v_exp_f32 v111, v111
  v_cvt_pk_bf16_f32 v168, v104, v105
  v_cvt_pk_bf16_f32 v169, v106, v107
  v_cvt_pk_bf16_f32 v170, v108, v109
  v_cvt_pk_bf16_f32 v171, v110, v111
  v_sub_f32 v112, v112, v238
  v_exp_f32 v112, v112
  v_sub_f32 v113, v113, v238
  v_exp_f32 v113, v113
  v_mfma_f32_32x32x16_bf16 v[152:167], v[16:19], v[168:171], v[152:167]
  v_sub_f32 v114, v114, v238
  v_exp_f32 v114, v114
  v_sub_f32 v115, v115, v238
  v_exp_f32 v115, v115
  v_sub_f32 v116, v116, v238
  v_exp_f32 v116, v116
  v_sub_f32 v117, v117, v238
  v_exp_f32 v117, v117
  v_sub_f32 v118, v118, v238
  v_exp_f32 v118, v118
  v_sub_f32 v119, v119, v238
  v_exp_f32 v119, v119
  v_cvt_pk_bf16_f32 v172, v112, v113
  v_cvt_pk_bf16_f32 v173, v114, v115
  v_cvt_pk_bf16_f32 v174, v116, v117
  v_cvt_pk_bf16_f32 v175, v118, v119
  s_nop 1
  v_mfma_f32_32x32x16_bf16 v[152:167], v[20:23], v[172:175], v[152:167]
  s_cmp_le_u32 s94, 1
  s_cbranch_scc1 L_fb_done_17
  v_mfma_f32_32x32x16_bf16 v[120:135], a[24:27], v[176:179], 0
  s_nop 11
  v_sub_f32 v120, v120, v239
  v_exp_f32 v120, v120
  v_sub_f32 v121, v121, v239
  v_exp_f32 v121, v121
  v_sub_f32 v122, v122, v239
  v_exp_f32 v122, v122
  v_sub_f32 v123, v123, v239
  v_exp_f32 v123, v123
  v_sub_f32 v124, v124, v239
  v_exp_f32 v124, v124
  v_sub_f32 v125, v125, v239
  v_exp_f32 v125, v125
  v_sub_f32 v126, v126, v239
  v_exp_f32 v126, v126
  v_sub_f32 v127, v127, v239
  v_exp_f32 v127, v127
  v_cvt_pk_bf16_f32 v168, v120, v121
  v_cvt_pk_bf16_f32 v169, v122, v123
  v_cvt_pk_bf16_f32 v170, v124, v125
  v_cvt_pk_bf16_f32 v171, v126, v127
  v_sub_f32 v128, v128, v239
  v_exp_f32 v128, v128
  v_sub_f32 v129, v129, v239
  v_exp_f32 v129, v129
  v_mfma_f32_32x32x16_bf16 v[136:151], v[24:27], v[168:171], v[136:151]
  v_sub_f32 v130, v130, v239
  v_exp_f32 v130, v130
  v_sub_f32 v131, v131, v239
  v_exp_f32 v131, v131
  v_sub_f32 v132, v132, v239
  v_exp_f32 v132, v132
  v_sub_f32 v133, v133, v239
  v_exp_f32 v133, v133
  v_sub_f32 v134, v134, v239
  v_exp_f32 v134, v134
  v_sub_f32 v135, v135, v239
  v_exp_f32 v135, v135
  v_cvt_pk_bf16_f32 v172, v128, v129
  v_cvt_pk_bf16_f32 v173, v130, v131
  v_cvt_pk_bf16_f32 v174, v132, v133
  v_cvt_pk_bf16_f32 v175, v134, v135
  s_nop 1
  v_mfma_f32_32x32x16_bf16 v[136:151], v[28:31], v[172:175], v[136:151]
  v_mfma_f32_32x32x16_bf16 v[104:119], a[28:31], v[176:179], 0
  s_nop 11
  v_sub_f32 v104, v104, v239
  v_exp_f32 v104, v104
  v_sub_f32 v105, v105, v239
  v_exp_f32 v105, v105
  v_sub_f32 v106, v106, v239
  v_exp_f32 v106, v106
  v_sub_f32 v107, v107, v239
  v_exp_f32 v107, v107
  v_sub_f32 v108, v108, v239
  v_exp_f32 v108, v108
  v_sub_f32 v109, v109, v239
  v_exp_f32 v109, v109
  v_sub_f32 v110, v110, v239
  v_exp_f32 v110, v110
  v_sub_f32 v111, v111, v239
  v_exp_f32 v111, v111
  v_cvt_pk_bf16_f32 v168, v104, v105
  v_cvt_pk_bf16_f32 v169, v106, v107
  v_cvt_pk_bf16_f32 v170, v108, v109
  v_cvt_pk_bf16_f32 v171, v110, v111
  v_sub_f32 v112, v112, v239
  v_exp_f32 v112, v112
  v_sub_f32 v113, v113, v239
  v_exp_f32 v113, v113
  v_mfma_f32_32x32x16_bf16 v[136:151], v[32:35], v[168:171], v[136:151]
  v_sub_f32 v114, v114, v239
  v_exp_f32 v114, v114
  v_sub_f32 v115, v115, v239
  v_exp_f32 v115, v115
  v_sub_f32 v116, v116, v239
  v_exp_f32 v116, v116
  v_sub_f32 v117, v117, v239
  v_exp_f32 v117, v117
  v_sub_f32 v118, v118, v239
  v_exp_f32 v118, v118
  v_sub_f32 v119, v119, v239
  v_exp_f32 v119, v119
  v_cvt_pk_bf16_f32 v172, v112, v113
  v_cvt_pk_bf16_f32 v173, v114, v115
  v_cvt_pk_bf16_f32 v174, v116, v117
  v_cvt_pk_bf16_f32 v175, v118, v119
  s_nop 1
  v_mfma_f32_32x32x16_bf16 v[136:151], v[36:39], v[172:175], v[136:151]
  v_mfma_f32_32x32x16_bf16 v[120:135], a[24:27], v[184:187], 0
  s_nop 11
  v_sub_f32 v120, v120, v238
  v_exp_f32 v120, v120
  v_sub_f32 v121, v121, v238
  v_exp_f32 v121, v121
  v_sub_f32 v122, v122, v238
  v_exp_f32 v122, v122
  v_sub_f32 v123, v123, v238
  v_exp_f32 v123, v123
  v_sub_f32 v124, v124, v238
  v_exp_f32 v124, v124
  v_sub_f32 v125, v125, v238
  v_exp_f32 v125, v125
  v_sub_f32 v126, v126, v238
  v_exp_f32 v126, v126
  v_sub_f32 v127, v127, v238
  v_exp_f32 v127, v127
  v_cvt_pk_bf16_f32 v168, v120, v121
  v_cvt_pk_bf16_f32 v169, v122, v123
  v_cvt_pk_bf16_f32 v170, v124, v125
  v_cvt_pk_bf16_f32 v171, v126, v127
  v_sub_f32 v128, v128, v238
  v_exp_f32 v128, v128
  v_sub_f32 v129, v129, v238
  v_exp_f32 v129, v129
  v_mfma_f32_32x32x16_bf16 v[152:167], v[24:27], v[168:171], v[152:167]
  v_sub_f32 v130, v130, v238
  v_exp_f32 v130, v130
  v_sub_f32 v131, v131, v238
  v_exp_f32 v131, v131
  v_sub_f32 v132, v132, v238
  v_exp_f32 v132, v132
  v_sub_f32 v133, v133, v238
  v_exp_f32 v133, v133
  v_sub_f32 v134, v134, v238
  v_exp_f32 v134, v134
  v_sub_f32 v135, v135, v238
  v_exp_f32 v135, v135
  v_cvt_pk_bf16_f32 v172, v128, v129
  v_cvt_pk_bf16_f32 v173, v130, v131
  v_cvt_pk_bf16_f32 v174, v132, v133
  v_cvt_pk_bf16_f32 v175, v134, v135
  s_nop 1
  v_mfma_f32_32x32x16_bf16 v[152:167], v[28:31], v[172:175], v[152:167]
  v_mfma_f32_32x32x16_bf16 v[104:119], a[28:31], v[184:187], 0
  s_nop 11
  v_sub_f32 v104, v104, v238
  v_exp_f32 v104, v104
  v_sub_f32 v105, v105, v238
  v_exp_f32 v105, v105
  v_sub_f32 v106, v106, v238
  v_exp_f32 v106, v106
  v_sub_f32 v107, v107, v238
  v_exp_f32 v107, v107
  v_sub_f32 v108, v108, v238
  v_exp_f32 v108, v108
  v_sub_f32 v109, v109, v238
  v_exp_f32 v109, v109
  v_sub_f32 v110, v110, v238
  v_exp_f32 v110, v110
  v_sub_f32 v111, v111, v238
  v_exp_f32 v111, v111
  v_cvt_pk_bf16_f32 v168, v104, v105
  v_cvt_pk_bf16_f32 v169, v106, v107
  v_cvt_pk_bf16_f32 v170, v108, v109
  v_cvt_pk_bf16_f32 v171, v110, v111
  v_sub_f32 v112, v112, v238
  v_exp_f32 v112, v112
  v_sub_f32 v113, v113, v238
  v_exp_f32 v113, v113
  v_mfma_f32_32x32x16_bf16 v[152:167], v[32:35], v[168:171], v[152:167]
  v_sub_f32 v114, v114, v238
  v_exp_f32 v114, v114
  v_sub_f32 v115, v115, v238
  v_exp_f32 v115, v115
  v_sub_f32 v116, v116, v238
  v_exp_f32 v116, v116
  v_sub_f32 v117, v117, v238
  v_exp_f32 v117, v117
  v_sub_f32 v118, v118, v238
  v_exp_f32 v118, v118
  v_sub_f32 v119, v119, v238
  v_exp_f32 v119, v119
  v_cvt_pk_bf16_f32 v172, v112, v113
  v_cvt_pk_bf16_f32 v173, v114, v115
  v_cvt_pk_bf16_f32 v174, v116, v117
  v_cvt_pk_bf16_f32 v175, v118, v119
  s_nop 1
  v_mfma_f32_32x32x16_bf16 v[152:167], v[36:39], v[172:175], v[152:167]
  s_cmp_le_u32 s94, 2
  s_cbranch_scc1 L_fb_done_17
  v_mfma_f32_32x32x16_bf16 v[120:135], a[32:35], v[176:179], 0
  s_nop 11
  v_sub_f32 v120, v120, v239
  v_exp_f32 v120, v120
  v_sub_f32 v121, v121, v239
  v_exp_f32 v121, v121
  v_sub_f32 v122, v122, v239
  v_exp_f32 v122, v122
  v_sub_f32 v123, v123, v239
  v_exp_f32 v123, v123
  v_sub_f32 v124, v124, v239
  v_exp_f32 v124, v124
  v_sub_f32 v125, v125, v239
  v_exp_f32 v125, v125
  v_sub_f32 v126, v126, v239
  v_exp_f32 v126, v126
  v_sub_f32 v127, v127, v239
  v_exp_f32 v127, v127
  v_cvt_pk_bf16_f32 v168, v120, v121
  v_cvt_pk_bf16_f32 v169, v122, v123
  v_cvt_pk_bf16_f32 v170, v124, v125
  v_cvt_pk_bf16_f32 v171, v126, v127
  v_sub_f32 v128, v128, v239
  v_exp_f32 v128, v128
  v_sub_f32 v129, v129, v239
  v_exp_f32 v129, v129
  v_mfma_f32_32x32x16_bf16 v[136:151], v[40:43], v[168:171], v[136:151]
  v_sub_f32 v130, v130, v239
  v_exp_f32 v130, v130
  v_sub_f32 v131, v131, v239
  v_exp_f32 v131, v131
  v_sub_f32 v132, v132, v239
  v_exp_f32 v132, v132
  v_sub_f32 v133, v133, v239
  v_exp_f32 v133, v133
  v_sub_f32 v134, v134, v239
  v_exp_f32 v134, v134
  v_sub_f32 v135, v135, v239
  v_exp_f32 v135, v135
  v_cvt_pk_bf16_f32 v172, v128, v129
  v_cvt_pk_bf16_f32 v173, v130, v131
  v_cvt_pk_bf16_f32 v174, v132, v133
  v_cvt_pk_bf16_f32 v175, v134, v135
  s_nop 1
  v_mfma_f32_32x32x16_bf16 v[136:151], v[44:47], v[172:175], v[136:151]
  v_mfma_f32_32x32x16_bf16 v[104:119], a[36:39], v[176:179], 0
  s_nop 11
  v_sub_f32 v104, v104, v239
  v_exp_f32 v104, v104
  v_sub_f32 v105, v105, v239
  v_exp_f32 v105, v105
  v_sub_f32 v106, v106, v239
  v_exp_f32 v106, v106
  v_sub_f32 v107, v107, v239
  v_exp_f32 v107, v107
  v_sub_f32 v108, v108, v239
  v_exp_f32 v108, v108
  v_sub_f32 v109, v109, v239
  v_exp_f32 v109, v109
  v_sub_f32 v110, v110, v239
  v_exp_f32 v110, v110
  v_sub_f32 v111, v111, v239
  v_exp_f32 v111, v111
  v_cvt_pk_bf16_f32 v168, v104, v105
  v_cvt_pk_bf16_f32 v169, v106, v107
  v_cvt_pk_bf16_f32 v170, v108, v109
  v_cvt_pk_bf16_f32 v171, v110, v111
  v_sub_f32 v112, v112, v239
  v_exp_f32 v112, v112
  v_sub_f32 v113, v113, v239
  v_exp_f32 v113, v113
  v_mfma_f32_32x32x16_bf16 v[136:151], v[48:51], v[168:171], v[136:151]
  v_sub_f32 v114, v114, v239
  v_exp_f32 v114, v114
  v_sub_f32 v115, v115, v239
  v_exp_f32 v115, v115
  v_sub_f32 v116, v116, v239
  v_exp_f32 v116, v116
  v_sub_f32 v117, v117, v239
  v_exp_f32 v117, v117
  v_sub_f32 v118, v118, v239
  v_exp_f32 v118, v118
  v_sub_f32 v119, v119, v239
  v_exp_f32 v119, v119
  v_cvt_pk_bf16_f32 v172, v112, v113
  v_cvt_pk_bf16_f32 v173, v114, v115
  v_cvt_pk_bf16_f32 v174, v116, v117
  v_cvt_pk_bf16_f32 v175, v118, v119
  s_nop 1
  v_mfma_f32_32x32x16_bf16 v[136:151], v[52:55], v[172:175], v[136:151]
  v_mfma_f32_32x32x16_bf16 v[120:135], a[32:35], v[184:187], 0
  s_nop 11
  v_sub_f32 v120, v120, v238
  v_exp_f32 v120, v120
  v_sub_f32 v121, v121, v238
  v_exp_f32 v121, v121
  v_sub_f32 v122, v122, v238
  v_exp_f32 v122, v122
  v_sub_f32 v123, v123, v238
  v_exp_f32 v123, v123
  v_sub_f32 v124, v124, v238
  v_exp_f32 v124, v124
  v_sub_f32 v125, v125, v238
  v_exp_f32 v125, v125
  v_sub_f32 v126, v126, v238
  v_exp_f32 v126, v126
  v_sub_f32 v127, v127, v238
  v_exp_f32 v127, v127
  v_cvt_pk_bf16_f32 v168, v120, v121
  v_cvt_pk_bf16_f32 v169, v122, v123
  v_cvt_pk_bf16_f32 v170, v124, v125
  v_cvt_pk_bf16_f32 v171, v126, v127
  v_sub_f32 v128, v128, v238
  v_exp_f32 v128, v128
  v_sub_f32 v129, v129, v238
  v_exp_f32 v129, v129
  v_mfma_f32_32x32x16_bf16 v[152:167], v[40:43], v[168:171], v[152:167]
  v_sub_f32 v130, v130, v238
  v_exp_f32 v130, v130
  v_sub_f32 v131, v131, v238
  v_exp_f32 v131, v131
  v_sub_f32 v132, v132, v238
  v_exp_f32 v132, v132
  v_sub_f32 v133, v133, v238
  v_exp_f32 v133, v133
  v_sub_f32 v134, v134, v238
  v_exp_f32 v134, v134
  v_sub_f32 v135, v135, v238
  v_exp_f32 v135, v135
  v_cvt_pk_bf16_f32 v172, v128, v129
  v_cvt_pk_bf16_f32 v173, v130, v131
  v_cvt_pk_bf16_f32 v174, v132, v133
  v_cvt_pk_bf16_f32 v175, v134, v135
  s_nop 1
  v_mfma_f32_32x32x16_bf16 v[152:167], v[44:47], v[172:175], v[152:167]
  v_mfma_f32_32x32x16_bf16 v[104:119], a[36:39], v[184:187], 0
  s_nop 11
  v_sub_f32 v104, v104, v238
  v_exp_f32 v104, v104
  v_sub_f32 v105, v105, v238
  v_exp_f32 v105, v105
  v_sub_f32 v106, v106, v238
  v_exp_f32 v106, v106
  v_sub_f32 v107, v107, v238
  v_exp_f32 v107, v107
  v_sub_f32 v108, v108, v238
  v_exp_f32 v108, v108
  v_sub_f32 v109, v109, v238
  v_exp_f32 v109, v109
  v_sub_f32 v110, v110, v238
  v_exp_f32 v110, v110
  v_sub_f32 v111, v111, v238
  v_exp_f32 v111, v111
  v_cvt_pk_bf16_f32 v168, v104, v105
  v_cvt_pk_bf16_f32 v169, v106, v107
  v_cvt_pk_bf16_f32 v170, v108, v109
  v_cvt_pk_bf16_f32 v171, v110, v111
  v_sub_f32 v112, v112, v238
  v_exp_f32 v112, v112
  v_sub_f32 v113, v113, v238
  v_exp_f32 v113, v113
  v_mfma_f32_32x32x16_bf16 v[152:167], v[48:51], v[168:171], v[152:167]
  v_sub_f32 v114, v114, v238
  v_exp_f32 v114, v114
  v_sub_f32 v115, v115, v238
  v_exp_f32 v115, v115
  v_sub_f32 v116, v116, v238
  v_exp_f32 v116, v116
  v_sub_f32 v117, v117, v238
  v_exp_f32 v117, v117
  v_sub_f32 v118, v118, v238
  v_exp_f32 v118, v118
  v_sub_f32 v119, v119, v238
  v_exp_f32 v119, v119
  v_cvt_pk_bf16_f32 v172, v112, v113
  v_cvt_pk_bf16_f32 v173, v114, v115
  v_cvt_pk_bf16_f32 v174, v116, v117
  v_cvt_pk_bf16_f32 v175, v118, v119
  s_nop 1
  v_mfma_f32_32x32x16_bf16 v[152:167], v[52:55], v[172:175], v[152:167]
  s_cmp_le_u32 s94, 3
  s_cbranch_scc1 L_fb_done_17
  v_mfma_f32_32x32x16_bf16 v[120:135], a[40:43], v[176:179], v[88:103]
  s_nop 11
  v_sub_f32 v120, v120, v239
  v_exp_f32 v120, v120
  v_sub_f32 v121, v121, v239
  v_exp_f32 v121, v121
  v_sub_f32 v122, v122, v239
  v_exp_f32 v122, v122
  v_sub_f32 v123, v123, v239
  v_exp_f32 v123, v123
  v_sub_f32 v124, v124, v239
  v_exp_f32 v124, v124
  v_sub_f32 v125, v125, v239
  v_exp_f32 v125, v125
  v_sub_f32 v126, v126, v239
  v_exp_f32 v126, v126
  v_sub_f32 v127, v127, v239
  v_exp_f32 v127, v127
  v_cvt_pk_bf16_f32 v168, v120, v121
  v_cvt_pk_bf16_f32 v169, v122, v123
  v_cvt_pk_bf16_f32 v170, v124, v125
  v_cvt_pk_bf16_f32 v171, v126, v127
  v_sub_f32 v128, v128, v239
  v_exp_f32 v128, v128
  v_sub_f32 v129, v129, v239
  v_exp_f32 v129, v129
  v_mfma_f32_32x32x16_bf16 v[136:151], v[56:59], v[168:171], v[136:151]
  v_sub_f32 v130, v130, v239
  v_exp_f32 v130, v130
  v_sub_f32 v131, v131, v239
  v_exp_f32 v131, v131
  v_sub_f32 v132, v132, v239
  v_exp_f32 v132, v132
  v_sub_f32 v133, v133, v239
  v_exp_f32 v133, v133
  v_sub_f32 v134, v134, v239
  v_exp_f32 v134, v134
  v_sub_f32 v135, v135, v239
  v_exp_f32 v135, v135
  v_cvt_pk_bf16_f32 v172, v128, v129
  v_cvt_pk_bf16_f32 v173, v130, v131
  v_cvt_pk_bf16_f32 v174, v132, v133
  v_cvt_pk_bf16_f32 v175, v134, v135
  s_nop 1
  v_mfma_f32_32x32x16_bf16 v[136:151], v[60:63], v[172:175], v[136:151]
  v_mfma_f32_32x32x16_bf16 v[104:119], a[44:47], v[176:179], 0
  s_nop 11
  v_sub_f32 v104, v104, v239
  v_exp_f32 v104, v104
  v_sub_f32 v105, v105, v239
  v_exp_f32 v105, v105
  v_sub_f32 v106, v106, v239
  v_exp_f32 v106, v106
  v_sub_f32 v107, v107, v239
  v_exp_f32 v107, v107
  v_sub_f32 v108, v108, v239
  v_exp_f32 v108, v108
  v_sub_f32 v109, v109, v239
  v_exp_f32 v109, v109
  v_sub_f32 v110, v110, v239
  v_exp_f32 v110, v110
  v_sub_f32 v111, v111, v239
  v_exp_f32 v111, v111
  v_cvt_pk_bf16_f32 v168, v104, v105
  v_cvt_pk_bf16_f32 v169, v106, v107
  v_cvt_pk_bf16_f32 v170, v108, v109
  v_cvt_pk_bf16_f32 v171, v110, v111
  v_sub_f32 v112, v112, v239
  v_exp_f32 v112, v112
  v_sub_f32 v113, v113, v239
  v_exp_f32 v113, v113
  v_mfma_f32_32x32x16_bf16 v[136:151], v[64:67], v[168:171], v[136:151]
  v_sub_f32 v114, v114, v239
  v_exp_f32 v114, v114
  v_sub_f32 v115, v115, v239
  v_exp_f32 v115, v115
  v_sub_f32 v116, v116, v239
  v_exp_f32 v116, v116
  v_sub_f32 v117, v117, v239
  v_exp_f32 v117, v117
  v_sub_f32 v118, v118, v239
  v_exp_f32 v118, v118
  v_sub_f32 v119, v119, v239
  v_exp_f32 v119, v119
  v_cvt_pk_bf16_f32 v172, v112, v113
  v_cvt_pk_bf16_f32 v173, v114, v115
  v_cvt_pk_bf16_f32 v174, v116, v117
  v_cvt_pk_bf16_f32 v175, v118, v119
  s_nop 1
  v_mfma_f32_32x32x16_bf16 v[136:151], v[68:71], v[172:175], v[136:151]
  v_mfma_f32_32x32x16_bf16 v[120:135], a[44:47], v[184:187], v[88:103]
  s_nop 11
  v_sub_f32 v120, v120, v238
  v_exp_f32 v120, v120
  v_sub_f32 v121, v121, v238
  v_exp_f32 v121, v121
  v_sub_f32 v122, v122, v238
  v_exp_f32 v122, v122
  v_sub_f32 v123, v123, v238
  v_exp_f32 v123, v123
  v_sub_f32 v124, v124, v238
  v_exp_f32 v124, v124
  v_sub_f32 v125, v125, v238
  v_exp_f32 v125, v125
  v_sub_f32 v126, v126, v238
  v_exp_f32 v126, v126
  v_sub_f32 v127, v127, v238
  v_exp_f32 v127, v127
  v_cvt_pk_bf16_f32 v168, v120, v121
  v_cvt_pk_bf16_f32 v169, v122, v123
  v_cvt_pk_bf16_f32 v170, v124, v125
  v_cvt_pk_bf16_f32 v171, v126, v127
  v_sub_f32 v128, v128, v238
  v_exp_f32 v128, v128
  v_sub_f32 v129, v129, v238
  v_exp_f32 v129, v129
  v_mfma_f32_32x32x16_bf16 v[152:167], v[64:67], v[168:171], v[152:167]
  v_sub_f32 v130, v130, v238
  v_exp_f32 v130, v130
  v_sub_f32 v131, v131, v238
  v_exp_f32 v131, v131
  v_sub_f32 v132, v132, v238
  v_exp_f32 v132, v132
  v_sub_f32 v133, v133, v238
  v_exp_f32 v133, v133
  v_sub_f32 v134, v134, v238
  v_exp_f32 v134, v134
  v_sub_f32 v135, v135, v238
  v_exp_f32 v135, v135
  v_cvt_pk_bf16_f32 v172, v128, v129
  v_cvt_pk_bf16_f32 v173, v130, v131
  v_cvt_pk_bf16_f32 v174, v132, v133
  v_cvt_pk_bf16_f32 v175, v134, v135
  s_nop 1
  v_mfma_f32_32x32x16_bf16 v[152:167], v[68:71], v[172:175], v[152:167]
L_fb_done_17:
  s_nop 15
  s_branch L_attn_norm_15
L_rdy_18:
  s_sub_u32 s89, s89, 1
  s_cbranch_scc1 L_rgo_20
  buffer_load_dword v241, v240, s[16:19], 0 offen sc1
  s_waitcnt vmcnt(0)
  v_xor_b32 v254, s88, v241
  v_cmp_lt_u32 vcc, 31, v254
  s_cbranch_vccnz L_rdy_18
  s_branch L_rret_19
L_rgo_20:
  s_mov_b32 s89, 0
  s_waitcnt vmcnt(0)
  s_branch L_rret_19
L_retry_21:
  s_sub_u32 s89, s89, 1
  s_cbranch_scc1 L_go_23
  buffer_load_dwordx4 v[28:31], v253, s[16:19], s97 offen offset:0 sc1
  buffer_load_dwordx4 v[32:35], v253, s[16:19], s97 offen offset:1024 sc1
  buffer_load_dwordx4 v[36:39], v253, s[16:19], s97 offen offset:2048 sc1
  buffer_load_dwordx4 v[40:43], v253, s[16:19], s97 offen offset:3072 sc1
  buffer_load_dwordx4 v[44:47], v253, s[16:19], s96 offen offset:0 sc1
  buffer_load_dwordx4 v[48:51], v253, s[16:19], s96 offen offset:1024 sc1
  buffer_load_dwordx4 v[52:55], v253, s[16:19], s96 offen offset:2048 sc1
  buffer_load_dwordx4 v[56:59], v253, s[16:19], s96 offen offset:3072 sc1
  buffer_load_dwordx4 v[60:63], v253, s[16:19], s77 offen offset:0 sc1
  s_waitcnt vmcnt(7)
  v_bitop3_b32 v254, v28, v32, 1 bitop3:0xa8
  v_cmp_ne_u32 vcc, 0, v254
  s_cbranch_vccnz L_retry_21
  s_branch L_ret_22
L_go_23:
  s_mov_b32 s89, 0
  s_waitcnt vmcnt(0)
  s_branch L_ret_22
L_retry_24:
  s_sub_u32 s89, s89, 1
  s_cbranch_scc1 L_go_26
  buffer_load_dwordx4 v[36:39], v253, s[16:19], s97 offen offset:2048 sc1
  buffer_load_dwordx4 v[40:43], v253, s[16:19], s97 offen offset:3072 sc1
  buffer_load_dwordx4 v[44:47], v253, s[16:19], s96 offen offset:0 sc1
  buffer_load_dwordx4 v[48:51], v253, s[16:19], s96 offen offset:1024 sc1
  buffer_load_dwordx4 v[52:55], v253, s[16:19], s96 offen offset:2048 sc1
  buffer_load_dwordx4 v[56:59], v253, s[16:19], s96 offen offset:3072 sc1
  buffer_load_dwordx4 v[60:63], v253, s[16:19], s77 offen offset:0 sc1
  buffer_load_dwordx4 v[64:67], v253, s[16:19], s77 offen offset:1024 sc1
  buffer_load_dwordx4 v[68:71], v253, s[16:19], s77 offen offset:2048 sc1
  s_waitcnt vmcnt(7)
  v_bitop3_b32 v254, v36, v40, 1 bitop3:0xa8
  v_cmp_ne_u32 vcc, 0, v254
  s_cbranch_vccnz L_retry_24
  s_branch L_ret_25
L_go_26:
  s_mov_b32 s89, 0
  s_waitcnt vmcnt(0)
  s_branch L_ret_25
L_retry_27:
  s_sub_u32 s89, s89, 1
  s_cbranch_scc1 L_go_29
  buffer_load_dwordx4 v[44:47], v253, s[16:19], s96 offen offset:0 sc1
  buffer_load_dwordx4 v[48:51], v253, s[16:19], s96 offen offset:1024 sc1
  buffer_load_dwordx4 v[52:55], v253, s[16:19], s96 offen offset:2048 sc1
  buffer_load_dwordx4 v[56:59], v253, s[16:19], s96 offen offset:3072 sc1
  buffer_load_dwordx4 v[60:63], v253, s[16:19], s77 offen offset:0 sc1
  buffer_load_dwordx4 v[64:67], v253, s[16:19], s77 offen offset:1024 sc1
  buffer_load_dwordx4 v[68:71], v253, s[16:19], s77 offen offset:2048 sc1
  buffer_load_dwordx4 v[72:75], v253, s[16:19], s77 offen offset:3072 sc1
  buffer_load_dwordx4 v[76:79], v253, s[16:19], s76 offen offset:0 sc1
  s_waitcnt vmcnt(7)
  v_bitop3_b32 v254, v44, v48, 1 bitop3:0xa8
  v_cmp_ne_u32 vcc, 0, v254
  s_cbranch_vccnz L_retry_27
  s_branch L_ret_28
L_go_29:
  s_mov_b32 s89, 0
  s_waitcnt vmcnt(0)
  s_branch L_ret_28
L_retry_30:
  s_sub_u32 s89, s89, 1
  s_cbranch_scc1 L_go_32
  buffer_load_dwordx4 v[52:55], v253, s[16:19], s96 offen offset:2048 sc1
  buffer_load_dwordx4 v[56:59], v253, s[16:19], s96 offen offset:3072 sc1
  buffer_load_dwordx4 v[60:63], v253, s[16:19], s77 offen offset:0 sc1
  buffer_load_dwordx4 v[64:67], v253, s[16:19], s77 offen offset:1024 sc1
  buffer_load_dwordx4 v[68:71], v253, s[16:19], s77 offen offset:2048 sc1
  buffer_load_dwordx4 v[72:75], v253, s[16:19], s77 offen offset:3072 sc1
  buffer_load_dwordx4 v[76:79], v253, s[16:19], s76 offen offset:0 sc1
  buffer_load_dwordx4 v[80:83], v253, s[16:19], s76 offen offset:1024 sc1
  buffer_load_dwordx4 v[84:87], v253, s[16:19], s76 offen offset:2048 sc1
  s_waitcnt vmcnt(7)
  v_bitop3_b32 v254, v52, v56, 1 bitop3:0xa8
  v_cmp_ne_u32 vcc, 0, v254
  s_cbranch_vccnz L_retry_30
  s_branch L_ret_31
L_go_32:
  s_mov_b32 s89, 0
  s_waitcnt vmcnt(0)
  s_branch L_ret_31
L_retry_33:
  s_sub_u32 s89, s89, 1
  s_cbranch_scc1 L_go_35
  buffer_load_dwordx4 v[60:63], v253, s[16:19], s77 offen offset:0 sc1
  buffer_load_dwordx4 v[64:67], v253, s[16:19], s77 offen offset:1024 sc1
  buffer_load_dwordx4 v[68:71], v253, s[16:19], s77 offen offset:2048 sc1
  buffer_load_dwordx4 v[72:75], v253, s[16:19], s77 offen offset:3072 sc1
  buffer_load_dwordx4 v[76:79], v253, s[16:19], s76 offen offset:0 sc1
  buffer_load_dwordx4 v[80:83], v253, s[16:19], s76 offen offset:1024 sc1
  buffer_load_dwordx4 v[84:87], v253, s[16:19], s76 offen offset:2048 sc1
  buffer_load_dwordx4 v[88:91], v253, s[16:19], s76 offen offset:3072 sc1
  s_waitcnt vmcnt(0)
  v_bitop3_b32 v254, v60, v64, 1 bitop3:0xa8
  v_cmp_ne_u32 vcc, 0, v254
  s_cbranch_vccnz L_retry_33
  s_branch L_ret_34
L_go_35:
  s_mov_b32 s89, 0
  s_waitcnt vmcnt(0)
  s_branch L_ret_34
L_retry_36:
  s_sub_u32 s89, s89, 1
  s_cbranch_scc1 L_go_38
  buffer_load_dwordx4 v[68:71], v253, s[16:19], s77 offen offset:2048 sc1
  buffer_load_dwordx4 v[72:75], v253, s[16:19], s77 offen offset:3072 sc1
  buffer_load_dwordx4 v[76:79], v253, s[16:19], s76 offen offset:0 sc1
  buffer_load_dwordx4 v[80:83], v253, s[16:19], s76 offen offset:1024 sc1
  buffer_load_dwordx4 v[84:87], v253, s[16:19], s76 offen offset:2048 sc1
  buffer_load_dwordx4 v[88:91], v253, s[16:19], s76 offen offset:3072 sc1
  s_waitcnt vmcnt(0)
  v_bitop3_b32 v254, v68, v72, 1 bitop3:0xa8
  v_cmp_ne_u32 vcc, 0, v254
  s_cbranch_vccnz L_retry_36
  s_branch L_ret_37
L_go_38:
  s_mov_b32 s89, 0
  s_waitcnt vmcnt(0)
  s_branch L_ret_37
L_retry_39:
  s_sub_u32 s89, s89, 1
  s_cbranch_scc1 L_go_41
  buffer_load_dwordx4 v[76:79], v253, s[16:19], s76 offen offset:0 sc1
  buffer_load_dwordx4 v[80:83], v253, s[16:19], s76 offen offset:1024 sc1
  buffer_load_dwordx4 v[84:87], v253, s[16:19], s76 offen offset:2048 sc1
  buffer_load_dwordx4 v[88:91], v253, s[16:19], s76 offen offset:3072 sc1
  s_waitcnt vmcnt(0)
  v_bitop3_b32 v254, v76, v80, 1 bitop3:0xa8
  v_cmp_ne_u32 vcc, 0, v254
  s_cbranch_vccnz L_retry_39
  s_branch L_ret_40
L_go_41:
  s_mov_b32 s89, 0
  s_waitcnt vmcnt(0)
  s_branch L_ret_40
L_retry_42:
  s_sub_u32 s89, s89, 1
  s_cbranch_scc1 L_go_44
  buffer_load_dwordx4 v[84:87], v253, s[16:19], s76 offen offset:2048 sc1
  buffer_load_dwordx4 v[88:91], v253, s[16:19], s76 offen offset:3072 sc1
  s_waitcnt vmcnt(0)
  v_bitop3_b32 v254, v84, v88, 1 bitop3:0xa8
  v_cmp_ne_u32 vcc, 0, v254
  s_cbranch_vccnz L_retry_42
  s_branch L_ret_43
L_go_44:
  s_mov_b32 s89, 0
  s_waitcnt vmcnt(0)
  s_branch L_ret_43
L_retry_45:
  s_sub_u32 s89, s89, 1
  s_cbranch_scc1 L_go_47
  buffer_load_dwordx2 v[108:109], v214, s[16:19], s70 offen sc1
  buffer_load_dwordx2 v[110:111], v214, s[16:19], s70 offen offset:128 sc1
  s_waitcnt vmcnt(0)
  v_max3_u32 v254, v108, v109, v110
  v_max_u32 v254, v254, v111
  v_cmp_eq_u32 vcc, -1, v254
  s_cbranch_vccnz L_retry_45
  s_branch L_ret_46
L_go_47:
  s_mov_b32 s89, 0
  s_waitcnt vmcnt(0)
  s_branch L_ret_46
L_rdy_48:
  s_sub_u32 s89, s89, 1
  s_cbranch_scc1 L_rgo_50
  buffer_load_dword v221, v220, s[16:19], 0 offen offset:1024 sc1
  s_waitcnt vmcnt(0)
  v_xor_b32 v254, s88, v221
  v_cmp_lt_u32 vcc, 31, v254
  s_cbranch_vccnz L_rdy_48
  s_branch L_rret_49
L_rgo_50:
  s_mov_b32 s89, 0
  s_waitcnt vmcnt(0)
  s_branch L_rret_49
L_retry_51:
  s_sub_u32 s89, s89, 1
  s_cbranch_scc1 L_go_53
  buffer_load_dwordx4 v[28:31], v253, s[16:19], s97 offen offset:0 sc1
  buffer_load_dwordx4 v[32:35], v253, s[16:19], s97 offen offset:1024 sc1
  buffer_load_dwordx4 v[36:39], v253, s[16:19], s97 offen offset:2048 sc1
  buffer_load_dwordx4 v[40:43], v253, s[16:19], s97 offen offset:3072 sc1
  buffer_load_dwordx4 v[44:47], v253, s[16:19], s96 offen offset:0 sc1
  buffer_load_dwordx4 v[48:51], v253, s[16:19], s96 offen offset:1024 sc1
  buffer_load_dwordx4 v[52:55], v253, s[16:19], s96 offen offset:2048 sc1
  buffer_load_dwordx4 v[56:59], v253, s[16:19], s96 offen offset:3072 sc1
  buffer_load_dwordx4 v[60:63], v253, s[16:19], s77 offen offset:0 sc1
  s_waitcnt vmcnt(7)
  v_bitop3_b32 v254, v28, v32, 1 bitop3:0xa8
  v_cmp_ne_u32 vcc, 0, v254
  s_cbranch_vccnz L_retry_51
  s_branch L_ret_52
L_go_53:
  s_mov_b32 s89, 0
  s_waitcnt vmcnt(0)
  s_branch L_ret_52
L_retry_54:
  s_sub_u32 s89, s89, 1
  s_cbranch_scc1 L_go_56
  buffer_load_dwordx4 v[36:39], v253, s[16:19], s97 offen offset:2048 sc1
  buffer_load_dwordx4 v[40:43], v253, s[16:19], s97 offen offset:3072 sc1
  buffer_load_dwordx4 v[44:47], v253, s[16:19], s96 offen offset:0 sc1
  buffer_load_dwordx4 v[48:51], v253, s[16:19], s96 offen offset:1024 sc1
  buffer_load_dwordx4 v[52:55], v253, s[16:19], s96 offen offset:2048 sc1
  buffer_load_dwordx4 v[56:59], v253, s[16:19], s96 offen offset:3072 sc1
  buffer_load_dwordx4 v[60:63], v253, s[16:19], s77 offen offset:0 sc1
  buffer_load_dwordx4 v[64:67], v253, s[16:19], s77 offen offset:1024 sc1
  buffer_load_dwordx4 v[68:71], v253, s[16:19], s77 offen offset:2048 sc1
  s_waitcnt vmcnt(7)
  v_bitop3_b32 v254, v36, v40, 1 bitop3:0xa8
  v_cmp_ne_u32 vcc, 0, v254
  s_cbranch_vccnz L_retry_54
  s_branch L_ret_55
L_go_56:
  s_mov_b32 s89, 0
  s_waitcnt vmcnt(0)
  s_branch L_ret_55
L_retry_57:
  s_sub_u32 s89, s89, 1
  s_cbranch_scc1 L_go_59
  buffer_load_dwordx4 v[44:47], v253, s[16:19], s96 offen offset:0 sc1
  buffer_load_dwordx4 v[48:51], v253, s[16:19], s96 offen offset:1024 sc1
  buffer_load_dwordx4 v[52:55], v253, s[16:19], s96 offen offset:2048 sc1
  buffer_load_dwordx4 v[56:59], v253, s[16:19], s96 offen offset:3072 sc1
  buffer_load_dwordx4 v[60:63], v253, s[16:19], s77 offen offset:0 sc1
  buffer_load_dwordx4 v[64:67], v253, s[16:19], s77 offen offset:1024 sc1
  buffer_load_dwordx4 v[68:71], v253, s[16:19], s77 offen offset:2048 sc1
  buffer_load_dwordx4 v[72:75], v253, s[16:19], s77 offen offset:3072 sc1
  buffer_load_dwordx4 v[76:79], v253, s[16:19], s76 offen offset:0 sc1
  s_waitcnt vmcnt(7)
  v_bitop3_b32 v254, v44, v48, 1 bitop3:0xa8
  v_cmp_ne_u32 vcc, 0, v254
  s_cbranch_vccnz L_retry_57
  s_branch L_ret_58
L_go_59:
  s_mov_b32 s89, 0
  s_waitcnt vmcnt(0)
  s_branch L_ret_58
L_retry_60:
  s_sub_u32 s89, s89, 1
  s_cbranch_scc1 L_go_62
  buffer_load_dwordx4 v[52:55], v253, s[16:19], s96 offen offset:2048 sc1
  buffer_load_dwordx4 v[56:59], v253, s[16:19], s96 offen offset:3072 sc1
  buffer_load_dwordx4 v[60:63], v253, s[16:19], s77 offen offset:0 sc1
  buffer_load_dwordx4 v[64:67], v253, s[16:19], s77 offen offset:1024 sc1
  buffer_load_dwordx4 v[68:71], v253, s[16:19], s77 offen offset:2048 sc1
  buffer_load_dwordx4 v[72:75], v253, s[16:19], s77 offen offset:3072 sc1
  buffer_load_dwordx4 v[76:79], v253, s[16:19], s76 offen offset:0 sc1
  buffer_load_dwordx4 v[80:83], v253, s[16:19], s76 offen offset:1024 sc1
  buffer_load_dwordx4 v[84:87], v253, s[16:19], s76 offen offset:2048 sc1
  s_waitcnt vmcnt(7)
  v_bitop3_b32 v254, v52, v56, 1 bitop3:0xa8
  v_cmp_ne_u32 vcc, 0, v254
  s_cbranch_vccnz L_retry_60
  s_branch L_ret_61
L_go_62:
  s_mov_b32 s89, 0
  s_waitcnt vmcnt(0)
  s_branch L_ret_61
L_retry_63:
  s_sub_u32 s89, s89, 1
  s_cbranch_scc1 L_go_65
  buffer_load_dwordx4 v[60:63], v253, s[16:19], s77 offen offset:0 sc1
  buffer_load_dwordx4 v[64:67], v253, s[16:19], s77 offen offset:1024 sc1
  buffer_load_dwordx4 v[68:71], v253, s[16:19], s77 offen offset:2048 sc1
  buffer_load_dwordx4 v[72:75], v253, s[16:19], s77 offen offset:3072 sc1
  buffer_load_dwordx4 v[76:79], v253, s[16:19], s76 offen offset:0 sc1
  buffer_load_dwordx4 v[80:83], v253, s[16:19], s76 offen offset:1024 sc1
  buffer_load_dwordx4 v[84:87], v253, s[16:19], s76 offen offset:2048 sc1
  buffer_load_dwordx4 v[88:91], v253, s[16:19], s76 offen offset:3072 sc1
  s_waitcnt vmcnt(0)
  v_bitop3_b32 v254, v60, v64, 1 bitop3:0xa8
  v_cmp_ne_u32 vcc, 0, v254
  s_cbranch_vccnz L_retry_63
  s_branch L_ret_64
L_go_65:
  s_mov_b32 s89, 0
  s_waitcnt vmcnt(0)
  s_branch L_ret_64
L_retry_66:
  s_sub_u32 s89, s89, 1
  s_cbranch_scc1 L_go_68
  buffer_load_dwordx4 v[68:71], v253, s[16:19], s77 offen offset:2048 sc1
  buffer_load_dwordx4 v[72:75], v253, s[16:19], s77 offen offset:3072 sc1
  buffer_load_dwordx4 v[76:79], v253, s[16:19], s76 offen offset:0 sc1
  buffer_load_dwordx4 v[80:83], v253, s[16:19], s76 offen offset:1024 sc1
  buffer_load_dwordx4 v[84:87], v253, s[16:19], s76 offen offset:2048 sc1
  buffer_load_dwordx4 v[88:91], v253, s[16:19], s76 offen offset:3072 sc1
  s_waitcnt vmcnt(0)
  v_bitop3_b32 v254, v68, v72, 1 bitop3:0xa8
  v_cmp_ne_u32 vcc, 0, v254
  s_cbranch_vccnz L_retry_66
  s_branch L_ret_67
L_go_68:
  s_mov_b32 s89, 0
  s_waitcnt vmcnt(0)
  s_branch L_ret_67
L_retry_69:
  s_sub_u32 s89, s89, 1
  s_cbranch_scc1 L_go_71
  buffer_load_dwordx4 v[76:79], v253, s[16:19], s76 offen offset:0 sc1
  buffer_load_dwordx4 v[80:83], v253, s[16:19], s76 offen offset:1024 sc1
  buffer_load_dwordx4 v[84:87], v253, s[16:19], s76 offen offset:2048 sc1
  buffer_load_dwordx4 v[88:91], v253, s[16:19], s76 offen offset:3072 sc1
  s_waitcnt vmcnt(0)
  v_bitop3_b32 v254, v76, v80, 1 bitop3:0xa8
  v_cmp_ne_u32 vcc, 0, v254
  s_cbranch_vccnz L_retry_69
  s_branch L_ret_70
L_go_71:
  s_mov_b32 s89, 0
  s_waitcnt vmcnt(0)
  s_branch L_ret_70
L_retry_72:
  s_sub_u32 s89, s89, 1
  s_cbranch_scc1 L_go_74
  buffer_load_dwordx4 v[84:87], v253, s[16:19], s76 offen offset:2048 sc1
  buffer_load_dwordx4 v[88:91], v253, s[16:19], s76 offen offset:3072 sc1
  s_waitcnt vmcnt(0)
  v_bitop3_b32 v254, v84, v88, 1 bitop3:0xa8
  v_cmp_ne_u32 vcc, 0, v254
  s_cbranch_vccnz L_retry_72
  s_branch L_ret_73
L_go_74:
  s_mov_b32 s89, 0
  s_waitcnt vmcnt(0)
  s_branch L_ret_73
L_retry_75:
  s_sub_u32 s89, s89, 1
  s_cbranch_scc1 L_go_77
  buffer_load_dwordx4 v[28:31], v253, s[16:19], s97 offen offset:0 sc1
  buffer_load_dwordx4 v[32:35], v253, s[16:19], s97 offen offset:1024 sc1
  buffer_load_dwordx4 v[36:39], v253, s[16:19], s97 offen offset:2048 sc1
  buffer_load_dwordx4 v[40:43], v253, s[16:19], s97 offen offset:3072 sc1
  buffer_load_dwordx4 v[44:47], v253, s[16:19], s96 offen offset:0 sc1
  buffer_load_dwordx4 v[48:51], v253, s[16:19], s96 offen offset:1024 sc1
  buffer_load_dwordx4 v[52:55], v253, s[16:19], s96 offen offset:2048 sc1
  buffer_load_dwordx4 v[56:59], v253, s[16:19], s96 offen offset:3072 sc1
  buffer_load_dwordx4 v[60:63], v201, s[16:19], s77 offen offset:0 sc1
  s_waitcnt vmcnt(7)
  v_bitop3_b32 v254, v28, v32, 1 bitop3:0x2a
  v_cmp_ne_u32 vcc, 0, v254
  s_cbranch_vccnz L_retry_75
  s_branch L_ret_76
L_go_77:
  s_mov_b32 s89, 0
  s_waitcnt vmcnt(0)
  s_branch L_ret_76
L_retry_78:
  s_sub_u32 s89, s89, 1
  s_cbranch_scc1 L_go_80
  buffer_load_dwordx4 v[36:39], v253, s[16:19], s97 offen offset:2048 sc1
  buffer_load_dwordx4 v[40:43], v253, s[16:19], s97 offen offset:3072 sc1
  buffer_load_dwordx4 v[44:47], v253, s[16:19], s96 offen offset:0 sc1
  buffer_load_dwordx4 v[48:51], v253, s[16:19], s96 offen offset:1024 sc1
  buffer_load_dwordx4 v[52:55], v253, s[16:19], s96 offen offset:2048 sc1
  buffer_load_dwordx4 v[56:59], v253, s[16:19], s96 offen offset:3072 sc1
  buffer_load_dwordx4 v[60:63], v201, s[16:19], s77 offen offset:0 sc1
  buffer_load_dwordx4 v[64:67], v201, s[16:19], s77 offen offset:1024 sc1
  buffer_load_dwordx4 v[68:71], v201, s[16:19], s77 offen offset:2048 sc1
  s_waitcnt vmcnt(7)
  v_bitop3_b32 v254, v36, v40, 1 bitop3:0x2a
  v_cmp_ne_u32 vcc, 0, v254
  s_cbranch_vccnz L_retry_78
  s_branch L_ret_79
L_go_80:
  s_mov_b32 s89, 0
  s_waitcnt vmcnt(0)
  s_branch L_ret_79
L_retry_81:
  s_sub_u32 s89, s89, 1
  s_cbranch_scc1 L_go_83
  buffer_load_dwordx4 v[44:47], v253, s[16:19], s96 offen offset:0 sc1
  buffer_load_dwordx4 v[48:51], v253, s[16:19], s96 offen offset:1024 sc1
  buffer_load_dwordx4 v[52:55], v253, s[16:19], s96 offen offset:2048 sc1
  buffer_load_dwordx4 v[56:59], v253, s[16:19], s96 offen offset:3072 sc1
  buffer_load_dwordx4 v[60:63], v201, s[16:19], s77 offen offset:0 sc1
  buffer_load_dwordx4 v[64:67], v201, s[16:19], s77 offen offset:1024 sc1
  buffer_load_dwordx4 v[68:71], v201, s[16:19], s77 offen offset:2048 sc1
  buffer_load_dwordx4 v[72:75], v201, s[16:19], s77 offen offset:3072 sc1
  buffer_load_dwordx4 v[76:79], v200, s[16:19], s76 offen offset:0 sc1
  s_waitcnt vmcnt(7)
  v_bitop3_b32 v254, v44, v48, 1 bitop3:0x2a
  v_cmp_ne_u32 vcc, 0, v254
  s_cbranch_vccnz L_retry_81
  s_branch L_ret_82
L_go_83:
  s_mov_b32 s89, 0
  s_waitcnt vmcnt(0)
  s_branch L_ret_82
L_retry_84:
  s_sub_u32 s89, s89, 1
  s_cbranch_scc1 L_go_86
  buffer_load_dwordx4 v[52:55], v253, s[16:19], s96 offen offset:2048 sc1
  buffer_load_dwordx4 v[56:59], v253, s[16:19], s96 offen offset:3072 sc1
  buffer_load_dwordx4 v[60:63], v201, s[16:19], s77 offen offset:0 sc1
  buffer_load_dwordx4 v[64:67], v201, s[16:19], s77 offen offset:1024 sc1
  buffer_load_dwordx4 v[68:71], v201, s[16:19], s77 offen offset:2048 sc1
  buffer_load_dwordx4 v[72:75], v201, s[16:19], s77 offen offset:3072 sc1
  buffer_load_dwordx4 v[76:79], v200, s[16:19], s76 offen offset:0 sc1
  buffer_load_dwordx4 v[80:83], v200, s[16:19], s76 offen offset:1024 sc1
  buffer_load_dwordx4 v[84:87], v200, s[16:19], s76 offen offset:2048 sc1
  s_waitcnt vmcnt(7)
  v_bitop3_b32 v254, v52, v56, 1 bitop3:0x2a
  v_cmp_ne_u32 vcc, 0, v254
  s_cbranch_vccnz L_retry_84
  s_branch L_ret_85
L_go_86:
  s_mov_b32 s89, 0
  s_waitcnt vmcnt(0)
  s_branch L_ret_85
L_retry_87:
  s_sub_u32 s89, s89, 1
  s_cbranch_scc1 L_go_89
  buffer_load_dwordx4 v[60:63], v201, s[16:19], s77 offen offset:0 sc1
  buffer_load_dwordx4 v[64:67], v201, s[16:19], s77 offen offset:1024 sc1
  buffer_load_dwordx4 v[68:71], v201, s[16:19], s77 offen offset:2048 sc1
  buffer_load_dwordx4 v[72:75], v201, s[16:19], s77 offen offset:3072 sc1
  buffer_load_dwordx4 v[76:79], v200, s[16:19], s76 offen offset:0 sc1
  buffer_load_dwordx4 v[80:83], v200, s[16:19], s76 offen offset:1024 sc1
  buffer_load_dwordx4 v[84:87], v200, s[16:19], s76 offen offset:2048 sc1
  buffer_load_dwordx4 v[88:91], v200, s[16:19], s76 offen offset:3072 sc1
  s_waitcnt vmcnt(0)
  v_bitop3_b32 v254, v60, v64, 1 bitop3:0x2a
  v_cmp_ne_u32 vcc, 0, v254
  s_cbranch_vccnz L_retry_87
  s_branch L_ret_88
L_go_89:
  s_mov_b32 s89, 0
  s_waitcnt vmcnt(0)
  s_branch L_ret_88
L_retry_90:
  s_sub_u32 s89, s89, 1
  s_cbranch_scc1 L_go_92
  buffer_load_dwordx4 v[68:71], v201, s[16:19], s77 offen offset:2048 sc1
  buffer_load_dwordx4 v[72:75], v201, s[16:19], s77 offen offset:3072 sc1
  buffer_load_dwordx4 v[76:79], v200, s[16:19], s76 offen offset:0 sc1
  buffer_load_dwordx4 v[80:83], v200, s[16:19], s76 offen offset:1024 sc1
  buffer_load_dwordx4 v[84:87], v200, s[16:19], s76 offen offset:2048 sc1
  buffer_load_dwordx4 v[88:91], v200, s[16:19], s76 offen offset:3072 sc1
  s_waitcnt vmcnt(0)
  v_bitop3_b32 v254, v68, v72, 1 bitop3:0x2a
  v_cmp_ne_u32 vcc, 0, v254
  s_cbranch_vccnz L_retry_90
  s_branch L_ret_91
L_go_92:
  s_mov_b32 s89, 0
  s_waitcnt vmcnt(0)
  s_branch L_ret_91
L_retry_93:
  s_sub_u32 s89, s89, 1
  s_cbranch_scc1 L_go_95
  buffer_load_dwordx4 v[76:79], v200, s[16:19], s76 offen offset:0 sc1
  buffer_load_dwordx4 v[80:83], v200, s[16:19], s76 offen offset:1024 sc1
  buffer_load_dwordx4 v[84:87], v200, s[16:19], s76 offen offset:2048 sc1
  buffer_load_dwordx4 v[88:91], v200, s[16:19], s76 offen offset:3072 sc1
  s_waitcnt vmcnt(0)
  v_bitop3_b32 v254, v76, v80, 1 bitop3:0x2a
  v_cmp_ne_u32 vcc, 0, v254
  s_cbranch_vccnz L_retry_93
  s_branch L_ret_94
L_go_95:
  s_mov_b32 s89, 0
  s_waitcnt vmcnt(0)
  s_branch L_ret_94
L_retry_96:
  s_sub_u32 s89, s89, 1
  s_cbranch_scc1 L_go_98
  buffer_load_dwordx4 v[84:87], v200, s[16:19], s76 offen offset:2048 sc1
  buffer_load_dwordx4 v[88:91], v200, s[16:19], s76 offen offset:3072 sc1
  s_waitcnt vmcnt(0)
  v_bitop3_b32 v254, v84, v88, 1 bitop3:0x2a
  v_cmp_ne_u32 vcc, 0, v254
  s_cbranch_vccnz L_retry_96
  s_branch L_ret_97
L_go_98:
  s_mov_b32 s89, 0
  s_waitcnt vmcnt(0)
  s_branch L_ret_97
L_rdy_101:
  s_sub_u32 s89, s89, 1
  s_cbranch_scc1 L_rgo_103
  buffer_load_dword v29, v28, s[16:19], s54 offen offset:0 sc1
  s_waitcnt vmcnt(0)
  v_xor_b32 v254, s88, v29
  v_cmp_lt_u32 vcc, 31, v254
  s_cbranch_vccnz L_rdy_101
  s_branch L_rret_102
L_rgo_103:
  s_mov_b32 s89, 0
  s_waitcnt vmcnt(0)
  s_branch L_rret_102
L_p6idle_99:
  s_lshr_b32 s97, s94, 1
  s_lshl_b32 s97, s97, 1
  s_and_b32 s91, s92, 1
  s_add_u32 s97, s97, s91
  s_lshl_b32 s97, s97, 2
  s_add_u32 s97, s97, s95
  s_mul_i32 s97, s97, 14336
  v_lshlrev_b32 v28, 7, v0
  buffer_load_dword a5, v28, s[36:39], s97 offen
  s_mov_b32 exec_hi, 0xffff
  s_add_u32 s72, s97, 8192
  buffer_load_dword a5, v28, s[36:39], s72 offen
  s_mov_b64 exec, -1
  s_waitcnt vmcnt(0)
  s_mul_i32 s72, s71, 14336
  s_mov_b64 exec, 0x3fff
  buffer_load_dword a5, v243, s[36:39], s72 offen
  s_mov_b64 exec, -1
  s_waitcnt vmcnt(0) lgkmcnt(0)
  s_barrier
  s_add_u32 m0, s73, 64512
  s_add_u32 s87, s70, 0
  buffer_load_dwordx4 v234, s[36:39], s87 offen lds
  buffer_load_dwordx4 v233, s[36:39], s87 offen offset:1024 lds
  buffer_load_dwordx4 v232, s[36:39], s87 offen offset:2048 lds
  buffer_load_dwordx4 v231, s[36:39], s87 offen offset:3072 lds
  s_add_u32 m0, s73, 0
  s_add_u32 s87, s65, 0
  buffer_load_dwordx4 v234, s[36:39], s87 offen lds
  buffer_load_dwordx4 v233, s[36:39], s87 offen offset:1024 lds
  buffer_load_dwordx4 v232, s[36:39], s87 offen offset:2048 lds
  buffer_load_dwordx4 v231, s[36:39], s87 offen offset:3072 lds
  s_add_u32 m0, s73, 16384
  s_add_u32 s87, s56, 0
  buffer_load_dwordx4 v234, s[36:39], s87 offen lds
  buffer_load_dwordx4 v233, s[36:39], s87 offen offset:1024 lds
  buffer_load_dwordx4 v232, s[36:39], s87 offen offset:2048 lds
  buffer_load_dwordx4 v231, s[36:39], s87 offen offset:3072 lds
  s_add_u32 m0, s73, 32768
  s_add_u32 s87, s70, 32768
  buffer_load_dwordx4 v234, s[36:39], s87 offen lds
  buffer_load_dwordx4 v233, s[36:39], s87 offen offset:1024 lds
  buffer_load_dwordx4 v232, s[36:39], s87 offen offset:2048 lds
  buffer_load_dwordx4 v231, s[36:39], s87 offen offset:3072 lds
  s_waitcnt vmcnt(12)
  ds_read_b64_tr_b16 a[8:9], v229 offset:64512
  ds_read_b64_tr_b16 a[10:11], v229 offset:65024
  ds_read_b64_tr_b16 a[12:13], v1 offset:64512
  ds_read_b64_tr_b16 a[14:15], v1 offset:65024
  ds_read_b64_tr_b16 a[16:17], v2 offset:64512
  ds_read_b64_tr_b16 a[18:19], v2 offset:65024
  ds_read_b64_tr_b16 a[20:21], v3 offset:64512
  ds_read_b64_tr_b16 a[22:23], v3 offset:65024
  s_waitcnt vmcnt(8)
  ds_read_b64_tr_b16 a[24:25], v229 offset:0
  ds_read_b64_tr_b16 a[26:27], v229 offset:512
  s_waitcnt lgkmcnt(2)
  s_add_u32 m0, s73, 64512
  s_add_u32 s87, s65, 32768
  buffer_load_dwordx4 v234, s[36:39], s87 offen lds
  ds_read_b64_tr_b16 a[28:29], v1 offset:0
  ds_read_b64_tr_b16 a[30:31], v1 offset:512
  buffer_load_dwordx4 v233, s[36:39], s87 offen offset:1024 lds
  ds_read_b64_tr_b16 a[32:33], v2 offset:0
  ds_read_b64_tr_b16 a[34:35], v2 offset:512
  buffer_load_dwordx4 v232, s[36:39], s87 offen offset:2048 lds
  ds_read_b64_tr_b16 a[36:37], v3 offset:0
  ds_read_b64_tr_b16 a[38:39], v3 offset:512
  buffer_load_dwordx4 v231, s[36:39], s87 offen offset:3072 lds
  s_waitcnt vmcnt(8)
  ds_read_b64_tr_b16 a[40:41], v229 offset:16384
  ds_read_b64_tr_b16 a[42:43], v229 offset:16896
  s_waitcnt lgkmcnt(2)
  s_add_u32 m0, s73, 0
  s_add_u32 s87, s56, 32768
  buffer_load_dwordx4 v234, s[36:39], s87 offen lds
  ds_read_b64_tr_b16 a[44:45], v1 offset:16384
  ds_read_b64_tr_b16 a[46:47], v1 offset:16896
  buffer_load_dwordx4 v233, s[36:39], s87 offen offset:1024 lds
  ds_read_b64_tr_b16 a[48:49], v2 offset:16384
  ds_read_b64_tr_b16 a[50:51], v2 offset:16896
  buffer_load_dwordx4 v232, s[36:39], s87 offen offset:2048 lds
  ds_read_b64_tr_b16 a[52:53], v3 offset:16384
  ds_read_b64_tr_b16 a[54:55], v3 offset:16896
  buffer_load_dwordx4 v231, s[36:39], s87 offen offset:3072 lds
  s_waitcnt vmcnt(8)
  ds_read_b64_tr_b16 a[56:57], v229 offset:32768
  ds_read_b64_tr_b16 a[58:59], v229 offset:33280
  s_waitcnt lgkmcnt(2)
  s_add_u32 m0, s73, 16384
  s_add_u32 s87, s55, 0
  buffer_load_dwordx4 v234, s[36:39], s87 offen lds
  ds_read_b64_tr_b16 a[60:61], v1 offset:32768
  ds_read_b64_tr_b16 a[62:63], v1 offset:33280
  buffer_load_dwordx4 v233, s[36:39], s87 offen offset:1024 lds
  ds_read_b64_tr_b16 a[64:65], v2 offset:32768
  ds_read_b64_tr_b16 a[66:67], v2 offset:33280
  buffer_load_dwordx4 v232, s[36:39], s87 offen offset:2048 lds
  ds_read_b64_tr_b16 a[68:69], v3 offset:32768
  ds_read_b64_tr_b16 a[70:71], v3 offset:33280
  buffer_load_dwordx4 v231, s[36:39], s87 offen offset:3072 lds
  s_waitcnt vmcnt(8)
  ds_read_b64_tr_b16 a[72:73], v229 offset:64512
  ds_read_b64_tr_b16 a[74:75], v229 offset:65024
  s_waitcnt lgkmcnt(2)
  s_add_u32 m0, s73, 32768
  s_add_u32 s87, s70, 65536
  buffer_load_dwordx4 v234, s[36:39], s87 offen lds
  ds_read_b64_tr_b16 a[76:77], v1 offset:64512
  ds_read_b64_tr_b16 a[78:79], v1 offset:65024
  buffer_load_dwordx4 v233, s[36:39], s87 offen offset:1024 lds
  ds_read_b64_tr_b16 a[80:81], v2 offset:64512
  ds_read_b64_tr_b16 a[82:83], v2 offset:65024
  buffer_load_dwordx4 v232, s[36:39], s87 offen offset:2048 lds
  ds_read_b64_tr_b16 a[84:85], v3 offset:64512
  ds_read_b64_tr_b16 a[86:87], v3 offset:65024
  buffer_load_dwordx4 v231, s[36:39], s87 offen offset:3072 lds
  s_waitcnt vmcnt(8)
  ds_read_b64_tr_b16 a[88:89], v229 offset:0
  ds_read_b64_tr_b16 a[90:91], v229 offset:512
  s_waitcnt lgkmcnt(2)
  s_add_u32 m0, s73, 64512
  s_add_u32 s87, s65, 65536
  buffer_load_dwordx4 v234, s[36:39], s87 offen lds
  ds_read_b64_tr_b16 a[92:93], v1 offset:0
  ds_read_b64_tr_b16 a[94:95], v1 offset:512
  buffer_load_dwordx4 v233, s[36:39], s87 offen offset:1024 lds
  ds_read_b64_tr_b16 a[96:97], v2 offset:0
  ds_read_b64_tr_b16 a[98:99], v2 offset:512
  buffer_load_dwordx4 v232, s[36:39], s87 offen offset:2048 lds
  ds_read_b64_tr_b16 a[100:101], v3 offset:0
  ds_read_b64_tr_b16 a[102:103], v3 offset:512
  buffer_load_dwordx4 v231, s[36:39], s87 offen offset:3072 lds
  s_waitcnt vmcnt(8)
  ds_read_b64_tr_b16 a[104:105], v229 offset:16384
  ds_read_b64_tr_b16 a[106:107], v229 offset:16896
  s_waitcnt lgkmcnt(2)
  s_add_u32 m0, s73, 0
  s_add_u32 s87, s56, 65536
  buffer_load_dwordx4 v234, s[36:39], s87 offen lds
  ds_read_b64_tr_b16 a[108:109], v1 offset:16384
  ds_read_b64_tr_b16 a[110:111], v1 offset:16896
  buffer_load_dwordx4 v233, s[36:39], s87 offen offset:1024 lds
  ds_read_b64_tr_b16 a[112:113], v2 offset:16384
  ds_read_b64_tr_b16 a[114:115], v2 offset:16896
  buffer_load_dwordx4 v232, s[36:39], s87 offen offset:2048 lds
  ds_read_b64_tr_b16 a[116:117], v3 offset:16384
  ds_read_b64_tr_b16 a[118:119], v3 offset:16896
  buffer_load_dwordx4 v231, s[36:39], s87 offen offset:3072 lds
  s_waitcnt vmcnt(8)
  ds_read_b64_tr_b16 a[120:121], v229 offset:32768
  ds_read_b64_tr_b16 a[122:123], v229 offset:33280
  s_waitcnt lgkmcnt(2)
  s_add_u32 m0, s73, 16384
  s_add_u32 s87, s55, 65536
  buffer_load_dwordx4 v234, s[36:39], s87 offen lds
  ds_read_b64_tr_b16 a[124:125], v1 offset:32768
  ds_read_b64_tr_b16 a[126:127], v1 offset:33280
  buffer_load_dwordx4 v233, s[36:39], s87 offen offset:1024 lds
  ds_read_b64_tr_b16 a[128:129], v2 offset:32768
  ds_read_b64_tr_b16 a[130:131], v2 offset:33280
  buffer_load_dwordx4 v232, s[36:39], s87 offen offset:2048 lds
  ds_read_b64_tr_b16 a[132:133], v3 offset:32768
  ds_read_b64_tr_b16 a[134:135], v3 offset:33280
  buffer_load_dwordx4 v231, s[36:39], s87 offen offset:3072 lds
  v_bfe_u32 v29, v0, 1, 2
  v_mov_b32 v28, s70
  v_cmp_eq_u32 vcc, 1, v29
  v_mov_b32 v255, s65
  s_nop 0
  v_cndmask_b32 v28, v28, v255, vcc
  v_cmp_eq_u32 vcc, 2, v29
  v_mov_b32 v255, s56
  s_nop 0
  v_cndmask_b32 v28, v28, v255, vcc
  v_cmp_eq_u32 vcc, 3, v29
  v_mov_b32 v255, s55
  s_nop 0
  v_cndmask_b32 v28, v28, v255, vcc
  v_lshrrev_b32 v28, 17, v28
  v_and_b32 v29, 1, v0
  v_lshl_add_u32 v28, v28, 2, v29
  s_and_b32 s91, s94, 1
  s_lshl_b32 s91, s91, 1
  v_add_u32 v28, s91, v28
  v_lshlrev_b32 v28, 2, v28
  buffer_load_dword v29, v28, s[16:19], s54 offen offset:0 sc1
  s_lshr_b32 s97, s70, 19
  s_lshl_b32 s97, s97, 16
  s_bfe_u32 s74, s70, 262159
  s_lshl_b32 s74, s74, 10
  s_add_u32 s97, s97, s74
  s_lshr_b32 s96, s65, 19
  s_lshl_b32 s96, s96, 16
  s_bfe_u32 s74, s65, 262159
  s_lshl_b32 s74, s74, 10
  s_add_u32 s96, s96, s74
  s_lshr_b32 s77, s56, 19
  s_lshl_b32 s77, s77, 16
  s_bfe_u32 s74, s56, 262159
  s_lshl_b32 s74, s74, 10
  s_add_u32 s77, s77, s74
  s_lshr_b32 s76, s55, 19
  s_lshl_b32 s76, s76, 16
  s_bfe_u32 s74, s55, 262159
  s_lshl_b32 s74, s74, 10
  s_add_u32 s76, s76, s74
  v_add_u32 v32, s97, v253
  v_add_u32 v33, s96, v253
  v_add_u32 v34, s77, v253
  v_add_u32 v35, s76, v253
  s_add_u32 s74, s95, 1
  s_and_b32 s74, s74, 3
  s_lshl_b32 s74, s74, 14
  s_add_u32 s97, s74, s86
  s_add_u32 s69, s95, 2
  s_and_b32 s69, s69, 3
  s_lshl_b32 s69, s69, 14
  s_add_u32 s96, s69, s86
  s_add_u32 s68, s95, 3
  s_and_b32 s68, s68, 3
  s_lshl_b32 s68, s68, 14
  s_add_u32 s77, s68, s86
  s_lshl_b32 s76, s95, 14
  s_add_u32 s76, s76, s86
  s_waitcnt vmcnt(0)
  v_xor_b32 v254, s88, v29
  v_cmp_lt_u32 vcc, 31, v254
  s_cbranch_vccnz L_rdy_101
L_rret_102:
  buffer_load_dwordx4 v[44:47], v32, s[16:19], s97 offen offset:0 sc1
  buffer_load_dwordx4 v[48:51], v33, s[16:19], s97 offen offset:0 sc1
  buffer_load_dwordx4 v[52:55], v34, s[16:19], s97 offen offset:0 sc1
  buffer_load_dwordx4 v[56:59], v32, s[16:19], s97 offen offset:1024 sc1
  buffer_load_dwordx4 v[60:63], v33, s[16:19], s97 offen offset:1024 sc1
  buffer_load_dwordx4 v[64:67], v34, s[16:19], s97 offen offset:1024 sc1
  buffer_load_dwordx4 v[68:71], v35, s[16:19], s97 offen offset:0 sc1
  buffer_load_dwordx4 v[72:75], v32, s[16:19], s96 offen offset:0 sc1
  buffer_load_dwordx4 v[76:79], v33, s[16:19], s96 offen offset:0 sc1
  buffer_load_dwordx4 v[80:83], v34, s[16:19], s96 offen offset:0 sc1
  buffer_load_dwordx4 v[84:87], v32, s[16:19], s96 offen offset:1024 sc1
  buffer_load_dwordx4 v[88:91], v33, s[16:19], s96 offen offset:1024 sc1
  buffer_load_dwordx4 v[92:95], v34, s[16:19], s96 offen offset:1024 sc1
  buffer_load_dwordx4 v[96:99], v35, s[16:19], s96 offen offset:0 sc1
  buffer_load_dwordx4 v[100:103], v32, s[16:19], s77 offen offset:0 sc1
  buffer_load_dwordx4 v[104:107], v33, s[16:19], s77 offen offset:0 sc1
  buffer_load_dwordx4 v[108:111], v34, s[16:19], s77 offen offset:0 sc1
  buffer_load_dwordx4 v[112:115], v32, s[16:19], s77 offen offset:1024 sc1
  buffer_load_dwordx4 v[116:119], v33, s[16:19], s77 offen offset:1024 sc1
  buffer_load_dwordx4 v[120:123], v34, s[16:19], s77 offen offset:1024 sc1
  buffer_load_dwordx4 v[124:127], v35, s[16:19], s77 offen offset:0 sc1
  buffer_load_dwordx4 v[128:131], v32, s[16:19], s76 offen offset:0 sc1
  buffer_load_dwordx4 v[132:135], v33, s[16:19], s76 offen offset:0 sc1
  buffer_load_dwordx4 v[136:139], v34, s[16:19], s76 offen offset:0 sc1
  s_waitcnt vmcnt(0) lgkmcnt(0)
  s_branch L_p6join_100
L_retry_104:
  s_sub_u32 s89, s89, 1
  s_cbranch_scc1 L_go_106
  s_add_u32 s67, s63, 331776
  buffer_load_dwordx2 v[220:221], v241, s[16:19], s67 offen offset:0 sc1
  buffer_load_dwordx2 v[222:223], v241, s[16:19], s67 offen offset:128 sc1
  buffer_load_dwordx2 v[224:225], v241, s[16:19], s67 offen offset:256 sc1
  buffer_load_dwordx2 v[226:227], v241, s[16:19], s67 offen offset:384 sc1
  s_waitcnt vmcnt(0)
  v_max3_u32 v254, v220, v221, v222
  v_max3_u32 v254, v254, v223, v224
  v_max3_u32 v254, v254, v225, v226
  v_max_u32 v254, v254, v227
  v_cmp_eq_u32 vcc, -1, v254
  s_cbranch_vccnz L_retry_104
  s_branch L_ret_105
L_go_106:
  s_mov_b32 s89, 0
  s_waitcnt vmcnt(0)
  s_branch L_ret_105
L_retry_107:
  s_sub_u32 s89, s89, 1
  s_cbranch_scc1 L_go_109
  buffer_load_dwordx4 v[28:31], v245, s[16:19], s97 offen offset:0 sc1
  buffer_load_dwordx4 v[32:35], v245, s[16:19], s97 offen offset:512 sc1
  buffer_load_dwordx4 v[36:39], v245, s[16:19], s97 offen offset:1024 sc1
  buffer_load_dwordx4 v[40:43], v245, s[16:19], s97 offen offset:1536 sc1
  buffer_load_dwordx4 v[44:47], v245, s[16:19], s97 offen offset:2048 sc1
  buffer_load_dwordx4 v[48:51], v245, s[16:19], s97 offen offset:2560 sc1
  buffer_load_dwordx4 v[52:55], v245, s[16:19], s97 offen offset:3072 sc1
  buffer_load_dwordx4 v[56:59], v245, s[16:19], s97 offen offset:3584 sc1
  buffer_load_dwordx4 v[60:63], v245, s[16:19], s96 offen offset:0 sc1
  buffer_load_dwordx4 v[64:67], v245, s[16:19], s96 offen offset:512 sc1
  s_waitcnt vmcnt(8)
  v_bitop3_b32 v254, v28, v32, 1 bitop3:0x7e
  v_and_b32 v254, 0x10001, v254
  v_cmp_ne_u32 vcc, 0, v254
  s_cbranch_vccnz L_retry_107
  s_branch L_ret_108
L_go_109:
  s_mov_b32 s89, 0
  s_waitcnt vmcnt(0)
  s_branch L_ret_108
L_retry_110:
  s_sub_u32 s89, s89, 1
  s_cbranch_scc1 L_go_112
  buffer_load_dwordx4 v[36:39], v245, s[16:19], s97 offen offset:1024 sc1
  buffer_load_dwordx4 v[40:43], v245, s[16:19], s97 offen offset:1536 sc1
  buffer_load_dwordx4 v[44:47], v245, s[16:19], s97 offen offset:2048 sc1
  buffer_load_dwordx4 v[48:51], v245, s[16:19], s97 offen offset:2560 sc1
  buffer_load_dwordx4 v[52:55], v245, s[16:19], s97 offen offset:3072 sc1
  buffer_load_dwordx4 v[56:59], v245, s[16:19], s97 offen offset:3584 sc1
  buffer_load_dwordx4 v[60:63], v245, s[16:19], s96 offen offset:0 sc1
  buffer_load_dwordx4 v[64:67], v245, s[16:19], s96 offen offset:512 sc1
  buffer_load_dwordx4 v[68:71], v245, s[16:19], s96 offen offset:1024 sc1
  buffer_load_dwordx4 v[72:75], v245, s[16:19], s96 offen offset:1536 sc1
  s_waitcnt vmcnt(8)
  v_bitop3_b32 v254, v36, v40, 1 bitop3:0x7e
  v_and_b32 v254, 0x10001, v254
  v_cmp_ne_u32 vcc, 0, v254
  s_cbranch_vccnz L_retry_110
  s_branch L_ret_111
L_go_112:
  s_mov_b32 s89, 0
  s_waitcnt vmcnt(0)
  s_branch L_ret_111
L_retry_113:
  s_sub_u32 s89, s89, 1
  s_cbranch_scc1 L_go_115
  buffer_load_dwordx4 v[44:47], v245, s[16:19], s97 offen offset:2048 sc1
  buffer_load_dwordx4 v[48:51], v245, s[16:19], s97 offen offset:2560 sc1
  buffer_load_dwordx4 v[52:55], v245, s[16:19], s97 offen offset:3072 sc1
  buffer_load_dwordx4 v[56:59], v245, s[16:19], s97 offen offset:3584 sc1
  buffer_load_dwordx4 v[60:63], v245, s[16:19], s96 offen offset:0 sc1
  buffer_load_dwordx4 v[64:67], v245, s[16:19], s96 offen offset:512 sc1
  buffer_load_dwordx4 v[68:71], v245, s[16:19], s96 offen offset:1024 sc1
  buffer_load_dwordx4 v[72:75], v245, s[16:19], s96 offen offset:1536 sc1
  buffer_load_dwordx4 v[76:79], v245, s[16:19], s96 offen offset:2048 sc1
  buffer_load_dwordx4 v[80:83], v245, s[16:19], s96 offen offset:2560 sc1
  s_waitcnt vmcnt(8)
  v_bitop3_b32 v254, v44, v48, 1 bitop3:0x7e
  v_and_b32 v254, 0x10001, v254
  v_cmp_ne_u32 vcc, 0, v254
  s_cbranch_vccnz L_retry_113
  s_branch L_ret_114
L_go_115:
  s_mov_b32 s89, 0
  s_waitcnt vmcnt(0)
  s_branch L_ret_114
L_rdy_116:
  s_sub_u32 s89, s89, 1
  s_cbranch_scc1 L_rgo_118
  buffer_load_dword v220, v221, s[16:19], 0 offen sc1
  s_waitcnt vmcnt(0)
  v_xor_b32 v254, s88, v220
  v_cmp_lt_u32 vcc, 31, v254
  s_cbranch_vccnz L_rdy_116
  s_branch L_rret_117
L_rgo_118:
  s_mov_b32 s89, 0
  s_waitcnt vmcnt(0)
  s_branch L_rret_117
L_retry_119:
  s_sub_u32 s89, s89, 1
  s_cbranch_scc1 L_go_121
  buffer_load_dwordx4 v[52:55], v245, s[16:19], s97 offen offset:3072 sc1
  buffer_load_dwordx4 v[56:59], v245, s[16:19], s97 offen offset:3584 sc1
  buffer_load_dwordx4 v[60:63], v245, s[16:19], s96 offen offset:0 sc1
  buffer_load_dwordx4 v[64:67], v245, s[16:19], s96 offen offset:512 sc1
  buffer_load_dwordx4 v[68:71], v245, s[16:19], s96 offen offset:1024 sc1
  buffer_load_dwordx4 v[72:75], v245, s[16:19], s96 offen offset:1536 sc1
  buffer_load_dwordx4 v[76:79], v245, s[16:19], s96 offen offset:2048 sc1
  buffer_load_dwordx4 v[80:83], v245, s[16:19], s96 offen offset:2560 sc1
  buffer_load_dwordx4 v[84:87], v245, s[16:19], s96 offen offset:3072 sc1
  buffer_load_dwordx4 v[88:91], v245, s[16:19], s96 offen offset:3584 sc1
  s_waitcnt vmcnt(8)
  v_bitop3_b32 v254, v52, v56, 1 bitop3:0x7e
  v_and_b32 v254, 0x10001, v254
  v_cmp_ne_u32 vcc, 0, v254
  s_cbranch_vccnz L_retry_119
  s_branch L_ret_120
L_go_121:
  s_mov_b32 s89, 0
  s_waitcnt vmcnt(0)
  s_branch L_ret_120
L_retry_122:
  s_sub_u32 s89, s89, 1
  s_cbranch_scc1 L_go_124
  buffer_load_dwordx4 v[60:63], v245, s[16:19], s96 offen offset:0 sc1
  buffer_load_dwordx4 v[64:67], v245, s[16:19], s96 offen offset:512 sc1
  buffer_load_dwordx4 v[68:71], v245, s[16:19], s96 offen offset:1024 sc1
  buffer_load_dwordx4 v[72:75], v245, s[16:19], s96 offen offset:1536 sc1
  buffer_load_dwordx4 v[76:79], v245, s[16:19], s96 offen offset:2048 sc1
  buffer_load_dwordx4 v[80:83], v245, s[16:19], s96 offen offset:2560 sc1
  buffer_load_dwordx4 v[84:87], v245, s[16:19], s96 offen offset:3072 sc1
  buffer_load_dwordx4 v[88:91], v245, s[16:19], s96 offen offset:3584 sc1
  buffer_load_dwordx4 v[92:95], v245, s[16:19], s77 offen offset:0 sc1
  buffer_load_dwordx4 v[96:99], v245, s[16:19], s77 offen offset:512 sc1
  s_waitcnt vmcnt(8)
  v_bitop3_b32 v254, v60, v64, 1 bitop3:0x7e
  v_and_b32 v254, 0x10001, v254
  v_cmp_ne_u32 vcc, 0, v254
  s_cbranch_vccnz L_retry_122
  s_branch L_ret_123
L_go_124:
  s_mov_b32 s89, 0
  s_waitcnt vmcnt(0)
  s_branch L_ret_123
L_retry_125:
  s_sub_u32 s89, s89, 1
  s_cbranch_scc1 L_go_127
  buffer_load_dwordx4 v[68:71], v245, s[16:19], s96 offen offset:1024 sc1
  buffer_load_dwordx4 v[72:75], v245, s[16:19], s96 offen offset:1536 sc1
  buffer_load_dwordx4 v[76:79], v245, s[16:19], s96 offen offset:2048 sc1
  buffer_load_dwordx4 v[80:83], v245, s[16:19], s96 offen offset:2560 sc1
  buffer_load_dwordx4 v[84:87], v245, s[16:19], s96 offen offset:3072 sc1
  buffer_load_dwordx4 v[88:91], v245, s[16:19], s96 offen offset:3584 sc1
  buffer_load_dwordx4 v[92:95], v245, s[16:19], s77 offen offset:0 sc1
  buffer_load_dwordx4 v[96:99], v245, s[16:19], s77 offen offset:512 sc1
  buffer_load_dwordx4 v[100:103], v245, s[16:19], s77 offen offset:1024 sc1
  buffer_load_dwordx4 v[104:107], v245, s[16:19], s77 offen offset:1536 sc1
  s_waitcnt vmcnt(8)
  v_bitop3_b32 v254, v68, v72, 1 bitop3:0x7e
  v_and_b32 v254, 0x10001, v254
  v_cmp_ne_u32 vcc, 0, v254
  s_cbranch_vccnz L_retry_125
  s_branch L_ret_126
L_go_127:
  s_mov_b32 s89, 0
  s_waitcnt vmcnt(0)
  s_branch L_ret_126
L_retry_128:
  s_sub_u32 s89, s89, 1
  s_cbranch_scc1 L_go_130
  buffer_load_dwordx4 v[76:79], v245, s[16:19], s96 offen offset:2048 sc1
  buffer_load_dwordx4 v[80:83], v245, s[16:19], s96 offen offset:2560 sc1
  buffer_load_dwordx4 v[84:87], v245, s[16:19], s96 offen offset:3072 sc1
  buffer_load_dwordx4 v[88:91], v245, s[16:19], s96 offen offset:3584 sc1
  buffer_load_dwordx4 v[92:95], v245, s[16:19], s77 offen offset:0 sc1
  buffer_load_dwordx4 v[96:99], v245, s[16:19], s77 offen offset:512 sc1
  buffer_load_dwordx4 v[100:103], v245, s[16:19], s77 offen offset:1024 sc1
  buffer_load_dwordx4 v[104:107], v245, s[16:19], s77 offen offset:1536 sc1
  buffer_load_dwordx4 v[108:111], v245, s[16:19], s77 offen offset:2048 sc1
  buffer_load_dwordx4 v[112:115], v245, s[16:19], s77 offen offset:2560 sc1
  s_waitcnt vmcnt(0)
  v_bitop3_b32 v254, v76, v80, 1 bitop3:0x7e
  v_and_b32 v254, 0x10001, v254
  v_cmp_ne_u32 vcc, 0, v254
  s_cbranch_vccnz L_retry_128
  s_branch L_ret_129
L_go_130:
  s_mov_b32 s89, 0
  s_waitcnt vmcnt(0)
  s_branch L_ret_129
L_retry_131:
  s_sub_u32 s89, s89, 1
  s_cbranch_scc1 L_go_133
  buffer_load_dwordx4 v[84:87], v245, s[16:19], s96 offen offset:3072 sc1
  buffer_load_dwordx4 v[88:91], v245, s[16:19], s96 offen offset:3584 sc1
  buffer_load_dwordx4 v[92:95], v245, s[16:19], s77 offen offset:0 sc1
  buffer_load_dwordx4 v[96:99], v245, s[16:19], s77 offen offset:512 sc1
  buffer_load_dwordx4 v[100:103], v245, s[16:19], s77 offen offset:1024 sc1
  buffer_load_dwordx4 v[104:107], v245, s[16:19], s77 offen offset:1536 sc1
  buffer_load_dwordx4 v[108:111], v245, s[16:19], s77 offen offset:2048 sc1
  buffer_load_dwordx4 v[112:115], v245, s[16:19], s77 offen offset:2560 sc1
  buffer_load_dwordx4 v[116:119], v245, s[16:19], s77 offen offset:3072 sc1
  buffer_load_dwordx4 v[120:123], v245, s[16:19], s77 offen offset:3584 sc1
  s_waitcnt vmcnt(0)
  v_bitop3_b32 v254, v84, v88, 1 bitop3:0x7e
  v_and_b32 v254, 0x10001, v254
  v_cmp_ne_u32 vcc, 0, v254
  s_cbranch_vccnz L_retry_131
  s_branch L_ret_132
L_go_133:
  s_mov_b32 s89, 0
  s_waitcnt vmcnt(0)
  s_branch L_ret_132
L_retry_134:
  s_sub_u32 s89, s89, 1
  s_cbranch_scc1 L_go_136
  buffer_load_dwordx4 v[92:95], v245, s[16:19], s77 offen offset:0 sc1
  buffer_load_dwordx4 v[96:99], v245, s[16:19], s77 offen offset:512 sc1
  buffer_load_dwordx4 v[100:103], v245, s[16:19], s77 offen offset:1024 sc1
  buffer_load_dwordx4 v[104:107], v245, s[16:19], s77 offen offset:1536 sc1
  buffer_load_dwordx4 v[108:111], v245, s[16:19], s77 offen offset:2048 sc1
  buffer_load_dwordx4 v[112:115], v245, s[16:19], s77 offen offset:2560 sc1
  buffer_load_dwordx4 v[116:119], v245, s[16:19], s77 offen offset:3072 sc1
  buffer_load_dwordx4 v[120:123], v245, s[16:19], s77 offen offset:3584 sc1
  buffer_load_dwordx4 v[124:127], v245, s[16:19], s76 offen offset:0 sc1
  buffer_load_dwordx4 v[128:131], v245, s[16:19], s76 offen offset:512 sc1
  s_waitcnt vmcnt(0)
  v_bitop3_b32 v254, v92, v96, 1 bitop3:0x7e
  v_and_b32 v254, 0x10001, v254
  v_cmp_ne_u32 vcc, 0, v254
  s_cbranch_vccnz L_retry_134
  s_branch L_ret_135
L_go_136:
  s_mov_b32 s89, 0
  s_waitcnt vmcnt(0)
  s_branch L_ret_135
L_retry_137:
  s_sub_u32 s89, s89, 1
  s_cbranch_scc1 L_go_139
  buffer_load_dwordx4 v[100:103], v245, s[16:19], s77 offen offset:1024 sc1
  buffer_load_dwordx4 v[104:107], v245, s[16:19], s77 offen offset:1536 sc1
  buffer_load_dwordx4 v[108:111], v245, s[16:19], s77 offen offset:2048 sc1
  buffer_load_dwordx4 v[112:115], v245, s[16:19], s77 offen offset:2560 sc1
  buffer_load_dwordx4 v[116:119], v245, s[16:19], s77 offen offset:3072 sc1
  buffer_load_dwordx4 v[120:123], v245, s[16:19], s77 offen offset:3584 sc1
  buffer_load_dwordx4 v[124:127], v245, s[16:19], s76 offen offset:0 sc1
  buffer_load_dwordx4 v[128:131], v245, s[16:19], s76 offen offset:512 sc1
  buffer_load_dwordx4 v[132:135], v245, s[16:19], s76 offen offset:1024 sc1
  buffer_load_dwordx4 v[136:139], v245, s[16:19], s76 offen offset:1536 sc1
  s_waitcnt vmcnt(0)
  v_bitop3_b32 v254, v100, v104, 1 bitop3:0x7e
  v_and_b32 v254, 0x10001, v254
  v_cmp_ne_u32 vcc, 0, v254
  s_cbranch_vccnz L_retry_137
  s_branch L_ret_138
L_go_139:
  s_mov_b32 s89, 0
  s_waitcnt vmcnt(0)
  s_branch L_ret_138
L_retry_140:
  s_sub_u32 s89, s89, 1
  s_cbranch_scc1 L_go_142
  buffer_load_dwordx4 v[108:111], v245, s[16:19], s77 offen offset:2048 sc1
  buffer_load_dwordx4 v[112:115], v245, s[16:19], s77 offen offset:2560 sc1
  buffer_load_dwordx4 v[116:119], v245, s[16:19], s77 offen offset:3072 sc1
  buffer_load_dwordx4 v[120:123], v245, s[16:19], s77 offen offset:3584 sc1
  buffer_load_dwordx4 v[124:127], v245, s[16:19], s76 offen offset:0 sc1
  buffer_load_dwordx4 v[128:131], v245, s[16:19], s76 offen offset:512 sc1
  buffer_load_dwordx4 v[132:135], v245, s[16:19], s76 offen offset:1024 sc1
  buffer_load_dwordx4 v[136:139], v245, s[16:19], s76 offen offset:1536 sc1
  buffer_load_dwordx4 v[140:143], v245, s[16:19], s76 offen offset:2048 sc1
  buffer_load_dwordx4 v[144:147], v245, s[16:19], s76 offen offset:2560 sc1
  s_waitcnt vmcnt(8)
  v_bitop3_b32 v254, v108, v112, 1 bitop3:0x7e
  v_and_b32 v254, 0x10001, v254
  v_cmp_ne_u32 vcc, 0, v254
  s_cbranch_vccnz L_retry_140
  s_branch L_ret_141
L_go_142:
  s_mov_b32 s89, 0
  s_waitcnt vmcnt(0)
  s_branch L_ret_141
L_retry_143:
  s_sub_u32 s89, s89, 1
  s_cbranch_scc1 L_go_145
  buffer_load_dwordx4 v[116:119], v245, s[16:19], s77 offen offset:3072 sc1
  buffer_load_dwordx4 v[120:123], v245, s[16:19], s77 offen offset:3584 sc1
  buffer_load_dwordx4 v[124:127], v245, s[16:19], s76 offen offset:0 sc1
  buffer_load_dwordx4 v[128:131], v245, s[16:19], s76 offen offset:512 sc1
  buffer_load_dwordx4 v[132:135], v245, s[16:19], s76 offen offset:1024 sc1
  buffer_load_dwordx4 v[136:139], v245, s[16:19], s76 offen offset:1536 sc1
  buffer_load_dwordx4 v[140:143], v245, s[16:19], s76 offen offset:2048 sc1
  buffer_load_dwordx4 v[144:147], v245, s[16:19], s76 offen offset:2560 sc1
  buffer_load_dwordx4 v[148:151], v245, s[16:19], s76 offen offset:3072 sc1
  buffer_load_dwordx4 v[152:155], v245, s[16:19], s76 offen offset:3584 sc1
  s_waitcnt vmcnt(8)
  v_bitop3_b32 v254, v116, v120, 1 bitop3:0x7e
  v_and_b32 v254, 0x10001, v254
  v_cmp_ne_u32 vcc, 0, v254
  s_cbranch_vccnz L_retry_143
  s_branch L_ret_144
L_go_145:
  s_mov_b32 s89, 0
  s_waitcnt vmcnt(0)
  s_branch L_ret_144
L_retry_146:
  s_sub_u32 s89, s89, 1
  s_cbranch_scc1 L_go_148
  buffer_load_dwordx4 v[124:127], v245, s[16:19], s76 offen offset:0 sc1
  buffer_load_dwordx4 v[128:131], v245, s[16:19], s76 offen offset:512 sc1
  buffer_load_dwordx4 v[132:135], v245, s[16:19], s76 offen offset:1024 sc1
  buffer_load_dwordx4 v[136:139], v245, s[16:19], s76 offen offset:1536 sc1
  buffer_load_dwordx4 v[140:143], v245, s[16:19], s76 offen offset:2048 sc1
  buffer_load_dwordx4 v[144:147], v245, s[16:19], s76 offen offset:2560 sc1
  buffer_load_dwordx4 v[148:151], v245, s[16:19], s76 offen offset:3072 sc1
  buffer_load_dwordx4 v[152:155], v245, s[16:19], s76 offen offset:3584 sc1
  s_waitcnt vmcnt(0)
  v_bitop3_b32 v254, v124, v128, 1 bitop3:0x7e
  v_and_b32 v254, 0x10001, v254
  v_cmp_ne_u32 vcc, 0, v254
  s_cbranch_vccnz L_retry_146
  s_branch L_ret_147
L_go_148:
  s_mov_b32 s89, 0
  s_waitcnt vmcnt(0)
  s_branch L_ret_147
L_retry_149:
  s_sub_u32 s89, s89, 1
  s_cbranch_scc1 L_go_151
  buffer_load_dwordx4 v[132:135], v245, s[16:19], s76 offen offset:1024 sc1
  buffer_load_dwordx4 v[136:139], v245, s[16:19], s76 offen offset:1536 sc1
  buffer_load_dwordx4 v[140:143], v245, s[16:19], s76 offen offset:2048 sc1
  buffer_load_dwordx4 v[144:147], v245, s[16:19], s76 offen offset:2560 sc1
  buffer_load_dwordx4 v[148:151], v245, s[16:19], s76 offen offset:3072 sc1
  buffer_load_dwordx4 v[152:155], v245, s[16:19], s76 offen offset:3584 sc1
  s_waitcnt vmcnt(0)
  v_bitop3_b32 v254, v132, v136, 1 bitop3:0x7e
  v_and_b32 v254, 0x10001, v254
  v_cmp_ne_u32 vcc, 0, v254
  s_cbranch_vccnz L_retry_149
  s_branch L_ret_150
L_go_151:
  s_mov_b32 s89, 0
  s_waitcnt vmcnt(0)
  s_branch L_ret_150
L_retry_152:
  s_sub_u32 s89, s89, 1
  s_cbranch_scc1 L_go_154
  buffer_load_dwordx4 v[140:143], v245, s[16:19], s76 offen offset:2048 sc1
  buffer_load_dwordx4 v[144:147], v245, s[16:19], s76 offen offset:2560 sc1
  buffer_load_dwordx4 v[148:151], v245, s[16:19], s76 offen offset:3072 sc1
  buffer_load_dwordx4 v[152:155], v245, s[16:19], s76 offen offset:3584 sc1
  s_waitcnt vmcnt(0)
  v_bitop3_b32 v254, v140, v144, 1 bitop3:0x7e
  v_and_b32 v254, 0x10001, v254
  v_cmp_ne_u32 vcc, 0, v254
  s_cbranch_vccnz L_retry_152
  s_branch L_ret_153
L_go_154:
  s_mov_b32 s89, 0
  s_waitcnt vmcnt(0)
  s_branch L_ret_153
L_retry_155:
  s_sub_u32 s89, s89, 1
  s_cbranch_scc1 L_go_157
  buffer_load_dwordx4 v[148:151], v245, s[16:19], s76 offen offset:3072 sc1
  buffer_load_dwordx4 v[152:155], v245, s[16:19], s76 offen offset:3584 sc1
  s_waitcnt vmcnt(0)
  v_bitop3_b32 v254, v148, v152, 1 bitop3:0x7e
  v_and_b32 v254, 0x10001, v254
  v_cmp_ne_u32 vcc, 0, v254
  s_cbranch_vccnz L_retry_155
  s_branch L_ret_156
L_go_157:
  s_mov_b32 s89, 0
  s_waitcnt vmcnt(0)
  s_branch L_ret_156
L_rdy_158:
  s_sub_u32 s89, s89, 1
  s_cbranch_scc1 L_rgo_160
  buffer_load_dword v29, v28, s[16:19], s54 offen offset:0 sc1
  s_waitcnt vmcnt(0)
  v_xor_b32 v254, s88, v29
  v_cmp_lt_u32 vcc, 31, v254
  s_cbranch_vccnz L_rdy_158
  s_branch L_rret_159
L_rgo_160:
  s_mov_b32 s89, 0
  s_waitcnt vmcnt(0)
  s_branch L_rret_159
L_rdy_161:
  s_sub_u32 s89, s89, 1
  s_cbranch_scc1 L_rgo_163
  buffer_load_dword v29, v28, s[16:19], s54 offen offset:256 sc1
  s_waitcnt vmcnt(0)
  v_xor_b32 v254, s88, v29
  v_cmp_lt_u32 vcc, 31, v254
  s_cbranch_vccnz L_rdy_161
  s_branch L_rret_162
L_rgo_163:
  s_mov_b32 s89, 0
  s_waitcnt vmcnt(0)
  s_branch L_rret_162
L_rdy_164:
  s_sub_u32 s89, s89, 1
  s_cbranch_scc1 L_rgo_166
  buffer_load_dword v29, v28, s[16:19], s54 offen offset:512 sc1
  s_waitcnt vmcnt(0)
  v_xor_b32 v254, s88, v29
  v_cmp_lt_u32 vcc, 31, v254
  s_cbranch_vccnz L_rdy_164
  s_branch L_rret_165
L_rgo_166:
  s_mov_b32 s89, 0
  s_waitcnt vmcnt(0)
  s_branch L_rret_165
L_slow:
  buffer_store_dwordx4 v[168:171], v239, s[16:19], s58 offen sc1
  s_add_u32 s91, s58, 32768
  buffer_store_dwordx4 v[172:175], v239, s[16:19], s91 offen sc1
  v_bfe_u32 v221, v0, 2, 2
  v_lshrrev_b32 v220, 1, v221
  v_and_b32 v229, 1, v251
  v_lshl_or_b32 v220, v229, 1, v220
  v_xor_b32 v220, 0, v220
  v_lshlrev_b32 v220, 5, v220
  v_lshl_add_u32 v220, v221, 7, v220
  v_lshl_add_u32 v220, v251, 12, v220
  v_and_b32 v221, 3, v0
  v_lshl_add_u32 v229, v221, 3, v220
  v_add_u32 v225, 65536, v229
  v_xor_b32 v228, 32, v229
  v_add_u32 v224, 65536, v228
  v_xor_b32 v227, 64, v229
  v_add_u32 v223, 65536, v227
  v_xor_b32 v226, 96, v229
  v_add_u32 v222, 65536, v226
  s_waitcnt vmcnt(2)
  s_barrier
  s_add_u32 s91, s86, s85
  s_add_u32 s91, s91, 357376
  s_cmp_eq_u32 s95, 0
  s_cselect_b32 s91, s91, 0x80000000
  v_mov_b32 v254, s84
  v_lshlrev_b32 v255, 2, v0
  s_mov_b32 exec_hi, 0
  buffer_store_dword v254, v255, s[16:19], s91 offen sc1
  s_mov_b32 exec_hi, -1
  v_accvgpr_read_b32 v220, a0
  s_add_u32 s97, s60, 0
  s_add_u32 s96, s60, 4096
  s_add_u32 s77, s60, 8192
  s_add_u32 s76, s60, 12288
  v_mov_b32 v20, 0x3f803f80
  v_mov_b32 v21, 0x3f803f80
  v_mov_b32 v22, 0x3f803f80
  v_mov_b32 v23, 0x3f803f80
  s_add_u32 m0, s67, s75
  s_add_u32 m0, m0, 65536
  s_mul_i32 s64, s67, 8
  buffer_load_dwordx4 v246, s[24:27], s64 offen lds
  s_lshl_b32 s91, s95, 5
  v_xor_b32 v217, s91, v225
  v_lshlrev_b32 v218, 4, v251
  s_add_u32 s87, s64, 31744
  buffer_load_dwordx4 v246, s[24:27], s87 offen offset:1024 lds
  v_add_u32 v218, 147456, v218
  s_lshl_b32 s91, s95, 6
  v_add_u32 v230, s91, v218
  s_add_u32 s87, s64, 63488
  buffer_load_dwordx4 v246, s[24:27], s87 offen offset:2048 lds
  v_add_u32 v250, s69, v217
  ds_read_b64_tr_b16 a[176:177], v250 offset:0
  ds_read_b64_tr_b16 a[178:179], v250 offset:512
  ds_read_b64_tr_b16 a[180:181], v250 offset:1024
  s_add_u32 s87, s64, 95232
  buffer_load_dwordx4 v246, s[24:27], s87 offen offset:3072 lds
  ds_read_b64_tr_b16 a[182:183], v250 offset:1536
  ds_read_b64_tr_b16 a[184:185], v250 offset:2048
  ds_read_b64_tr_b16 a[186:187], v250 offset:2560
  ds_read_b64_tr_b16 a[188:189], v250 offset:3072
  s_add_u32 m0, s66, s75
  s_add_u32 m0, m0, 65536
  s_mul_i32 s64, s66, 8
  buffer_load_dwordx4 v246, s[24:27], s64 offen lds
  ds_read_b64_tr_b16 a[190:191], v250 offset:3584
  v_add_u32 v250, s68, v217
  ds_read_b64_tr_b16 a[192:193], v250 offset:0
  ds_read_b64_tr_b16 a[194:195], v250 offset:512
  s_add_u32 s87, s64, 31744
  buffer_load_dwordx4 v246, s[24:27], s87 offen offset:1024 lds
  ds_read_b64_tr_b16 a[196:197], v250 offset:1024
  ds_read_b64_tr_b16 a[198:199], v250 offset:1536
  ds_read_b64_tr_b16 a[200:201], v250 offset:2048
  s_add_u32 s87, s64, 63488
  buffer_load_dwordx4 v246, s[24:27], s87 offen offset:2048 lds
  ds_read_b64_tr_b16 a[202:203], v250 offset:2560
  ds_read_b64_tr_b16 a[204:205], v250 offset:3072
  ds_read_b64_tr_b16 a[206:207], v250 offset:3584
  s_add_u32 s87, s64, 95232
  buffer_load_dwordx4 v246, s[24:27], s87 offen offset:3072 lds
  ds_read_b64_tr_b16 a[8:9], v229 offset:0
  ds_read_b64_tr_b16 a[10:11], v229 offset:512
  ds_read_b64_tr_b16 a[12:13], v228 offset:0
  ds_read_b64_tr_b16 a[14:15], v228 offset:512
  ds_read_b64_tr_b16 a[16:17], v227 offset:0
  ds_read_b64_tr_b16 a[18:19], v227 offset:512
  ds_read_b64_tr_b16 a[20:21], v226 offset:0
  ds_read_b64_tr_b16 a[22:23], v226 offset:512
  ds_read_b64_tr_b16 a[24:25], v229 offset:1024
  ds_read_b64_tr_b16 a[26:27], v229 offset:1536
  ds_read_b64_tr_b16 a[28:29], v228 offset:1024
  ds_read_b64_tr_b16 a[30:31], v228 offset:1536
  ds_read_b64_tr_b16 a[32:33], v227 offset:1024
  ds_read_b64_tr_b16 a[34:35], v227 offset:1536
  ds_read_b64_tr_b16 a[36:37], v226 offset:1024
  ds_read_b64_tr_b16 a[38:39], v226 offset:1536
  ds_read_b64_tr_b16 a[40:41], v229 offset:2048
  s_waitcnt lgkmcnt(14)
  v_mfma_f32_16x16x32_bf16 v[116:119], a[176:179], v[20:23], 0
  ds_read_b64_tr_b16 a[42:43], v229 offset:2560
  ds_read_b64_tr_b16 a[44:45], v228 offset:2048
  ds_read_b64_tr_b16 a[46:47], v228 offset:2560
  buffer_load_dwordx4 v[28:31], v253, s[16:19], s97 offen offset:0 sc1
  ds_read_b64_tr_b16 a[56:57], v227 offset:2048
  ds_read_b64_tr_b16 a[58:59], v227 offset:2560
  ds_read_b64_tr_b16 a[60:61], v226 offset:2048
  ds_read_b64_tr_b16 a[62:63], v226 offset:2560
  ds_read_b64_tr_b16 a[64:65], v229 offset:3072
  ds_read_b64_tr_b16 a[66:67], v229 offset:3584
  buffer_load_dwordx4 v[32:35], v253, s[16:19], s97 offen offset:1024 sc1
  v_mfma_f32_16x16x32_bf16 v[116:119], a[180:183], v[20:23], v[116:119]
  ds_read_b64_tr_b16 a[68:69], v228 offset:3072
  ds_read_b64_tr_b16 a[70:71], v228 offset:3584
  ds_read_b64_tr_b16 a[72:73], v227 offset:3072
  ds_read_b64_tr_b16 a[74:75], v227 offset:3584
  ds_read_b64_tr_b16 a[76:77], v226 offset:3072
  buffer_load_dwordx4 v[36:39], v253, s[16:19], s97 offen offset:2048 sc1
  ds_read_b64_tr_b16 a[78:79], v226 offset:3584
  ds_read_b64_tr_b16 a[80:81], v229 offset:16384
  ds_read_b64_tr_b16 a[82:83], v229 offset:16896
  ds_read_b64_tr_b16 a[84:85], v228 offset:16384
  v_mfma_f32_16x16x32_bf16 v[116:119], a[184:187], v[20:23], v[116:119]
  ds_read_b64_tr_b16 a[86:87], v228 offset:16896
  buffer_load_dwordx4 v[40:43], v253, s[16:19], s97 offen offset:3072 sc1
  ds_read_b64_tr_b16 a[88:89], v227 offset:16384
  ds_read_b64_tr_b16 a[90:91], v227 offset:16896
  ds_read_b64_tr_b16 a[92:93], v226 offset:16384
  ds_read_b64_tr_b16 a[94:95], v226 offset:16896
  ds_read_b64_tr_b16 a[96:97], v229 offset:17408
  ds_read_b64_tr_b16 a[98:99], v229 offset:17920
  buffer_load_dwordx4 v[44:47], v253, s[16:19], s96 offen offset:0 sc1
  ds_read_b64_tr_b16 a[100:101], v228 offset:17408
  ds_read_b64_tr_b16 a[102:103], v228 offset:17920
  v_mfma_f32_16x16x32_bf16 v[116:119], a[188:191], v[20:23], v[116:119]
  ds_read_b64_tr_b16 a[104:105], v227 offset:17408
  ds_read_b64_tr_b16 a[106:107], v227 offset:17920
  ds_read_b64_tr_b16 a[108:109], v226 offset:17408
  buffer_load_dwordx4 v[48:51], v253, s[16:19], s96 offen offset:1024 sc1
  ds_read_b64_tr_b16 a[110:111], v226 offset:17920
  ds_read_b64_tr_b16 a[112:113], v229 offset:18432
  ds_read_b64_tr_b16 a[114:115], v229 offset:18944
  ds_read_b64_tr_b16 a[116:117], v228 offset:18432
  ds_read_b64_tr_b16 a[118:119], v228 offset:18944
  ds_read_b64_tr_b16 a[120:121], v227 offset:18432
  buffer_load_dwordx4 v[52:55], v253, s[16:19], s96 offen offset:2048 sc1
  v_mfma_f32_16x16x32_bf16 v[116:119], a[192:195], v[20:23], v[116:119]
  ds_read_b64_tr_b16 a[122:123], v227 offset:18944
  ds_read_b64_tr_b16 a[124:125], v226 offset:18432
  ds_read_b64_tr_b16 a[126:127], v226 offset:18944
  ds_read_b64_tr_b16 a[128:129], v229 offset:19456
  ds_read_b64_tr_b16 a[130:131], v229 offset:19968
  buffer_load_dwordx4 v[56:59], v253, s[16:19], s96 offen offset:3072 sc1
  ds_read_b64_tr_b16 a[132:133], v228 offset:19456
  ds_read_b64_tr_b16 a[134:135], v228 offset:19968
  ds_read_b64_tr_b16 a[136:137], v227 offset:19456
  ds_read_b64_tr_b16 a[138:139], v227 offset:19968
  v_mfma_f32_16x16x32_bf16 v[116:119], a[196:199], v[20:23], v[116:119]
  ds_read_b64_tr_b16 a[140:141], v226 offset:19456
  buffer_load_dwordx4 v[60:63], v253, s[16:19], s77 offen offset:0 sc1
  ds_read_b64_tr_b16 a[142:143], v226 offset:19968
  ds_read_b64_tr_b16 a[144:145], v229 offset:32768
  ds_read_b64_tr_b16 a[146:147], v229 offset:33280
  ds_read_b64_tr_b16 a[148:149], v228 offset:32768
  ds_read_b64_tr_b16 a[150:151], v228 offset:33280
  ds_read_b64_tr_b16 a[152:153], v227 offset:32768
  ds_read_b64_tr_b16 a[154:155], v227 offset:33280
  ds_read_b64_tr_b16 a[156:157], v226 offset:32768
  v_mfma_f32_16x16x32_bf16 v[116:119], a[200:203], v[20:23], v[116:119]
  ds_read_b64_tr_b16 a[158:159], v226 offset:33280
  ds_read_b64_tr_b16 a[160:161], v229 offset:33792
  ds_read_b64_tr_b16 a[162:163], v229 offset:34304
  ds_read_b64_tr_b16 a[164:165], v228 offset:33792
  ds_read_b64_tr_b16 a[166:167], v228 offset:34304
  ds_read_b64_tr_b16 a[168:169], v227 offset:33792
  ds_read_b64_tr_b16 a[170:171], v227 offset:34304
  ds_read_b64_tr_b16 a[172:173], v226 offset:33792
  ds_read_b64_tr_b16 a[174:175], v226 offset:34304
  v_mfma_f32_16x16x32_bf16 v[116:119], a[204:207], v[20:23], v[116:119]
  v_accvgpr_read_b32 v92, a48
  v_accvgpr_read_b32 v93, a49
  v_accvgpr_read_b32 v94, a50
  v_accvgpr_read_b32 v95, a51
  v_accvgpr_read_b32 v96, a52
  v_accvgpr_read_b32 v97, a53
  v_accvgpr_read_b32 v98, a54
  v_accvgpr_read_b32 v99, a55
  v_accvgpr_read_b32 v219, a1
  v_permlane16_swap_b32 v92, v94
  v_permlane16_swap_b32 v96, v98
  v_permlane16_swap_b32 v93, v95
  v_permlane16_swap_b32 v97, v99
  v_permlane32_swap_b32 v92, v96
  v_permlane32_swap_b32 v94, v98
  v_permlane32_swap_b32 v93, v97
  v_permlane32_swap_b32 v95, v99
  v_lshlrev_b32 v100, 16, v92
  v_and_b32 v101, 0xffff0000, v92
  v_lshlrev_b32 v102, 16, v93
  v_and_b32 v103, 0xffff0000, v93
  v_lshlrev_b32 v104, 16, v94
  v_and_b32 v105, 0xffff0000, v94
  v_lshlrev_b32 v106, 16, v95
  v_and_b32 v107, 0xffff0000, v95
  v_lshlrev_b32 v108, 16, v96
  v_and_b32 v109, 0xffff0000, v96
  v_lshlrev_b32 v110, 16, v97
  v_and_b32 v111, 0xffff0000, v97
  v_lshlrev_b32 v112, 16, v98
  v_and_b32 v113, 0xffff0000, v98
  v_lshlrev_b32 v114, 16, v99
  v_and_b32 v115, 0xffff0000, v99
  s_add_u32 s74, s60, s57
  s_add_u32 s74, s74, 262144
  v_accvgpr_read_b32 v216, a2
  v_accvgpr_read_b32 v215, a3
  v_lshlrev_b32 v214, 8, v251
  v_lshl_add_u32 v214, v252, 3, v214
  s_add_u32 s70, s59, 327680
  s_add_u32 s73, s86, s57
  s_add_u32 s73, s73, 0
  s_waitcnt vmcnt(7)
  v_bitop3_b32 v254, v28, v32, 1 bitop3:0xa8
  v_cmp_ne_u32 vcc, 0, v254
  s_cbranch_vccnz L_retry_167
L_ret_168:
  v_mfma_f32_16x16x32_bf16 v[4:7], a[8:11], v[28:31], 0
  s_waitcnt lgkmcnt(12)
  ds_read_b64_tr_b16 a[8:9], v229 offset:34816
  ds_read_b64_tr_b16 a[10:11], v229 offset:35328
  buffer_load_dwordx4 v[64:67], v253, s[16:19], s77 offen offset:1024 sc1
  v_mfma_f32_16x16x32_bf16 v[8:11], a[12:15], v[28:31], 0
  ds_read_b64_tr_b16 a[12:13], v228 offset:34816
  ds_read_b64_tr_b16 a[14:15], v228 offset:35328
  v_mfma_f32_16x16x32_bf16 v[12:15], a[16:19], v[28:31], 0
  ds_read_b64_tr_b16 a[16:17], v227 offset:34816
  ds_read_b64_tr_b16 a[18:19], v227 offset:35328
  v_mfma_f32_16x16x32_bf16 v[16:19], a[20:23], v[28:31], 0
  ds_read_b64_tr_b16 a[20:21], v226 offset:34816
  ds_read_b64_tr_b16 a[22:23], v226 offset:35328
  v_mfma_f32_16x16x32_bf16 v[4:7], a[24:27], v[32:35], v[4:7]
  ds_read_b64_tr_b16 a[24:25], v229 offset:35840
  ds_read_b64_tr_b16 a[26:27], v229 offset:36352
  buffer_load_dwordx4 v[68:71], v253, s[16:19], s77 offen offset:2048 sc1
  s_waitcnt vmcnt(7)
  v_bitop3_b32 v254, v36, v40, 1 bitop3:0xa8
  v_mfma_f32_16x16x32_bf16 v[8:11], a[28:31], v[32:35], v[8:11]
  ds_read_b64_tr_b16 a[28:29], v228 offset:35840
  ds_read_b64_tr_b16 a[30:31], v228 offset:36352
  v_cmp_ne_u32 vcc, 0, v254
  v_mfma_f32_16x16x32_bf16 v[12:15], a[32:35], v[32:35], v[12:15]
  ds_read_b64_tr_b16 a[32:33], v227 offset:35840
  ds_read_b64_tr_b16 a[34:35], v227 offset:36352
  v_mfma_f32_16x16x32_bf16 v[16:19], a[36:39], v[32:35], v[16:19]
  ds_read_b64_tr_b16 a[36:37], v226 offset:35840
  ds_read_b64_tr_b16 a[38:39], v226 offset:36352
  s_cbranch_vccnz L_retry_170
L_ret_171:
  v_mfma_f32_16x16x32_bf16 v[4:7], a[40:43], v[36:39], v[4:7]
  ds_read_b64_tr_b16 a[40:41], v229 offset:49152
  ds_read_b64_tr_b16 a[42:43], v229 offset:49664
  buffer_load_dwordx4 v[72:75], v253, s[16:19], s77 offen offset:3072 sc1
  v_mfma_f32_16x16x32_bf16 v[8:11], a[44:47], v[36:39], v[8:11]
  ds_read_b64_tr_b16 a[44:45], v228 offset:49152
  ds_read_b64_tr_b16 a[46:47], v228 offset:49664
  v_mfma_f32_16x16x32_bf16 v[12:15], a[56:59], v[36:39], v[12:15]
  ds_read_b64_tr_b16 a[56:57], v227 offset:49152
  ds_read_b64_tr_b16 a[58:59], v227 offset:49664
  v_mfma_f32_16x16x32_bf16 v[16:19], a[60:63], v[36:39], v[16:19]
  ds_read_b64_tr_b16 a[60:61], v226 offset:49152
  ds_read_b64_tr_b16 a[62:63], v226 offset:49664
  v_mfma_f32_16x16x32_bf16 v[4:7], a[64:67], v[40:43], v[4:7]
  ds_read_b64_tr_b16 a[64:65], v229 offset:50176
  ds_read_b64_tr_b16 a[66:67], v229 offset:50688
  buffer_load_dwordx4 v[76:79], v253, s[16:19], s76 offen offset:0 sc1
  s_waitcnt vmcnt(7)
  v_bitop3_b32 v254, v44, v48, 1 bitop3:0xa8
  v_mfma_f32_16x16x32_bf16 v[8:11], a[68:71], v[40:43], v[8:11]
  ds_read_b64_tr_b16 a[68:69], v228 offset:50176
  ds_read_b64_tr_b16 a[70:71], v228 offset:50688
  v_cmp_ne_u32 vcc, 0, v254
  v_mfma_f32_16x16x32_bf16 v[12:15], a[72:75], v[40:43], v[12:15]
  ds_read_b64_tr_b16 a[72:73], v227 offset:50176
  ds_read_b64_tr_b16 a[74:75], v227 offset:50688
  v_mfma_f32_16x16x32_bf16 v[16:19], a[76:79], v[40:43], v[16:19]
  ds_read_b64_tr_b16 a[76:77], v226 offset:50176
  ds_read_b64_tr_b16 a[78:79], v226 offset:50688
  s_cbranch_vccnz L_retry_173
L_ret_174:
  v_mfma_f32_16x16x32_bf16 v[4:7], a[80:83], v[44:47], v[4:7]
  ds_read_b64_tr_b16 a[80:81], v229 offset:51200
  ds_read_b64_tr_b16 a[82:83], v229 offset:51712
  buffer_load_dwordx4 v[80:83], v253, s[16:19], s76 offen offset:1024 sc1
  v_mfma_f32_16x16x32_bf16 v[8:11], a[84:87], v[44:47], v[8:11]
  ds_read_b64_tr_b16 a[84:85], v228 offset:51200
  ds_read_b64_tr_b16 a[86:87], v228 offset:51712
  v_mfma_f32_16x16x32_bf16 v[12:15], a[88:91], v[44:47], v[12:15]
  ds_read_b64_tr_b16 a[88:89], v227 offset:51200
  ds_read_b64_tr_b16 a[90:91], v227 offset:51712
  v_mfma_f32_16x16x32_bf16 v[16:19], a[92:95], v[44:47], v[16:19]
  ds_read_b64_tr_b16 a[92:93], v226 offset:51200
  ds_read_b64_tr_b16 a[94:95], v226 offset:51712
  v_mfma_f32_16x16x32_bf16 v[4:7], a[96:99], v[48:51], v[4:7]
  ds_read_b64_tr_b16 a[96:97], v229 offset:52224
  ds_read_b64_tr_b16 a[98:99], v229 offset:52736
  buffer_load_dwordx4 v[84:87], v253, s[16:19], s76 offen offset:2048 sc1
  s_waitcnt vmcnt(7)
  v_bitop3_b32 v254, v52, v56, 1 bitop3:0xa8
  v_mfma_f32_16x16x32_bf16 v[8:11], a[100:103], v[48:51], v[8:11]
  ds_read_b64_tr_b16 a[100:101], v228 offset:52224
  ds_read_b64_tr_b16 a[102:103], v228 offset:52736
  v_cmp_ne_u32 vcc, 0, v254
  v_mfma_f32_16x16x32_bf16 v[12:15], a[104:107], v[48:51], v[12:15]
  ds_read_b64_tr_b16 a[104:105], v227 offset:52224
  ds_read_b64_tr_b16 a[106:107], v227 offset:52736
  v_mfma_f32_16x16x32_bf16 v[16:19], a[108:111], v[48:51], v[16:19]
  ds_read_b64_tr_b16 a[108:109], v226 offset:52224
  ds_read_b64_tr_b16 a[110:111], v226 offset:52736
  s_cbranch_vccnz L_retry_176
L_ret_177:
  v_mfma_f32_16x16x32_bf16 v[4:7], a[112:115], v[52:55], v[4:7]
  buffer_load_dwordx4 v[88:91], v253, s[16:19], s76 offen offset:3072 sc1
  v_mfma_f32_16x16x32_bf16 v[8:11], a[116:119], v[52:55], v[8:11]
  v_mfma_f32_16x16x32_bf16 v[12:15], a[120:123], v[52:55], v[12:15]
  v_mfma_f32_16x16x32_bf16 v[16:19], a[124:127], v[52:55], v[16:19]
  v_mfma_f32_16x16x32_bf16 v[4:7], a[128:131], v[56:59], v[4:7]
  s_waitcnt lgkmcnt(0)
  s_barrier
  buffer_load_dword v221, v220, s[16:19], 0 offen offset:1024 sc1
  s_mul_i32 s72, s71, 4096
  s_mov_b64 exec, 0xf
  buffer_load_dword a5, v243, s[28:31], s72 offen
  s_mov_b64 exec, -1
  s_waitcnt vmcnt(8)
  v_bitop3_b32 v254, v60, v64, 1 bitop3:0xa8
  v_mfma_f32_16x16x32_bf16 v[8:11], a[132:135], v[56:59], v[8:11]
  v_cmp_ne_u32 vcc, 0, v254
  v_mfma_f32_16x16x32_bf16 v[12:15], a[136:139], v[56:59], v[12:15]
  s_add_u32 m0, s69, s75
  s_mul_i32 s64, s69, 8
  buffer_load_dwordx4 v246, s[28:31], s64 offen lds
  v_mfma_f32_16x16x32_bf16 v[16:19], a[140:143], v[56:59], v[16:19]
  s_cbranch_vccnz L_retry_179
L_ret_180:
  v_mfma_f32_16x16x32_bf16 v[4:7], a[144:147], v[60:63], v[4:7]
  v_mfma_f32_16x16x32_bf16 v[8:11], a[148:151], v[60:63], v[8:11]
  v_mfma_f32_16x16x32_bf16 v[12:15], a[152:155], v[60:63], v[12:15]
  s_add_u32 s87, s64, 31744
  buffer_load_dwordx4 v246, s[28:31], s87 offen offset:1024 lds
  v_mfma_f32_16x16x32_bf16 v[16:19], a[156:159], v[60:63], v[16:19]
  v_mfma_f32_16x16x32_bf16 v[4:7], a[160:163], v[64:67], v[4:7]
  s_waitcnt vmcnt(8)
  v_bitop3_b32 v254, v68, v72, 1 bitop3:0xa8
  v_mfma_f32_16x16x32_bf16 v[8:11], a[164:167], v[64:67], v[8:11]
  v_cmp_ne_u32 vcc, 0, v254
  v_mfma_f32_16x16x32_bf16 v[12:15], a[168:171], v[64:67], v[12:15]
  s_add_u32 s87, s64, 63488
  buffer_load_dwordx4 v246, s[28:31], s87 offen offset:2048 lds
  v_mfma_f32_16x16x32_bf16 v[16:19], a[172:175], v[64:67], v[16:19]
  s_cbranch_vccnz L_retry_182
L_ret_183:
  v_mfma_f32_16x16x32_bf16 v[4:7], a[8:11], v[68:71], v[4:7]
  v_mfma_f32_16x16x32_bf16 v[8:11], a[12:15], v[68:71], v[8:11]
  v_mfma_f32_16x16x32_bf16 v[12:15], a[16:19], v[68:71], v[12:15]
  s_add_u32 s87, s64, 95232
  buffer_load_dwordx4 v246, s[28:31], s87 offen offset:3072 lds
  v_mfma_f32_16x16x32_bf16 v[16:19], a[20:23], v[68:71], v[16:19]
  v_mfma_f32_16x16x32_bf16 v[4:7], a[24:27], v[72:75], v[4:7]
  s_waitcnt vmcnt(8)
  v_bitop3_b32 v254, v76, v80, 1 bitop3:0xa8
  v_mfma_f32_16x16x32_bf16 v[8:11], a[28:31], v[72:75], v[8:11]
  v_cmp_ne_u32 vcc, 0, v254
  v_mfma_f32_16x16x32_bf16 v[12:15], a[32:35], v[72:75], v[12:15]
  s_add_u32 m0, s68, s75
  s_mul_i32 s64, s68, 8
  buffer_load_dwordx4 v246, s[28:31], s64 offen lds
  v_mfma_f32_16x16x32_bf16 v[16:19], a[36:39], v[72:75], v[16:19]
  s_cbranch_vccnz L_retry_185
L_ret_186:
  v_mfma_f32_16x16x32_bf16 v[4:7], a[40:43], v[76:79], v[4:7]
  v_mfma_f32_16x16x32_bf16 v[8:11], a[44:47], v[76:79], v[8:11]
  v_mfma_f32_16x16x32_bf16 v[12:15], a[56:59], v[76:79], v[12:15]
  s_add_u32 s87, s64, 31744
  buffer_load_dwordx4 v246, s[28:31], s87 offen offset:1024 lds
  v_mfma_f32_16x16x32_bf16 v[16:19], a[60:63], v[76:79], v[16:19]
  v_mfma_f32_16x16x32_bf16 v[4:7], a[64:67], v[80:83], v[4:7]
  s_waitcnt vmcnt(8)
  v_bitop3_b32 v254, v84, v88, 1 bitop3:0xa8
  v_mfma_f32_16x16x32_bf16 v[8:11], a[68:71], v[80:83], v[8:11]
  v_cmp_ne_u32 vcc, 0, v254
  v_mfma_f32_16x16x32_bf16 v[12:15], a[72:75], v[80:83], v[12:15]
  s_add_u32 s87, s64, 63488
  buffer_load_dwordx4 v246, s[28:31], s87 offen offset:2048 lds
  v_mfma_f32_16x16x32_bf16 v[16:19], a[76:79], v[80:83], v[16:19]
  s_cbranch_vccnz L_retry_188
L_ret_189:
  v_mfma_f32_16x16x32_bf16 v[4:7], a[80:83], v[84:87], v[4:7]
  v_mfma_f32_16x16x32_bf16 v[8:11], a[84:87], v[84:87], v[8:11]
  v_mfma_f32_16x16x32_bf16 v[12:15], a[88:91], v[84:87], v[12:15]
  s_add_u32 s87, s64, 95232
  buffer_load_dwordx4 v246, s[28:31], s87 offen offset:3072 lds
  v_mfma_f32_16x16x32_bf16 v[16:19], a[92:95], v[84:87], v[16:19]
  v_mfma_f32_16x16x32_bf16 v[4:7], a[96:99], v[88:91], v[4:7]
  s_add_u32 m0, s67, s75
  s_mul_i32 s64, s67, 8
  buffer_load_dwordx4 v246, s[28:31], s64 offen lds
  v_mfma_f32_16x16x32_bf16 v[8:11], a[100:103], v[88:91], v[8:11]
  v_mfma_f32_16x16x32_bf16 v[12:15], a[104:107], v[88:91], v[12:15]
  v_mfma_f32_16x16x32_bf16 v[16:19], a[108:111], v[88:91], v[16:19]
  s_nop 1
  v_pk_add_f32 v[4:5], v[4:5], v[100:101]
  v_pk_add_f32 v[6:7], v[6:7], v[102:103]
  s_nop 1
  v_pk_add_f32 v[8:9], v[8:9], v[104:105]
  v_pk_add_f32 v[10:11], v[10:11], v[106:107]
  v_pk_add_f32 v[12:13], v[12:13], v[108:109]
  v_pk_add_f32 v[14:15], v[14:15], v[110:111]
  v_pk_add_f32 v[16:17], v[16:17], v[112:113]
  v_pk_add_f32 v[18:19], v[18:19], v[114:115]
  v_cvt_pk_bf16_f32 v168, v4, v5
  v_cvt_pk_bf16_f32 v169, v6, v7
  v_and_b32 v168, -2, v168
  v_cvt_pk_bf16_f32 v170, v8, v9
  v_cvt_pk_bf16_f32 v171, v10, v11
  buffer_store_dwordx4 v[168:171], v253, s[16:19], s74 offen offset:0 sc1
  v_cvt_pk_bf16_f32 v172, v12, v13
  v_cvt_pk_bf16_f32 v173, v14, v15
  v_and_b32 v172, -2, v172
  v_cvt_pk_bf16_f32 v174, v16, v17
  v_cvt_pk_bf16_f32 v175, v18, v19
  buffer_store_dwordx4 v[172:175], v253, s[16:19], s74 offen offset:1024 sc1
  v_pk_add_f32 v[210:211], v[4:5], v[6:7]
  v_pk_mul_f32 v[208:209], v[4:5], v[4:5]
  v_pk_fma_f32 v[208:209], v[6:7], v[6:7], v[208:209]
  v_pk_add_f32 v[210:211], v[210:211], v[8:9]
  v_pk_fma_f32 v[208:209], v[8:9], v[8:9], v[208:209]
  v_pk_add_f32 v[210:211], v[210:211], v[10:11]
  v_pk_fma_f32 v[208:209], v[10:11], v[10:11], v[208:209]
  v_pk_add_f32 v[210:211], v[210:211], v[12:13]
  v_pk_fma_f32 v[208:209], v[12:13], v[12:13], v[208:209]
  v_pk_add_f32 v[210:211], v[210:211], v[14:15]
  v_pk_fma_f32 v[208:209], v[14:15], v[14:15], v[208:209]
  v_pk_add_f32 v[210:211], v[210:211], v[16:17]
  v_pk_fma_f32 v[208:209], v[16:17], v[16:17], v[208:209]
  s_add_u32 s87, s64, 31744
  buffer_load_dwordx4 v246, s[28:31], s87 offen offset:1024 lds
  v_pk_add_f32 v[210:211], v[210:211], v[18:19]
  v_pk_fma_f32 v[208:209], v[18:19], v[18:19], v[208:209]
  v_add_f32 v210, v210, v211
  v_add_f32 v208, v208, v209
  s_add_u32 s90, s59, s85
  s_add_u32 s90, s90, 327680
  v_permlane32_swap_b32 v210, v208
  v_add_f32 v210, v210, v208
  v_mov_b32 v208, v210
  s_nop 1
  v_permlane16_swap_b32 v210, v208
  v_add_f32 v210, v210, v208
  buffer_store_dword v210, v219, s[16:19], s90 offen sc1
  s_add_u32 s87, s64, 63488
  buffer_load_dwordx4 v246, s[28:31], s87 offen offset:2048 lds
  s_add_u32 s97, s60, 262144
  s_add_u32 s96, s60, 266240
  s_add_u32 s77, s60, 270336
  s_add_u32 s76, s60, 274432
  s_lshl_b32 s65, s92, 8
  s_cmp_lt_u32 s92, 14
  s_cselect_b32 s65, s65, 0x80000000
  v_lshrrev_b32 v212, 3, v0
  v_and_b32 v211, 7, v0
  s_mov_b32 s90, s95
  v_bfe_u32 v209, v212, 1, 1
  v_lshlrev_b32 v209, 1, v209
  v_lshlrev_b32 v209, 1, v209
  v_xor_b32 v211, v211, v209
  s_add_u32 s87, s64, 95232
  buffer_load_dwordx4 v246, s[28:31], s87 offen offset:3072 lds
  v_lshlrev_b32 v211, 4, v211
  v_and_b32 v210, 3, v212
  v_lshrrev_b32 v209, 2, v212
  v_lshl_add_u32 v210, v209, 4, v210
  s_lshl_b32 s91, s90, 2
  v_add_u32 v210, s91, v210
  s_mov_b32 s91, 3584
  v_mad_u32_u24 v213, v210, s91, v211
  s_add_u32 m0, s66, s75
  s_mul_i32 s64, s66, 8
  buffer_load_dwordx4 v246, s[28:31], s64 offen lds
  ds_read_b64_tr_b16 a[8:9], v225 offset:0
  ds_read_b64_tr_b16 a[10:11], v225 offset:512
  ds_read_b64_tr_b16 a[12:13], v224 offset:0
  ds_read_b64_tr_b16 a[14:15], v224 offset:512
  ds_read_b64_tr_b16 a[16:17], v223 offset:0
  ds_read_b64_tr_b16 a[18:19], v223 offset:512
  ds_read_b64_tr_b16 a[20:21], v222 offset:0
  ds_read_b64_tr_b16 a[22:23], v222 offset:512
  s_add_u32 s87, s64, 31744
  buffer_load_dwordx4 v246, s[28:31], s87 offen offset:1024 lds
  ds_read_b64_tr_b16 a[24:25], v225 offset:1024
  ds_read_b64_tr_b16 a[26:27], v225 offset:1536
  ds_read_b64_tr_b16 a[28:29], v224 offset:1024
  ds_read_b64_tr_b16 a[30:31], v224 offset:1536
  ds_read_b64_tr_b16 a[32:33], v223 offset:1024
  ds_read_b64_tr_b16 a[34:35], v223 offset:1536
  ds_read_b64_tr_b16 a[36:37], v222 offset:1024
  ds_read_b64_tr_b16 a[38:39], v222 offset:1536
  s_add_u32 s87, s64, 63488
  buffer_load_dwordx4 v246, s[28:31], s87 offen offset:2048 lds
  ds_read_b64_tr_b16 a[40:41], v225 offset:2048
  ds_read_b64_tr_b16 a[42:43], v225 offset:2560
  ds_read_b64_tr_b16 a[44:45], v224 offset:2048
  ds_read_b64_tr_b16 a[46:47], v224 offset:2560
  ds_read_b64_tr_b16 a[56:57], v223 offset:2048
  ds_read_b64_tr_b16 a[58:59], v223 offset:2560
  ds_read_b64_tr_b16 a[60:61], v222 offset:2048
  ds_read_b64_tr_b16 a[62:63], v222 offset:2560
  s_add_u32 s87, s64, 95232
  buffer_load_dwordx4 v246, s[28:31], s87 offen offset:3072 lds
  ds_read_b64_tr_b16 a[64:65], v225 offset:3072
  ds_read_b64_tr_b16 a[66:67], v225 offset:3584
  ds_read_b64_tr_b16 a[68:69], v224 offset:3072
  ds_read_b64_tr_b16 a[70:71], v224 offset:3584
  ds_read_b64_tr_b16 a[72:73], v223 offset:3072
  ds_read_b64_tr_b16 a[74:75], v223 offset:3584
  ds_read_b64_tr_b16 a[76:77], v222 offset:3072
  ds_read_b64_tr_b16 a[78:79], v222 offset:3584
  ds_read_b64_tr_b16 a[80:81], v225 offset:16384
  ds_read_b64_tr_b16 a[82:83], v225 offset:16896
  ds_read_b64_tr_b16 a[84:85], v224 offset:16384
  ds_read_b64_tr_b16 a[86:87], v224 offset:16896
  ds_read_b64_tr_b16 a[88:89], v223 offset:16384
  ds_read_b64_tr_b16 a[90:91], v223 offset:16896
  ds_read_b64_tr_b16 a[92:93], v222 offset:16384
  ds_read_b64_tr_b16 a[94:95], v222 offset:16896
  ds_read_b64_tr_b16 a[96:97], v225 offset:17408
  ds_read_b64_tr_b16 a[98:99], v225 offset:17920
  buffer_load_dwordx4 v[28:31], v253, s[16:19], s97 offen offset:0 sc1
  ds_read_b64_tr_b16 a[100:101], v224 offset:17408
  ds_read_b64_tr_b16 a[102:103], v224 offset:17920
  ds_read_b64_tr_b16 a[104:105], v223 offset:17408
  ds_read_b64_tr_b16 a[106:107], v223 offset:17920
  ds_read_b64_tr_b16 a[108:109], v222 offset:17408
  ds_read_b64_tr_b16 a[110:111], v222 offset:17920
  buffer_load_dwordx4 v[32:35], v253, s[16:19], s97 offen offset:1024 sc1
  v_add_u32 v213, s65, v213
  v_add_u32 v212, s67, v217
  ds_read_b64_tr_b16 a[48:49], v212 offset:0
  ds_read_b64_tr_b16 a[50:51], v212 offset:512
  ds_read_b64_tr_b16 a[52:53], v212 offset:1024
  ds_read_b64_tr_b16 a[54:55], v212 offset:1536
  ds_read_b64_tr_b16 a[176:177], v212 offset:2048
  ds_read_b64_tr_b16 a[178:179], v212 offset:2560
  buffer_load_dwordx4 v[36:39], v253, s[16:19], s97 offen offset:2048 sc1
  ds_read_b64_tr_b16 a[180:181], v212 offset:3072
  ds_read_b64_tr_b16 a[182:183], v212 offset:3584
  v_add_u32 v212, s66, v217
  ds_read_b64_tr_b16 a[184:185], v212 offset:0
  ds_read_b64_tr_b16 a[186:187], v212 offset:512
  ds_read_b64_tr_b16 a[188:189], v212 offset:1024
  ds_read_b64_tr_b16 a[190:191], v212 offset:1536
  buffer_load_dwordx4 v[40:43], v253, s[16:19], s97 offen offset:3072 sc1
  ds_read_b64_tr_b16 a[192:193], v212 offset:2048
  ds_read_b64_tr_b16 a[194:195], v212 offset:2560
  ds_read_b64_tr_b16 a[196:197], v212 offset:3072
  ds_read_b64_tr_b16 a[198:199], v212 offset:3584
  ds_read_b64_tr_b16 a[112:113], v225 offset:18432
  ds_read_b64_tr_b16 a[114:115], v225 offset:18944
  buffer_load_dwordx4 v[44:47], v253, s[16:19], s96 offen offset:0 sc1
  ds_read_b64_tr_b16 a[116:117], v224 offset:18432
  ds_read_b64_tr_b16 a[118:119], v224 offset:18944
  s_waitcnt lgkmcnt(14)
  v_mfma_f32_16x16x32_bf16 v[116:119], a[48:51], v[20:23], v[116:119]
  ds_read_b64_tr_b16 a[120:121], v223 offset:18432
  ds_read_b64_tr_b16 a[122:123], v223 offset:18944
  ds_read_b64_tr_b16 a[124:125], v222 offset:18432
  buffer_load_dwordx4 v[48:51], v253, s[16:19], s96 offen offset:1024 sc1
  ds_read_b64_tr_b16 a[126:127], v222 offset:18944
  v_mfma_f32_16x16x32_bf16 v[116:119], a[52:55], v[20:23], v[116:119]
  ds_read_b64_tr_b16 a[128:129], v225 offset:19456
  ds_read_b64_tr_b16 a[130:131], v225 offset:19968
  ds_read_b64_tr_b16 a[132:133], v224 offset:19456
  v_mfma_f32_16x16x32_bf16 v[116:119], a[176:179], v[20:23], v[116:119]
  s_waitcnt lgkmcnt(10)
  buffer_load_dwordx4 v[52:55], v253, s[16:19], s96 offen offset:2048 sc1
  ds_read_b64_tr_b16 a[134:135], v224 offset:19968
  ds_read_b64_tr_b16 a[136:137], v223 offset:19456
  ds_read_b64_tr_b16 a[138:139], v223 offset:19968
  ds_read_b64_tr_b16 a[140:141], v222 offset:19456
  v_mfma_f32_16x16x32_bf16 v[116:119], a[180:183], v[20:23], v[116:119]
  ds_read_b64_tr_b16 a[142:143], v222 offset:19968
  buffer_load_dwordx4 v[56:59], v253, s[16:19], s96 offen offset:3072 sc1
  ds_read_b64_tr_b16 a[144:145], v225 offset:32768
  ds_read_b64_tr_b16 a[146:147], v225 offset:33280
  v_mfma_f32_16x16x32_bf16 v[116:119], a[184:187], v[20:23], v[116:119]
  ds_read_b64_tr_b16 a[148:149], v224 offset:32768
  ds_read_b64_tr_b16 a[150:151], v224 offset:33280
  ds_read_b64_tr_b16 a[152:153], v223 offset:32768
  buffer_load_dwordx4 v[60:63], v253, s[16:19], s77 offen offset:0 sc1
  ds_read_b64_tr_b16 a[154:155], v223 offset:33280
  v_mfma_f32_16x16x32_bf16 v[116:119], a[188:191], v[20:23], v[116:119]
  ds_read_b64_tr_b16 a[156:157], v222 offset:32768
  ds_read_b64_tr_b16 a[158:159], v222 offset:33280
  ds_read_b64_tr_b16 a[160:161], v225 offset:33792
  v_mfma_f32_16x16x32_bf16 v[116:119], a[192:195], v[20:23], v[116:119]
  ds_read_b64_tr_b16 a[162:163], v225 offset:34304
  ds_read_b64_tr_b16 a[164:165], v224 offset:33792
  ds_read_b64_tr_b16 a[166:167], v224 offset:34304
  ds_read_b64_tr_b16 a[168:169], v223 offset:33792
  v_mfma_f32_16x16x32_bf16 v[116:119], a[196:199], v[20:23], v[116:119]
  ds_read_b64_tr_b16 a[170:171], v223 offset:34304
  ds_read_b64_tr_b16 a[172:173], v222 offset:33792
  ds_read_b64_tr_b16 a[174:175], v222 offset:34304
  s_mov_b64 exec, s[80:81]
  s_nop 3
  ds_write_b128 v230, v[116:119] offset:0
  s_mov_b64 exec, -1
  s_waitcnt vmcnt(7)
  v_bitop3_b32 v254, v28, v32, 1 bitop3:0xa8
  v_cmp_ne_u32 vcc, 0, v254
  s_cbranch_vccnz L_retry_197
L_ret_198:
  v_mfma_f32_16x16x32_bf16 v[92:95], a[8:11], v[28:31], 0
  ds_read_b64_tr_b16 a[8:9], v225 offset:34816
  ds_read_b64_tr_b16 a[10:11], v225 offset:35328
  buffer_load_dwordx4 v[64:67], v253, s[16:19], s77 offen offset:1024 sc1
  v_mfma_f32_16x16x32_bf16 v[96:99], a[12:15], v[28:31], 0
  ds_read_b64_tr_b16 a[12:13], v224 offset:34816
  ds_read_b64_tr_b16 a[14:15], v224 offset:35328
  v_mfma_f32_16x16x32_bf16 v[100:103], a[16:19], v[28:31], 0
  ds_read_b64_tr_b16 a[16:17], v223 offset:34816
  ds_read_b64_tr_b16 a[18:19], v223 offset:35328
  v_mfma_f32_16x16x32_bf16 v[104:107], a[20:23], v[28:31], 0
  ds_read_b64_tr_b16 a[20:21], v222 offset:34816
  ds_read_b64_tr_b16 a[22:23], v222 offset:35328
  v_mfma_f32_16x16x32_bf16 v[92:95], a[24:27], v[32:35], v[92:95]
  ds_read_b64_tr_b16 a[24:25], v225 offset:35840
  ds_read_b64_tr_b16 a[26:27], v225 offset:36352
  buffer_load_dwordx4 v[68:71], v253, s[16:19], s77 offen offset:2048 sc1
  s_waitcnt vmcnt(7)
  v_bitop3_b32 v254, v36, v40, 1 bitop3:0xa8
  v_mfma_f32_16x16x32_bf16 v[96:99], a[28:31], v[32:35], v[96:99]
  ds_read_b64_tr_b16 a[28:29], v224 offset:35840
  ds_read_b64_tr_b16 a[30:31], v224 offset:36352
  v_cmp_ne_u32 vcc, 0, v254
  v_mfma_f32_16x16x32_bf16 v[100:103], a[32:35], v[32:35], v[100:103]
  ds_read_b64_tr_b16 a[32:33], v223 offset:35840
  ds_read_b64_tr_b16 a[34:35], v223 offset:36352
  v_mfma_f32_16x16x32_bf16 v[104:107], a[36:39], v[32:35], v[104:107]
  ds_read_b64_tr_b16 a[36:37], v222 offset:35840
  ds_read_b64_tr_b16 a[38:39], v222 offset:36352
  s_cbranch_vccnz L_retry_200
L_ret_201:
  v_mfma_f32_16x16x32_bf16 v[92:95], a[40:43], v[36:39], v[92:95]
  ds_read_b64_tr_b16 a[40:41], v225 offset:49152
  ds_read_b64_tr_b16 a[42:43], v225 offset:49664
  buffer_load_dwordx4 v[72:75], v253, s[16:19], s77 offen offset:3072 sc1
  v_mfma_f32_16x16x32_bf16 v[96:99], a[44:47], v[36:39], v[96:99]
  ds_read_b64_tr_b16 a[44:45], v224 offset:49152
  ds_read_b64_tr_b16 a[46:47], v224 offset:49664
  v_mfma_f32_16x16x32_bf16 v[100:103], a[56:59], v[36:39], v[100:103]
  ds_read_b64_tr_b16 a[56:57], v223 offset:49152
  ds_read_b64_tr_b16 a[58:59], v223 offset:49664
  v_mfma_f32_16x16x32_bf16 v[104:107], a[60:63], v[36:39], v[104:107]
  ds_read_b64_tr_b16 a[60:61], v222 offset:49152
  ds_read_b64_tr_b16 a[62:63], v222 offset:49664
  v_mfma_f32_16x16x32_bf16 v[92:95], a[64:67], v[40:43], v[92:95]
  ds_read_b64_tr_b16 a[64:65], v225 offset:50176
  ds_read_b64_tr_b16 a[66:67], v225 offset:50688
  buffer_load_dwordx4 v[76:79], v253, s[16:19], s76 offen offset:0 sc1
  s_waitcnt vmcnt(7)
  v_bitop3_b32 v254, v44, v48, 1 bitop3:0xa8
  v_mfma_f32_16x16x32_bf16 v[96:99], a[68:71], v[40:43], v[96:99]
  ds_read_b64_tr_b16 a[68:69], v224 offset:50176
  ds_read_b64_tr_b16 a[70:71], v224 offset:50688
  v_cmp_ne_u32 vcc, 0, v254
  v_mfma_f32_16x16x32_bf16 v[100:103], a[72:75], v[40:43], v[100:103]
  ds_read_b64_tr_b16 a[72:73], v223 offset:50176
  ds_read_b64_tr_b16 a[74:75], v223 offset:50688
  v_mfma_f32_16x16x32_bf16 v[104:107], a[76:79], v[40:43], v[104:107]
  ds_read_b64_tr_b16 a[76:77], v222 offset:50176
  ds_read_b64_tr_b16 a[78:79], v222 offset:50688
  s_cbranch_vccnz L_retry_203
L_ret_204:
  v_mfma_f32_16x16x32_bf16 v[92:95], a[80:83], v[44:47], v[92:95]
  ds_read_b64_tr_b16 a[80:81], v225 offset:51200
  ds_read_b64_tr_b16 a[82:83], v225 offset:51712
  buffer_load_dwordx4 v[80:83], v253, s[16:19], s76 offen offset:1024 sc1
  v_mfma_f32_16x16x32_bf16 v[96:99], a[84:87], v[44:47], v[96:99]
  ds_read_b64_tr_b16 a[84:85], v224 offset:51200
  ds_read_b64_tr_b16 a[86:87], v224 offset:51712
  v_mfma_f32_16x16x32_bf16 v[100:103], a[88:91], v[44:47], v[100:103]
  ds_read_b64_tr_b16 a[88:89], v223 offset:51200
  ds_read_b64_tr_b16 a[90:91], v223 offset:51712
  v_mfma_f32_16x16x32_bf16 v[104:107], a[92:95], v[44:47], v[104:107]
  ds_read_b64_tr_b16 a[92:93], v222 offset:51200
  ds_read_b64_tr_b16 a[94:95], v222 offset:51712
  v_mfma_f32_16x16x32_bf16 v[92:95], a[96:99], v[48:51], v[92:95]
  ds_read_b64_tr_b16 a[96:97], v225 offset:52224
  ds_read_b64_tr_b16 a[98:99], v225 offset:52736
  buffer_load_dwordx4 v[84:87], v253, s[16:19], s76 offen offset:2048 sc1
  s_waitcnt vmcnt(7)
  v_bitop3_b32 v254, v52, v56, 1 bitop3:0xa8
  v_mfma_f32_16x16x32_bf16 v[96:99], a[100:103], v[48:51], v[96:99]
  ds_read_b64_tr_b16 a[100:101], v224 offset:52224
  ds_read_b64_tr_b16 a[102:103], v224 offset:52736
  v_cmp_ne_u32 vcc, 0, v254
  v_mfma_f32_16x16x32_bf16 v[100:103], a[104:107], v[48:51], v[100:103]
  ds_read_b64_tr_b16 a[104:105], v223 offset:52224
  ds_read_b64_tr_b16 a[106:107], v223 offset:52736
  v_mfma_f32_16x16x32_bf16 v[104:107], a[108:111], v[48:51], v[104:107]
  ds_read_b64_tr_b16 a[108:109], v222 offset:52224
  ds_read_b64_tr_b16 a[110:111], v222 offset:52736
  s_cbranch_vccnz L_retry_206
L_ret_207:
  s_waitcnt lgkmcnt(14)
  v_mfma_f32_16x16x32_bf16 v[92:95], a[112:115], v[52:55], v[92:95]
  buffer_load_dwordx4 v[88:91], v253, s[16:19], s76 offen offset:3072 sc1
  v_lshlrev_b32 v198, 5, v251
  v_mfma_f32_16x16x32_bf16 v[96:99], a[116:119], v[52:55], v[96:99]
  v_mfma_f32_16x16x32_bf16 v[100:103], a[120:123], v[52:55], v[100:103]
  v_and_b32 v199, 1, v252
  v_mfma_f32_16x16x32_bf16 v[104:107], a[124:127], v[52:55], v[104:107]
  v_mfma_f32_16x16x32_bf16 v[92:95], a[128:131], v[56:59], v[92:95]
  s_waitcnt lgkmcnt(0)
  s_barrier
  buffer_load_dwordx2 v[108:109], v214, s[16:19], s70 offen sc1
  buffer_load_dwordx2 v[110:111], v214, s[16:19], s70 offen offset:128 sc1
  v_lshl_add_u32 v198, v199, 4, v198
  s_waitcnt vmcnt(8)
  v_bitop3_b32 v254, v60, v64, 1 bitop3:0xa8
  v_mfma_f32_16x16x32_bf16 v[96:99], a[132:135], v[56:59], v[96:99]
  v_cmp_ne_u32 vcc, 0, v254
  v_mfma_f32_16x16x32_bf16 v[100:103], a[136:139], v[56:59], v[100:103]
  s_lshl_b32 s91, s95, 14
  s_sub_u32 s91, 335872, s91
  v_add_u32 v199, s91, v198
  s_cmp_eq_u32 s95, 0
  s_cselect_b32 s58, 4096, 0
  s_cselect_b32 s91, 0, 15
  v_xor_b32 v198, s91, v252
  v_mfma_f32_16x16x32_bf16 v[104:107], a[140:143], v[56:59], v[104:107]
  s_cbranch_vccnz L_retry_209
L_ret_210:
  v_mfma_f32_16x16x32_bf16 v[92:95], a[144:147], v[60:63], v[92:95]
  s_add_u32 s91, s95, 1
  s_bitcmp0_b32 s91, 1
  s_cselect_b32 s91, 1, 0
  v_cmp_gt_u32 s[78:79], s91, v198
  v_mfma_f32_16x16x32_bf16 v[96:99], a[148:151], v[60:63], v[96:99]
  v_mfma_f32_16x16x32_bf16 v[100:103], a[152:155], v[60:63], v[100:103]
  v_cndmask_b32 v201, v253, v199, s[78:79]
  v_mfma_f32_16x16x32_bf16 v[104:107], a[156:159], v[60:63], v[104:107]
  v_mfma_f32_16x16x32_bf16 v[92:95], a[160:163], v[64:67], v[92:95]
  s_add_u32 s91, s95, 1
  s_bitcmp0_b32 s91, 1
  s_cselect_b32 s91, 2, 0
  v_cmp_gt_u32 s[78:79], s91, v198
  s_waitcnt vmcnt(6)
  v_bitop3_b32 v254, v68, v72, 1 bitop3:0xa8
  v_mfma_f32_16x16x32_bf16 v[96:99], a[164:167], v[64:67], v[96:99]
  v_cmp_ne_u32 vcc, 0, v254
  v_mfma_f32_16x16x32_bf16 v[100:103], a[168:171], v[64:67], v[100:103]
  v_mfma_f32_16x16x32_bf16 v[104:107], a[172:175], v[64:67], v[104:107]
  s_cbranch_vccnz L_retry_212
L_ret_213:
  v_mfma_f32_16x16x32_bf16 v[92:95], a[8:11], v[68:71], v[92:95]
  v_cndmask_b32 v200, v253, v199, s[78:79]
  v_mfma_f32_16x16x32_bf16 v[96:99], a[12:15], v[68:71], v[96:99]
  v_mfma_f32_16x16x32_bf16 v[100:103], a[16:19], v[68:71], v[100:103]
  s_add_u32 m0, s69, s75
  s_add_u32 m0, m0, 65536
  s_mul_i32 s64, s69, 28
  buffer_load_dwordx4 v213, s[32:35], s64 offen lds
  v_mfma_f32_16x16x32_bf16 v[104:107], a[20:23], v[68:71], v[104:107]
  v_mfma_f32_16x16x32_bf16 v[92:95], a[24:27], v[72:75], v[92:95]
  s_lshl_b32 s90, s58, 2
  v_subrev_u32 v225, s90, v229
  v_add_u32 v229, s90, v229
  v_subrev_u32 v224, s90, v228
  v_add_u32 v228, s90, v228
  v_subrev_u32 v223, s90, v227
  v_add_u32 v227, s90, v227
  v_subrev_u32 v222, s90, v226
  v_add_u32 v226, s90, v226
  s_waitcnt vmcnt(5)
  v_bitop3_b32 v254, v76, v80, 1 bitop3:0xa8
  v_mfma_f32_16x16x32_bf16 v[96:99], a[28:31], v[72:75], v[96:99]
  v_cmp_ne_u32 vcc, 0, v254
  v_mfma_f32_16x16x32_bf16 v[100:103], a[32:35], v[72:75], v[100:103]
  s_add_u32 s87, s64, 113664
  buffer_load_dwordx4 v213, s[32:35], s87 offen offset:1024 lds
  v_mfma_f32_16x16x32_bf16 v[104:107], a[36:39], v[72:75], v[104:107]
  s_cbranch_vccnz L_retry_215
L_ret_216:
  v_mfma_f32_16x16x32_bf16 v[92:95], a[40:43], v[76:79], v[92:95]
  ds_read_b128 v[120:123], v218 offset:0
  v_mfma_f32_16x16x32_bf16 v[96:99], a[44:47], v[76:79], v[96:99]
  v_mfma_f32_16x16x32_bf16 v[100:103], a[56:59], v[76:79], v[100:103]
  s_add_u32 s87, s64, 227328
  buffer_load_dwordx4 v213, s[32:35], s87 offen offset:2048 lds
  v_mfma_f32_16x16x32_bf16 v[104:107], a[60:63], v[76:79], v[104:107]
  v_mfma_f32_16x16x32_bf16 v[92:95], a[64:67], v[80:83], v[92:95]
  ds_read_b128 v[124:127], v218 offset:64
  s_waitcnt vmcnt(5)
  v_bitop3_b32 v254, v84, v88, 1 bitop3:0xa8
  v_mfma_f32_16x16x32_bf16 v[96:99], a[68:71], v[80:83], v[96:99]
  v_cmp_ne_u32 vcc, 0, v254
  v_mfma_f32_16x16x32_bf16 v[100:103], a[72:75], v[80:83], v[100:103]
  s_add_u32 s87, s64, 340992
  buffer_load_dwordx4 v213, s[32:35], s87 offen offset:3072 lds
  v_mfma_f32_16x16x32_bf16 v[104:107], a[76:79], v[80:83], v[104:107]
  s_cbranch_vccnz L_retry_218
L_ret_219:
  v_mfma_f32_16x16x32_bf16 v[92:95], a[80:83], v[84:87], v[92:95]
  ds_read_b128 v[128:131], v218 offset:128
  v_mfma_f32_16x16x32_bf16 v[96:99], a[84:87], v[84:87], v[96:99]
  v_mfma_f32_16x16x32_bf16 v[100:103], a[88:91], v[84:87], v[100:103]
  s_add_u32 m0, s68, s75
  s_add_u32 m0, m0, 65536
  s_mul_i32 s64, s68, 28
  buffer_load_dwordx4 v213, s[32:35], s64 offen lds
  v_mfma_f32_16x16x32_bf16 v[104:107], a[92:95], v[84:87], v[104:107]
  s_barrier
  v_mfma_f32_16x16x32_bf16 v[92:95], a[96:99], v[88:91], v[92:95]
  s_add_u32 s87, s64, 113664
  buffer_load_dwordx4 v213, s[32:35], s87 offen offset:1024 lds
  ds_read_b128 v[132:135], v218 offset:192
  v_mfma_f32_16x16x32_bf16 v[96:99], a[100:103], v[88:91], v[96:99]
  v_mfma_f32_16x16x32_bf16 v[100:103], a[104:107], v[88:91], v[100:103]
  v_mfma_f32_16x16x32_bf16 v[104:107], a[108:111], v[88:91], v[104:107]
  v_xor_b32 v254, s88, v221
  v_cmp_lt_u32 vcc, 31, v254
  s_cbranch_vccnz L_rdy_194
L_rret_195:
  s_waitcnt vmcnt(6)
  v_max3_u32 v254, v108, v109, v110
  v_max_u32 v254, v254, v111
  v_cmp_eq_u32 vcc, -1, v254
  s_cbranch_vccnz L_retry_191
L_ret_192:
  v_pk_add_f32 v[108:109], v[108:109], v[110:111]
  s_nop 1
  v_permlane32_swap_b32 v108, v109
  v_add_f32 v108, v108, v109
  v_mov_b32 v109, v108
  s_nop 1
  v_permlane16_swap_b32 v108, v109
  v_add_f32 v108, v108, v109
  v_mov_b32 v109, v108
  s_nop 1
  v_permlane32_swap_b32 v108, v109
  v_mul_f32 v210, 0xbb000000, v108
  v_mul_f32 v250, 0x3b000000, v109
  v_fma_f32 v250, -v210, v210, v250
  v_max_f32 v250, 0, v250
  v_add_f32 v249, 0x3727c5ac, v250
  v_rsq_f32 v208, v249
  v_mov_b32 v249, 0x3727c5ac
  v_mul_f32 v250, v250, v208
  v_fmac_f32 v249, v250, v208
  v_rsq_f32 v249, v249
  s_nop 0
  v_mul_f32 v249, v249, v208
  v_mul_f32 v206, 0xc0135761, v249
  v_mul_f32 v204, v249, v249
  v_rcp_f32 v202, v249
  v_mul_f32 v204, v204, v249
  v_mul_f32 v204, 0xbdd2d3e8, v204
  s_add_u32 s87, s64, 227328
  buffer_load_dwordx4 v213, s[32:35], s87 offen offset:2048 lds
  s_waitcnt lgkmcnt(3)
  v_pk_fma_f32 v[92:93], v[120:121], v[210:211], v[92:93] op_sel_hi:[1,0,1]
  v_pk_fma_f32 v[94:95], v[122:123], v[210:211], v[94:95] op_sel_hi:[1,0,1]
  s_waitcnt lgkmcnt(2)
  v_pk_fma_f32 v[96:97], v[124:125], v[210:211], v[96:97] op_sel_hi:[1,0,1]
  v_pk_fma_f32 v[98:99], v[126:127], v[210:211], v[98:99] op_sel_hi:[1,0,1]
  s_waitcnt lgkmcnt(1)
  v_pk_fma_f32 v[100:101], v[128:129], v[210:211], v[100:101] op_sel_hi:[1,0,1]
  v_pk_fma_f32 v[102:103], v[130:131], v[210:211], v[102:103] op_sel_hi:[1,0,1]
  s_waitcnt lgkmcnt(0)
  v_pk_fma_f32 v[104:105], v[132:133], v[210:211], v[104:105] op_sel_hi:[1,0,1]
  v_pk_fma_f32 v[106:107], v[134:135], v[210:211], v[106:107] op_sel_hi:[1,0,1]
  v_pk_mul_f32 v[108:109], v[92:93], v[92:93]
  v_pk_mul_f32 v[110:111], v[94:95], v[94:95]
  v_pk_fma_f32 v[108:109], v[108:109], v[204:205], v[206:207] op_sel_hi:[1,0,0]
  v_pk_fma_f32 v[110:111], v[110:111], v[204:205], v[206:207] op_sel_hi:[1,0,0]
  v_pk_mul_f32 v[108:109], v[108:109], v[92:93]
  v_pk_mul_f32 v[110:111], v[110:111], v[94:95]
  v_exp_f32 v108, v108
  v_exp_f32 v110, v110
  v_exp_f32 v109, v109
  v_exp_f32 v111, v111
  v_pk_fma_f32 v[108:109], v[108:109], v[202:203], v[202:203] op_sel_hi:[1,0,0]
  v_pk_fma_f32 v[110:111], v[110:111], v[202:203], v[202:203] op_sel_hi:[1,0,0]
  v_rcp_f32 v108, v108
  v_rcp_f32 v110, v110
  v_rcp_f32 v109, v109
  v_rcp_f32 v111, v111
  v_pk_mul_f32 v[108:109], v[108:109], v[92:93]
  v_pk_mul_f32 v[110:111], v[110:111], v[94:95]
  v_cvt_pk_bf16_f32 v168, v108, v109
  v_cvt_pk_bf16_f32 v169, v110, v111
  s_add_u32 s87, s64, 340992
  buffer_load_dwordx4 v213, s[32:35], s87 offen offset:3072 lds
  v_pk_mul_f32 v[108:109], v[96:97], v[96:97]
  v_pk_mul_f32 v[110:111], v[98:99], v[98:99]
  v_pk_fma_f32 v[108:109], v[108:109], v[204:205], v[206:207] op_sel_hi:[1,0,0]
  v_pk_fma_f32 v[110:111], v[110:111], v[204:205], v[206:207] op_sel_hi:[1,0,0]
  v_pk_mul_f32 v[108:109], v[108:109], v[96:97]
  v_pk_mul_f32 v[110:111], v[110:111], v[98:99]
  v_exp_f32 v108, v108
  v_exp_f32 v110, v110
  v_exp_f32 v109, v109
  v_exp_f32 v111, v111
  v_pk_fma_f32 v[108:109], v[108:109], v[202:203], v[202:203] op_sel_hi:[1,0,0]
  v_pk_fma_f32 v[110:111], v[110:111], v[202:203], v[202:203] op_sel_hi:[1,0,0]
  v_rcp_f32 v108, v108
  v_rcp_f32 v110, v110
  v_rcp_f32 v109, v109
  v_rcp_f32 v111, v111
  v_pk_mul_f32 v[108:109], v[108:109], v[96:97]
  v_pk_mul_f32 v[110:111], v[110:111], v[98:99]
  v_cvt_pk_bf16_f32 v170, v108, v109
  v_cvt_pk_bf16_f32 v171, v110, v111
  s_add_u32 m0, s67, s75
  s_add_u32 m0, m0, 65536
  s_mul_i32 s64, s67, 28
  buffer_load_dwordx4 v213, s[32:35], s64 offen lds
  v_or_b32 v168, 1, v168
  buffer_store_dwordx4 v[168:171], v215, s[16:19], s57 offen offset:0 sc1
  buffer_store_dwordx4 v[168:171], v216, s[16:19], s73 offen offset:0 sc1
  v_pk_mul_f32 v[108:109], v[100:101], v[100:101]
  v_pk_mul_f32 v[110:111], v[102:103], v[102:103]
  v_pk_fma_f32 v[108:109], v[108:109], v[204:205], v[206:207] op_sel_hi:[1,0,0]
  v_pk_fma_f32 v[110:111], v[110:111], v[204:205], v[206:207] op_sel_hi:[1,0,0]
  v_pk_mul_f32 v[108:109], v[108:109], v[100:101]
  v_pk_mul_f32 v[110:111], v[110:111], v[102:103]
  v_exp_f32 v108, v108
  v_exp_f32 v110, v110
  v_exp_f32 v109, v109
  v_exp_f32 v111, v111
  v_pk_fma_f32 v[108:109], v[108:109], v[202:203], v[202:203] op_sel_hi:[1,0,0]
  v_pk_fma_f32 v[110:111], v[110:111], v[202:203], v[202:203] op_sel_hi:[1,0,0]
  v_rcp_f32 v108, v108
  v_rcp_f32 v110, v110
  v_rcp_f32 v109, v109
  v_rcp_f32 v111, v111
  v_pk_mul_f32 v[108:109], v[108:109], v[100:101]
  v_pk_mul_f32 v[110:111], v[110:111], v[102:103]
  v_cvt_pk_bf16_f32 v172, v108, v109
  v_cvt_pk_bf16_f32 v173, v110, v111
  s_add_u32 s87, s64, 113664
  buffer_load_dwordx4 v213, s[32:35], s87 offen offset:1024 lds
  v_pk_mul_f32 v[108:109], v[104:105], v[104:105]
  v_pk_mul_f32 v[110:111], v[106:107], v[106:107]
  v_pk_fma_f32 v[108:109], v[108:109], v[204:205], v[206:207] op_sel_hi:[1,0,0]
  v_pk_fma_f32 v[110:111], v[110:111], v[204:205], v[206:207] op_sel_hi:[1,0,0]
  v_pk_mul_f32 v[108:109], v[108:109], v[104:105]
  v_pk_mul_f32 v[110:111], v[110:111], v[106:107]
  v_exp_f32 v108, v108
  v_exp_f32 v110, v110
  v_exp_f32 v109, v109
  v_exp_f32 v111, v111
  v_pk_fma_f32 v[108:109], v[108:109], v[202:203], v[202:203] op_sel_hi:[1,0,0]
  v_pk_fma_f32 v[110:111], v[110:111], v[202:203], v[202:203] op_sel_hi:[1,0,0]
  v_rcp_f32 v108, v108
  v_rcp_f32 v110, v110
  v_rcp_f32 v109, v109
  v_rcp_f32 v111, v111
  v_pk_mul_f32 v[108:109], v[108:109], v[104:105]
  v_pk_mul_f32 v[110:111], v[110:111], v[106:107]
  v_cvt_pk_bf16_f32 v174, v108, v109
  v_cvt_pk_bf16_f32 v175, v110, v111
  s_add_u32 s87, s64, 227328
  buffer_load_dwordx4 v213, s[32:35], s87 offen offset:2048 lds
  v_or_b32 v172, 1, v172
  buffer_store_dwordx4 v[172:175], v215, s[16:19], s57 offen offset:1024 sc1
  buffer_store_dwordx4 v[172:175], v216, s[16:19], s73 offen offset:1024 sc1
  s_xor_b32 s97, s58, 0
  s_add_u32 s97, s97, s60
  s_xor_b32 s96, s58, 8192
  s_add_u32 s96, s96, s60
  s_xor_b32 s77, s58, 4096
  s_add_u32 s77, s77, s60
  s_xor_b32 s76, s58, 12288
  s_add_u32 s76, s76, s60
  v_pk_add_f32 v[92:93], v[4:5], v[210:211] op_sel_hi:[1,0]
  v_pk_add_f32 v[94:95], v[6:7], v[210:211] op_sel_hi:[1,0]
  v_pk_add_f32 v[96:97], v[8:9], v[210:211] op_sel_hi:[1,0]
  v_pk_add_f32 v[98:99], v[10:11], v[210:211] op_sel_hi:[1,0]
  v_pk_add_f32 v[100:101], v[12:13], v[210:211] op_sel_hi:[1,0]
  v_pk_add_f32 v[102:103], v[14:15], v[210:211] op_sel_hi:[1,0]
  s_add_u32 s87, s64, 340992
  buffer_load_dwordx4 v213, s[32:35], s87 offen offset:3072 lds
  v_pk_add_f32 v[104:105], v[16:17], v[210:211] op_sel_hi:[1,0]
  v_pk_add_f32 v[106:107], v[18:19], v[210:211] op_sel_hi:[1,0]
  v_pk_mul_f32 v[92:93], v[92:93], v[208:209] op_sel_hi:[1,0]
  v_pk_mul_f32 v[94:95], v[94:95], v[208:209] op_sel_hi:[1,0]
  v_pk_mul_f32 v[96:97], v[96:97], v[208:209] op_sel_hi:[1,0]
  s_add_u32 m0, s66, s75
  s_add_u32 m0, m0, 65536
  s_mul_i32 s64, s66, 28
  buffer_load_dwordx4 v213, s[32:35], s64 offen lds
  v_pk_mul_f32 v[98:99], v[98:99], v[208:209] op_sel_hi:[1,0]
  v_pk_mul_f32 v[100:101], v[100:101], v[208:209] op_sel_hi:[1,0]
  v_pk_mul_f32 v[102:103], v[102:103], v[208:209] op_sel_hi:[1,0]
  v_pk_mul_f32 v[104:105], v[104:105], v[208:209] op_sel_hi:[1,0]
  v_pk_mul_f32 v[106:107], v[106:107], v[208:209] op_sel_hi:[1,0]
  s_add_u32 s87, s64, 113664
  buffer_load_dwordx4 v213, s[32:35], s87 offen offset:1024 lds
  s_add_u32 s74, s60, s57
  s_add_u32 s74, s74, 262144
  ds_read_b64_tr_b16 a[8:9], v229 offset:0
  ds_read_b64_tr_b16 a[10:11], v229 offset:512
  ds_read_b64_tr_b16 a[12:13], v228 offset:0
  s_add_u32 s87, s64, 227328
  buffer_load_dwordx4 v213, s[32:35], s87 offen offset:2048 lds
  ds_read_b64_tr_b16 a[14:15], v228 offset:512
  ds_read_b64_tr_b16 a[16:17], v227 offset:0
  ds_read_b64_tr_b16 a[18:19], v227 offset:512
  ds_read_b64_tr_b16 a[20:21], v226 offset:0
  ds_read_b64_tr_b16 a[22:23], v226 offset:512
  s_add_u32 s87, s64, 340992
  buffer_load_dwordx4 v213, s[32:35], s87 offen offset:3072 lds
  ds_read_b64_tr_b16 a[24:25], v229 offset:1024
  ds_read_b64_tr_b16 a[26:27], v229 offset:1536
  ds_read_b64_tr_b16 a[28:29], v228 offset:1024
  ds_read_b64_tr_b16 a[30:31], v228 offset:1536
  ds_read_b64_tr_b16 a[32:33], v227 offset:1024
  ds_read_b64_tr_b16 a[34:35], v227 offset:1536
  ds_read_b64_tr_b16 a[36:37], v226 offset:1024
  ds_read_b64_tr_b16 a[38:39], v226 offset:1536
  ds_read_b64_tr_b16 a[40:41], v229 offset:2048
  ds_read_b64_tr_b16 a[42:43], v229 offset:2560
  ds_read_b64_tr_b16 a[44:45], v228 offset:2048
  ds_read_b64_tr_b16 a[46:47], v228 offset:2560
  ds_read_b64_tr_b16 a[56:57], v227 offset:2048
  ds_read_b64_tr_b16 a[58:59], v227 offset:2560
  ds_read_b64_tr_b16 a[60:61], v226 offset:2048
  ds_read_b64_tr_b16 a[62:63], v226 offset:2560
  ds_read_b64_tr_b16 a[64:65], v229 offset:3072
  ds_read_b64_tr_b16 a[66:67], v229 offset:3584
  ds_read_b64_tr_b16 a[68:69], v228 offset:3072
  ds_read_b64_tr_b16 a[70:71], v228 offset:3584
  ds_read_b64_tr_b16 a[72:73], v227 offset:3072
  ds_read_b64_tr_b16 a[74:75], v227 offset:3584
  ds_read_b64_tr_b16 a[76:77], v226 offset:3072
  ds_read_b64_tr_b16 a[78:79], v226 offset:3584
  ds_read_b64_tr_b16 a[80:81], v229 offset:32768
  ds_read_b64_tr_b16 a[82:83], v229 offset:33280
  ds_read_b64_tr_b16 a[84:85], v228 offset:32768
  ds_read_b64_tr_b16 a[86:87], v228 offset:33280
  ds_read_b64_tr_b16 a[88:89], v227 offset:32768
  ds_read_b64_tr_b16 a[90:91], v227 offset:33280
  ds_read_b64_tr_b16 a[92:93], v226 offset:32768
  ds_read_b64_tr_b16 a[94:95], v226 offset:33280
  ds_read_b64_tr_b16 a[96:97], v229 offset:33792
  ds_read_b64_tr_b16 a[98:99], v229 offset:34304
  buffer_load_dwordx4 v[28:31], v253, s[16:19], s97 offen offset:0 sc1
  ds_read_b64_tr_b16 a[100:101], v228 offset:33792
  ds_read_b64_tr_b16 a[102:103], v228 offset:34304
  ds_read_b64_tr_b16 a[104:105], v227 offset:33792
  ds_read_b64_tr_b16 a[106:107], v227 offset:34304
  ds_read_b64_tr_b16 a[108:109], v226 offset:33792
  ds_read_b64_tr_b16 a[110:111], v226 offset:34304
  buffer_load_dwordx4 v[32:35], v253, s[16:19], s97 offen offset:1024 sc1
  ds_read_b64_tr_b16 a[112:113], v229 offset:34816
  ds_read_b64_tr_b16 a[114:115], v229 offset:35328
  ds_read_b64_tr_b16 a[116:117], v228 offset:34816
  ds_read_b64_tr_b16 a[118:119], v228 offset:35328
  ds_read_b64_tr_b16 a[120:121], v227 offset:34816
  ds_read_b64_tr_b16 a[122:123], v227 offset:35328
  buffer_load_dwordx4 v[36:39], v253, s[16:19], s97 offen offset:2048 sc1
  ds_read_b64_tr_b16 a[124:125], v226 offset:34816
  ds_read_b64_tr_b16 a[126:127], v226 offset:35328
  ds_read_b64_tr_b16 a[128:129], v229 offset:35840
  ds_read_b64_tr_b16 a[130:131], v229 offset:36352
  ds_read_b64_tr_b16 a[132:133], v228 offset:35840
  ds_read_b64_tr_b16 a[134:135], v228 offset:36352
  buffer_load_dwordx4 v[40:43], v253, s[16:19], s97 offen offset:3072 sc1
  ds_read_b64_tr_b16 a[136:137], v227 offset:35840
  ds_read_b64_tr_b16 a[138:139], v227 offset:36352
  ds_read_b64_tr_b16 a[140:141], v226 offset:35840
  ds_read_b64_tr_b16 a[142:143], v226 offset:36352
  ds_read_b64_tr_b16 a[144:145], v225 offset:16384
  ds_read_b64_tr_b16 a[146:147], v225 offset:16896
  buffer_load_dwordx4 v[44:47], v253, s[16:19], s96 offen offset:0 sc1
  ds_read_b64_tr_b16 a[148:149], v224 offset:16384
  ds_read_b64_tr_b16 a[150:151], v224 offset:16896
  ds_read_b64_tr_b16 a[152:153], v223 offset:16384
  ds_read_b64_tr_b16 a[154:155], v223 offset:16896
  ds_read_b64_tr_b16 a[156:157], v222 offset:16384
  ds_read_b64_tr_b16 a[158:159], v222 offset:16896
  buffer_load_dwordx4 v[48:51], v253, s[16:19], s96 offen offset:1024 sc1
  ds_read_b64_tr_b16 a[160:161], v225 offset:17408
  ds_read_b64_tr_b16 a[162:163], v225 offset:17920
  ds_read_b64_tr_b16 a[164:165], v224 offset:17408
  ds_read_b64_tr_b16 a[166:167], v224 offset:17920
  ds_read_b64_tr_b16 a[168:169], v223 offset:17408
  ds_read_b64_tr_b16 a[170:171], v223 offset:17920
  buffer_load_dwordx4 v[52:55], v253, s[16:19], s96 offen offset:2048 sc1
  ds_read_b64_tr_b16 a[172:173], v222 offset:17408
  ds_read_b64_tr_b16 a[174:175], v222 offset:17920
  buffer_load_dwordx4 v[56:59], v253, s[16:19], s96 offen offset:3072 sc1
  v_and_b32 v250, 1, v251
  v_add_u32 v250, s62, v250
  v_lshrrev_b32 v249, 5, v0
  v_lshlrev_b32 v245, 14, v250
  v_lshl_add_u32 v245, v249, 8, v245
  v_lshl_add_u32 v245, v252, 4, v245
  v_lshlrev_b32 v241, 10, v250
  v_lshl_add_u32 v241, v249, 9, v241
  v_lshl_add_u32 v241, v252, 3, v241
  v_lshlrev_b32 v239, 4, v249
  buffer_load_dwordx4 v[60:63], v201, s[16:19], s77 offen offset:0 sc1
  v_add_u32 v239, 147712, v239
  v_bfe_u32 v250, v0, 2, 2
  v_and_b32 v249, 1, v251
  v_and_b32 v242, 2, v250
  v_xor_b32 v249, v249, v242
  s_waitcnt vmcnt(7)
  v_bitop3_b32 v254, v28, v32, 1 bitop3:0x2a
  v_cmp_ne_u32 vcc, 0, v254
  s_cbranch_vccnz L_retry_221
L_ret_222:
  s_waitcnt lgkmcnt(14)
  v_mfma_f32_16x16x32_bf16 v[92:95], a[8:11], v[28:31], v[92:95]
  ds_read_b64_tr_b16 a[8:9], v225 offset:18432
  ds_read_b64_tr_b16 a[10:11], v225 offset:18944
  buffer_load_dwordx4 v[64:67], v201, s[16:19], s77 offen offset:1024 sc1
  v_mfma_f32_16x16x32_bf16 v[96:99], a[12:15], v[28:31], v[96:99]
  ds_read_b64_tr_b16 a[12:13], v224 offset:18432
  ds_read_b64_tr_b16 a[14:15], v224 offset:18944
  v_mfma_f32_16x16x32_bf16 v[100:103], a[16:19], v[28:31], v[100:103]
  ds_read_b64_tr_b16 a[16:17], v223 offset:18432
  ds_read_b64_tr_b16 a[18:19], v223 offset:18944
  v_mfma_f32_16x16x32_bf16 v[104:107], a[20:23], v[28:31], v[104:107]
  ds_read_b64_tr_b16 a[20:21], v222 offset:18432
  ds_read_b64_tr_b16 a[22:23], v222 offset:18944
  v_mfma_f32_16x16x32_bf16 v[92:95], a[24:27], v[32:35], v[92:95]
  ds_read_b64_tr_b16 a[24:25], v225 offset:19456
  ds_read_b64_tr_b16 a[26:27], v225 offset:19968
  buffer_load_dwordx4 v[68:71], v201, s[16:19], s77 offen offset:2048 sc1
  s_waitcnt vmcnt(7)
  v_bitop3_b32 v254, v36, v40, 1 bitop3:0x2a
  v_mfma_f32_16x16x32_bf16 v[96:99], a[28:31], v[32:35], v[96:99]
  ds_read_b64_tr_b16 a[28:29], v224 offset:19456
  ds_read_b64_tr_b16 a[30:31], v224 offset:19968
  v_cmp_ne_u32 vcc, 0, v254
  v_mfma_f32_16x16x32_bf16 v[100:103], a[32:35], v[32:35], v[100:103]
  ds_read_b64_tr_b16 a[32:33], v223 offset:19456
  ds_read_b64_tr_b16 a[34:35], v223 offset:19968
  v_mfma_f32_16x16x32_bf16 v[104:107], a[36:39], v[32:35], v[104:107]
  ds_read_b64_tr_b16 a[36:37], v222 offset:19456
  ds_read_b64_tr_b16 a[38:39], v222 offset:19968
  s_cbranch_vccnz L_retry_224
L_ret_225:
  v_mfma_f32_16x16x32_bf16 v[92:95], a[40:43], v[36:39], v[92:95]
  ds_read_b64_tr_b16 a[40:41], v225 offset:49152
  ds_read_b64_tr_b16 a[42:43], v225 offset:49664
  buffer_load_dwordx4 v[72:75], v201, s[16:19], s77 offen offset:3072 sc1
  v_mfma_f32_16x16x32_bf16 v[96:99], a[44:47], v[36:39], v[96:99]
  ds_read_b64_tr_b16 a[44:45], v224 offset:49152
  ds_read_b64_tr_b16 a[46:47], v224 offset:49664
  v_mfma_f32_16x16x32_bf16 v[100:103], a[56:59], v[36:39], v[100:103]
  ds_read_b64_tr_b16 a[56:57], v223 offset:49152
  ds_read_b64_tr_b16 a[58:59], v223 offset:49664
  v_mfma_f32_16x16x32_bf16 v[104:107], a[60:63], v[36:39], v[104:107]
  ds_read_b64_tr_b16 a[60:61], v222 offset:49152
  ds_read_b64_tr_b16 a[62:63], v222 offset:49664
  v_mfma_f32_16x16x32_bf16 v[92:95], a[64:67], v[40:43], v[92:95]
  ds_read_b64_tr_b16 a[64:65], v225 offset:50176
  ds_read_b64_tr_b16 a[66:67], v225 offset:50688
  buffer_load_dwordx4 v[76:79], v200, s[16:19], s76 offen offset:0 sc1
  s_waitcnt vmcnt(7)
  v_bitop3_b32 v254, v44, v48, 1 bitop3:0x2a
  v_mfma_f32_16x16x32_bf16 v[96:99], a[68:71], v[40:43], v[96:99]
  ds_read_b64_tr_b16 a[68:69], v224 offset:50176
  ds_read_b64_tr_b16 a[70:71], v224 offset:50688
  v_cmp_ne_u32 vcc, 0, v254
  v_mfma_f32_16x16x32_bf16 v[100:103], a[72:75], v[40:43], v[100:103]
  ds_read_b64_tr_b16 a[72:73], v223 offset:50176
  ds_read_b64_tr_b16 a[74:75], v223 offset:50688
  v_mfma_f32_16x16x32_bf16 v[104:107], a[76:79], v[40:43], v[104:107]
  ds_read_b64_tr_b16 a[76:77], v222 offset:50176
  ds_read_b64_tr_b16 a[78:79], v222 offset:50688
  s_cbranch_vccnz L_retry_227
L_ret_228:
  v_mfma_f32_16x16x32_bf16 v[92:95], a[80:83], v[44:47], v[92:95]
  ds_read_b64_tr_b16 a[80:81], v225 offset:51200
  ds_read_b64_tr_b16 a[82:83], v225 offset:51712
  buffer_load_dwordx4 v[80:83], v200, s[16:19], s76 offen offset:1024 sc1
  v_mfma_f32_16x16x32_bf16 v[96:99], a[84:87], v[44:47], v[96:99]
  ds_read_b64_tr_b16 a[84:85], v224 offset:51200
  ds_read_b64_tr_b16 a[86:87], v224 offset:51712
  v_mfma_f32_16x16x32_bf16 v[100:103], a[88:91], v[44:47], v[100:103]
  ds_read_b64_tr_b16 a[88:89], v223 offset:51200
  ds_read_b64_tr_b16 a[90:91], v223 offset:51712
  v_mfma_f32_16x16x32_bf16 v[104:107], a[92:95], v[44:47], v[104:107]
  ds_read_b64_tr_b16 a[92:93], v222 offset:51200
  ds_read_b64_tr_b16 a[94:95], v222 offset:51712
  v_mfma_f32_16x16x32_bf16 v[92:95], a[96:99], v[48:51], v[92:95]
  ds_read_b64_tr_b16 a[96:97], v225 offset:52224
  ds_read_b64_tr_b16 a[98:99], v225 offset:52736
  buffer_load_dwordx4 v[84:87], v200, s[16:19], s76 offen offset:2048 sc1
  s_waitcnt vmcnt(7)
  v_bitop3_b32 v254, v52, v56, 1 bitop3:0x2a
  v_mfma_f32_16x16x32_bf16 v[96:99], a[100:103], v[48:51], v[96:99]
  ds_read_b64_tr_b16 a[100:101], v224 offset:52224
  ds_read_b64_tr_b16 a[102:103], v224 offset:52736
  v_cmp_ne_u32 vcc, 0, v254
  v_mfma_f32_16x16x32_bf16 v[100:103], a[104:107], v[48:51], v[100:103]
  ds_read_b64_tr_b16 a[104:105], v223 offset:52224
  ds_read_b64_tr_b16 a[106:107], v223 offset:52736
  v_mfma_f32_16x16x32_bf16 v[104:107], a[108:111], v[48:51], v[104:107]
  ds_read_b64_tr_b16 a[108:109], v222 offset:52224
  ds_read_b64_tr_b16 a[110:111], v222 offset:52736
  s_cbranch_vccnz L_retry_230
L_ret_231:
  v_mfma_f32_16x16x32_bf16 v[92:95], a[112:115], v[52:55], v[92:95]
  buffer_load_dwordx4 v[88:91], v200, s[16:19], s76 offen offset:3072 sc1
  s_lshl_b32 s91, s58, 2
  v_subrev_u32 v229, s91, v229
  v_lshlrev_b32 v249, 5, v249
  v_lshl_add_u32 v249, v250, 7, v249
  v_mfma_f32_16x16x32_bf16 v[96:99], a[116:119], v[52:55], v[96:99]
  v_lshrrev_b32 v250, 5, v0
  v_lshl_add_u32 v249, v250, 12, v249
  v_and_b32 v250, 3, v0
  v_mfma_f32_16x16x32_bf16 v[100:103], a[120:123], v[52:55], v[100:103]
  v_lshl_add_u32 v242, v250, 3, v249
  v_xor_b32 v235, 64, v242
  v_add_u32 v248, 65536, v242
  v_mfma_f32_16x16x32_bf16 v[104:107], a[124:127], v[52:55], v[104:107]
  v_add_u32 v247, 65536, v235
  v_bfe_u32 v221, v0, 2, 2
  v_and_b32 v220, 2, v221
  v_mfma_f32_16x16x32_bf16 v[92:95], a[128:131], v[56:59], v[92:95]
  s_waitcnt lgkmcnt(0)
  s_barrier
  s_mul_i32 s72, s71, 14336
  s_mov_b64 exec, 0x3fff
  buffer_load_dword a5, v243, s[32:35], s72 offen
  s_mov_b64 exec, -1
  v_xor_b32 v220, s95, v220
  v_lshlrev_b32 v220, 5, v220
  v_lshl_add_u32 v220, v221, 7, v220
  s_waitcnt vmcnt(7)
  v_bitop3_b32 v254, v60, v64, 1 bitop3:0x2a
  v_mfma_f32_16x16x32_bf16 v[96:99], a[132:135], v[56:59], v[96:99]
  v_lshl_add_u32 v220, v251, 12, v220
  v_and_b32 v221, 3, v0
  v_lshl_add_u32 v237, v221, 3, v220
  v_cmp_ne_u32 vcc, 0, v254
  v_mfma_f32_16x16x32_bf16 v[100:103], a[136:139], v[56:59], v[100:103]
  s_add_u32 m0, s69, s75
  s_mul_i32 s64, s69, 28
  s_add_u32 s87, s64, 128
  buffer_load_dwordx4 v213, s[32:35], s87 offen lds
  v_add_u32 v24, 65536, v237
  v_lshrrev_b32 v221, 3, v0
  v_and_b32 v220, 7, v0
  s_mov_b32 s90, 0
  v_bfe_u32 v216, v221, 1, 1
  v_mfma_f32_16x16x32_bf16 v[104:107], a[140:143], v[56:59], v[104:107]
  s_cbranch_vccnz L_retry_233
L_ret_234:
  v_mfma_f32_16x16x32_bf16 v[92:95], a[144:147], v[60:63], v[92:95]
  s_and_b32 s91, s90, 1
  s_lshl_b32 s91, s91, 1
  v_or_b32 v216, s91, v216
  v_mfma_f32_16x16x32_bf16 v[96:99], a[148:151], v[60:63], v[96:99]
  v_lshlrev_b32 v216, 1, v216
  v_xor_b32 v220, v220, v216
  v_lshlrev_b32 v220, 4, v220
  v_mfma_f32_16x16x32_bf16 v[100:103], a[152:155], v[60:63], v[100:103]
  s_add_u32 s87, s64, 113792
  buffer_load_dwordx4 v213, s[32:35], s87 offen offset:1024 lds
  v_and_b32 v217, 3, v221
  v_lshrrev_b32 v216, 2, v221
  v_lshl_add_u32 v217, v216, 3, v217
  v_mfma_f32_16x16x32_bf16 v[104:107], a[156:159], v[60:63], v[104:107]
  s_lshr_b32 s91, s90, 1
  s_lshl_b32 s91, s91, 4
  v_mfma_f32_16x16x32_bf16 v[92:95], a[160:163], v[64:67], v[92:95]
  s_and_b32 s90, s90, 1
  s_lshl_b32 s90, s90, 2
  s_add_u32 s91, s91, s90
  s_waitcnt vmcnt(7)
  v_bitop3_b32 v254, v68, v72, 1 bitop3:0x2a
  v_mfma_f32_16x16x32_bf16 v[96:99], a[164:167], v[64:67], v[96:99]
  v_add_u32 v217, s91, v217
  s_mov_b32 s91, 1024
  v_mad_u32_u24 v234, v217, s91, v220
  v_cmp_ne_u32 vcc, 0, v254
  v_mfma_f32_16x16x32_bf16 v[100:103], a[168:171], v[64:67], v[100:103]
  s_add_u32 s87, s64, 227456
  buffer_load_dwordx4 v213, s[32:35], s87 offen offset:2048 lds
  v_lshrrev_b32 v221, 3, v0
  v_and_b32 v220, 7, v0
  s_mov_b32 s90, 1
  v_bfe_u32 v216, v221, 1, 1
  s_and_b32 s91, s90, 1
  v_mfma_f32_16x16x32_bf16 v[104:107], a[172:175], v[64:67], v[104:107]
  s_cbranch_vccnz L_retry_236
L_ret_237:
  v_mfma_f32_16x16x32_bf16 v[92:95], a[8:11], v[68:71], v[92:95]
  s_lshl_b32 s91, s91, 1
  v_or_b32 v216, s91, v216
  v_lshlrev_b32 v216, 1, v216
  v_mfma_f32_16x16x32_bf16 v[96:99], a[12:15], v[68:71], v[96:99]
  v_xor_b32 v220, v220, v216
  v_lshlrev_b32 v220, 4, v220
  v_and_b32 v217, 3, v221
  v_mfma_f32_16x16x32_bf16 v[100:103], a[16:19], v[68:71], v[100:103]
  s_add_u32 s87, s64, 341120
  buffer_load_dwordx4 v213, s[32:35], s87 offen offset:3072 lds
  v_lshrrev_b32 v216, 2, v221
  v_lshl_add_u32 v217, v216, 3, v217
  s_lshr_b32 s91, s90, 1
  v_mfma_f32_16x16x32_bf16 v[104:107], a[20:23], v[68:71], v[104:107]
  s_lshl_b32 s91, s91, 4
  s_and_b32 s90, s90, 1
  v_mfma_f32_16x16x32_bf16 v[92:95], a[24:27], v[72:75], v[92:95]
  s_lshl_b32 s90, s90, 2
  s_add_u32 s91, s91, s90
  v_add_u32 v217, s91, v217
  s_waitcnt vmcnt(7)
  v_bitop3_b32 v254, v76, v80, 1 bitop3:0x2a
  v_mfma_f32_16x16x32_bf16 v[96:99], a[28:31], v[72:75], v[96:99]
  s_mov_b32 s91, 1024
  v_mad_u32_u24 v233, v217, s91, v220
  v_add_u32 v232, 14336, v234
  v_cmp_ne_u32 vcc, 0, v254
  v_mfma_f32_16x16x32_bf16 v[100:103], a[32:35], v[72:75], v[100:103]
  s_add_u32 m0, s68, s75
  s_mul_i32 s64, s68, 28
  s_add_u32 s87, s64, 128
  buffer_load_dwordx4 v213, s[32:35], s87 offen lds
  v_add_u32 v231, 13312, v233
  v_subrev_u32 v233, 1024, v233
  s_and_b32 s70, s94, 3
  s_mul_i32 s70, s70, 3
  s_add_u32 s70, s70, s95
  v_mfma_f32_16x16x32_bf16 v[104:107], a[36:39], v[72:75], v[104:107]
  s_cbranch_vccnz L_retry_239
L_ret_240:
  v_mfma_f32_16x16x32_bf16 v[92:95], a[40:43], v[76:79], v[92:95]
  s_add_u32 s70, s70, 0
  s_cmp_ge_u32 s70, 12
  s_cselect_b32 s91, 12, 0
  s_sub_u32 s70, s70, s91
  v_mfma_f32_16x16x32_bf16 v[96:99], a[44:47], v[76:79], v[96:99]
  s_lshl_b32 s70, s70, 17
  s_add_u32 s70, s70, s85
  s_and_b32 s65, s94, 3
  v_mfma_f32_16x16x32_bf16 v[100:103], a[56:59], v[76:79], v[100:103]
  s_add_u32 s87, s64, 113792
  buffer_load_dwordx4 v213, s[32:35], s87 offen offset:1024 lds
  s_mul_i32 s65, s65, 3
  s_add_u32 s65, s65, s95
  s_add_u32 s65, s65, 4
  v_mfma_f32_16x16x32_bf16 v[104:107], a[60:63], v[76:79], v[104:107]
  s_cmp_ge_u32 s65, 12
  s_cselect_b32 s91, 12, 0
  s_sub_u32 s65, s65, s91
  v_mfma_f32_16x16x32_bf16 v[92:95], a[64:67], v[80:83], v[92:95]
  s_lshl_b32 s65, s65, 17
  s_add_u32 s65, s65, s85
  s_and_b32 s56, s94, 3
  s_waitcnt vmcnt(7)
  v_bitop3_b32 v254, v84, v88, 1 bitop3:0x2a
  v_mfma_f32_16x16x32_bf16 v[96:99], a[68:71], v[80:83], v[96:99]
  s_mul_i32 s56, s56, 3
  s_add_u32 s56, s56, s95
  s_add_u32 s56, s56, 8
  v_cmp_ne_u32 vcc, 0, v254
  v_mfma_f32_16x16x32_bf16 v[100:103], a[72:75], v[80:83], v[100:103]
  s_add_u32 s87, s64, 227456
  buffer_load_dwordx4 v213, s[32:35], s87 offen offset:2048 lds
  s_cmp_ge_u32 s56, 12
  s_cselect_b32 s91, 12, 0
  s_sub_u32 s56, s56, s91
  s_lshl_b32 s56, s56, 17
  s_add_u32 s56, s56, s85
  s_lshr_b32 s55, s95, 1
  v_mfma_f32_16x16x32_bf16 v[104:107], a[76:79], v[80:83], v[104:107]
  s_cbranch_vccnz L_retry_242
L_ret_243:
  v_mfma_f32_16x16x32_bf16 v[92:95], a[80:83], v[84:87], v[92:95]
  s_lshl_b32 s55, s55, 2
  s_and_b32 s91, s95, 1
  s_add_u32 s55, s55, s91
  v_mfma_f32_16x16x32_bf16 v[96:99], a[84:87], v[84:87], v[96:99]
  s_add_u32 s55, s55, 48
  s_lshl_b32 s55, s55, 15
  s_add_u32 s55, s55, s85
  v_mfma_f32_16x16x32_bf16 v[100:103], a[88:91], v[84:87], v[100:103]
  s_add_u32 s87, s64, 341120
  buffer_load_dwordx4 v213, s[32:35], s87 offen offset:3072 lds
  s_lshl_b32 s73, s95, 12
  s_add_u32 s73, s73, 66560
  s_and_b32 s54, s94, -2
  v_mfma_f32_16x16x32_bf16 v[104:107], a[92:95], v[84:87], v[104:107]
  s_mul_i32 s54, s54, 360448
  s_add_u32 s54, s54, 358400
  v_mfma_f32_16x16x32_bf16 v[92:95], a[96:99], v[88:91], v[92:95]
  s_add_u32 m0, s67, s75
  s_mul_i32 s64, s67, 28
  s_add_u32 s87, s64, 128
  buffer_load_dwordx4 v213, s[32:35], s87 offen lds
  s_lshl_b32 s53, s92, 2
  s_add_u32 s53, s53, s95
  s_lshl_b32 s53, s53, 2
  v_mfma_f32_16x16x32_bf16 v[96:99], a[100:103], v[88:91], v[96:99]
  s_add_u32 s53, s53, s54
  v_lshlrev_b32 v250, 12, v251
  v_sub_u32 v250, v229, v250
  v_mfma_f32_16x16x32_bf16 v[100:103], a[104:107], v[88:91], v[100:103]
  v_lshl_add_u32 v250, v251, 10, v250
  v_add_u32 v229, s73, v250
  v_xor_b32 v1, 32, v229
  v_mfma_f32_16x16x32_bf16 v[104:107], a[108:111], v[88:91], v[104:107]
  v_xor_b32 v2, 64, v229
  v_xor_b32 v3, 96, v229
  s_mov_b32 s91, 0xfffefffe
  v_cvt_pk_bf16_f32 v168, v92, v93
  v_cvt_pk_bf16_f32 v169, v94, v95
  v_and_or_b32 v168, v168, s91, 1
  v_cvt_pk_bf16_f32 v170, v96, v97
  v_cvt_pk_bf16_f32 v171, v98, v99
  buffer_store_dwordx4 v[168:171], v253, s[16:19], s74 offen offset:0 sc1
  v_cvt_pk_bf16_f32 v172, v100, v101
  v_cvt_pk_bf16_f32 v173, v102, v103
  v_and_or_b32 v172, v172, s91, 1
  v_cvt_pk_bf16_f32 v174, v104, v105
  v_cvt_pk_bf16_f32 v175, v106, v107
  buffer_store_dwordx4 v[172:175], v253, s[16:19], s74 offen offset:1024 sc1
  v_pk_add_f32 v[220:221], v[92:93], v[94:95]
  v_pk_mul_f32 v[216:217], v[92:93], v[92:93]
  v_pk_fma_f32 v[216:217], v[94:95], v[94:95], v[216:217]
  v_pk_add_f32 v[220:221], v[220:221], v[96:97]
  v_pk_fma_f32 v[216:217], v[96:97], v[96:97], v[216:217]
  v_pk_add_f32 v[220:221], v[220:221], v[98:99]
  v_pk_fma_f32 v[216:217], v[98:99], v[98:99], v[216:217]
  v_pk_add_f32 v[220:221], v[220:221], v[100:101]
  v_pk_fma_f32 v[216:217], v[100:101], v[100:101], v[216:217]
  v_pk_add_f32 v[220:221], v[220:221], v[102:103]
  v_pk_fma_f32 v[216:217], v[102:103], v[102:103], v[216:217]
  v_pk_add_f32 v[220:221], v[220:221], v[104:105]
  v_pk_fma_f32 v[216:217], v[104:105], v[104:105], v[216:217]
  s_add_u32 s87, s64, 113792
  buffer_load_dwordx4 v213, s[32:35], s87 offen offset:1024 lds
  v_pk_add_f32 v[220:221], v[220:221], v[106:107]
  v_pk_fma_f32 v[216:217], v[106:107], v[106:107], v[216:217]
  v_add_f32 v220, v220, v221
  v_add_f32 v216, v216, v217
  s_add_u32 s90, s59, s85
  s_add_u32 s90, s90, 331776
  v_permlane32_swap_b32 v220, v216
  v_add_f32 v220, v220, v216
  v_mov_b32 v216, v220
  s_nop 1
  v_permlane16_swap_b32 v220, v216
  v_add_f32 v220, v220, v216
  buffer_store_dword v220, v219, s[16:19], s90 offen sc1
  s_add_u32 s87, s64, 227456
  buffer_load_dwordx4 v213, s[32:35], s87 offen offset:2048 lds
  v_pk_add_f32 v[4:5], v[4:5], v[92:93]
  v_pk_add_f32 v[6:7], v[6:7], v[94:95]
  s_add_u32 s87, s64, 341120
  buffer_load_dwordx4 v213, s[32:35], s87 offen offset:3072 lds
  v_pk_add_f32 v[8:9], v[8:9], v[96:97]
  v_pk_add_f32 v[10:11], v[10:11], v[98:99]
  s_add_u32 m0, s66, s75
  s_mul_i32 s64, s66, 28
  s_add_u32 s87, s64, 128
  buffer_load_dwordx4 v213, s[32:35], s87 offen lds
  v_pk_add_f32 v[12:13], v[12:13], v[100:101]
  s_add_u32 s87, s64, 113792
  buffer_load_dwordx4 v213, s[32:35], s87 offen offset:1024 lds
  v_pk_add_f32 v[14:15], v[14:15], v[102:103]
  v_pk_add_f32 v[16:17], v[16:17], v[104:105]
  s_add_u32 s87, s64, 227456
  buffer_load_dwordx4 v213, s[32:35], s87 offen offset:2048 lds
  v_pk_add_f32 v[18:19], v[18:19], v[106:107]
  s_add_u32 s87, s64, 341120
  buffer_load_dwordx4 v213, s[32:35], s87 offen offset:3072 lds
  s_cmp_ge_u32 s92, 14
  s_cbranch_scc1 L_p6idle_245
  s_add_u32 s97, s63, 262144
  s_add_u32 s96, s63, 266240
  s_add_u32 s77, s63, 270336
  s_add_u32 s76, s63, 274432
  s_and_b32 s91, s94, -2
  s_add_u32 s91, s91, s95
  s_add_u32 s91, s91, 2
  s_min_u32 s91, s91, 31
  s_mul_i32 s91, s91, 360448
  s_add_u32 s91, s91, 357376
  v_and_b32 v221, 7, v0
  v_lshlrev_b32 v221, 7, v221
  v_add_u32 v221, s91, v221
  buffer_load_dword v220, v221, s[16:19], 0 offen sc1
  ds_read_b64_tr_b16 a[168:169], v24 offset:0
  ds_read_b64_tr_b16 a[170:171], v24 offset:512
  ds_read_b64_tr_b16 a[172:173], v24 offset:1024
  ds_read_b64_tr_b16 a[174:175], v24 offset:1536
  ds_read_b64_tr_b16 a[176:177], v24 offset:2048
  ds_read_b64_tr_b16 a[178:179], v24 offset:2560
  ds_read_b64_tr_b16 a[180:181], v24 offset:3072
  ds_read_b64_tr_b16 a[182:183], v24 offset:3584
  ds_read_b64_tr_b16 a[184:185], v24 offset:16384
  ds_read_b64_tr_b16 a[186:187], v24 offset:16896
  ds_read_b64_tr_b16 a[188:189], v24 offset:17408
  ds_read_b64_tr_b16 a[190:191], v24 offset:17920
  ds_read_b64_tr_b16 a[192:193], v24 offset:18432
  ds_read_b64_tr_b16 a[194:195], v24 offset:18944
  ds_read_b64_tr_b16 a[196:197], v24 offset:19456
  ds_read_b64_tr_b16 a[198:199], v24 offset:19968
  ds_read_b64_tr_b16 a[200:201], v24 offset:32768
  ds_read_b64_tr_b16 a[202:203], v24 offset:33280
  ds_read_b64_tr_b16 a[204:205], v24 offset:33792
  ds_read_b64_tr_b16 a[206:207], v24 offset:34304
  ds_read_b64_tr_b16 a[208:209], v24 offset:34816
  ds_read_b64_tr_b16 a[210:211], v24 offset:35328
  ds_read_b64_tr_b16 a[212:213], v24 offset:35840
  ds_read_b64_tr_b16 a[214:215], v24 offset:36352
  ds_read_b64_tr_b16 a[216:217], v24 offset:49152
  ds_read_b64_tr_b16 a[218:219], v24 offset:49664
  ds_read_b64_tr_b16 a[220:221], v24 offset:50176
  ds_read_b64_tr_b16 a[222:223], v24 offset:50688
  buffer_load_dwordx4 v[28:31], v245, s[16:19], s97 offen offset:0 sc1
  ds_read_b64_tr_b16 a[224:225], v24 offset:51200
  ds_read_b64_tr_b16 a[226:227], v24 offset:51712
  ds_read_b64_tr_b16 a[228:229], v24 offset:52224
  ds_read_b64_tr_b16 a[230:231], v24 offset:52736
  ds_read_b64_tr_b16 a[232:233], v248 offset:0
  ds_read_b64_tr_b16 a[234:235], v248 offset:512
  buffer_load_dwordx4 v[32:35], v245, s[16:19], s97 offen offset:512 sc1
  ds_read_b64_tr_b16 a[236:237], v247 offset:0
  ds_read_b64_tr_b16 a[238:239], v247 offset:512
  ds_read_b64_tr_b16 a[240:241], v248 offset:8192
  ds_read_b64_tr_b16 a[242:243], v248 offset:8704
  ds_read_b64_tr_b16 a[244:245], v247 offset:8192
  ds_read_b64_tr_b16 a[246:247], v247 offset:8704
  buffer_load_dwordx4 v[36:39], v245, s[16:19], s97 offen offset:1024 sc1
  ds_read_b64_tr_b16 a[248:249], v248 offset:1024
  ds_read_b64_tr_b16 a[250:251], v248 offset:1536
  s_waitcnt lgkmcnt(14)
  v_mfma_f32_16x16x32_bf16 v[204:207], a[168:171], v[20:23], 0
  v_mfma_f32_16x16x32_bf16 v[204:207], a[172:175], v[20:23], v[204:207]
  v_mfma_f32_16x16x32_bf16 v[204:207], a[176:179], v[20:23], v[204:207]
  v_mfma_f32_16x16x32_bf16 v[204:207], a[180:183], v[20:23], v[204:207]
  buffer_load_dwordx4 v[40:43], v245, s[16:19], s97 offen offset:1536 sc1
  v_mfma_f32_16x16x32_bf16 v[204:207], a[184:187], v[20:23], v[204:207]
  v_mfma_f32_16x16x32_bf16 v[204:207], a[188:191], v[20:23], v[204:207]
  v_mfma_f32_16x16x32_bf16 v[204:207], a[192:195], v[20:23], v[204:207]
  v_mfma_f32_16x16x32_bf16 v[204:207], a[196:199], v[20:23], v[204:207]
  v_mfma_f32_16x16x32_bf16 v[204:207], a[200:203], v[20:23], v[204:207]
  v_mfma_f32_16x16x32_bf16 v[204:207], a[204:207], v[20:23], v[204:207]
  buffer_load_dwordx4 v[44:47], v245, s[16:19], s97 offen offset:2048 sc1
  v_mfma_f32_16x16x32_bf16 v[204:207], a[208:211], v[20:23], v[204:207]
  v_mfma_f32_16x16x32_bf16 v[204:207], a[212:215], v[20:23], v[204:207]
  v_mfma_f32_16x16x32_bf16 v[204:207], a[216:219], v[20:23], v[204:207]
  v_mfma_f32_16x16x32_bf16 v[204:207], a[220:223], v[20:23], v[204:207]
  s_waitcnt lgkmcnt(12)
  v_mfma_f32_16x16x32_bf16 v[204:207], a[224:227], v[20:23], v[204:207]
  s_waitcnt lgkmcnt(10)
  v_mfma_f32_16x16x32_bf16 v[204:207], a[228:231], v[20:23], v[204:207]
  buffer_load_dwordx4 v[48:51], v245, s[16:19], s97 offen offset:2560 sc1
  s_mov_b64 exec, s[80:81]
  s_nop 5
  ds_write_b128 v230, v[204:207] offset:256
  s_mov_b64 exec, -1
  buffer_load_dwordx4 v[52:55], v245, s[16:19], s97 offen offset:3072 sc1
  buffer_load_dwordx4 v[56:59], v245, s[16:19], s97 offen offset:3584 sc1
  buffer_load_dwordx4 v[60:63], v245, s[16:19], s96 offen offset:0 sc1
  buffer_load_dwordx4 v[64:67], v245, s[16:19], s96 offen offset:512 sc1
  s_waitcnt vmcnt(8)
  v_bitop3_b32 v254, v28, v32, 1 bitop3:0x7e
  v_and_b32 v254, 0x10001, v254
  v_cmp_ne_u32 vcc, 0, v254
  s_cbranch_vccnz L_retry_253
L_ret_254:
  ds_read_b64_tr_b16 a[252:253], v247 offset:1024
  ds_read_b64_tr_b16 a[254:255], v247 offset:1536
  s_waitcnt lgkmcnt(11)
  v_mfma_f32_32x32x16_bf16 v[156:171], a[232:235], v[28:31], 0
  s_waitcnt lgkmcnt(9)
  buffer_load_dwordx4 v[68:71], v245, s[16:19], s96 offen offset:1024 sc1
  ds_read_b64_tr_b16 a[232:233], v248 offset:9216
  ds_read_b64_tr_b16 a[234:235], v248 offset:9728
  v_mfma_f32_32x32x16_bf16 v[172:187], a[236:239], v[28:31], 0
  s_waitcnt lgkmcnt(9)
  ds_read_b64_tr_b16 a[236:237], v247 offset:9216
  ds_read_b64_tr_b16 a[238:239], v247 offset:9728
  v_mfma_f32_32x32x16_bf16 v[156:171], a[240:243], v[32:35], v[156:171]
  buffer_load_dwordx4 v[72:75], v245, s[16:19], s96 offen offset:1536 sc1
  ds_read_b64_tr_b16 a[240:241], v248 offset:2048
  ds_read_b64_tr_b16 a[242:243], v248 offset:2560
  s_waitcnt vmcnt(8)
  v_bitop3_b32 v254, v36, v40, 1 bitop3:0x7e
  v_and_b32 v254, 0x10001, v254
  v_cmp_ne_u32 vcc, 0, v254
  s_waitcnt lgkmcnt(11)
  v_mfma_f32_32x32x16_bf16 v[172:187], a[244:247], v[32:35], v[172:187]
  s_cbranch_vccnz L_retry_256
L_ret_257:
  ds_read_b64_tr_b16 a[244:245], v247 offset:2048
  ds_read_b64_tr_b16 a[246:247], v247 offset:2560
  s_waitcnt lgkmcnt(11)
  v_mfma_f32_32x32x16_bf16 v[156:171], a[248:251], v[36:39], v[156:171]
  s_waitcnt lgkmcnt(8)
  buffer_load_dwordx4 v[76:79], v245, s[16:19], s96 offen offset:2048 sc1
  ds_read_b64_tr_b16 a[248:249], v248 offset:10240
  ds_read_b64_tr_b16 a[250:251], v248 offset:10752
  v_mfma_f32_32x32x16_bf16 v[172:187], a[252:255], v[36:39], v[172:187]
  s_waitcnt lgkmcnt(8)
  ds_read_b64_tr_b16 a[252:253], v247 offset:10240
  ds_read_b64_tr_b16 a[254:255], v247 offset:10752
  v_mfma_f32_32x32x16_bf16 v[156:171], a[232:235], v[40:43], v[156:171]
  buffer_load_dwordx4 v[80:83], v245, s[16:19], s96 offen offset:2560 sc1
  ds_read_b64_tr_b16 a[232:233], v248 offset:3072
  ds_read_b64_tr_b16 a[234:235], v248 offset:3584
  s_waitcnt vmcnt(8)
  v_bitop3_b32 v254, v44, v48, 1 bitop3:0x7e
  v_and_b32 v254, 0x10001, v254
  v_cmp_ne_u32 vcc, 0, v254
  s_waitcnt lgkmcnt(10)
  v_mfma_f32_32x32x16_bf16 v[172:187], a[236:239], v[40:43], v[172:187]
  s_cbranch_vccnz L_retry_259
L_ret_260:
  ds_read_b64_tr_b16 a[236:237], v247 offset:3072
  ds_read_b64_tr_b16 a[238:239], v247 offset:3584
  s_waitcnt lgkmcnt(10)
  v_mfma_f32_32x32x16_bf16 v[156:171], a[240:243], v[44:47], v[156:171]
  buffer_load_dwordx4 v[84:87], v245, s[16:19], s96 offen offset:3072 sc1
  v_xor_b32 v254, s88, v220
  v_cmp_lt_u32 vcc, 31, v254
  s_cbranch_vccnz L_rdy_262
L_rret_263:
  ds_read_b64_tr_b16 a[240:241], v248 offset:11264
  ds_read_b64_tr_b16 a[242:243], v248 offset:11776
  s_waitcnt lgkmcnt(10)
  v_mfma_f32_32x32x16_bf16 v[172:187], a[244:247], v[44:47], v[172:187]
  s_waitcnt lgkmcnt(8)
  ds_read_b64_tr_b16 a[244:245], v247 offset:11264
  ds_read_b64_tr_b16 a[246:247], v247 offset:11776
  v_mfma_f32_32x32x16_bf16 v[156:171], a[248:251], v[48:51], v[156:171]
  buffer_load_dwordx4 v[88:91], v245, s[16:19], s96 offen offset:3584 sc1
  ds_read_b64_tr_b16 a[248:249], v248 offset:16384
  ds_read_b64_tr_b16 a[250:251], v248 offset:16896
  s_waitcnt vmcnt(8)
  v_bitop3_b32 v254, v52, v56, 1 bitop3:0x7e
  v_and_b32 v254, 0x10001, v254
  v_cmp_ne_u32 vcc, 0, v254
  s_waitcnt lgkmcnt(10)
  v_mfma_f32_32x32x16_bf16 v[172:187], a[252:255], v[48:51], v[172:187]
  s_cbranch_vccnz L_retry_265
L_ret_266:
  ds_read_b64_tr_b16 a[252:253], v247 offset:16384
  ds_read_b64_tr_b16 a[254:255], v247 offset:16896
  s_waitcnt lgkmcnt(10)
  v_mfma_f32_32x32x16_bf16 v[156:171], a[232:235], v[52:55], v[156:171]
  s_waitcnt lgkmcnt(8)
  buffer_load_dwordx4 v[92:95], v245, s[16:19], s77 offen offset:0 sc1
  ds_read_b64_tr_b16 a[232:233], v248 offset:24576
  ds_read_b64_tr_b16 a[234:235], v248 offset:25088
  v_mfma_f32_32x32x16_bf16 v[172:187], a[236:239], v[52:55], v[172:187]
  s_waitcnt lgkmcnt(8)
  ds_read_b64_tr_b16 a[236:237], v247 offset:24576
  ds_read_b64_tr_b16 a[238:239], v247 offset:25088
  v_mfma_f32_32x32x16_bf16 v[156:171], a[240:243], v[56:59], v[156:171]
  buffer_load_dwordx4 v[96:99], v245, s[16:19], s77 offen offset:512 sc1
  ds_read_b64_tr_b16 a[240:241], v248 offset:17408
  ds_read_b64_tr_b16 a[242:243], v248 offset:17920
  s_waitcnt vmcnt(8)
  v_bitop3_b32 v254, v60, v64, 1 bitop3:0x7e
  v_and_b32 v254, 0x10001, v254
  v_cmp_ne_u32 vcc, 0, v254
  s_waitcnt lgkmcnt(10)
  v_mfma_f32_32x32x16_bf16 v[172:187], a[244:247], v[56:59], v[172:187]
  s_cbranch_vccnz L_retry_268
L_ret_269:
  ds_read_b64_tr_b16 a[244:245], v247 offset:17408
  ds_read_b64_tr_b16 a[246:247], v247 offset:17920
  s_waitcnt lgkmcnt(10)
  v_mfma_f32_32x32x16_bf16 v[156:171], a[248:251], v[60:63], v[156:171]
  s_waitcnt lgkmcnt(8)
  buffer_load_dwordx4 v[100:103], v245, s[16:19], s77 offen offset:1024 sc1
  ds_read_b64_tr_b16 a[248:249], v248 offset:25600
  ds_read_b64_tr_b16 a[250:251], v248 offset:26112
  v_mfma_f32_32x32x16_bf16 v[172:187], a[252:255], v[60:63], v[172:187]
  s_waitcnt lgkmcnt(8)
  ds_read_b64_tr_b16 a[252:253], v247 offset:25600
  ds_read_b64_tr_b16 a[254:255], v247 offset:26112
  v_mfma_f32_32x32x16_bf16 v[156:171], a[232:235], v[64:67], v[156:171]
  buffer_load_dwordx4 v[104:107], v245, s[16:19], s77 offen offset:1536 sc1
  ds_read_b64_tr_b16 a[232:233], v248 offset:18432
  ds_read_b64_tr_b16 a[234:235], v248 offset:18944
  s_waitcnt vmcnt(8)
  v_bitop3_b32 v254, v68, v72, 1 bitop3:0x7e
  v_and_b32 v254, 0x10001, v254
  v_cmp_ne_u32 vcc, 0, v254
  s_waitcnt lgkmcnt(10)
  v_mfma_f32_32x32x16_bf16 v[172:187], a[236:239], v[64:67], v[172:187]
  s_cbranch_vccnz L_retry_271
L_ret_272:
  ds_read_b64_tr_b16 a[236:237], v247 offset:18432
  ds_read_b64_tr_b16 a[238:239], v247 offset:18944
  s_waitcnt lgkmcnt(10)
  v_mfma_f32_32x32x16_bf16 v[156:171], a[240:243], v[68:71], v[156:171]
  s_waitcnt lgkmcnt(8)
  buffer_load_dwordx4 v[108:111], v245, s[16:19], s77 offen offset:2048 sc1
  s_add_u32 s67, s63, 331776
  buffer_load_dwordx2 v[220:221], v241, s[16:19], s67 offen offset:0 sc1
  buffer_load_dwordx2 v[222:223], v241, s[16:19], s67 offen offset:128 sc1
  buffer_load_dwordx2 v[224:225], v241, s[16:19], s67 offen offset:256 sc1
  buffer_load_dwordx2 v[226:227], v241, s[16:19], s67 offen offset:384 sc1
  ds_read_b64_tr_b16 a[240:241], v248 offset:26624
  ds_read_b64_tr_b16 a[242:243], v248 offset:27136
  v_mfma_f32_32x32x16_bf16 v[172:187], a[244:247], v[68:71], v[172:187]
  s_waitcnt lgkmcnt(8)
  ds_read_b64_tr_b16 a[244:245], v247 offset:26624
  ds_read_b64_tr_b16 a[246:247], v247 offset:27136
  v_mfma_f32_32x32x16_bf16 v[156:171], a[248:251], v[72:75], v[156:171]
  buffer_load_dwordx4 v[112:115], v245, s[16:19], s77 offen offset:2560 sc1
  ds_read_b64_tr_b16 a[248:249], v248 offset:19456
  ds_read_b64_tr_b16 a[250:251], v248 offset:19968
  s_waitcnt vmcnt(12)
  v_bitop3_b32 v254, v76, v80, 1 bitop3:0x7e
  v_and_b32 v254, 0x10001, v254
  v_cmp_ne_u32 vcc, 0, v254
  s_waitcnt lgkmcnt(10)
  v_mfma_f32_32x32x16_bf16 v[172:187], a[252:255], v[72:75], v[172:187]
  s_cbranch_vccnz L_retry_274
L_ret_275:
  ds_read_b64_tr_b16 a[252:253], v247 offset:19456
  ds_read_b64_tr_b16 a[254:255], v247 offset:19968
  s_waitcnt lgkmcnt(10)
  v_mfma_f32_32x32x16_bf16 v[156:171], a[232:235], v[76:79], v[156:171]
  s_waitcnt lgkmcnt(8)
  buffer_load_dwordx4 v[116:119], v245, s[16:19], s77 offen offset:3072 sc1
  ds_read_b64_tr_b16 a[232:233], v248 offset:27648
  ds_read_b64_tr_b16 a[234:235], v248 offset:28160
  v_mfma_f32_32x32x16_bf16 v[172:187], a[236:239], v[76:79], v[172:187]
  s_waitcnt lgkmcnt(8)
  ds_read_b64_tr_b16 a[236:237], v247 offset:27648
  ds_read_b64_tr_b16 a[238:239], v247 offset:28160
  v_mfma_f32_32x32x16_bf16 v[156:171], a[240:243], v[80:83], v[156:171]
  buffer_load_dwordx4 v[120:123], v245, s[16:19], s77 offen offset:3584 sc1
  ds_read_b64_tr_b16 a[240:241], v248 offset:32768
  ds_read_b64_tr_b16 a[242:243], v248 offset:33280
  s_waitcnt vmcnt(12)
  v_bitop3_b32 v254, v84, v88, 1 bitop3:0x7e
  v_and_b32 v254, 0x10001, v254
  v_cmp_ne_u32 vcc, 0, v254
  s_waitcnt lgkmcnt(10)
  v_mfma_f32_32x32x16_bf16 v[172:187], a[244:247], v[80:83], v[172:187]
  s_cbranch_vccnz L_retry_277
L_ret_278:
  s_barrier
  ds_read_b64_tr_b16 a[244:245], v247 offset:32768
  ds_read_b64_tr_b16 a[246:247], v247 offset:33280
  s_waitcnt lgkmcnt(10)
  v_mfma_f32_32x32x16_bf16 v[156:171], a[248:251], v[84:87], v[156:171]
  s_waitcnt lgkmcnt(8)
  buffer_load_dwordx4 v[124:127], v245, s[16:19], s76 offen offset:0 sc1
  ds_read_b64_tr_b16 a[168:169], v237 offset:0
  ds_read_b64_tr_b16 a[170:171], v237 offset:512
  ds_read_b64_tr_b16 a[172:173], v237 offset:1024
  ds_read_b64_tr_b16 a[174:175], v237 offset:1536
  ds_read_b64_tr_b16 a[248:249], v248 offset:40960
  ds_read_b64_tr_b16 a[250:251], v248 offset:41472
  v_mfma_f32_32x32x16_bf16 v[172:187], a[252:255], v[84:87], v[172:187]
  s_waitcnt lgkmcnt(12)
  ds_read_b64_tr_b16 a[252:253], v247 offset:40960
  ds_read_b64_tr_b16 a[254:255], v247 offset:41472
  v_mfma_f32_32x32x16_bf16 v[156:171], a[232:235], v[88:91], v[156:171]
  buffer_load_dwordx4 v[128:131], v245, s[16:19], s76 offen offset:512 sc1
  ds_read_b64_tr_b16 a[176:177], v237 offset:2048
  ds_read_b64_tr_b16 a[178:179], v237 offset:2560
  ds_read_b64_tr_b16 a[180:181], v237 offset:3072
  ds_read_b64_tr_b16 a[182:183], v237 offset:3584
  ds_read_b64_tr_b16 a[232:233], v248 offset:33792
  ds_read_b64_tr_b16 a[234:235], v248 offset:34304
  s_waitcnt vmcnt(12)
  v_bitop3_b32 v254, v92, v96, 1 bitop3:0x7e
  v_and_b32 v254, 0x10001, v254
  v_cmp_ne_u32 vcc, 0, v254
  s_waitcnt lgkmcnt(14)
  v_mfma_f32_32x32x16_bf16 v[172:187], a[236:239], v[88:91], v[172:187]
  s_cbranch_vccnz L_retry_280
L_ret_281:
  ds_read_b64_tr_b16 a[236:237], v247 offset:33792
  ds_read_b64_tr_b16 a[238:239], v247 offset:34304
  v_mfma_f32_32x32x16_bf16 v[156:171], a[240:243], v[92:95], v[156:171]
  buffer_load_dwordx4 v[132:135], v245, s[16:19], s76 offen offset:1024 sc1
  ds_read_b64_tr_b16 a[184:185], v237 offset:16384
  ds_read_b64_tr_b16 a[186:187], v237 offset:16896
  ds_read_b64_tr_b16 a[188:189], v237 offset:17408
  ds_read_b64_tr_b16 a[190:191], v237 offset:17920
  ds_read_b64_tr_b16 a[240:241], v248 offset:41984
  ds_read_b64_tr_b16 a[242:243], v248 offset:42496
  v_mfma_f32_32x32x16_bf16 v[172:187], a[244:247], v[92:95], v[172:187]
  s_waitcnt lgkmcnt(14)
  v_mfma_f32_16x16x32_bf16 v[204:207], a[168:171], v[20:23], 0
  v_mfma_f32_16x16x32_bf16 v[204:207], a[172:175], v[20:23], v[204:207]
  ds_read_b64_tr_b16 a[244:245], v247 offset:41984
  ds_read_b64_tr_b16 a[246:247], v247 offset:42496
  v_mfma_f32_32x32x16_bf16 v[156:171], a[248:251], v[96:99], v[156:171]
  buffer_load_dwordx4 v[136:139], v245, s[16:19], s76 offen offset:1536 sc1
  ds_read_b64_tr_b16 a[192:193], v237 offset:18432
  ds_read_b64_tr_b16 a[194:195], v237 offset:18944
  ds_read_b64_tr_b16 a[196:197], v237 offset:19456
  ds_read_b64_tr_b16 a[198:199], v237 offset:19968
  ds_read_b64_tr_b16 a[248:249], v248 offset:34816
  ds_read_b64_tr_b16 a[250:251], v248 offset:35328
  s_waitcnt vmcnt(12)
  v_bitop3_b32 v254, v100, v104, 1 bitop3:0x7e
  v_and_b32 v254, 0x10001, v254
  v_cmp_ne_u32 vcc, 0, v254
  v_mfma_f32_32x32x16_bf16 v[172:187], a[252:255], v[96:99], v[172:187]
  s_cbranch_vccnz L_retry_283
L_ret_284:
  s_waitcnt lgkmcnt(14)
  v_mfma_f32_16x16x32_bf16 v[204:207], a[176:179], v[20:23], v[204:207]
  ds_read_b64_tr_b16 a[252:253], v247 offset:34816
  ds_read_b64_tr_b16 a[254:255], v247 offset:35328
  v_mfma_f32_32x32x16_bf16 v[156:171], a[232:235], v[100:103], v[156:171]
  buffer_load_dwordx4 v[140:143], v245, s[16:19], s76 offen offset:2048 sc1
  ds_read_b64_tr_b16 a[200:201], v237 offset:32768
  ds_read_b64_tr_b16 a[202:203], v237 offset:33280
  ds_read_b64_tr_b16 a[204:205], v237 offset:33792
  ds_read_b64_tr_b16 a[206:207], v237 offset:34304
  ds_read_b64_tr_b16 a[232:233], v248 offset:43008
  ds_read_b64_tr_b16 a[234:235], v248 offset:43520
  v_mfma_f32_32x32x16_bf16 v[172:187], a[236:239], v[100:103], v[172:187]
  v_mfma_f32_16x16x32_bf16 v[204:207], a[180:183], v[20:23], v[204:207]
  s_waitcnt lgkmcnt(12)
  ds_read_b64_tr_b16 a[236:237], v247 offset:43008
  ds_read_b64_tr_b16 a[238:239], v247 offset:43520
  v_mfma_f32_32x32x16_bf16 v[156:171], a[240:243], v[104:107], v[156:171]
  buffer_load_dwordx4 v[144:147], v245, s[16:19], s76 offen offset:2560 sc1
  ds_read_b64_tr_b16 a[208:209], v237 offset:34816
  ds_read_b64_tr_b16 a[210:211], v237 offset:35328
  ds_read_b64_tr_b16 a[212:213], v237 offset:35840
  ds_read_b64_tr_b16 a[214:215], v237 offset:36352
  ds_read_b64_tr_b16 a[240:241], v248 offset:35840
  ds_read_b64_tr_b16 a[242:243], v248 offset:36352
  s_waitcnt vmcnt(8)
  v_bitop3_b32 v254, v108, v112, 1 bitop3:0x7e
  v_and_b32 v254, 0x10001, v254
  v_cmp_ne_u32 vcc, 0, v254
  v_mfma_f32_32x32x16_bf16 v[172:187], a[244:247], v[104:107], v[172:187]
  s_cbranch_vccnz L_retry_286
L_ret_287:
  v_mfma_f32_16x16x32_bf16 v[204:207], a[184:187], v[20:23], v[204:207]
  s_waitcnt lgkmcnt(12)
  ds_read_b64_tr_b16 a[244:245], v247 offset:35840
  ds_read_b64_tr_b16 a[246:247], v247 offset:36352
  v_mfma_f32_32x32x16_bf16 v[156:171], a[248:251], v[108:111], v[156:171]
  buffer_load_dwordx4 v[148:151], v245, s[16:19], s76 offen offset:3072 sc1
  ds_read_b64_tr_b16 a[216:217], v237 offset:49152
  ds_read_b64_tr_b16 a[218:219], v237 offset:49664
  ds_read_b64_tr_b16 a[220:221], v237 offset:50176
  ds_read_b64_tr_b16 a[222:223], v237 offset:50688
  ds_read_b64_tr_b16 a[248:249], v248 offset:44032
  ds_read_b64_tr_b16 a[250:251], v248 offset:44544
  v_mfma_f32_32x32x16_bf16 v[172:187], a[252:255], v[108:111], v[172:187]
  v_mfma_f32_16x16x32_bf16 v[204:207], a[188:191], v[20:23], v[204:207]
  s_waitcnt lgkmcnt(12)
  ds_read_b64_tr_b16 a[252:253], v247 offset:44032
  ds_read_b64_tr_b16 a[254:255], v247 offset:44544
  v_mfma_f32_32x32x16_bf16 v[156:171], a[232:235], v[112:115], v[156:171]
  buffer_load_dwordx4 v[152:155], v245, s[16:19], s76 offen offset:3584 sc1
  ds_read_b64_tr_b16 a[224:225], v237 offset:51200
  ds_read_b64_tr_b16 a[226:227], v237 offset:51712
  ds_read_b64_tr_b16 a[228:229], v237 offset:52224
  ds_read_b64_tr_b16 a[230:231], v237 offset:52736
  ds_read_b64_tr_b16 a[232:233], v248 offset:49152
  ds_read_b64_tr_b16 a[234:235], v248 offset:49664
  s_waitcnt vmcnt(8)
  v_bitop3_b32 v254, v116, v120, 1 bitop3:0x7e
  v_and_b32 v254, 0x10001, v254
  v_cmp_ne_u32 vcc, 0, v254
  v_mfma_f32_32x32x16_bf16 v[172:187], a[236:239], v[112:115], v[172:187]
  s_cbranch_vccnz L_retry_289
L_ret_290:
  v_mfma_f32_16x16x32_bf16 v[204:207], a[192:195], v[20:23], v[204:207]
  s_waitcnt lgkmcnt(12)
  ds_read_b64_tr_b16 a[236:237], v247 offset:49152
  ds_read_b64_tr_b16 a[238:239], v247 offset:49664
  v_mfma_f32_32x32x16_bf16 v[156:171], a[240:243], v[116:119], v[156:171]
  s_mul_i32 s72, s71, 14336
  s_mov_b64 exec, 0x3fff
  buffer_load_dword a5, v243, s[36:39], s72 offen
  s_mov_b64 exec, -1
  v_max3_u32 v254, v220, v221, v222
  v_max3_u32 v254, v254, v223, v224
  v_max3_u32 v254, v254, v225, v226
  v_max_u32 v254, v254, v227
  v_cmp_eq_u32 vcc, -1, v254
  s_cbranch_vccnz L_retry_250
L_ret_251:
  ds_read_b64_tr_b16 a[240:241], v248 offset:57344
  ds_read_b64_tr_b16 a[242:243], v248 offset:57856
  v_mfma_f32_32x32x16_bf16 v[172:187], a[244:247], v[116:119], v[172:187]
  v_mfma_f32_16x16x32_bf16 v[204:207], a[196:199], v[20:23], v[204:207]
  s_waitcnt lgkmcnt(12)
  ds_read_b64_tr_b16 a[244:245], v247 offset:57344
  ds_read_b64_tr_b16 a[246:247], v247 offset:57856
  v_mfma_f32_32x32x16_bf16 v[156:171], a[248:251], v[120:123], v[156:171]
  ds_read_b64_tr_b16 a[248:249], v248 offset:50176
  ds_read_b64_tr_b16 a[250:251], v248 offset:50688
  s_waitcnt vmcnt(7)
  v_bitop3_b32 v254, v124, v128, 1 bitop3:0x7e
  v_and_b32 v254, 0x10001, v254
  v_cmp_ne_u32 vcc, 0, v254
  s_waitcnt lgkmcnt(14)
  v_mfma_f32_32x32x16_bf16 v[172:187], a[252:255], v[120:123], v[172:187]
  s_cbranch_vccnz L_retry_292
L_ret_293:
  v_mfma_f32_16x16x32_bf16 v[204:207], a[200:203], v[20:23], v[204:207]
  s_waitcnt lgkmcnt(8)
  ds_read_b64_tr_b16 a[252:253], v247 offset:50176
  ds_read_b64_tr_b16 a[254:255], v247 offset:50688
  v_mfma_f32_32x32x16_bf16 v[156:171], a[232:235], v[124:127], v[156:171]
  s_waitcnt lgkmcnt(8)
  ds_read_b64_tr_b16 a[232:233], v248 offset:58368
  ds_read_b64_tr_b16 a[234:235], v248 offset:58880
  v_add_f32 v220, v220, v222
  v_add_f32 v221, v221, v223
  v_add_f32 v224, v224, v226
  v_add_f32 v225, v225, v227
  v_add_f32 v220, v220, v224
  v_add_f32 v221, v221, v225
  v_mov_b32 v222, v220
  v_mfma_f32_32x32x16_bf16 v[172:187], a[236:239], v[124:127], v[172:187]
  v_mfma_f32_16x16x32_bf16 v[204:207], a[204:207], v[20:23], v[204:207]
  s_waitcnt lgkmcnt(8)
  ds_read_b64_tr_b16 a[236:237], v247 offset:58368
  ds_read_b64_tr_b16 a[238:239], v247 offset:58880
  v_mfma_f32_32x32x16_bf16 v[156:171], a[240:243], v[128:131], v[156:171]
  ds_read_b64_tr_b16 a[240:241], v248 offset:51200
  ds_read_b64_tr_b16 a[242:243], v248 offset:51712
  s_waitcnt vmcnt(5)
  v_bitop3_b32 v254, v132, v136, 1 bitop3:0x7e
  v_and_b32 v254, 0x10001, v254
  v_cmp_ne_u32 vcc, 0, v254
  s_waitcnt lgkmcnt(10)
  v_mfma_f32_32x32x16_bf16 v[172:187], a[244:247], v[128:131], v[172:187]
  s_cbranch_vccnz L_retry_295
L_ret_296:
  v_mfma_f32_16x16x32_bf16 v[204:207], a[208:211], v[20:23], v[204:207]
  s_waitcnt lgkmcnt(8)
  ds_read_b64_tr_b16 a[244:245], v247 offset:51200
  ds_read_b64_tr_b16 a[246:247], v247 offset:51712
  v_mfma_f32_32x32x16_bf16 v[156:171], a[248:251], v[132:135], v[156:171]
  s_waitcnt lgkmcnt(8)
  ds_read_b64_tr_b16 a[248:249], v248 offset:59392
  ds_read_b64_tr_b16 a[250:251], v248 offset:59904
  v_mov_b32 v223, v221
  v_permlane32_swap_b32 v220, v222
  s_nop 0
  v_permlane32_swap_b32 v221, v223
  v_add_f32 v220, v220, v222
  v_add_f32 v221, v221, v223
  v_mul_f32 v244, 0xbb000000, v220
  v_mul_f32 v250, 0x3b000000, v221
  v_mfma_f32_32x32x16_bf16 v[172:187], a[252:255], v[132:135], v[172:187]
  v_mfma_f32_16x16x32_bf16 v[204:207], a[212:215], v[20:23], v[204:207]
  s_waitcnt lgkmcnt(8)
  ds_read_b64_tr_b16 a[252:253], v247 offset:59392
  ds_read_b64_tr_b16 a[254:255], v247 offset:59904
  v_mfma_f32_32x32x16_bf16 v[156:171], a[232:235], v[136:139], v[156:171]
  ds_read_b64_tr_b16 a[232:233], v248 offset:52224
  ds_read_b64_tr_b16 a[234:235], v248 offset:52736
  s_waitcnt vmcnt(3)
  v_bitop3_b32 v254, v140, v144, 1 bitop3:0x7e
  v_and_b32 v254, 0x10001, v254
  v_cmp_ne_u32 vcc, 0, v254
  s_waitcnt lgkmcnt(10)
  v_mfma_f32_32x32x16_bf16 v[172:187], a[236:239], v[136:139], v[172:187]
  s_cbranch_vccnz L_retry_298
L_ret_299:
  v_mfma_f32_16x16x32_bf16 v[204:207], a[216:219], v[20:23], v[204:207]
  s_waitcnt lgkmcnt(8)
  ds_read_b64_tr_b16 a[236:237], v247 offset:52224
  ds_read_b64_tr_b16 a[238:239], v247 offset:52736
  v_mfma_f32_32x32x16_bf16 v[156:171], a[240:243], v[140:143], v[156:171]
  s_waitcnt lgkmcnt(8)
  ds_read_b64_tr_b16 a[240:241], v248 offset:60416
  ds_read_b64_tr_b16 a[242:243], v248 offset:60928
  v_fma_f32 v250, -v244, v244, v250
  v_max_f32 v250, 0, v250
  v_add_f32 v250, 0x3727c5ac, v250
  v_rsq_f32 v250, v250
  s_nop 0
  v_mul_f32 v240, 0xc0135761, v250
  v_mul_f32 v238, v250, v250
  v_mfma_f32_32x32x16_bf16 v[172:187], a[244:247], v[140:143], v[172:187]
  v_mfma_f32_16x16x32_bf16 v[204:207], a[220:223], v[20:23], v[204:207]
  s_waitcnt lgkmcnt(8)
  ds_read_b64_tr_b16 a[244:245], v247 offset:60416
  ds_read_b64_tr_b16 a[246:247], v247 offset:60928
  v_mfma_f32_32x32x16_bf16 v[156:171], a[248:251], v[144:147], v[156:171]
  ds_read_b64_tr_b16 a[248:249], v242 offset:0
  ds_read_b64_tr_b16 a[250:251], v242 offset:512
  s_waitcnt vmcnt(1)
  v_bitop3_b32 v254, v148, v152, 1 bitop3:0x7e
  v_and_b32 v254, 0x10001, v254
  v_cmp_ne_u32 vcc, 0, v254
  s_waitcnt lgkmcnt(10)
  v_mfma_f32_32x32x16_bf16 v[172:187], a[252:255], v[144:147], v[172:187]
  s_cbranch_vccnz L_retry_301
L_ret_302:
  v_mfma_f32_16x16x32_bf16 v[204:207], a[224:227], v[20:23], v[204:207]
  s_waitcnt lgkmcnt(8)
  ds_read_b64_tr_b16 a[252:253], v242 offset:8192
  ds_read_b64_tr_b16 a[254:255], v242 offset:8704
  v_mfma_f32_32x32x16_bf16 v[156:171], a[232:235], v[148:151], v[156:171]
  s_waitcnt lgkmcnt(8)
  ds_read_b128 v[220:223], v239 offset:0
  ds_read_b128 v[224:227], v239 offset:32
  ds_read_b64_tr_b16 a[232:233], v242 offset:1024
  ds_read_b64_tr_b16 a[234:235], v242 offset:1536
  v_rcp_f32 v236, v250
  v_mul_f32 v238, v238, v250
  v_mul_f32 v238, 0xbdd2d3e8, v238
  v_accvgpr_read_b32 v241, a4
  v_mfma_f32_32x32x16_bf16 v[172:187], a[236:239], v[148:151], v[172:187]
  v_mfma_f32_16x16x32_bf16 v[204:207], a[228:231], v[20:23], v[204:207]
  s_waitcnt lgkmcnt(10)
  ds_read_b64_tr_b16 a[236:237], v242 offset:9216
  ds_read_b64_tr_b16 a[238:239], v242 offset:9728
  v_mfma_f32_32x32x16_bf16 v[156:171], a[240:243], v[152:155], v[156:171]
  s_waitcnt lgkmcnt(10)
  ds_read_b64_tr_b16 a[240:241], v242 offset:2048
  ds_read_b64_tr_b16 a[242:243], v242 offset:2560
  v_mfma_f32_32x32x16_bf16 v[172:187], a[244:247], v[152:155], v[172:187]
  s_mov_b64 exec, s[80:81]
  ds_write_b128 v230, v[204:207] offset:512
  s_mov_b64 exec, -1
  s_waitcnt lgkmcnt(0)
  s_barrier
  s_nop 2
  v_pk_fma_f32 v[156:157], v[220:221], v[244:245], v[156:157] op_sel_hi:[1,0,1]
  v_pk_fma_f32 v[158:159], v[222:223], v[244:245], v[158:159] op_sel_hi:[1,0,1]
  v_pk_fma_f32 v[160:161], v[224:225], v[244:245], v[160:161] op_sel_hi:[1,0,1]
  v_pk_fma_f32 v[162:163], v[226:227], v[244:245], v[162:163] op_sel_hi:[1,0,1]
  ds_read_b128 v[220:223], v239 offset:64
  ds_read_b128 v[224:227], v239 offset:96
  s_add_u32 m0, s73, 64512
  s_add_u32 s87, s70, 0
  buffer_load_dwordx4 v234, s[36:39], s87 offen lds
  v_pk_mul_f32 v[24:25], v[156:157], v[156:157]
  v_pk_mul_f32 v[26:27], v[158:159], v[158:159]
  v_pk_fma_f32 v[24:25], v[24:25], v[238:239], v[240:241] op_sel_hi:[1,0,0]
  v_pk_fma_f32 v[26:27], v[26:27], v[238:239], v[240:241] op_sel_hi:[1,0,0]
  v_pk_mul_f32 v[24:25], v[24:25], v[156:157]
  v_pk_mul_f32 v[26:27], v[26:27], v[158:159]
  v_mfma_f32_32x32x16_bf16 v[188:203], a[248:251], v[28:31], 0
  ds_read_b64_tr_b16 a[244:245], v242 offset:10240
  ds_read_b64_tr_b16 a[246:247], v242 offset:10752
  buffer_load_dwordx4 v233, s[36:39], s87 offen offset:1024 lds
  v_exp_f32 v24, v24
  v_exp_f32 v26, v26
  v_exp_f32 v25, v25
  v_exp_f32 v27, v27
  v_pk_fma_f32 v[24:25], v[24:25], v[236:237], v[236:237] op_sel_hi:[1,0,0]
  v_pk_fma_f32 v[26:27], v[26:27], v[236:237], v[236:237] op_sel_hi:[1,0,0]
  v_mfma_f32_32x32x16_bf16 v[188:203], a[252:255], v[32:35], v[188:203]
  ds_read_b64_tr_b16 a[248:249], v242 offset:3072
  ds_read_b64_tr_b16 a[250:251], v242 offset:3584
  buffer_load_dwordx4 v232, s[36:39], s87 offen offset:2048 lds
  v_rcp_f32 v24, v24
  v_rcp_f32 v26, v26
  v_rcp_f32 v25, v25
  v_rcp_f32 v27, v27
  v_pk_mul_f32 v[24:25], v[24:25], v[156:157]
  v_pk_mul_f32 v[26:27], v[26:27], v[158:159]
  v_cvt_pk_bf16_f32 v156, v24, v25
  v_cvt_pk_bf16_f32 v157, v26, v27
  v_pk_mul_f32 v[24:25], v[160:161], v[160:161]
  v_pk_mul_f32 v[26:27], v[162:163], v[162:163]
  v_pk_fma_f32 v[24:25], v[24:25], v[238:239], v[240:241] op_sel_hi:[1,0,0]
  v_pk_fma_f32 v[26:27], v[26:27], v[238:239], v[240:241] op_sel_hi:[1,0,0]
  v_pk_mul_f32 v[24:25], v[24:25], v[160:161]
  v_pk_mul_f32 v[26:27], v[26:27], v[162:163]
  v_mfma_f32_32x32x16_bf16 v[188:203], a[232:235], v[36:39], v[188:203]
  ds_read_b64_tr_b16 a[252:253], v242 offset:11264
  buffer_load_dwordx4 v231, s[36:39], s87 offen offset:3072 lds
  ds_read_b64_tr_b16 a[254:255], v242 offset:11776
  v_exp_f32 v24, v24
  v_exp_f32 v26, v26
  v_exp_f32 v25, v25
  v_exp_f32 v27, v27
  v_pk_fma_f32 v[24:25], v[24:25], v[236:237], v[236:237] op_sel_hi:[1,0,0]
  v_pk_fma_f32 v[26:27], v[26:27], v[236:237], v[236:237] op_sel_hi:[1,0,0]
  v_mfma_f32_32x32x16_bf16 v[188:203], a[236:239], v[40:43], v[188:203]
  ds_read_b64_tr_b16 a[232:233], v242 offset:16384
  ds_read_b64_tr_b16 a[234:235], v242 offset:16896
  s_add_u32 m0, s73, 0
  s_add_u32 s87, s65, 0
  buffer_load_dwordx4 v234, s[36:39], s87 offen lds
  v_rcp_f32 v24, v24
  v_rcp_f32 v26, v26
  v_rcp_f32 v25, v25
  v_rcp_f32 v27, v27
  v_pk_mul_f32 v[24:25], v[24:25], v[160:161]
  v_pk_mul_f32 v[26:27], v[26:27], v[162:163]
  v_cvt_pk_bf16_f32 v158, v24, v25
  v_cvt_pk_bf16_f32 v159, v26, v27
  buffer_store_dwordx4 v[156:159], v241, s[16:19], s61 offen offset:0 sc1
  buffer_load_dwordx4 v233, s[36:39], s87 offen offset:1024 lds
  s_waitcnt lgkmcnt(9)
  v_pk_fma_f32 v[164:165], v[220:221], v[244:245], v[164:165] op_sel_hi:[1,0,1]
  v_pk_fma_f32 v[166:167], v[222:223], v[244:245], v[166:167] op_sel_hi:[1,0,1]
  s_waitcnt lgkmcnt(8)
  v_pk_fma_f32 v[168:169], v[224:225], v[244:245], v[168:169] op_sel_hi:[1,0,1]
  v_pk_fma_f32 v[170:171], v[226:227], v[244:245], v[170:171] op_sel_hi:[1,0,1]
  ds_read_b128 v[220:223], v239 offset:128
  ds_read_b128 v[224:227], v239 offset:160
  buffer_load_dwordx4 v232, s[36:39], s87 offen offset:2048 lds
  v_pk_mul_f32 v[24:25], v[164:165], v[164:165]
  v_pk_mul_f32 v[26:27], v[166:167], v[166:167]
  v_pk_fma_f32 v[24:25], v[24:25], v[238:239], v[240:241] op_sel_hi:[1,0,0]
  v_pk_fma_f32 v[26:27], v[26:27], v[238:239], v[240:241] op_sel_hi:[1,0,0]
  v_pk_mul_f32 v[24:25], v[24:25], v[164:165]
  v_pk_mul_f32 v[26:27], v[26:27], v[166:167]
  v_mfma_f32_32x32x16_bf16 v[188:203], a[240:243], v[44:47], v[188:203]
  s_waitcnt lgkmcnt(8)
  ds_read_b64_tr_b16 a[236:237], v242 offset:24576
  ds_read_b64_tr_b16 a[238:239], v242 offset:25088
  buffer_load_dwordx4 v231, s[36:39], s87 offen offset:3072 lds
  v_exp_f32 v24, v24
  v_exp_f32 v26, v26
  v_exp_f32 v25, v25
  v_exp_f32 v27, v27
  v_pk_fma_f32 v[24:25], v[24:25], v[236:237], v[236:237] op_sel_hi:[1,0,0]
  v_pk_fma_f32 v[26:27], v[26:27], v[236:237], v[236:237] op_sel_hi:[1,0,0]
  v_mfma_f32_32x32x16_bf16 v[188:203], a[244:247], v[48:51], v[188:203]
  ds_read_b64_tr_b16 a[240:241], v242 offset:17408
  ds_read_b64_tr_b16 a[242:243], v242 offset:17920
  s_add_u32 m0, s73, 16384
  s_add_u32 s87, s56, 0
  buffer_load_dwordx4 v234, s[36:39], s87 offen lds
  v_rcp_f32 v24, v24
  v_rcp_f32 v26, v26
  v_rcp_f32 v25, v25
  v_rcp_f32 v27, v27
  v_pk_mul_f32 v[24:25], v[24:25], v[164:165]
  v_pk_mul_f32 v[26:27], v[26:27], v[166:167]
  v_cvt_pk_bf16_f32 v164, v24, v25
  v_cvt_pk_bf16_f32 v165, v26, v27
  v_pk_mul_f32 v[24:25], v[168:169], v[168:169]
  v_pk_mul_f32 v[26:27], v[170:171], v[170:171]
  v_pk_fma_f32 v[24:25], v[24:25], v[238:239], v[240:241] op_sel_hi:[1,0,0]
  v_pk_fma_f32 v[26:27], v[26:27], v[238:239], v[240:241] op_sel_hi:[1,0,0]
  v_pk_mul_f32 v[24:25], v[24:25], v[168:169]
  v_pk_mul_f32 v[26:27], v[26:27], v[170:171]
  s_waitcnt lgkmcnt(10)
  v_mfma_f32_32x32x16_bf16 v[188:203], a[248:251], v[52:55], v[188:203]
  s_waitcnt lgkmcnt(8)
  ds_read_b64_tr_b16 a[244:245], v242 offset:25600
  buffer_load_dwordx4 v233, s[36:39], s87 offen offset:1024 lds
  ds_read_b64_tr_b16 a[246:247], v242 offset:26112
  v_exp_f32 v24, v24
  v_exp_f32 v26, v26
  v_exp_f32 v25, v25
  v_exp_f32 v27, v27
  v_pk_fma_f32 v[24:25], v[24:25], v[236:237], v[236:237] op_sel_hi:[1,0,0]
  v_pk_fma_f32 v[26:27], v[26:27], v[236:237], v[236:237] op_sel_hi:[1,0,0]
  v_mfma_f32_32x32x16_bf16 v[188:203], a[252:255], v[56:59], v[188:203]
  ds_read_b64_tr_b16 a[248:249], v242 offset:18432
  ds_read_b64_tr_b16 a[250:251], v242 offset:18944
  buffer_load_dwordx4 v232, s[36:39], s87 offen offset:2048 lds
  v_rcp_f32 v24, v24
  v_rcp_f32 v26, v26
  v_rcp_f32 v25, v25
  v_rcp_f32 v27, v27
  v_pk_mul_f32 v[24:25], v[24:25], v[168:169]
  v_pk_mul_f32 v[26:27], v[26:27], v[170:171]
  v_cvt_pk_bf16_f32 v166, v24, v25
  v_cvt_pk_bf16_f32 v167, v26, v27
  buffer_store_dwordx4 v[164:167], v241, s[16:19], s61 offen offset:512 sc1
  buffer_load_dwordx4 v231, s[36:39], s87 offen offset:3072 lds
  s_waitcnt lgkmcnt(9)
  v_pk_fma_f32 v[172:173], v[220:221], v[244:245], v[172:173] op_sel_hi:[1,0,1]
  v_pk_fma_f32 v[174:175], v[222:223], v[244:245], v[174:175] op_sel_hi:[1,0,1]
  s_waitcnt lgkmcnt(8)
  v_pk_fma_f32 v[176:177], v[224:225], v[244:245], v[176:177] op_sel_hi:[1,0,1]
  v_pk_fma_f32 v[178:179], v[226:227], v[244:245], v[178:179] op_sel_hi:[1,0,1]
  ds_read_b128 v[220:223], v239 offset:192
  ds_read_b128 v[224:227], v239 offset:224
  s_add_u32 m0, s73, 32768
  s_add_u32 s87, s70, 32768
  buffer_load_dwordx4 v234, s[36:39], s87 offen lds
  v_pk_mul_f32 v[24:25], v[172:173], v[172:173]
  v_pk_mul_f32 v[26:27], v[174:175], v[174:175]
  v_pk_fma_f32 v[24:25], v[24:25], v[238:239], v[240:241] op_sel_hi:[1,0,0]
  v_pk_fma_f32 v[26:27], v[26:27], v[238:239], v[240:241] op_sel_hi:[1,0,0]
  v_pk_mul_f32 v[24:25], v[24:25], v[172:173]
  v_pk_mul_f32 v[26:27], v[26:27], v[174:175]
  v_mfma_f32_32x32x16_bf16 v[188:203], a[232:235], v[60:63], v[188:203]
  s_waitcnt lgkmcnt(8)
  ds_read_b64_tr_b16 a[252:253], v242 offset:26624
  ds_read_b64_tr_b16 a[254:255], v242 offset:27136
  buffer_load_dwordx4 v233, s[36:39], s87 offen offset:1024 lds
  v_exp_f32 v24, v24
  v_exp_f32 v26, v26
  v_exp_f32 v25, v25
  v_exp_f32 v27, v27
  v_pk_fma_f32 v[24:25], v[24:25], v[236:237], v[236:237] op_sel_hi:[1,0,0]
  v_pk_fma_f32 v[26:27], v[26:27], v[236:237], v[236:237] op_sel_hi:[1,0,0]
  v_mfma_f32_32x32x16_bf16 v[188:203], a[236:239], v[64:67], v[188:203]
  ds_read_b64_tr_b16 a[232:233], v242 offset:19456
  ds_read_b64_tr_b16 a[234:235], v242 offset:19968
  buffer_load_dwordx4 v232, s[36:39], s87 offen offset:2048 lds
  v_rcp_f32 v24, v24
  v_rcp_f32 v26, v26
  v_rcp_f32 v25, v25
  v_rcp_f32 v27, v27
  v_pk_mul_f32 v[24:25], v[24:25], v[172:173]
  v_pk_mul_f32 v[26:27], v[26:27], v[174:175]
  v_cvt_pk_bf16_f32 v172, v24, v25
  v_cvt_pk_bf16_f32 v173, v26, v27
  v_pk_mul_f32 v[24:25], v[176:177], v[176:177]
  v_pk_mul_f32 v[26:27], v[178:179], v[178:179]
  v_pk_fma_f32 v[24:25], v[24:25], v[238:239], v[240:241] op_sel_hi:[1,0,0]
  v_pk_fma_f32 v[26:27], v[26:27], v[238:239], v[240:241] op_sel_hi:[1,0,0]
  v_pk_mul_f32 v[24:25], v[24:25], v[176:177]
  v_pk_mul_f32 v[26:27], v[26:27], v[178:179]
  s_waitcnt lgkmcnt(10)
  v_mfma_f32_32x32x16_bf16 v[188:203], a[240:243], v[68:71], v[188:203]
  s_waitcnt lgkmcnt(8)
  ds_read_b64_tr_b16 a[236:237], v242 offset:27648
  buffer_load_dwordx4 v231, s[36:39], s87 offen offset:3072 lds
  ds_read_b64_tr_b16 a[238:239], v242 offset:28160
  v_exp_f32 v24, v24
  v_exp_f32 v26, v26
  v_exp_f32 v25, v25
  v_exp_f32 v27, v27
  v_pk_fma_f32 v[24:25], v[24:25], v[236:237], v[236:237] op_sel_hi:[1,0,0]
  v_pk_fma_f32 v[26:27], v[26:27], v[236:237], v[236:237] op_sel_hi:[1,0,0]
  v_mfma_f32_32x32x16_bf16 v[188:203], a[244:247], v[72:75], v[188:203]
  ds_read_b64_tr_b16 a[240:241], v242 offset:32768
  ds_read_b64_tr_b16 a[242:243], v242 offset:33280
  s_waitcnt vmcnt(14)
  ds_read_b64_tr_b16 a[8:9], v229 offset:64512
  ds_read_b64_tr_b16 a[10:11], v229 offset:65024
  v_rcp_f32 v24, v24
  v_rcp_f32 v26, v26
  v_rcp_f32 v25, v25
  v_rcp_f32 v27, v27
  v_pk_mul_f32 v[24:25], v[24:25], v[176:177]
  v_pk_mul_f32 v[26:27], v[26:27], v[178:179]
  v_cvt_pk_bf16_f32 v174, v24, v25
  v_cvt_pk_bf16_f32 v175, v26, v27
  buffer_store_dwordx4 v[172:175], v241, s[16:19], s61 offen offset:1024 sc1
  ds_read_b64_tr_b16 a[12:13], v1 offset:64512
  ds_read_b64_tr_b16 a[14:15], v1 offset:65024
  s_waitcnt lgkmcnt(13)
  v_pk_fma_f32 v[180:181], v[220:221], v[244:245], v[180:181] op_sel_hi:[1,0,1]
  v_pk_fma_f32 v[182:183], v[222:223], v[244:245], v[182:183] op_sel_hi:[1,0,1]
  s_waitcnt lgkmcnt(12)
  v_pk_fma_f32 v[184:185], v[224:225], v[244:245], v[184:185] op_sel_hi:[1,0,1]
  v_pk_fma_f32 v[186:187], v[226:227], v[244:245], v[186:187] op_sel_hi:[1,0,1]
  ds_read_b128 v[220:223], v239 offset:256
  ds_read_b128 v[224:227], v239 offset:288
  ds_read_b64_tr_b16 a[16:17], v2 offset:64512
  ds_read_b64_tr_b16 a[18:19], v2 offset:65024
  v_pk_mul_f32 v[24:25], v[180:181], v[180:181]
  v_pk_mul_f32 v[26:27], v[182:183], v[182:183]
  v_pk_fma_f32 v[24:25], v[24:25], v[238:239], v[240:241] op_sel_hi:[1,0,0]
  v_pk_fma_f32 v[26:27], v[26:27], v[238:239], v[240:241] op_sel_hi:[1,0,0]
  v_pk_mul_f32 v[24:25], v[24:25], v[180:181]
  v_pk_mul_f32 v[26:27], v[26:27], v[182:183]
  v_mfma_f32_32x32x16_bf16 v[188:203], a[248:251], v[76:79], v[188:203]
  s_waitcnt lgkmcnt(10)
  ds_read_b64_tr_b16 a[244:245], v242 offset:40960
  ds_read_b64_tr_b16 a[246:247], v242 offset:41472
  ds_read_b64_tr_b16 a[20:21], v3 offset:64512
  ds_read_b64_tr_b16 a[22:23], v3 offset:65024
  v_exp_f32 v24, v24
  v_exp_f32 v26, v26
  v_exp_f32 v25, v25
  v_exp_f32 v27, v27
  v_pk_fma_f32 v[24:25], v[24:25], v[236:237], v[236:237] op_sel_hi:[1,0,0]
  v_pk_fma_f32 v[26:27], v[26:27], v[236:237], v[236:237] op_sel_hi:[1,0,0]
  v_mfma_f32_32x32x16_bf16 v[188:203], a[252:255], v[80:83], v[188:203]
  ds_read_b64_tr_b16 a[248:249], v242 offset:33792
  ds_read_b64_tr_b16 a[250:251], v242 offset:34304
  v_rcp_f32 v24, v24
  v_rcp_f32 v26, v26
  v_rcp_f32 v25, v25
  v_rcp_f32 v27, v27
  v_pk_mul_f32 v[24:25], v[24:25], v[180:181]
  v_pk_mul_f32 v[26:27], v[26:27], v[182:183]
  s_waitcnt vmcnt(10)
  ds_read_b64_tr_b16 a[24:25], v229 offset:0
  ds_read_b64_tr_b16 a[26:27], v229 offset:512
  v_cvt_pk_bf16_f32 v180, v24, v25
  v_cvt_pk_bf16_f32 v181, v26, v27
  v_pk_mul_f32 v[24:25], v[184:185], v[184:185]
  v_pk_mul_f32 v[26:27], v[186:187], v[186:187]
  v_pk_fma_f32 v[24:25], v[24:25], v[238:239], v[240:241] op_sel_hi:[1,0,0]
  v_pk_fma_f32 v[26:27], v[26:27], v[238:239], v[240:241] op_sel_hi:[1,0,0]
  v_pk_mul_f32 v[24:25], v[24:25], v[184:185]
  v_pk_mul_f32 v[26:27], v[26:27], v[186:187]
  v_mfma_f32_32x32x16_bf16 v[188:203], a[232:235], v[84:87], v[188:203]
  s_waitcnt lgkmcnt(4)
  ds_read_b64_tr_b16 a[252:253], v242 offset:41984
  s_add_u32 m0, s73, 64512
  s_add_u32 s87, s65, 32768
  buffer_load_dwordx4 v234, s[36:39], s87 offen lds
  ds_read_b64_tr_b16 a[254:255], v242 offset:42496
  v_exp_f32 v24, v24
  v_exp_f32 v26, v26
  v_exp_f32 v25, v25
  v_exp_f32 v27, v27
  v_pk_fma_f32 v[24:25], v[24:25], v[236:237], v[236:237] op_sel_hi:[1,0,0]
  v_pk_fma_f32 v[26:27], v[26:27], v[236:237], v[236:237] op_sel_hi:[1,0,0]
  v_mfma_f32_32x32x16_bf16 v[188:203], a[236:239], v[88:91], v[188:203]
  ds_read_b64_tr_b16 a[232:233], v242 offset:34816
  ds_read_b64_tr_b16 a[234:235], v242 offset:35328
  ds_read_b64_tr_b16 a[28:29], v1 offset:0
  ds_read_b64_tr_b16 a[30:31], v1 offset:512
  v_rcp_f32 v24, v24
  v_rcp_f32 v26, v26
  v_rcp_f32 v25, v25
  v_rcp_f32 v27, v27
  v_pk_mul_f32 v[24:25], v[24:25], v[184:185]
  v_pk_mul_f32 v[26:27], v[26:27], v[186:187]
  v_cvt_pk_bf16_f32 v182, v24, v25
  v_cvt_pk_bf16_f32 v183, v26, v27
  buffer_store_dwordx4 v[180:183], v241, s[16:19], s61 offen offset:1536 sc1
  buffer_load_dwordx4 v233, s[36:39], s87 offen offset:1024 lds
  ds_read_b64_tr_b16 a[236:237], v242 offset:43008
  ds_read_b64_tr_b16 a[238:239], v242 offset:43520
  v_mfma_f32_32x32x16_bf16 v[188:203], a[240:243], v[92:95], v[188:203]
  ds_read_b64_tr_b16 a[32:33], v2 offset:0
  ds_read_b64_tr_b16 a[34:35], v2 offset:512
  ds_read_b64_tr_b16 a[240:241], v242 offset:35840
  ds_read_b64_tr_b16 a[242:243], v242 offset:36352
  v_mfma_f32_32x32x16_bf16 v[188:203], a[244:247], v[96:99], v[188:203]
  s_waitcnt lgkmcnt(12)
  buffer_load_dwordx4 v232, s[36:39], s87 offen offset:2048 lds
  s_lshr_b32 s97, s70, 19
  ds_read_b64_tr_b16 a[244:245], v242 offset:44032
  ds_read_b64_tr_b16 a[246:247], v242 offset:44544
  v_mfma_f32_32x32x16_bf16 v[188:203], a[248:251], v[100:103], v[188:203]
  s_waitcnt lgkmcnt(10)
  ds_read_b64_tr_b16 a[36:37], v3 offset:0
  ds_read_b64_tr_b16 a[38:39], v3 offset:512
  s_lshl_b32 s97, s97, 16
  ds_read_b64_tr_b16 a[248:249], v242 offset:49152
  ds_read_b64_tr_b16 a[250:251], v242 offset:49664
  v_mfma_f32_32x32x16_bf16 v[188:203], a[252:255], v[104:107], v[188:203]
  buffer_load_dwordx4 v231, s[36:39], s87 offen offset:3072 lds
  s_waitcnt vmcnt(10)
  ds_read_b64_tr_b16 a[40:41], v229 offset:16384
  ds_read_b64_tr_b16 a[42:43], v229 offset:16896
  ds_read_b64_tr_b16 a[252:253], v242 offset:57344
  ds_read_b64_tr_b16 a[254:255], v242 offset:57856
  v_mfma_f32_32x32x16_bf16 v[188:203], a[232:235], v[108:111], v[188:203]
  s_bfe_u32 s74, s70, 262159
  s_waitcnt lgkmcnt(6)
  s_add_u32 m0, s73, 0
  s_add_u32 s87, s56, 32768
  buffer_load_dwordx4 v234, s[36:39], s87 offen lds
  ds_read_b64_tr_b16 a[232:233], v242 offset:50176
  ds_read_b64_tr_b16 a[234:235], v242 offset:50688
  v_mfma_f32_32x32x16_bf16 v[188:203], a[236:239], v[112:115], v[188:203]
  s_lshl_b32 s74, s74, 10
  ds_read_b64_tr_b16 a[236:237], v242 offset:58368
  ds_read_b64_tr_b16 a[238:239], v242 offset:58880
  v_mfma_f32_32x32x16_bf16 v[188:203], a[240:243], v[116:119], v[188:203]
  ds_read_b64_tr_b16 a[44:45], v1 offset:16384
  ds_read_b64_tr_b16 a[46:47], v1 offset:16896
  buffer_load_dwordx4 v233, s[36:39], s87 offen offset:1024 lds
  ds_read_b64_tr_b16 a[240:241], v242 offset:51200
  ds_read_b64_tr_b16 a[242:243], v242 offset:51712
  v_mfma_f32_32x32x16_bf16 v[188:203], a[244:247], v[120:123], v[188:203]
  s_add_u32 s97, s97, s74
  ds_read_b64_tr_b16 a[48:49], v2 offset:16384
  ds_read_b64_tr_b16 a[50:51], v2 offset:16896
  ds_read_b64_tr_b16 a[244:245], v242 offset:59392
  ds_read_b64_tr_b16 a[246:247], v242 offset:59904
  s_waitcnt lgkmcnt(14)
  v_mfma_f32_32x32x16_bf16 v[188:203], a[248:251], v[124:127], v[188:203]
  s_lshr_b32 s96, s65, 19
  buffer_load_dwordx4 v232, s[36:39], s87 offen offset:2048 lds
  ds_read_b64_tr_b16 a[248:249], v242 offset:52224
  ds_read_b64_tr_b16 a[250:251], v242 offset:52736
  s_waitcnt lgkmcnt(14)
  v_mfma_f32_32x32x16_bf16 v[188:203], a[252:255], v[128:131], v[188:203]
  s_waitcnt lgkmcnt(10)
  ds_read_b64_tr_b16 a[52:53], v3 offset:16384
  ds_read_b64_tr_b16 a[54:55], v3 offset:16896
  s_lshl_b32 s96, s96, 16
  ds_read_b64_tr_b16 a[252:253], v242 offset:60416
  ds_read_b64_tr_b16 a[254:255], v242 offset:60928
  v_mfma_f32_32x32x16_bf16 v[188:203], a[232:235], v[132:135], v[188:203]
  buffer_load_dwordx4 v231, s[36:39], s87 offen offset:3072 lds
  ds_read_b64_tr_b16 a[232:233], v235 offset:0
  ds_read_b64_tr_b16 a[234:235], v235 offset:512
  v_mfma_f32_32x32x16_bf16 v[188:203], a[236:239], v[136:139], v[188:203]
  s_bfe_u32 s74, s65, 262159
  s_waitcnt vmcnt(10)
  ds_read_b64_tr_b16 a[56:57], v229 offset:32768
  ds_read_b64_tr_b16 a[58:59], v229 offset:33280
  ds_read_b64_tr_b16 a[236:237], v235 offset:8192
  ds_read_b64_tr_b16 a[238:239], v235 offset:8704
  s_waitcnt lgkmcnt(14)
  v_mfma_f32_32x32x16_bf16 v[188:203], a[240:243], v[140:143], v[188:203]
  s_waitcnt lgkmcnt(8)
  s_add_u32 m0, s73, 16384
  s_add_u32 s87, s55, 0
  buffer_load_dwordx4 v234, s[36:39], s87 offen lds
  s_lshl_b32 s74, s74, 10
  ds_read_b64_tr_b16 a[240:241], v235 offset:1024
  ds_read_b64_tr_b16 a[242:243], v235 offset:1536
  v_mfma_f32_32x32x16_bf16 v[188:203], a[244:247], v[144:147], v[188:203]
  ds_read_b64_tr_b16 a[60:61], v1 offset:32768
  ds_read_b64_tr_b16 a[62:63], v1 offset:33280
  s_add_u32 s96, s96, s74
  ds_read_b64_tr_b16 a[244:245], v235 offset:9216
  ds_read_b64_tr_b16 a[246:247], v235 offset:9728
  v_mfma_f32_32x32x16_bf16 v[188:203], a[248:251], v[148:151], v[188:203]
  s_waitcnt lgkmcnt(10)
  buffer_load_dwordx4 v233, s[36:39], s87 offen offset:1024 lds
  ds_read_b64_tr_b16 a[64:65], v2 offset:32768
  ds_read_b64_tr_b16 a[66:67], v2 offset:33280
  ds_read_b64_tr_b16 a[248:249], v235 offset:2048
  ds_read_b64_tr_b16 a[250:251], v235 offset:2560
  v_mfma_f32_32x32x16_bf16 v[188:203], a[252:255], v[152:155], v[188:203]
  s_lshr_b32 s77, s56, 19
  buffer_load_dwordx4 v232, s[36:39], s87 offen offset:2048 lds
  ds_read_b64_tr_b16 a[252:253], v235 offset:10240
  ds_read_b64_tr_b16 a[254:255], v235 offset:10752
  v_mfma_f32_32x32x16_bf16 v[204:219], a[232:235], v[28:31], 0
  s_lshl_b32 s77, s77, 16
  ds_read_b64_tr_b16 a[232:233], v235 offset:3072
  ds_read_b64_tr_b16 a[234:235], v235 offset:3584
  s_waitcnt lgkmcnt(14)
  v_mfma_f32_32x32x16_bf16 v[204:219], a[236:239], v[32:35], v[204:219]
  s_waitcnt lgkmcnt(10)
  ds_read_b64_tr_b16 a[68:69], v3 offset:32768
  ds_read_b64_tr_b16 a[70:71], v3 offset:33280
  buffer_load_dwordx4 v231, s[36:39], s87 offen offset:3072 lds
  ds_read_b64_tr_b16 a[236:237], v235 offset:11264
  ds_read_b64_tr_b16 a[238:239], v235 offset:11776
  v_mfma_f32_32x32x16_bf16 v[204:219], a[240:243], v[36:39], v[204:219]
  s_waitcnt vmcnt(11)
  v_mov_b32 v255, s84
  s_mov_b64 exec, 1
  buffer_store_dword v255, off, s[16:19], s53 offset:0 sc1
  s_mov_b64 exec, -1
  s_bfe_u32 s74, s56, 262159
  s_waitcnt vmcnt(9)
  ds_read_b64_tr_b16 a[72:73], v229 offset:64512
  ds_read_b64_tr_b16 a[74:75], v229 offset:65024
  ds_read_b64_tr_b16 a[240:241], v235 offset:16384
  ds_read_b64_tr_b16 a[242:243], v235 offset:16896
  s_waitcnt lgkmcnt(14)
  v_mfma_f32_32x32x16_bf16 v[204:219], a[244:247], v[40:43], v[204:219]
  s_waitcnt lgkmcnt(6)
  v_bfe_u32 v29, v0, 1, 2
  v_mov_b32 v28, s70
  s_lshl_b32 s74, s74, 10
  s_add_u32 m0, s73, 32768
  s_add_u32 s87, s70, 65536
  buffer_load_dwordx4 v234, s[36:39], s87 offen lds
  ds_read_b64_tr_b16 a[244:245], v235 offset:24576
  ds_read_b64_tr_b16 a[246:247], v235 offset:25088
  v_mfma_f32_32x32x16_bf16 v[204:219], a[248:251], v[44:47], v[204:219]
  ds_read_b64_tr_b16 a[76:77], v1 offset:64512
  ds_read_b64_tr_b16 a[78:79], v1 offset:65024
  ds_read_b64_tr_b16 a[248:249], v235 offset:17408
  ds_read_b64_tr_b16 a[250:251], v235 offset:17920
  v_cmp_eq_u32 vcc, 1, v29
  v_mov_b32 v255, s65
  s_add_u32 s77, s77, s74
  v_mfma_f32_32x32x16_bf16 v[204:219], a[252:255], v[48:51], v[204:219]
  buffer_load_dwordx4 v233, s[36:39], s87 offen offset:1024 lds
  ds_read_b64_tr_b16 a[252:253], v235 offset:25600
  ds_read_b64_tr_b16 a[254:255], v235 offset:26112
  v_cndmask_b32 v28, v28, v255, vcc
  v_mfma_f32_32x32x16_bf16 v[204:219], a[232:235], v[52:55], v[204:219]
  s_waitcnt lgkmcnt(10)
  ds_read_b64_tr_b16 a[80:81], v2 offset:64512
  ds_read_b64_tr_b16 a[82:83], v2 offset:65024
  ds_read_b64_tr_b16 a[232:233], v235 offset:18432
  ds_read_b64_tr_b16 a[234:235], v235 offset:18944
  v_cmp_eq_u32 vcc, 2, v29
  v_mov_b32 v255, s56
  s_lshr_b32 s76, s55, 19
  v_mfma_f32_32x32x16_bf16 v[204:219], a[236:239], v[56:59], v[204:219]
  s_waitcnt lgkmcnt(12)
  buffer_load_dwordx4 v232, s[36:39], s87 offen offset:2048 lds
  ds_read_b64_tr_b16 a[236:237], v235 offset:26624
  ds_read_b64_tr_b16 a[238:239], v235 offset:27136
  v_cndmask_b32 v28, v28, v255, vcc
  s_lshl_b32 s76, s76, 16
  v_mfma_f32_32x32x16_bf16 v[204:219], a[240:243], v[60:63], v[204:219]
  s_waitcnt lgkmcnt(10)
  ds_read_b64_tr_b16 a[84:85], v3 offset:64512
  ds_read_b64_tr_b16 a[86:87], v3 offset:65024
  ds_read_b64_tr_b16 a[240:241], v235 offset:19456
  ds_read_b64_tr_b16 a[242:243], v235 offset:19968
  v_cmp_eq_u32 vcc, 3, v29
  v_mov_b32 v255, s55
  s_bfe_u32 s74, s55, 262159
  v_mfma_f32_32x32x16_bf16 v[204:219], a[244:247], v[64:67], v[204:219]
  buffer_load_dwordx4 v231, s[36:39], s87 offen offset:3072 lds
  v_cndmask_b32 v28, v28, v255, vcc
  s_waitcnt vmcnt(9)
  ds_read_b64_tr_b16 a[88:89], v229 offset:0
  ds_read_b64_tr_b16 a[90:91], v229 offset:512
  ds_read_b64_tr_b16 a[244:245], v235 offset:27648
  ds_read_b64_tr_b16 a[246:247], v235 offset:28160
  s_waitcnt lgkmcnt(14)
  v_mfma_f32_32x32x16_bf16 v[204:219], a[248:251], v[68:71], v[204:219]
  ds_read_b64_tr_b16 a[248:249], v235 offset:32768
  ds_read_b64_tr_b16 a[250:251], v235 offset:33280
  v_lshrrev_b32 v28, 17, v28
  v_and_b32 v29, 1, v0
  s_lshl_b32 s74, s74, 10
  v_mfma_f32_32x32x16_bf16 v[204:219], a[252:255], v[72:75], v[204:219]
  s_waitcnt lgkmcnt(8)
  v_lshl_add_u32 v28, v28, 2, v29
  s_add_u32 m0, s73, 64512
  s_add_u32 s87, s65, 65536
  buffer_load_dwordx4 v234, s[36:39], s87 offen lds
  s_add_u32 s76, s76, s74
  ds_read_b64_tr_b16 a[252:253], v235 offset:40960
  ds_read_b64_tr_b16 a[254:255], v235 offset:41472
  v_mfma_f32_32x32x16_bf16 v[204:219], a[232:235], v[76:79], v[204:219]
  ds_read_b64_tr_b16 a[92:93], v1 offset:0
  ds_read_b64_tr_b16 a[94:95], v1 offset:512
  buffer_load_dwordx4 v233, s[36:39], s87 offen offset:1024 lds
  ds_read_b64_tr_b16 a[232:233], v235 offset:33792
  ds_read_b64_tr_b16 a[234:235], v235 offset:34304
  s_and_b32 s91, s94, 1
  s_lshl_b32 s91, s91, 1
  v_add_u32 v28, s91, v28
  v_mfma_f32_32x32x16_bf16 v[204:219], a[236:239], v[80:83], v[204:219]
  s_waitcnt lgkmcnt(10)
  ds_read_b64_tr_b16 a[96:97], v2 offset:0
  ds_read_b64_tr_b16 a[98:99], v2 offset:512
  ds_read_b64_tr_b16 a[236:237], v235 offset:41984
  ds_read_b64_tr_b16 a[238:239], v235 offset:42496
  v_lshlrev_b32 v28, 2, v28
  v_add_u32 v32, s97, v253
  v_add_u32 v33, s96, v253
  v_add_u32 v34, s77, v253
  v_add_u32 v35, s76, v253
  v_mfma_f32_32x32x16_bf16 v[204:219], a[240:243], v[84:87], v[204:219]
  s_add_u32 s74, s95, 1
  buffer_load_dwordx4 v232, s[36:39], s87 offen offset:2048 lds
  ds_read_b64_tr_b16 a[240:241], v235 offset:34816
  ds_read_b64_tr_b16 a[242:243], v235 offset:35328
  s_waitcnt lgkmcnt(14)
  v_mfma_f32_32x32x16_bf16 v[204:219], a[244:247], v[88:91], v[204:219]
  s_waitcnt lgkmcnt(10)
  ds_read_b64_tr_b16 a[100:101], v3 offset:0
  ds_read_b64_tr_b16 a[102:103], v3 offset:512
  s_and_b32 s74, s74, 3
  ds_read_b64_tr_b16 a[244:245], v235 offset:43008
  ds_read_b64_tr_b16 a[246:247], v235 offset:43520
  v_mfma_f32_32x32x16_bf16 v[204:219], a[248:251], v[92:95], v[204:219]
  buffer_load_dwordx4 v231, s[36:39], s87 offen offset:3072 lds
  ds_read_b64_tr_b16 a[248:249], v235 offset:35840
  ds_read_b64_tr_b16 a[250:251], v235 offset:36352
  v_mfma_f32_32x32x16_bf16 v[204:219], a[252:255], v[96:99], v[204:219]
  s_lshl_b32 s74, s74, 14
  s_waitcnt vmcnt(9)
  ds_read_b64_tr_b16 a[104:105], v229 offset:16384
  ds_read_b64_tr_b16 a[106:107], v229 offset:16896
  ds_read_b64_tr_b16 a[252:253], v235 offset:44032
  ds_read_b64_tr_b16 a[254:255], v235 offset:44544
  s_waitcnt lgkmcnt(14)
  v_mfma_f32_32x32x16_bf16 v[204:219], a[232:235], v[100:103], v[204:219]
  s_waitcnt lgkmcnt(8)
  buffer_load_dword v29, v28, s[16:19], s54 offen offset:0 sc1
  s_add_u32 m0, s73, 0
  s_add_u32 s87, s56, 65536
  buffer_load_dwordx4 v234, s[36:39], s87 offen lds
  s_add_u32 s97, s74, s86
  ds_read_b64_tr_b16 a[232:233], v235 offset:49152
  ds_read_b64_tr_b16 a[234:235], v235 offset:49664
  v_mfma_f32_32x32x16_bf16 v[204:219], a[236:239], v[104:107], v[204:219]
  ds_read_b64_tr_b16 a[108:109], v1 offset:16384
  ds_read_b64_tr_b16 a[110:111], v1 offset:16896
  s_add_u32 s69, s95, 2
  ds_read_b64_tr_b16 a[236:237], v235 offset:57344
  ds_read_b64_tr_b16 a[238:239], v235 offset:57856
  v_mfma_f32_32x32x16_bf16 v[204:219], a[240:243], v[108:111], v[204:219]
  s_waitcnt lgkmcnt(10)
  buffer_load_dwordx4 v233, s[36:39], s87 offen offset:1024 lds
  ds_read_b64_tr_b16 a[112:113], v2 offset:16384
  ds_read_b64_tr_b16 a[114:115], v2 offset:16896
  ds_read_b64_tr_b16 a[240:241], v235 offset:50176
  ds_read_b64_tr_b16 a[242:243], v235 offset:50688
  v_mfma_f32_32x32x16_bf16 v[204:219], a[244:247], v[112:115], v[204:219]
  s_and_b32 s69, s69, 3
  ds_read_b64_tr_b16 a[244:245], v235 offset:58368
  ds_read_b64_tr_b16 a[246:247], v235 offset:58880
  v_mfma_f32_32x32x16_bf16 v[204:219], a[248:251], v[116:119], v[204:219]
  s_waitcnt lgkmcnt(12)
  buffer_load_dwordx4 v232, s[36:39], s87 offen offset:2048 lds
  s_lshl_b32 s69, s69, 14
  ds_read_b64_tr_b16 a[248:249], v235 offset:51200
  ds_read_b64_tr_b16 a[250:251], v235 offset:51712
  v_mfma_f32_32x32x16_bf16 v[204:219], a[252:255], v[120:123], v[204:219]
  s_waitcnt lgkmcnt(10)
  ds_read_b64_tr_b16 a[116:117], v3 offset:16384
  ds_read_b64_tr_b16 a[118:119], v3 offset:16896
  buffer_load_dwordx4 v231, s[36:39], s87 offen offset:3072 lds
  ds_read_b64_tr_b16 a[252:253], v235 offset:59392
  ds_read_b64_tr_b16 a[254:255], v235 offset:59904
  v_mfma_f32_32x32x16_bf16 v[204:219], a[232:235], v[124:127], v[204:219]
  s_add_u32 s96, s69, s86
  s_waitcnt vmcnt(9)
  ds_read_b64_tr_b16 a[120:121], v229 offset:32768
  ds_read_b64_tr_b16 a[122:123], v229 offset:33280
  ds_read_b64_tr_b16 a[232:233], v235 offset:52224
  ds_read_b64_tr_b16 a[234:235], v235 offset:52736
  s_waitcnt lgkmcnt(14)
  v_mfma_f32_32x32x16_bf16 v[204:219], a[236:239], v[128:131], v[204:219]
  s_add_u32 s68, s95, 3
  s_waitcnt lgkmcnt(6)
  s_add_u32 m0, s73, 16384
  s_add_u32 s87, s55, 65536
  buffer_load_dwordx4 v234, s[36:39], s87 offen lds
  ds_read_b64_tr_b16 a[236:237], v235 offset:60416
  ds_read_b64_tr_b16 a[238:239], v235 offset:60928
  v_mfma_f32_32x32x16_bf16 v[204:219], a[240:243], v[132:135], v[204:219]
  ds_read_b64_tr_b16 a[124:125], v1 offset:32768
  ds_read_b64_tr_b16 a[126:127], v1 offset:33280
  v_mfma_f32_32x32x16_bf16 v[204:219], a[244:247], v[136:139], v[204:219]
  s_and_b32 s68, s68, 3
  buffer_load_dwordx4 v233, s[36:39], s87 offen offset:1024 lds
  v_mfma_f32_32x32x16_bf16 v[204:219], a[248:251], v[140:143], v[204:219]
  s_lshl_b32 s68, s68, 14
  ds_read_b64_tr_b16 a[128:129], v2 offset:32768
  ds_read_b64_tr_b16 a[130:131], v2 offset:33280
  s_waitcnt lgkmcnt(10)
  v_mfma_f32_32x32x16_bf16 v[204:219], a[252:255], v[144:147], v[204:219]
  s_waitcnt lgkmcnt(6)
  buffer_load_dwordx4 v232, s[36:39], s87 offen offset:2048 lds
  s_add_u32 s77, s68, s86
  v_mfma_f32_32x32x16_bf16 v[204:219], a[232:235], v[148:151], v[204:219]
  s_waitcnt lgkmcnt(4)
  ds_read_b64_tr_b16 a[132:133], v3 offset:32768
  ds_read_b64_tr_b16 a[134:135], v3 offset:33280
  s_lshl_b32 s76, s95, 14
  v_mfma_f32_32x32x16_bf16 v[204:219], a[236:239], v[152:155], v[204:219]
  buffer_load_dwordx4 v231, s[36:39], s87 offen offset:3072 lds
  s_add_u32 s76, s76, s86
  v_pk_fma_f32 v[188:189], v[220:221], v[244:245], v[188:189] op_sel_hi:[1,0,1]
  v_pk_fma_f32 v[190:191], v[222:223], v[244:245], v[190:191] op_sel_hi:[1,0,1]
  v_pk_fma_f32 v[192:193], v[224:225], v[244:245], v[192:193] op_sel_hi:[1,0,1]
  v_pk_fma_f32 v[194:195], v[226:227], v[244:245], v[194:195] op_sel_hi:[1,0,1]
  ds_read_b128 v[220:223], v239 offset:320
  ds_read_b128 v[224:227], v239 offset:352
  v_pk_mul_f32 v[24:25], v[188:189], v[188:189]
  v_pk_mul_f32 v[26:27], v[190:191], v[190:191]
  v_pk_fma_f32 v[24:25], v[24:25], v[238:239], v[240:241] op_sel_hi:[1,0,0]
  v_pk_fma_f32 v[26:27], v[26:27], v[238:239], v[240:241] op_sel_hi:[1,0,0]
  s_waitcnt vmcnt(8)
  v_xor_b32 v254, s88, v29
  v_cmp_lt_u32 vcc, 31, v254
  s_cbranch_vccnz L_rdy_304
L_rret_305:
  v_pk_mul_f32 v[24:25], v[24:25], v[188:189]
  buffer_load_dwordx4 v[44:47], v32, s[16:19], s97 offen offset:0 sc1
  v_pk_mul_f32 v[26:27], v[26:27], v[190:191]
  v_exp_f32 v24, v24
  v_exp_f32 v26, v26
  v_exp_f32 v25, v25
  v_exp_f32 v27, v27
  v_pk_fma_f32 v[24:25], v[24:25], v[236:237], v[236:237] op_sel_hi:[1,0,0]
  v_pk_fma_f32 v[26:27], v[26:27], v[236:237], v[236:237] op_sel_hi:[1,0,0]
  v_rcp_f32 v24, v24
  buffer_load_dwordx4 v[48:51], v33, s[16:19], s97 offen offset:0 sc1
  v_rcp_f32 v26, v26
  v_rcp_f32 v25, v25
  v_rcp_f32 v27, v27
  v_pk_mul_f32 v[24:25], v[24:25], v[188:189]
  v_pk_mul_f32 v[26:27], v[26:27], v[190:191]
  v_cvt_pk_bf16_f32 v188, v24, v25
  v_cvt_pk_bf16_f32 v189, v26, v27
  v_pk_mul_f32 v[24:25], v[192:193], v[192:193]
  buffer_load_dwordx4 v[52:55], v34, s[16:19], s97 offen offset:0 sc1
  v_pk_mul_f32 v[26:27], v[194:195], v[194:195]
  v_pk_fma_f32 v[24:25], v[24:25], v[238:239], v[240:241] op_sel_hi:[1,0,0]
  v_pk_fma_f32 v[26:27], v[26:27], v[238:239], v[240:241] op_sel_hi:[1,0,0]
  v_pk_mul_f32 v[24:25], v[24:25], v[192:193]
  v_pk_mul_f32 v[26:27], v[26:27], v[194:195]
  v_exp_f32 v24, v24
  v_exp_f32 v26, v26
  v_exp_f32 v25, v25
  buffer_load_dwordx4 v[56:59], v32, s[16:19], s97 offen offset:1024 sc1
  v_exp_f32 v27, v27
  v_pk_fma_f32 v[24:25], v[24:25], v[236:237], v[236:237] op_sel_hi:[1,0,0]
  v_pk_fma_f32 v[26:27], v[26:27], v[236:237], v[236:237] op_sel_hi:[1,0,0]
  v_rcp_f32 v24, v24
  v_rcp_f32 v26, v26
  v_rcp_f32 v25, v25
  v_rcp_f32 v27, v27
  v_pk_mul_f32 v[24:25], v[24:25], v[192:193]
  buffer_load_dwordx4 v[60:63], v33, s[16:19], s97 offen offset:1024 sc1
  v_pk_mul_f32 v[26:27], v[26:27], v[194:195]
  v_cvt_pk_bf16_f32 v190, v24, v25
  v_cvt_pk_bf16_f32 v191, v26, v27
  buffer_store_dwordx4 v[188:191], v241, s[16:19], s61 offen offset:2048 sc1
  s_waitcnt lgkmcnt(1)
  v_pk_fma_f32 v[196:197], v[220:221], v[244:245], v[196:197] op_sel_hi:[1,0,1]
  v_pk_fma_f32 v[198:199], v[222:223], v[244:245], v[198:199] op_sel_hi:[1,0,1]
  s_waitcnt lgkmcnt(0)
  v_pk_fma_f32 v[200:201], v[224:225], v[244:245], v[200:201] op_sel_hi:[1,0,1]
  v_pk_fma_f32 v[202:203], v[226:227], v[244:245], v[202:203] op_sel_hi:[1,0,1]
  buffer_load_dwordx4 v[64:67], v34, s[16:19], s97 offen offset:1024 sc1
  ds_read_b128 v[220:223], v239 offset:384
  ds_read_b128 v[224:227], v239 offset:416
  buffer_load_dwordx4 v[68:71], v35, s[16:19], s97 offen offset:0 sc1
  v_pk_mul_f32 v[24:25], v[196:197], v[196:197]
  v_pk_mul_f32 v[26:27], v[198:199], v[198:199]
  v_pk_fma_f32 v[24:25], v[24:25], v[238:239], v[240:241] op_sel_hi:[1,0,0]
  v_pk_fma_f32 v[26:27], v[26:27], v[238:239], v[240:241] op_sel_hi:[1,0,0]
  v_pk_mul_f32 v[24:25], v[24:25], v[196:197]
  v_pk_mul_f32 v[26:27], v[26:27], v[198:199]
  v_exp_f32 v24, v24
  v_exp_f32 v26, v26
  v_exp_f32 v25, v25
  v_exp_f32 v27, v27
  v_pk_fma_f32 v[24:25], v[24:25], v[236:237], v[236:237] op_sel_hi:[1,0,0]
  v_pk_fma_f32 v[26:27], v[26:27], v[236:237], v[236:237] op_sel_hi:[1,0,0]
  v_rcp_f32 v24, v24
  v_rcp_f32 v26, v26
  buffer_load_dwordx4 v[72:75], v32, s[16:19], s96 offen offset:0 sc1
  v_rcp_f32 v25, v25
  v_rcp_f32 v27, v27
  v_pk_mul_f32 v[24:25], v[24:25], v[196:197]
  v_pk_mul_f32 v[26:27], v[26:27], v[198:199]
  v_cvt_pk_bf16_f32 v196, v24, v25
  v_cvt_pk_bf16_f32 v197, v26, v27
  v_pk_mul_f32 v[24:25], v[200:201], v[200:201]
  v_pk_mul_f32 v[26:27], v[202:203], v[202:203]
  buffer_load_dwordx4 v[76:79], v33, s[16:19], s96 offen offset:0 sc1
  v_pk_fma_f32 v[24:25], v[24:25], v[238:239], v[240:241] op_sel_hi:[1,0,0]
  v_pk_fma_f32 v[26:27], v[26:27], v[238:239], v[240:241] op_sel_hi:[1,0,0]
  v_pk_mul_f32 v[24:25], v[24:25], v[200:201]
  v_pk_mul_f32 v[26:27], v[26:27], v[202:203]
  v_exp_f32 v24, v24
  v_exp_f32 v26, v26
  v_exp_f32 v25, v25
  v_exp_f32 v27, v27
  buffer_load_dwordx4 v[80:83], v34, s[16:19], s96 offen offset:0 sc1
  v_pk_fma_f32 v[24:25], v[24:25], v[236:237], v[236:237] op_sel_hi:[1,0,0]
  v_pk_fma_f32 v[26:27], v[26:27], v[236:237], v[236:237] op_sel_hi:[1,0,0]
  v_rcp_f32 v24, v24
  v_rcp_f32 v26, v26
  v_rcp_f32 v25, v25
  v_rcp_f32 v27, v27
  v_pk_mul_f32 v[24:25], v[24:25], v[200:201]
  v_pk_mul_f32 v[26:27], v[26:27], v[202:203]
  buffer_load_dwordx4 v[84:87], v32, s[16:19], s96 offen offset:1024 sc1
  v_cvt_pk_bf16_f32 v198, v24, v25
  v_cvt_pk_bf16_f32 v199, v26, v27
  buffer_store_dwordx4 v[196:199], v241, s[16:19], s61 offen offset:2560 sc1
  s_waitcnt lgkmcnt(1)
  v_pk_fma_f32 v[204:205], v[220:221], v[244:245], v[204:205] op_sel_hi:[1,0,1]
  v_pk_fma_f32 v[206:207], v[222:223], v[244:245], v[206:207] op_sel_hi:[1,0,1]
  s_waitcnt lgkmcnt(0)
  v_pk_fma_f32 v[208:209], v[224:225], v[244:245], v[208:209] op_sel_hi:[1,0,1]
  v_pk_fma_f32 v[210:211], v[226:227], v[244:245], v[210:211] op_sel_hi:[1,0,1]
  ds_read_b128 v[220:223], v239 offset:448
  buffer_load_dwordx4 v[88:91], v33, s[16:19], s96 offen offset:1024 sc1
  ds_read_b128 v[224:227], v239 offset:480
  buffer_load_dwordx4 v[92:95], v34, s[16:19], s96 offen offset:1024 sc1
  v_pk_mul_f32 v[24:25], v[204:205], v[204:205]
  v_pk_mul_f32 v[26:27], v[206:207], v[206:207]
  v_pk_fma_f32 v[24:25], v[24:25], v[238:239], v[240:241] op_sel_hi:[1,0,0]
  v_pk_fma_f32 v[26:27], v[26:27], v[238:239], v[240:241] op_sel_hi:[1,0,0]
  v_pk_mul_f32 v[24:25], v[24:25], v[204:205]
  v_pk_mul_f32 v[26:27], v[26:27], v[206:207]
  v_exp_f32 v24, v24
  v_exp_f32 v26, v26
  v_exp_f32 v25, v25
  v_exp_f32 v27, v27
  v_pk_fma_f32 v[24:25], v[24:25], v[236:237], v[236:237] op_sel_hi:[1,0,0]
  v_pk_fma_f32 v[26:27], v[26:27], v[236:237], v[236:237] op_sel_hi:[1,0,0]
  v_rcp_f32 v24, v24
  v_rcp_f32 v26, v26
  v_rcp_f32 v25, v25
  buffer_load_dwordx4 v[96:99], v35, s[16:19], s96 offen offset:0 sc1
  v_rcp_f32 v27, v27
  v_pk_mul_f32 v[24:25], v[24:25], v[204:205]
  v_pk_mul_f32 v[26:27], v[26:27], v[206:207]
  v_cvt_pk_bf16_f32 v204, v24, v25
  v_cvt_pk_bf16_f32 v205, v26, v27
  v_pk_mul_f32 v[24:25], v[208:209], v[208:209]
  v_pk_mul_f32 v[26:27], v[210:211], v[210:211]
  v_pk_fma_f32 v[24:25], v[24:25], v[238:239], v[240:241] op_sel_hi:[1,0,0]
  buffer_load_dwordx4 v[100:103], v32, s[16:19], s77 offen offset:0 sc1
  v_pk_fma_f32 v[26:27], v[26:27], v[238:239], v[240:241] op_sel_hi:[1,0,0]
  v_pk_mul_f32 v[24:25], v[24:25], v[208:209]
  v_pk_mul_f32 v[26:27], v[26:27], v[210:211]
  v_exp_f32 v24, v24
  v_exp_f32 v26, v26
  v_exp_f32 v25, v25
  v_exp_f32 v27, v27
  v_pk_fma_f32 v[24:25], v[24:25], v[236:237], v[236:237] op_sel_hi:[1,0,0]
  buffer_load_dwordx4 v[104:107], v33, s[16:19], s77 offen offset:0 sc1
  v_pk_fma_f32 v[26:27], v[26:27], v[236:237], v[236:237] op_sel_hi:[1,0,0]
  v_rcp_f32 v24, v24
  s_waitcnt vmcnt(5)
  v_mov_b32 v255, s84
  s_mov_b64 exec, 1
  buffer_store_dword v255, off, s[16:19], s53 offset:256 sc1
  s_mov_b64 exec, -1
  v_rcp_f32 v26, v26
  v_rcp_f32 v25, v25
  v_rcp_f32 v27, v27
  v_pk_mul_f32 v[24:25], v[24:25], v[208:209]
  v_pk_mul_f32 v[26:27], v[26:27], v[210:211]
  v_cvt_pk_bf16_f32 v206, v24, v25
  buffer_load_dwordx4 v[108:111], v34, s[16:19], s77 offen offset:0 sc1
  v_cvt_pk_bf16_f32 v207, v26, v27
  buffer_store_dwordx4 v[204:207], v241, s[16:19], s61 offen offset:3072 sc1
  s_waitcnt lgkmcnt(1)
  v_pk_fma_f32 v[212:213], v[220:221], v[244:245], v[212:213] op_sel_hi:[1,0,1]
  v_pk_fma_f32 v[214:215], v[222:223], v[244:245], v[214:215] op_sel_hi:[1,0,1]
  s_waitcnt lgkmcnt(0)
  v_pk_fma_f32 v[216:217], v[224:225], v[244:245], v[216:217] op_sel_hi:[1,0,1]
  v_pk_fma_f32 v[218:219], v[226:227], v[244:245], v[218:219] op_sel_hi:[1,0,1]
  v_pk_mul_f32 v[24:25], v[212:213], v[212:213]
  v_pk_mul_f32 v[26:27], v[214:215], v[214:215]
  buffer_load_dwordx4 v[112:115], v32, s[16:19], s77 offen offset:1024 sc1
  v_pk_fma_f32 v[24:25], v[24:25], v[238:239], v[240:241] op_sel_hi:[1,0,0]
  v_pk_fma_f32 v[26:27], v[26:27], v[238:239], v[240:241] op_sel_hi:[1,0,0]
  v_pk_mul_f32 v[24:25], v[24:25], v[212:213]
  v_pk_mul_f32 v[26:27], v[26:27], v[214:215]
  v_exp_f32 v24, v24
  v_exp_f32 v26, v26
  v_exp_f32 v25, v25
  v_exp_f32 v27, v27
  buffer_load_dwordx4 v[116:119], v33, s[16:19], s77 offen offset:1024 sc1
  v_pk_fma_f32 v[24:25], v[24:25], v[236:237], v[236:237] op_sel_hi:[1,0,0]
  v_pk_fma_f32 v[26:27], v[26:27], v[236:237], v[236:237] op_sel_hi:[1,0,0]
  v_rcp_f32 v24, v24
  v_rcp_f32 v26, v26
  v_rcp_f32 v25, v25
  v_rcp_f32 v27, v27
  v_pk_mul_f32 v[24:25], v[24:25], v[212:213]
  v_pk_mul_f32 v[26:27], v[26:27], v[214:215]
  buffer_load_dwordx4 v[120:123], v34, s[16:19], s77 offen offset:1024 sc1
  v_cvt_pk_bf16_f32 v212, v24, v25
  v_cvt_pk_bf16_f32 v213, v26, v27
  v_pk_mul_f32 v[24:25], v[216:217], v[216:217]
  v_pk_mul_f32 v[26:27], v[218:219], v[218:219]
  v_pk_fma_f32 v[24:25], v[24:25], v[238:239], v[240:241] op_sel_hi:[1,0,0]
  v_pk_fma_f32 v[26:27], v[26:27], v[238:239], v[240:241] op_sel_hi:[1,0,0]
  v_pk_mul_f32 v[24:25], v[24:25], v[216:217]
  v_pk_mul_f32 v[26:27], v[26:27], v[218:219]
  buffer_load_dwordx4 v[124:127], v35, s[16:19], s77 offen offset:0 sc1
  v_exp_f32 v24, v24
  v_exp_f32 v26, v26
  v_exp_f32 v25, v25
  v_exp_f32 v27, v27
  v_pk_fma_f32 v[24:25], v[24:25], v[236:237], v[236:237] op_sel_hi:[1,0,0]
  v_pk_fma_f32 v[26:27], v[26:27], v[236:237], v[236:237] op_sel_hi:[1,0,0]
  v_rcp_f32 v24, v24
  v_rcp_f32 v26, v26
  buffer_load_dwordx4 v[128:131], v32, s[16:19], s76 offen offset:0 sc1
  v_rcp_f32 v25, v25
  v_rcp_f32 v27, v27
  v_pk_mul_f32 v[24:25], v[24:25], v[216:217]
  v_pk_mul_f32 v[26:27], v[26:27], v[218:219]
  v_cvt_pk_bf16_f32 v214, v24, v25
  v_cvt_pk_bf16_f32 v215, v26, v27
  buffer_store_dwordx4 v[212:215], v241, s[16:19], s61 offen offset:3584 sc1
  buffer_load_dwordx4 v[132:135], v33, s[16:19], s76 offen offset:0 sc1
  buffer_load_dwordx4 v[136:139], v34, s[16:19], s76 offen offset:0 sc1
L_p6join_246:
  v_mfma_f32_16x16x32_bf16 v[156:159], a[8:11], v[44:47], 0
  v_mfma_f32_16x16x32_bf16 v[160:163], a[12:15], v[44:47], 0
  v_mfma_f32_16x16x32_bf16 v[164:167], a[16:19], v[44:47], 0
  v_mfma_f32_16x16x32_bf16 v[168:171], a[20:23], v[44:47], 0
  v_mfma_f32_16x16x32_bf16 v[156:159], a[24:27], v[48:51], v[156:159]
  v_mfma_f32_16x16x32_bf16 v[160:163], a[28:31], v[48:51], v[160:163]
  v_mfma_f32_16x16x32_bf16 v[164:167], a[32:35], v[48:51], v[164:167]
  v_mfma_f32_16x16x32_bf16 v[168:171], a[36:39], v[48:51], v[168:171]
  v_mfma_f32_16x16x32_bf16 v[156:159], a[40:43], v[52:55], v[156:159]
  v_mfma_f32_16x16x32_bf16 v[160:163], a[44:47], v[52:55], v[160:163]
  v_mfma_f32_16x16x32_bf16 v[164:167], a[48:51], v[52:55], v[164:167]
  v_mfma_f32_16x16x32_bf16 v[168:171], a[52:55], v[52:55], v[168:171]
  v_mfma_f32_16x16x32_bf16 v[156:159], a[56:59], v[56:59], v[156:159]
  v_mfma_f32_16x16x32_bf16 v[160:163], a[60:63], v[56:59], v[160:163]
  ds_read_b64_tr_b16 a[136:137], v229 offset:64512
  ds_read_b64_tr_b16 a[138:139], v229 offset:65024
  v_mfma_f32_16x16x32_bf16 v[164:167], a[64:67], v[56:59], v[164:167]
  v_mfma_f32_16x16x32_bf16 v[168:171], a[68:71], v[56:59], v[168:171]
  s_add_u32 m0, s73, 32768
  s_add_u32 s87, s70, 98304
  buffer_load_dwordx4 v234, s[36:39], s87 offen lds
  v_mfma_f32_16x16x32_bf16 v[156:159], a[72:75], v[60:63], v[156:159]
  v_mfma_f32_16x16x32_bf16 v[160:163], a[76:79], v[60:63], v[160:163]
  ds_read_b64_tr_b16 a[140:141], v1 offset:64512
  ds_read_b64_tr_b16 a[142:143], v1 offset:65024
  v_mfma_f32_16x16x32_bf16 v[164:167], a[80:83], v[60:63], v[164:167]
  v_mfma_f32_16x16x32_bf16 v[168:171], a[84:87], v[60:63], v[168:171]
  buffer_load_dwordx4 v233, s[36:39], s87 offen offset:1024 lds
  v_mfma_f32_16x16x32_bf16 v[156:159], a[88:91], v[64:67], v[156:159]
  v_mfma_f32_16x16x32_bf16 v[160:163], a[92:95], v[64:67], v[160:163]
  ds_read_b64_tr_b16 a[144:145], v2 offset:64512
  ds_read_b64_tr_b16 a[146:147], v2 offset:65024
  v_mfma_f32_16x16x32_bf16 v[164:167], a[96:99], v[64:67], v[164:167]
  v_mfma_f32_16x16x32_bf16 v[168:171], a[100:103], v[64:67], v[168:171]
  buffer_load_dwordx4 v232, s[36:39], s87 offen offset:2048 lds
  v_mfma_f32_16x16x32_bf16 v[156:159], a[104:107], v[68:71], v[156:159]
  v_mfma_f32_16x16x32_bf16 v[160:163], a[108:111], v[68:71], v[160:163]
  ds_read_b64_tr_b16 a[148:149], v3 offset:64512
  ds_read_b64_tr_b16 a[150:151], v3 offset:65024
  v_mfma_f32_16x16x32_bf16 v[164:167], a[112:115], v[68:71], v[164:167]
  v_mfma_f32_16x16x32_bf16 v[168:171], a[116:119], v[68:71], v[168:171]
  buffer_load_dwordx4 v231, s[36:39], s87 offen offset:3072 lds
  v_mfma_f32_16x16x32_bf16 v[172:175], a[8:11], v[72:75], 0
  v_mfma_f32_16x16x32_bf16 v[176:179], a[12:15], v[72:75], 0
  ds_read_b64_tr_b16 a[152:153], v229 offset:0
  ds_read_b64_tr_b16 a[154:155], v229 offset:512
  buffer_load_dword v29, v28, s[16:19], s54 offen offset:256 sc1
  v_mfma_f32_16x16x32_bf16 v[180:183], a[16:19], v[72:75], 0
  v_mfma_f32_16x16x32_bf16 v[184:187], a[20:23], v[72:75], 0
  s_waitcnt lgkmcnt(2)
  s_add_u32 m0, s73, 64512
  s_add_u32 s87, s65, 98304
  buffer_load_dwordx4 v234, s[36:39], s87 offen lds
  v_mfma_f32_16x16x32_bf16 v[172:175], a[24:27], v[76:79], v[172:175]
  v_mfma_f32_16x16x32_bf16 v[176:179], a[28:31], v[76:79], v[176:179]
  ds_read_b64_tr_b16 a[156:157], v1 offset:0
  ds_read_b64_tr_b16 a[158:159], v1 offset:512
  v_mfma_f32_16x16x32_bf16 v[180:183], a[32:35], v[76:79], v[180:183]
  s_waitcnt vmcnt(8)
  v_mov_b32 v255, s84
  s_mov_b64 exec, 1
  buffer_store_dword v255, off, s[16:19], s53 offset:512 sc1
  s_mov_b64 exec, -1
  v_mfma_f32_16x16x32_bf16 v[184:187], a[36:39], v[76:79], v[184:187]
  buffer_load_dwordx4 v233, s[36:39], s87 offen offset:1024 lds
  v_mfma_f32_16x16x32_bf16 v[172:175], a[40:43], v[80:83], v[172:175]
  v_mfma_f32_16x16x32_bf16 v[176:179], a[44:47], v[80:83], v[176:179]
  ds_read_b64_tr_b16 a[160:161], v2 offset:0
  ds_read_b64_tr_b16 a[162:163], v2 offset:512
  v_mfma_f32_16x16x32_bf16 v[180:183], a[48:51], v[80:83], v[180:183]
  v_mfma_f32_16x16x32_bf16 v[184:187], a[52:55], v[80:83], v[184:187]
  buffer_load_dwordx4 v232, s[36:39], s87 offen offset:2048 lds
  v_mfma_f32_16x16x32_bf16 v[172:175], a[56:59], v[84:87], v[172:175]
  v_mfma_f32_16x16x32_bf16 v[176:179], a[60:63], v[84:87], v[176:179]
  ds_read_b64_tr_b16 a[164:165], v3 offset:0
  ds_read_b64_tr_b16 a[166:167], v3 offset:512
  v_mfma_f32_16x16x32_bf16 v[180:183], a[64:67], v[84:87], v[180:183]
  v_mfma_f32_16x16x32_bf16 v[184:187], a[68:71], v[84:87], v[184:187]
  buffer_load_dwordx4 v231, s[36:39], s87 offen offset:3072 lds
  v_mfma_f32_16x16x32_bf16 v[172:175], a[72:75], v[88:91], v[172:175]
  v_mfma_f32_16x16x32_bf16 v[176:179], a[76:79], v[88:91], v[176:179]
  ds_read_b64_tr_b16 a[168:169], v229 offset:16384
  ds_read_b64_tr_b16 a[170:171], v229 offset:16896
  v_mfma_f32_16x16x32_bf16 v[180:183], a[80:83], v[88:91], v[180:183]
  v_mfma_f32_16x16x32_bf16 v[184:187], a[84:87], v[88:91], v[184:187]
  s_waitcnt lgkmcnt(2)
  s_add_u32 m0, s73, 0
  s_add_u32 s87, s56, 98304
  buffer_load_dwordx4 v234, s[36:39], s87 offen lds
  v_mfma_f32_16x16x32_bf16 v[172:175], a[88:91], v[92:95], v[172:175]
  v_mfma_f32_16x16x32_bf16 v[176:179], a[92:95], v[92:95], v[176:179]
  ds_read_b64_tr_b16 a[172:173], v1 offset:16384
  ds_read_b64_tr_b16 a[174:175], v1 offset:16896
  v_mfma_f32_16x16x32_bf16 v[180:183], a[96:99], v[92:95], v[180:183]
  v_mfma_f32_16x16x32_bf16 v[184:187], a[100:103], v[92:95], v[184:187]
  buffer_load_dwordx4 v233, s[36:39], s87 offen offset:1024 lds
  v_mfma_f32_16x16x32_bf16 v[172:175], a[104:107], v[96:99], v[172:175]
  s_waitcnt vmcnt(7)
  v_xor_b32 v254, s88, v29
  v_mfma_f32_16x16x32_bf16 v[176:179], a[108:111], v[96:99], v[176:179]
  ds_read_b64_tr_b16 a[176:177], v2 offset:16384
  ds_read_b64_tr_b16 a[178:179], v2 offset:16896
  v_cmp_lt_u32 vcc, 31, v254
  v_mfma_f32_16x16x32_bf16 v[180:183], a[112:115], v[96:99], v[180:183]
  v_mfma_f32_16x16x32_bf16 v[184:187], a[116:119], v[96:99], v[184:187]
  buffer_load_dwordx4 v232, s[36:39], s87 offen offset:2048 lds
  s_cbranch_vccnz L_rdy_307
L_rret_308:
  v_mfma_f32_16x16x32_bf16 v[188:191], a[8:11], v[100:103], 0
  buffer_load_dwordx4 v[140:143], v32, s[16:19], s97 offen offset:2048 sc1
  v_mfma_f32_16x16x32_bf16 v[192:195], a[12:15], v[100:103], 0
  ds_read_b64_tr_b16 a[180:181], v3 offset:16384
  ds_read_b64_tr_b16 a[182:183], v3 offset:16896
  v_mfma_f32_16x16x32_bf16 v[196:199], a[16:19], v[100:103], 0
  v_mfma_f32_16x16x32_bf16 v[200:203], a[20:23], v[100:103], 0
  buffer_load_dwordx4 v231, s[36:39], s87 offen offset:3072 lds
  v_mfma_f32_16x16x32_bf16 v[188:191], a[24:27], v[104:107], v[188:191]
  buffer_load_dwordx4 v[144:147], v33, s[16:19], s97 offen offset:2048 sc1
  v_mfma_f32_16x16x32_bf16 v[192:195], a[28:31], v[104:107], v[192:195]
  ds_read_b64_tr_b16 a[184:185], v229 offset:32768
  ds_read_b64_tr_b16 a[186:187], v229 offset:33280
  v_mfma_f32_16x16x32_bf16 v[196:199], a[32:35], v[104:107], v[196:199]
  v_mfma_f32_16x16x32_bf16 v[200:203], a[36:39], v[104:107], v[200:203]
  ds_read_b64_tr_b16 a[188:189], v1 offset:32768
  ds_read_b64_tr_b16 a[190:191], v1 offset:33280
  v_mfma_f32_16x16x32_bf16 v[188:191], a[40:43], v[108:111], v[188:191]
  buffer_load_dwordx4 v[148:151], v34, s[16:19], s97 offen offset:2048 sc1
  v_mfma_f32_16x16x32_bf16 v[192:195], a[44:47], v[108:111], v[192:195]
  ds_read_b64_tr_b16 a[192:193], v2 offset:32768
  ds_read_b64_tr_b16 a[194:195], v2 offset:33280
  v_mfma_f32_16x16x32_bf16 v[196:199], a[48:51], v[108:111], v[196:199]
  v_mfma_f32_16x16x32_bf16 v[200:203], a[52:55], v[108:111], v[200:203]
  ds_read_b64_tr_b16 a[196:197], v3 offset:32768
  ds_read_b64_tr_b16 a[198:199], v3 offset:33280
  v_mfma_f32_16x16x32_bf16 v[188:191], a[56:59], v[112:115], v[188:191]
  buffer_load_dwordx4 v[152:155], v32, s[16:19], s96 offen offset:2048 sc1
  v_mfma_f32_16x16x32_bf16 v[192:195], a[60:63], v[112:115], v[192:195]
  s_waitcnt vmcnt(8)
  ds_read_b64_tr_b16 a[200:201], v229 offset:64512
  ds_read_b64_tr_b16 a[202:203], v229 offset:65024
  v_mfma_f32_16x16x32_bf16 v[196:199], a[64:67], v[112:115], v[196:199]
  v_mfma_f32_16x16x32_bf16 v[200:203], a[68:71], v[112:115], v[200:203]
  ds_read_b64_tr_b16 a[204:205], v1 offset:64512
  ds_read_b64_tr_b16 a[206:207], v1 offset:65024
  v_mfma_f32_16x16x32_bf16 v[188:191], a[72:75], v[116:119], v[188:191]
  buffer_load_dwordx4 v[44:47], v33, s[16:19], s96 offen offset:2048 sc1
  v_mfma_f32_16x16x32_bf16 v[192:195], a[76:79], v[116:119], v[192:195]
  ds_read_b64_tr_b16 a[208:209], v2 offset:64512
  ds_read_b64_tr_b16 a[210:211], v2 offset:65024
  buffer_load_dword v29, v28, s[16:19], s54 offen offset:512 sc1
  v_mfma_f32_16x16x32_bf16 v[196:199], a[80:83], v[116:119], v[196:199]
  v_mfma_f32_16x16x32_bf16 v[200:203], a[84:87], v[116:119], v[200:203]
  ds_read_b64_tr_b16 a[212:213], v3 offset:64512
  ds_read_b64_tr_b16 a[214:215], v3 offset:65024
  v_mfma_f32_16x16x32_bf16 v[188:191], a[88:91], v[120:123], v[188:191]
  buffer_load_dwordx4 v[48:51], v34, s[16:19], s96 offen offset:2048 sc1
  v_mfma_f32_16x16x32_bf16 v[192:195], a[92:95], v[120:123], v[192:195]
  s_waitcnt vmcnt(6)
  ds_read_b64_tr_b16 a[216:217], v229 offset:0
  ds_read_b64_tr_b16 a[218:219], v229 offset:512
  v_mfma_f32_16x16x32_bf16 v[196:199], a[96:99], v[120:123], v[196:199]
  v_mfma_f32_16x16x32_bf16 v[200:203], a[100:103], v[120:123], v[200:203]
  ds_read_b64_tr_b16 a[220:221], v1 offset:0
  ds_read_b64_tr_b16 a[222:223], v1 offset:512
  v_mfma_f32_16x16x32_bf16 v[188:191], a[104:107], v[124:127], v[188:191]
  buffer_load_dwordx4 v[52:55], v32, s[16:19], s77 offen offset:2048 sc1
  v_mfma_f32_16x16x32_bf16 v[192:195], a[108:111], v[124:127], v[192:195]
  ds_read_b64_tr_b16 a[224:225], v2 offset:0
  ds_read_b64_tr_b16 a[226:227], v2 offset:512
  v_mfma_f32_16x16x32_bf16 v[196:199], a[112:115], v[124:127], v[196:199]
  v_mfma_f32_16x16x32_bf16 v[200:203], a[116:119], v[124:127], v[200:203]
  ds_read_b64_tr_b16 a[228:229], v3 offset:0
  ds_read_b64_tr_b16 a[230:231], v3 offset:512
  v_mfma_f32_16x16x32_bf16 v[4:7], a[8:11], v[128:131], v[4:7]
  buffer_load_dwordx4 v[56:59], v33, s[16:19], s77 offen offset:2048 sc1
  v_mfma_f32_16x16x32_bf16 v[8:11], a[12:15], v[128:131], v[8:11]
  v_mfma_f32_16x16x32_bf16 v[12:15], a[16:19], v[128:131], v[12:15]
  v_mfma_f32_16x16x32_bf16 v[16:19], a[20:23], v[128:131], v[16:19]
  v_mfma_f32_16x16x32_bf16 v[4:7], a[24:27], v[132:135], v[4:7]
  buffer_load_dwordx4 v[60:63], v34, s[16:19], s77 offen offset:2048 sc1
  v_mfma_f32_16x16x32_bf16 v[8:11], a[28:31], v[132:135], v[8:11]
  v_mfma_f32_16x16x32_bf16 v[12:15], a[32:35], v[132:135], v[12:15]
  v_mfma_f32_16x16x32_bf16 v[16:19], a[36:39], v[132:135], v[16:19]
  v_mfma_f32_16x16x32_bf16 v[4:7], a[40:43], v[136:139], v[4:7]
  v_mfma_f32_16x16x32_bf16 v[8:11], a[44:47], v[136:139], v[8:11]
  v_mfma_f32_16x16x32_bf16 v[12:15], a[48:51], v[136:139], v[12:15]
  v_mfma_f32_16x16x32_bf16 v[16:19], a[52:55], v[136:139], v[16:19]
  v_mfma_f32_16x16x32_bf16 v[156:159], a[120:123], v[140:143], v[156:159]
  s_waitcnt vmcnt(4)
  v_xor_b32 v254, s88, v29
  v_mfma_f32_16x16x32_bf16 v[160:163], a[124:127], v[140:143], v[160:163]
  v_cmp_lt_u32 vcc, 31, v254
  v_mfma_f32_16x16x32_bf16 v[164:167], a[128:131], v[140:143], v[164:167]
  v_mfma_f32_16x16x32_bf16 v[168:171], a[132:135], v[140:143], v[168:171]
  s_cbranch_vccnz L_rdy_310
L_rret_311:
  v_mfma_f32_16x16x32_bf16 v[156:159], a[136:139], v[144:147], v[156:159]
  buffer_load_dwordx4 v[64:67], v35, s[16:19], s97 offen offset:2048 sc1
  v_mfma_f32_16x16x32_bf16 v[160:163], a[140:143], v[144:147], v[160:163]
  v_mfma_f32_16x16x32_bf16 v[164:167], a[144:147], v[144:147], v[164:167]
  v_mfma_f32_16x16x32_bf16 v[168:171], a[148:151], v[144:147], v[168:171]
  v_mfma_f32_16x16x32_bf16 v[156:159], a[152:155], v[148:151], v[156:159]
  buffer_load_dwordx4 v[68:71], v32, s[16:19], s97 offen offset:3072 sc1
  v_mfma_f32_16x16x32_bf16 v[160:163], a[156:159], v[148:151], v[160:163]
  v_mfma_f32_16x16x32_bf16 v[164:167], a[160:163], v[148:151], v[164:167]
  v_mfma_f32_16x16x32_bf16 v[168:171], a[164:167], v[148:151], v[168:171]
  v_mfma_f32_16x16x32_bf16 v[172:175], a[120:123], v[152:155], v[172:175]
  buffer_load_dwordx4 v[72:75], v33, s[16:19], s97 offen offset:3072 sc1
  v_mfma_f32_16x16x32_bf16 v[176:179], a[124:127], v[152:155], v[176:179]
  s_sub_u32 s91, s95, 1
  s_and_b32 s91, s91, 3
  v_mfma_f32_16x16x32_bf16 v[180:183], a[128:131], v[152:155], v[180:183]
  s_lshl_b32 s91, s91, 12
  v_mfma_f32_16x16x32_bf16 v[184:187], a[132:135], v[152:155], v[184:187]
  s_add_u32 s91, s91, 66560
  v_mfma_f32_16x16x32_bf16 v[172:175], a[136:139], v[44:47], v[172:175]
  buffer_load_dwordx4 v[76:79], v34, s[16:19], s97 offen offset:3072 sc1
  v_mfma_f32_16x16x32_bf16 v[176:179], a[140:143], v[44:47], v[176:179]
  v_add_u32 v28, s91, v253
  v_mfma_f32_16x16x32_bf16 v[180:183], a[144:147], v[44:47], v[180:183]
  v_mfma_f32_16x16x32_bf16 v[184:187], a[148:151], v[44:47], v[184:187]
  s_waitcnt vmcnt(7)
  v_mfma_f32_16x16x32_bf16 v[172:175], a[152:155], v[48:51], v[172:175]
  buffer_load_dwordx4 v[80:83], v35, s[16:19], s96 offen offset:2048 sc1
  v_mfma_f32_16x16x32_bf16 v[176:179], a[156:159], v[48:51], v[176:179]
  s_sub_u32 s91, s95, 2
  s_and_b32 s91, s91, 3
  v_mfma_f32_16x16x32_bf16 v[180:183], a[160:163], v[48:51], v[180:183]
  s_lshl_b32 s91, s91, 12
  v_mfma_f32_16x16x32_bf16 v[184:187], a[164:167], v[48:51], v[184:187]
  s_add_u32 s91, s91, 66560
  s_waitcnt vmcnt(7)
  v_mfma_f32_16x16x32_bf16 v[188:191], a[120:123], v[52:55], v[188:191]
  buffer_load_dwordx4 v[84:87], v32, s[16:19], s96 offen offset:3072 sc1
  v_mfma_f32_16x16x32_bf16 v[192:195], a[124:127], v[52:55], v[192:195]
  v_add_u32 v29, s91, v253
  v_mfma_f32_16x16x32_bf16 v[196:199], a[128:131], v[52:55], v[196:199]
  v_mfma_f32_16x16x32_bf16 v[200:203], a[132:135], v[52:55], v[200:203]
  s_waitcnt vmcnt(7)
  v_mfma_f32_16x16x32_bf16 v[188:191], a[136:139], v[56:59], v[188:191]
  buffer_load_dwordx4 v[88:91], v33, s[16:19], s96 offen offset:3072 sc1
  v_mfma_f32_16x16x32_bf16 v[192:195], a[140:143], v[56:59], v[192:195]
  s_sub_u32 s91, s95, 3
  s_and_b32 s91, s91, 3
  v_mfma_f32_16x16x32_bf16 v[196:199], a[144:147], v[56:59], v[196:199]
  s_lshl_b32 s91, s91, 12
  v_mfma_f32_16x16x32_bf16 v[200:203], a[148:151], v[56:59], v[200:203]
  s_add_u32 s91, s91, 66560
  s_waitcnt vmcnt(7)
  v_mfma_f32_16x16x32_bf16 v[188:191], a[152:155], v[60:63], v[188:191]
  buffer_load_dwordx4 v[92:95], v34, s[16:19], s96 offen offset:3072 sc1
  v_mfma_f32_16x16x32_bf16 v[192:195], a[156:159], v[60:63], v[192:195]
  v_add_u32 v249, s91, v253
  v_mfma_f32_16x16x32_bf16 v[196:199], a[160:163], v[60:63], v[196:199]
  v_mfma_f32_16x16x32_bf16 v[200:203], a[164:167], v[60:63], v[200:203]
  s_waitcnt vmcnt(7) lgkmcnt(14)
  v_mfma_f32_16x16x32_bf16 v[156:159], a[168:171], v[64:67], v[156:159]
  buffer_load_dwordx4 v[96:99], v35, s[16:19], s77 offen offset:2048 sc1
  v_mfma_f32_16x16x32_bf16 v[160:163], a[172:175], v[64:67], v[160:163]
  v_mfma_f32_16x16x32_bf16 v[164:167], a[176:179], v[64:67], v[164:167]
  v_mfma_f32_16x16x32_bf16 v[168:171], a[180:183], v[64:67], v[168:171]
  s_waitcnt vmcnt(7)
  v_mfma_f32_16x16x32_bf16 v[156:159], a[184:187], v[68:71], v[156:159]
  buffer_load_dwordx4 v[100:103], v32, s[16:19], s77 offen offset:3072 sc1
  v_mfma_f32_16x16x32_bf16 v[160:163], a[188:191], v[68:71], v[160:163]
  s_lshl_b32 s74, s94, 2
  v_lshlrev_b32 v250, 10, v252
  s_add_u32 s74, s74, s95
  v_mfma_f32_16x16x32_bf16 v[164:167], a[192:195], v[68:71], v[164:167]
  v_mfma_f32_16x16x32_bf16 v[168:171], a[196:199], v[68:71], v[168:171]
  s_lshl_b32 s74, s74, 14
  v_lshl_add_u32 v250, v251, 5, v250
  s_add_u32 s74, s74, s85
  s_waitcnt vmcnt(7)
  v_mfma_f32_16x16x32_bf16 v[156:159], a[200:203], v[72:75], v[156:159]
  s_waitcnt lgkmcnt(12)
  buffer_load_dwordx4 v[104:107], v33, s[16:19], s77 offen offset:3072 sc1
  v_mfma_f32_16x16x32_bf16 v[160:163], a[204:207], v[72:75], v[160:163]
  s_waitcnt lgkmcnt(10)
  v_mfma_f32_16x16x32_bf16 v[164:167], a[208:211], v[72:75], v[164:167]
  s_waitcnt lgkmcnt(8)
  v_mfma_f32_16x16x32_bf16 v[168:171], a[212:215], v[72:75], v[168:171]
  s_waitcnt vmcnt(7) lgkmcnt(6)
  v_mfma_f32_16x16x32_bf16 v[156:159], a[216:219], v[76:79], v[156:159]
  s_waitcnt lgkmcnt(4)
  buffer_load_dwordx4 v[108:111], v34, s[16:19], s77 offen offset:3072 sc1
  v_mfma_f32_16x16x32_bf16 v[160:163], a[220:223], v[76:79], v[160:163]
  s_waitcnt lgkmcnt(2)
  v_mfma_f32_16x16x32_bf16 v[164:167], a[224:227], v[76:79], v[164:167]
  s_waitcnt lgkmcnt(0)
  v_mfma_f32_16x16x32_bf16 v[168:171], a[228:231], v[76:79], v[168:171]
  s_waitcnt vmcnt(7)
  v_mfma_f32_16x16x32_bf16 v[172:175], a[168:171], v[80:83], v[172:175]
  buffer_load_dwordx4 v[112:115], v32, s[16:19], s76 offen offset:1024 sc1
  v_mfma_f32_16x16x32_bf16 v[176:179], a[172:175], v[80:83], v[176:179]
  v_mfma_f32_16x16x32_bf16 v[180:183], a[176:179], v[80:83], v[180:183]
  v_add_u32 v30, s73, v253
  v_mfma_f32_16x16x32_bf16 v[184:187], a[180:183], v[80:83], v[184:187]
  s_waitcnt vmcnt(7)
  v_mfma_f32_16x16x32_bf16 v[172:175], a[184:187], v[84:87], v[172:175]
  buffer_load_dwordx4 v[116:119], v33, s[16:19], s76 offen offset:1024 sc1
  v_mfma_f32_16x16x32_bf16 v[176:179], a[188:191], v[84:87], v[176:179]
  v_mfma_f32_16x16x32_bf16 v[180:183], a[192:195], v[84:87], v[180:183]
  ds_write_b128 v30, v[156:159] offset:0
  v_mfma_f32_16x16x32_bf16 v[184:187], a[196:199], v[84:87], v[184:187]
  s_waitcnt vmcnt(7)
  v_mfma_f32_16x16x32_bf16 v[172:175], a[200:203], v[88:91], v[172:175]
  buffer_load_dwordx4 v[120:123], v34, s[16:19], s76 offen offset:1024 sc1
  v_mfma_f32_16x16x32_bf16 v[176:179], a[204:207], v[88:91], v[176:179]
  ds_write_b128 v30, v[160:163] offset:1024
  v_mfma_f32_16x16x32_bf16 v[180:183], a[208:211], v[88:91], v[180:183]
  ds_write_b128 v30, v[164:167] offset:2048
  v_mfma_f32_16x16x32_bf16 v[184:187], a[212:215], v[88:91], v[184:187]
  s_waitcnt vmcnt(7)
  v_mfma_f32_16x16x32_bf16 v[172:175], a[216:219], v[92:95], v[172:175]
  buffer_load_dwordx4 v[124:127], v35, s[16:19], s76 offen offset:0 sc1
  v_mfma_f32_16x16x32_bf16 v[176:179], a[220:223], v[92:95], v[176:179]
  ds_write_b128 v30, v[168:171] offset:3072
  v_mfma_f32_16x16x32_bf16 v[180:183], a[224:227], v[92:95], v[180:183]
  v_mfma_f32_16x16x32_bf16 v[184:187], a[228:231], v[92:95], v[184:187]
  s_waitcnt vmcnt(7)
  v_mfma_f32_16x16x32_bf16 v[188:191], a[168:171], v[96:99], v[188:191]
  buffer_load_dwordx4 v[128:131], v32, s[16:19], s76 offen offset:2048 sc1
  v_mfma_f32_16x16x32_bf16 v[192:195], a[172:175], v[96:99], v[192:195]
  v_mfma_f32_16x16x32_bf16 v[196:199], a[176:179], v[96:99], v[196:199]
  v_mfma_f32_16x16x32_bf16 v[200:203], a[180:183], v[96:99], v[200:203]
  s_waitcnt vmcnt(7)
  v_mfma_f32_16x16x32_bf16 v[188:191], a[184:187], v[100:103], v[188:191]
  buffer_load_dwordx4 v[132:135], v33, s[16:19], s76 offen offset:2048 sc1
  v_mfma_f32_16x16x32_bf16 v[192:195], a[188:191], v[100:103], v[192:195]
  v_mfma_f32_16x16x32_bf16 v[196:199], a[192:195], v[100:103], v[196:199]
  ds_write_b128 v30, v[172:175] offset:16384
  v_mfma_f32_16x16x32_bf16 v[200:203], a[196:199], v[100:103], v[200:203]
  s_waitcnt vmcnt(7)
  v_mfma_f32_16x16x32_bf16 v[188:191], a[200:203], v[104:107], v[188:191]
  buffer_load_dwordx4 v[136:139], v34, s[16:19], s76 offen offset:2048 sc1
  v_mfma_f32_16x16x32_bf16 v[192:195], a[204:207], v[104:107], v[192:195]
  ds_write_b128 v30, v[176:179] offset:17408
  v_mfma_f32_16x16x32_bf16 v[196:199], a[208:211], v[104:107], v[196:199]
  ds_write_b128 v30, v[180:183] offset:18432
  v_mfma_f32_16x16x32_bf16 v[200:203], a[212:215], v[104:107], v[200:203]
  s_waitcnt vmcnt(7)
  v_mfma_f32_16x16x32_bf16 v[188:191], a[216:219], v[108:111], v[188:191]
  buffer_load_dwordx4 v[140:143], v35, s[16:19], s76 offen offset:2048 sc1
  v_mfma_f32_16x16x32_bf16 v[192:195], a[220:223], v[108:111], v[192:195]
  ds_write_b128 v30, v[184:187] offset:19456
  v_mfma_f32_16x16x32_bf16 v[196:199], a[224:227], v[108:111], v[196:199]
  v_mfma_f32_16x16x32_bf16 v[200:203], a[228:231], v[108:111], v[200:203]
  s_waitcnt vmcnt(7)
  v_mfma_f32_16x16x32_bf16 v[4:7], a[56:59], v[112:115], v[4:7]
  buffer_load_dwordx4 v[144:147], v32, s[16:19], s76 offen offset:3072 sc1
  v_mfma_f32_16x16x32_bf16 v[8:11], a[60:63], v[112:115], v[8:11]
  v_mfma_f32_16x16x32_bf16 v[12:15], a[64:67], v[112:115], v[12:15]
  v_mfma_f32_16x16x32_bf16 v[16:19], a[68:71], v[112:115], v[16:19]
  s_waitcnt vmcnt(7)
  v_mfma_f32_16x16x32_bf16 v[4:7], a[72:75], v[116:119], v[4:7]
  buffer_load_dwordx4 v[148:151], v33, s[16:19], s76 offen offset:3072 sc1
  ds_write_b128 v30, v[188:191] offset:32768
  v_mfma_f32_16x16x32_bf16 v[8:11], a[76:79], v[116:119], v[8:11]
  ds_write_b128 v30, v[192:195] offset:33792
  v_mfma_f32_16x16x32_bf16 v[12:15], a[80:83], v[116:119], v[12:15]
  ds_write_b128 v30, v[196:199] offset:34816
  v_mfma_f32_16x16x32_bf16 v[16:19], a[84:87], v[116:119], v[16:19]
  s_waitcnt vmcnt(7)
  v_mfma_f32_16x16x32_bf16 v[4:7], a[88:91], v[120:123], v[4:7]
  buffer_load_dwordx4 v[152:155], v34, s[16:19], s76 offen offset:3072 sc1
  ds_write_b128 v30, v[200:203] offset:35840
  v_mfma_f32_16x16x32_bf16 v[8:11], a[92:95], v[120:123], v[8:11]
  v_mfma_f32_16x16x32_bf16 v[12:15], a[96:99], v[120:123], v[12:15]
  v_mfma_f32_16x16x32_bf16 v[16:19], a[100:103], v[120:123], v[16:19]
  s_waitcnt vmcnt(7)
  v_mfma_f32_16x16x32_bf16 v[4:7], a[104:107], v[124:127], v[4:7]
  s_waitcnt lgkmcnt(0)
  s_barrier
  ds_read_b128 v[156:159], v28 offset:0
  ds_read_b128 v[172:175], v29 offset:16384
  ds_read_b128 v[188:191], v249 offset:32768
  v_mfma_f32_16x16x32_bf16 v[8:11], a[108:111], v[124:127], v[8:11]
  ds_read_b128 v[160:163], v28 offset:1024
  ds_read_b128 v[176:179], v29 offset:17408
  ds_read_b128 v[192:195], v249 offset:33792
  v_mfma_f32_16x16x32_bf16 v[12:15], a[112:115], v[124:127], v[12:15]
  ds_read_b128 v[164:167], v28 offset:2048
  ds_read_b128 v[180:183], v29 offset:18432
  ds_read_b128 v[196:199], v249 offset:34816
  v_mfma_f32_16x16x32_bf16 v[16:19], a[116:119], v[124:127], v[16:19]
  ds_read_b128 v[168:171], v28 offset:3072
  ds_read_b128 v[184:187], v29 offset:19456
  ds_read_b128 v[200:203], v249 offset:35840
  s_waitcnt vmcnt(6)
  v_mfma_f32_16x16x32_bf16 v[4:7], a[120:123], v[128:131], v[4:7]
  v_mfma_f32_16x16x32_bf16 v[8:11], a[124:127], v[128:131], v[8:11]
  v_mfma_f32_16x16x32_bf16 v[12:15], a[128:131], v[128:131], v[12:15]
  v_mfma_f32_16x16x32_bf16 v[16:19], a[132:135], v[128:131], v[16:19]
  s_waitcnt vmcnt(5)
  v_mfma_f32_16x16x32_bf16 v[4:7], a[136:139], v[132:135], v[4:7]
  v_mfma_f32_16x16x32_bf16 v[8:11], a[140:143], v[132:135], v[8:11]
  v_mfma_f32_16x16x32_bf16 v[12:15], a[144:147], v[132:135], v[12:15]
  v_mfma_f32_16x16x32_bf16 v[16:19], a[148:151], v[132:135], v[16:19]
  s_waitcnt vmcnt(4)
  v_mfma_f32_16x16x32_bf16 v[4:7], a[152:155], v[136:139], v[4:7]
  s_waitcnt lgkmcnt(10)
  v_add_f32 v156, v156, v172
  v_add_f32 v157, v157, v173
  v_mfma_f32_16x16x32_bf16 v[8:11], a[156:159], v[136:139], v[8:11]
  v_add_f32 v158, v158, v174
  v_add_f32 v159, v159, v175
  v_mfma_f32_16x16x32_bf16 v[12:15], a[160:163], v[136:139], v[12:15]
  s_waitcnt lgkmcnt(9)
  v_add_f32 v156, v156, v188
  v_add_f32 v157, v157, v189
  v_mfma_f32_16x16x32_bf16 v[16:19], a[164:167], v[136:139], v[16:19]
  v_add_f32 v158, v158, v190
  s_waitcnt vmcnt(3)
  v_mfma_f32_16x16x32_bf16 v[4:7], a[168:171], v[140:143], v[4:7]
  s_waitcnt lgkmcnt(7)
  v_add_f32 v159, v159, v191
  v_add_f32 v160, v160, v176
  v_mfma_f32_16x16x32_bf16 v[8:11], a[172:175], v[140:143], v[8:11]
  v_add_f32 v161, v161, v177
  v_add_f32 v162, v162, v178
  v_mfma_f32_16x16x32_bf16 v[12:15], a[176:179], v[140:143], v[12:15]
  s_waitcnt lgkmcnt(6)
  v_add_f32 v163, v163, v179
  v_add_f32 v160, v160, v192
  v_mfma_f32_16x16x32_bf16 v[16:19], a[180:183], v[140:143], v[16:19]
  v_add_f32 v161, v161, v193
  s_waitcnt vmcnt(2)
  v_mfma_f32_16x16x32_bf16 v[4:7], a[184:187], v[144:147], v[4:7]
  v_add_f32 v162, v162, v194
  v_add_f32 v163, v163, v195
  v_mfma_f32_16x16x32_bf16 v[8:11], a[188:191], v[144:147], v[8:11]
  s_waitcnt lgkmcnt(4)
  v_add_f32 v164, v164, v180
  v_add_f32 v165, v165, v181
  v_mfma_f32_16x16x32_bf16 v[12:15], a[192:195], v[144:147], v[12:15]
  v_add_f32 v166, v166, v182
  v_add_f32 v167, v167, v183
  v_mfma_f32_16x16x32_bf16 v[16:19], a[196:199], v[144:147], v[16:19]
  s_waitcnt lgkmcnt(3)
  v_add_f32 v164, v164, v196
  s_waitcnt vmcnt(1)
  v_mfma_f32_16x16x32_bf16 v[4:7], a[200:203], v[148:151], v[4:7]
  v_add_f32 v165, v165, v197
  v_add_f32 v166, v166, v198
  v_mfma_f32_16x16x32_bf16 v[8:11], a[204:207], v[148:151], v[8:11]
  v_add_f32 v167, v167, v199
  s_waitcnt lgkmcnt(1)
  v_add_f32 v168, v168, v184
  v_mfma_f32_16x16x32_bf16 v[12:15], a[208:211], v[148:151], v[12:15]
  v_add_f32 v169, v169, v185
  v_add_f32 v170, v170, v186
  v_mfma_f32_16x16x32_bf16 v[16:19], a[212:215], v[148:151], v[16:19]
  v_add_f32 v171, v171, v187
  s_waitcnt vmcnt(0)
  v_mfma_f32_16x16x32_bf16 v[4:7], a[216:219], v[152:155], v[4:7]
  s_waitcnt lgkmcnt(0)
  v_add_f32 v168, v168, v200
  v_add_f32 v169, v169, v201
  v_mfma_f32_16x16x32_bf16 v[8:11], a[220:223], v[152:155], v[8:11]
  v_add_f32 v170, v170, v202
  v_add_f32 v171, v171, v203
  v_mfma_f32_16x16x32_bf16 v[12:15], a[224:227], v[152:155], v[12:15]
  v_mfma_f32_16x16x32_bf16 v[16:19], a[228:231], v[152:155], v[16:19]
  v_pk_add_f32 v[4:5], v[4:5], v[156:157]
  v_pk_add_f32 v[6:7], v[6:7], v[158:159]
  s_nop 1
  v_pk_add_f32 v[8:9], v[8:9], v[160:161]
  v_pk_add_f32 v[10:11], v[10:11], v[162:163]
  s_nop 0
  v_pk_add_f32 v[12:13], v[12:13], v[164:165]
  v_pk_add_f32 v[14:15], v[14:15], v[166:167]
  v_pk_add_f32 v[16:17], v[16:17], v[168:169]
  v_pk_add_f32 v[18:19], v[18:19], v[170:171]
  v_cvt_pk_bf16_f32 v20, v4, v5
  v_cvt_pk_bf16_f32 v21, v6, v7
  v_cvt_pk_bf16_f32 v22, v8, v9
  v_cvt_pk_bf16_f32 v23, v10, v11
  v_cvt_pk_bf16_f32 v24, v12, v13
  v_cvt_pk_bf16_f32 v25, v14, v15
  v_cvt_pk_bf16_f32 v26, v16, v17
  v_cvt_pk_bf16_f32 v27, v18, v19
  v_permlane16_swap_b32 v20, v22
  v_permlane16_swap_b32 v24, v26
  v_permlane16_swap_b32 v21, v23
  v_permlane16_swap_b32 v25, v27
  v_permlane32_swap_b32 v20, v24
  v_permlane32_swap_b32 v22, v26
  v_permlane32_swap_b32 v21, v25
  v_permlane32_swap_b32 v23, v27
  buffer_store_dwordx4 v[20:23], v250, s[40:43], s74 offen
  buffer_store_dwordx4 v[24:27], v250, s[40:43], s74 offen offset:16
  s_endpgm
L_retry_167:
  s_sub_u32 s89, s89, 1
  s_cbranch_scc1 L_go_169
  buffer_load_dwordx4 v[28:31], v253, s[16:19], s97 offen offset:0 sc1
  buffer_load_dwordx4 v[32:35], v253, s[16:19], s97 offen offset:1024 sc1
  buffer_load_dwordx4 v[36:39], v253, s[16:19], s97 offen offset:2048 sc1
  buffer_load_dwordx4 v[40:43], v253, s[16:19], s97 offen offset:3072 sc1
  buffer_load_dwordx4 v[44:47], v253, s[16:19], s96 offen offset:0 sc1
  buffer_load_dwordx4 v[48:51], v253, s[16:19], s96 offen offset:1024 sc1
  buffer_load_dwordx4 v[52:55], v253, s[16:19], s96 offen offset:2048 sc1
  buffer_load_dwordx4 v[56:59], v253, s[16:19], s96 offen offset:3072 sc1
  buffer_load_dwordx4 v[60:63], v253, s[16:19], s77 offen offset:0 sc1
  s_waitcnt vmcnt(7)
  v_bitop3_b32 v254, v28, v32, 1 bitop3:0xa8
  v_cmp_ne_u32 vcc, 0, v254
  s_cbranch_vccnz L_retry_167
  s_branch L_ret_168
L_go_169:
  s_mov_b32 s89, 0
  s_waitcnt vmcnt(0)
  s_branch L_ret_168
L_retry_170:
  s_sub_u32 s89, s89, 1
  s_cbranch_scc1 L_go_172
  buffer_load_dwordx4 v[36:39], v253, s[16:19], s97 offen offset:2048 sc1
  buffer_load_dwordx4 v[40:43], v253, s[16:19], s97 offen offset:3072 sc1
  buffer_load_dwordx4 v[44:47], v253, s[16:19], s96 offen offset:0 sc1
  buffer_load_dwordx4 v[48:51], v253, s[16:19], s96 offen offset:1024 sc1
  buffer_load_dwordx4 v[52:55], v253, s[16:19], s96 offen offset:2048 sc1
  buffer_load_dwordx4 v[56:59], v253, s[16:19], s96 offen offset:3072 sc1
  buffer_load_dwordx4 v[60:63], v253, s[16:19], s77 offen offset:0 sc1
  buffer_load_dwordx4 v[64:67], v253, s[16:19], s77 offen offset:1024 sc1
  buffer_load_dwordx4 v[68:71], v253, s[16:19], s77 offen offset:2048 sc1
  s_waitcnt vmcnt(7)
  v_bitop3_b32 v254, v36, v40, 1 bitop3:0xa8
  v_cmp_ne_u32 vcc, 0, v254
  s_cbranch_vccnz L_retry_170
  s_branch L_ret_171
L_go_172:
  s_mov_b32 s89, 0
  s_waitcnt vmcnt(0)
  s_branch L_ret_171
L_retry_173:
  s_sub_u32 s89, s89, 1
  s_cbranch_scc1 L_go_175
  buffer_load_dwordx4 v[44:47], v253, s[16:19], s96 offen offset:0 sc1
  buffer_load_dwordx4 v[48:51], v253, s[16:19], s96 offen offset:1024 sc1
  buffer_load_dwordx4 v[52:55], v253, s[16:19], s96 offen offset:2048 sc1
  buffer_load_dwordx4 v[56:59], v253, s[16:19], s96 offen offset:3072 sc1
  buffer_load_dwordx4 v[60:63], v253, s[16:19], s77 offen offset:0 sc1
  buffer_load_dwordx4 v[64:67], v253, s[16:19], s77 offen offset:1024 sc1
  buffer_load_dwordx4 v[68:71], v253, s[16:19], s77 offen offset:2048 sc1
  buffer_load_dwordx4 v[72:75], v253, s[16:19], s77 offen offset:3072 sc1
  buffer_load_dwordx4 v[76:79], v253, s[16:19], s76 offen offset:0 sc1
  s_waitcnt vmcnt(7)
  v_bitop3_b32 v254, v44, v48, 1 bitop3:0xa8
  v_cmp_ne_u32 vcc, 0, v254
  s_cbranch_vccnz L_retry_173
  s_branch L_ret_174
L_go_175:
  s_mov_b32 s89, 0
  s_waitcnt vmcnt(0)
  s_branch L_ret_174
L_retry_176:
  s_sub_u32 s89, s89, 1
  s_cbranch_scc1 L_go_178
  buffer_load_dwordx4 v[52:55], v253, s[16:19], s96 offen offset:2048 sc1
  buffer_load_dwordx4 v[56:59], v253, s[16:19], s96 offen offset:3072 sc1
  buffer_load_dwordx4 v[60:63], v253, s[16:19], s77 offen offset:0 sc1
  buffer_load_dwordx4 v[64:67], v253, s[16:19], s77 offen offset:1024 sc1
  buffer_load_dwordx4 v[68:71], v253, s[16:19], s77 offen offset:2048 sc1
  buffer_load_dwordx4 v[72:75], v253, s[16:19], s77 offen offset:3072 sc1
  buffer_load_dwordx4 v[76:79], v253, s[16:19], s76 offen offset:0 sc1
  buffer_load_dwordx4 v[80:83], v253, s[16:19], s76 offen offset:1024 sc1
  buffer_load_dwordx4 v[84:87], v253, s[16:19], s76 offen offset:2048 sc1
  s_waitcnt vmcnt(7)
  v_bitop3_b32 v254, v52, v56, 1 bitop3:0xa8
  v_cmp_ne_u32 vcc, 0, v254
  s_cbranch_vccnz L_retry_176
  s_branch L_ret_177
L_go_178:
  s_mov_b32 s89, 0
  s_waitcnt vmcnt(0)
  s_branch L_ret_177
L_retry_179:
  s_sub_u32 s89, s89, 1
  s_cbranch_scc1 L_go_181
  buffer_load_dwordx4 v[60:63], v253, s[16:19], s77 offen offset:0 sc1
  buffer_load_dwordx4 v[64:67], v253, s[16:19], s77 offen offset:1024 sc1
  buffer_load_dwordx4 v[68:71], v253, s[16:19], s77 offen offset:2048 sc1
  buffer_load_dwordx4 v[72:75], v253, s[16:19], s77 offen offset:3072 sc1
  buffer_load_dwordx4 v[76:79], v253, s[16:19], s76 offen offset:0 sc1
  buffer_load_dwordx4 v[80:83], v253, s[16:19], s76 offen offset:1024 sc1
  buffer_load_dwordx4 v[84:87], v253, s[16:19], s76 offen offset:2048 sc1
  buffer_load_dwordx4 v[88:91], v253, s[16:19], s76 offen offset:3072 sc1
  s_waitcnt vmcnt(0)
  v_bitop3_b32 v254, v60, v64, 1 bitop3:0xa8
  v_cmp_ne_u32 vcc, 0, v254
  s_cbranch_vccnz L_retry_179
  s_branch L_ret_180
L_go_181:
  s_mov_b32 s89, 0
  s_waitcnt vmcnt(0)
  s_branch L_ret_180
L_retry_182:
  s_sub_u32 s89, s89, 1
  s_cbranch_scc1 L_go_184
  buffer_load_dwordx4 v[68:71], v253, s[16:19], s77 offen offset:2048 sc1
  buffer_load_dwordx4 v[72:75], v253, s[16:19], s77 offen offset:3072 sc1
  buffer_load_dwordx4 v[76:79], v253, s[16:19], s76 offen offset:0 sc1
  buffer_load_dwordx4 v[80:83], v253, s[16:19], s76 offen offset:1024 sc1
  buffer_load_dwordx4 v[84:87], v253, s[16:19], s76 offen offset:2048 sc1
  buffer_load_dwordx4 v[88:91], v253, s[16:19], s76 offen offset:3072 sc1
  s_waitcnt vmcnt(0)
  v_bitop3_b32 v254, v68, v72, 1 bitop3:0xa8
  v_cmp_ne_u32 vcc, 0, v254
  s_cbranch_vccnz L_retry_182
  s_branch L_ret_183
L_go_184:
  s_mov_b32 s89, 0
  s_waitcnt vmcnt(0)
  s_branch L_ret_183
L_retry_185:
  s_sub_u32 s89, s89, 1
  s_cbranch_scc1 L_go_187
  buffer_load_dwordx4 v[76:79], v253, s[16:19], s76 offen offset:0 sc1
  buffer_load_dwordx4 v[80:83], v253, s[16:19], s76 offen offset:1024 sc1
  buffer_load_dwordx4 v[84:87], v253, s[16:19], s76 offen offset:2048 sc1
  buffer_load_dwordx4 v[88:91], v253, s[16:19], s76 offen offset:3072 sc1
  s_waitcnt vmcnt(0)
  v_bitop3_b32 v254, v76, v80, 1 bitop3:0xa8
  v_cmp_ne_u32 vcc, 0, v254
  s_cbranch_vccnz L_retry_185
  s_branch L_ret_186
L_go_187:
  s_mov_b32 s89, 0
  s_waitcnt vmcnt(0)
  s_branch L_ret_186
L_retry_188:
  s_sub_u32 s89, s89, 1
  s_cbranch_scc1 L_go_190
  buffer_load_dwordx4 v[84:87], v253, s[16:19], s76 offen offset:2048 sc1
  buffer_load_dwordx4 v[88:91], v253, s[16:19], s76 offen offset:3072 sc1
  s_waitcnt vmcnt(0)
  v_bitop3_b32 v254, v84, v88, 1 bitop3:0xa8
  v_cmp_ne_u32 vcc, 0, v254
  s_cbranch_vccnz L_retry_188
  s_branch L_ret_189
L_go_190:
  s_mov_b32 s89, 0
  s_waitcnt vmcnt(0)
  s_branch L_ret_189
L_retry_191:
  s_sub_u32 s89, s89, 1
  s_cbranch_scc1 L_go_193
  buffer_load_dwordx2 v[108:109], v214, s[16:19], s70 offen sc1
  buffer_load_dwordx2 v[110:111], v214, s[16:19], s70 offen offset:128 sc1
  s_waitcnt vmcnt(0)
  v_max3_u32 v254, v108, v109, v110
  v_max_u32 v254, v254, v111
  v_cmp_eq_u32 vcc, -1, v254
  s_cbranch_vccnz L_retry_191
  s_branch L_ret_192
L_go_193:
  s_mov_b32 s89, 0
  s_waitcnt vmcnt(0)
  s_branch L_ret_192
L_rdy_194:
  s_sub_u32 s89, s89, 1
  s_cbranch_scc1 L_rgo_196
  buffer_load_dword v221, v220, s[16:19], 0 offen offset:1024 sc1
  s_waitcnt vmcnt(0)
  v_xor_b32 v254, s88, v221
  v_cmp_lt_u32 vcc, 31, v254
  s_cbranch_vccnz L_rdy_194
  s_branch L_rret_195
L_rgo_196:
  s_mov_b32 s89, 0
  s_waitcnt vmcnt(0)
  s_branch L_rret_195
L_retry_197:
  s_sub_u32 s89, s89, 1
  s_cbranch_scc1 L_go_199
  buffer_load_dwordx4 v[28:31], v253, s[16:19], s97 offen offset:0 sc1
  buffer_load_dwordx4 v[32:35], v253, s[16:19], s97 offen offset:1024 sc1
  buffer_load_dwordx4 v[36:39], v253, s[16:19], s97 offen offset:2048 sc1
  buffer_load_dwordx4 v[40:43], v253, s[16:19], s97 offen offset:3072 sc1
  buffer_load_dwordx4 v[44:47], v253, s[16:19], s96 offen offset:0 sc1
  buffer_load_dwordx4 v[48:51], v253, s[16:19], s96 offen offset:1024 sc1
  buffer_load_dwordx4 v[52:55], v253, s[16:19], s96 offen offset:2048 sc1
  buffer_load_dwordx4 v[56:59], v253, s[16:19], s96 offen offset:3072 sc1
  buffer_load_dwordx4 v[60:63], v253, s[16:19], s77 offen offset:0 sc1
  s_waitcnt vmcnt(7)
  v_bitop3_b32 v254, v28, v32, 1 bitop3:0xa8
  v_cmp_ne_u32 vcc, 0, v254
  s_cbranch_vccnz L_retry_197
  s_branch L_ret_198
L_go_199:
  s_mov_b32 s89, 0
  s_waitcnt vmcnt(0)
  s_branch L_ret_198
L_retry_200:
  s_sub_u32 s89, s89, 1
  s_cbranch_scc1 L_go_202
  buffer_load_dwordx4 v[36:39], v253, s[16:19], s97 offen offset:2048 sc1
  buffer_load_dwordx4 v[40:43], v253, s[16:19], s97 offen offset:3072 sc1
  buffer_load_dwordx4 v[44:47], v253, s[16:19], s96 offen offset:0 sc1
  buffer_load_dwordx4 v[48:51], v253, s[16:19], s96 offen offset:1024 sc1
  buffer_load_dwordx4 v[52:55], v253, s[16:19], s96 offen offset:2048 sc1
  buffer_load_dwordx4 v[56:59], v253, s[16:19], s96 offen offset:3072 sc1
  buffer_load_dwordx4 v[60:63], v253, s[16:19], s77 offen offset:0 sc1
  buffer_load_dwordx4 v[64:67], v253, s[16:19], s77 offen offset:1024 sc1
  buffer_load_dwordx4 v[68:71], v253, s[16:19], s77 offen offset:2048 sc1
  s_waitcnt vmcnt(7)
  v_bitop3_b32 v254, v36, v40, 1 bitop3:0xa8
  v_cmp_ne_u32 vcc, 0, v254
  s_cbranch_vccnz L_retry_200
  s_branch L_ret_201
L_go_202:
  s_mov_b32 s89, 0
  s_waitcnt vmcnt(0)
  s_branch L_ret_201
L_retry_203:
  s_sub_u32 s89, s89, 1
  s_cbranch_scc1 L_go_205
  buffer_load_dwordx4 v[44:47], v253, s[16:19], s96 offen offset:0 sc1
  buffer_load_dwordx4 v[48:51], v253, s[16:19], s96 offen offset:1024 sc1
  buffer_load_dwordx4 v[52:55], v253, s[16:19], s96 offen offset:2048 sc1
  buffer_load_dwordx4 v[56:59], v253, s[16:19], s96 offen offset:3072 sc1
  buffer_load_dwordx4 v[60:63], v253, s[16:19], s77 offen offset:0 sc1
  buffer_load_dwordx4 v[64:67], v253, s[16:19], s77 offen offset:1024 sc1
  buffer_load_dwordx4 v[68:71], v253, s[16:19], s77 offen offset:2048 sc1
  buffer_load_dwordx4 v[72:75], v253, s[16:19], s77 offen offset:3072 sc1
  buffer_load_dwordx4 v[76:79], v253, s[16:19], s76 offen offset:0 sc1
  s_waitcnt vmcnt(7)
  v_bitop3_b32 v254, v44, v48, 1 bitop3:0xa8
  v_cmp_ne_u32 vcc, 0, v254
  s_cbranch_vccnz L_retry_203
  s_branch L_ret_204
L_go_205:
  s_mov_b32 s89, 0
  s_waitcnt vmcnt(0)
  s_branch L_ret_204
L_retry_206:
  s_sub_u32 s89, s89, 1
  s_cbranch_scc1 L_go_208
  buffer_load_dwordx4 v[52:55], v253, s[16:19], s96 offen offset:2048 sc1
  buffer_load_dwordx4 v[56:59], v253, s[16:19], s96 offen offset:3072 sc1
  buffer_load_dwordx4 v[60:63], v253, s[16:19], s77 offen offset:0 sc1
  buffer_load_dwordx4 v[64:67], v253, s[16:19], s77 offen offset:1024 sc1
  buffer_load_dwordx4 v[68:71], v253, s[16:19], s77 offen offset:2048 sc1
  buffer_load_dwordx4 v[72:75], v253, s[16:19], s77 offen offset:3072 sc1
  buffer_load_dwordx4 v[76:79], v253, s[16:19], s76 offen offset:0 sc1
  buffer_load_dwordx4 v[80:83], v253, s[16:19], s76 offen offset:1024 sc1
  buffer_load_dwordx4 v[84:87], v253, s[16:19], s76 offen offset:2048 sc1
  s_waitcnt vmcnt(7)
  v_bitop3_b32 v254, v52, v56, 1 bitop3:0xa8
  v_cmp_ne_u32 vcc, 0, v254
  s_cbranch_vccnz L_retry_206
  s_branch L_ret_207
L_go_208:
  s_mov_b32 s89, 0
  s_waitcnt vmcnt(0)
  s_branch L_ret_207
L_retry_209:
  s_sub_u32 s89, s89, 1
  s_cbranch_scc1 L_go_211
  buffer_load_dwordx4 v[60:63], v253, s[16:19], s77 offen offset:0 sc1
  buffer_load_dwordx4 v[64:67], v253, s[16:19], s77 offen offset:1024 sc1
  buffer_load_dwordx4 v[68:71], v253, s[16:19], s77 offen offset:2048 sc1
  buffer_load_dwordx4 v[72:75], v253, s[16:19], s77 offen offset:3072 sc1
  buffer_load_dwordx4 v[76:79], v253, s[16:19], s76 offen offset:0 sc1
  buffer_load_dwordx4 v[80:83], v253, s[16:19], s76 offen offset:1024 sc1
  buffer_load_dwordx4 v[84:87], v253, s[16:19], s76 offen offset:2048 sc1
  buffer_load_dwordx4 v[88:91], v253, s[16:19], s76 offen offset:3072 sc1
  s_waitcnt vmcnt(0)
  v_bitop3_b32 v254, v60, v64, 1 bitop3:0xa8
  v_cmp_ne_u32 vcc, 0, v254
  s_cbranch_vccnz L_retry_209
  s_branch L_ret_210
L_go_211:
  s_mov_b32 s89, 0
  s_waitcnt vmcnt(0)
  s_branch L_ret_210
L_retry_212:
  s_sub_u32 s89, s89, 1
  s_cbranch_scc1 L_go_214
  buffer_load_dwordx4 v[68:71], v253, s[16:19], s77 offen offset:2048 sc1
  buffer_load_dwordx4 v[72:75], v253, s[16:19], s77 offen offset:3072 sc1
  buffer_load_dwordx4 v[76:79], v253, s[16:19], s76 offen offset:0 sc1
  buffer_load_dwordx4 v[80:83], v253, s[16:19], s76 offen offset:1024 sc1
  buffer_load_dwordx4 v[84:87], v253, s[16:19], s76 offen offset:2048 sc1
  buffer_load_dwordx4 v[88:91], v253, s[16:19], s76 offen offset:3072 sc1
  s_waitcnt vmcnt(0)
  v_bitop3_b32 v254, v68, v72, 1 bitop3:0xa8
  v_cmp_ne_u32 vcc, 0, v254
  s_cbranch_vccnz L_retry_212
  s_branch L_ret_213
L_go_214:
  s_mov_b32 s89, 0
  s_waitcnt vmcnt(0)
  s_branch L_ret_213
L_retry_215:
  s_sub_u32 s89, s89, 1
  s_cbranch_scc1 L_go_217
  buffer_load_dwordx4 v[76:79], v253, s[16:19], s76 offen offset:0 sc1
  buffer_load_dwordx4 v[80:83], v253, s[16:19], s76 offen offset:1024 sc1
  buffer_load_dwordx4 v[84:87], v253, s[16:19], s76 offen offset:2048 sc1
  buffer_load_dwordx4 v[88:91], v253, s[16:19], s76 offen offset:3072 sc1
  s_waitcnt vmcnt(0)
  v_bitop3_b32 v254, v76, v80, 1 bitop3:0xa8
  v_cmp_ne_u32 vcc, 0, v254
  s_cbranch_vccnz L_retry_215
  s_branch L_ret_216
L_go_217:
  s_mov_b32 s89, 0
  s_waitcnt vmcnt(0)
  s_branch L_ret_216
L_retry_218:
  s_sub_u32 s89, s89, 1
  s_cbranch_scc1 L_go_220
  buffer_load_dwordx4 v[84:87], v253, s[16:19], s76 offen offset:2048 sc1
  buffer_load_dwordx4 v[88:91], v253, s[16:19], s76 offen offset:3072 sc1
  s_waitcnt vmcnt(0)
  v_bitop3_b32 v254, v84, v88, 1 bitop3:0xa8
  v_cmp_ne_u32 vcc, 0, v254
  s_cbranch_vccnz L_retry_218
  s_branch L_ret_219
L_go_220:
  s_mov_b32 s89, 0
  s_waitcnt vmcnt(0)
  s_branch L_ret_219
L_retry_221:
  s_sub_u32 s89, s89, 1
  s_cbranch_scc1 L_go_223
  buffer_load_dwordx4 v[28:31], v253, s[16:19], s97 offen offset:0 sc1
  buffer_load_dwordx4 v[32:35], v253, s[16:19], s97 offen offset:1024 sc1
  buffer_load_dwordx4 v[36:39], v253, s[16:19], s97 offen offset:2048 sc1
  buffer_load_dwordx4 v[40:43], v253, s[16:19], s97 offen offset:3072 sc1
  buffer_load_dwordx4 v[44:47], v253, s[16:19], s96 offen offset:0 sc1
  buffer_load_dwordx4 v[48:51], v253, s[16:19], s96 offen offset:1024 sc1
  buffer_load_dwordx4 v[52:55], v253, s[16:19], s96 offen offset:2048 sc1
  buffer_load_dwordx4 v[56:59], v253, s[16:19], s96 offen offset:3072 sc1
  buffer_load_dwordx4 v[60:63], v201, s[16:19], s77 offen offset:0 sc1
  s_waitcnt vmcnt(7)
  v_bitop3_b32 v254, v28, v32, 1 bitop3:0x2a
  v_cmp_ne_u32 vcc, 0, v254
  s_cbranch_vccnz L_retry_221
  s_branch L_ret_222
L_go_223:
  s_mov_b32 s89, 0
  s_waitcnt vmcnt(0)
  s_branch L_ret_222
L_retry_224:
  s_sub_u32 s89, s89, 1
  s_cbranch_scc1 L_go_226
  buffer_load_dwordx4 v[36:39], v253, s[16:19], s97 offen offset:2048 sc1
  buffer_load_dwordx4 v[40:43], v253, s[16:19], s97 offen offset:3072 sc1
  buffer_load_dwordx4 v[44:47], v253, s[16:19], s96 offen offset:0 sc1
  buffer_load_dwordx4 v[48:51], v253, s[16:19], s96 offen offset:1024 sc1
  buffer_load_dwordx4 v[52:55], v253, s[16:19], s96 offen offset:2048 sc1
  buffer_load_dwordx4 v[56:59], v253, s[16:19], s96 offen offset:3072 sc1
  buffer_load_dwordx4 v[60:63], v201, s[16:19], s77 offen offset:0 sc1
  buffer_load_dwordx4 v[64:67], v201, s[16:19], s77 offen offset:1024 sc1
  buffer_load_dwordx4 v[68:71], v201, s[16:19], s77 offen offset:2048 sc1
  s_waitcnt vmcnt(7)
  v_bitop3_b32 v254, v36, v40, 1 bitop3:0x2a
  v_cmp_ne_u32 vcc, 0, v254
  s_cbranch_vccnz L_retry_224
  s_branch L_ret_225
L_go_226:
  s_mov_b32 s89, 0
  s_waitcnt vmcnt(0)
  s_branch L_ret_225
L_retry_227:
  s_sub_u32 s89, s89, 1
  s_cbranch_scc1 L_go_229
  buffer_load_dwordx4 v[44:47], v253, s[16:19], s96 offen offset:0 sc1
  buffer_load_dwordx4 v[48:51], v253, s[16:19], s96 offen offset:1024 sc1
  buffer_load_dwordx4 v[52:55], v253, s[16:19], s96 offen offset:2048 sc1
  buffer_load_dwordx4 v[56:59], v253, s[16:19], s96 offen offset:3072 sc1
  buffer_load_dwordx4 v[60:63], v201, s[16:19], s77 offen offset:0 sc1
  buffer_load_dwordx4 v[64:67], v201, s[16:19], s77 offen offset:1024 sc1
  buffer_load_dwordx4 v[68:71], v201, s[16:19], s77 offen offset:2048 sc1
  buffer_load_dwordx4 v[72:75], v201, s[16:19], s77 offen offset:3072 sc1
  buffer_load_dwordx4 v[76:79], v200, s[16:19], s76 offen offset:0 sc1
  s_waitcnt vmcnt(7)
  v_bitop3_b32 v254, v44, v48, 1 bitop3:0x2a
  v_cmp_ne_u32 vcc, 0, v254
  s_cbranch_vccnz L_retry_227
  s_branch L_ret_228
L_go_229:
  s_mov_b32 s89, 0
  s_waitcnt vmcnt(0)
  s_branch L_ret_228
L_retry_230:
  s_sub_u32 s89, s89, 1
  s_cbranch_scc1 L_go_232
  buffer_load_dwordx4 v[52:55], v253, s[16:19], s96 offen offset:2048 sc1
  buffer_load_dwordx4 v[56:59], v253, s[16:19], s96 offen offset:3072 sc1
  buffer_load_dwordx4 v[60:63], v201, s[16:19], s77 offen offset:0 sc1
  buffer_load_dwordx4 v[64:67], v201, s[16:19], s77 offen offset:1024 sc1
  buffer_load_dwordx4 v[68:71], v201, s[16:19], s77 offen offset:2048 sc1
  buffer_load_dwordx4 v[72:75], v201, s[16:19], s77 offen offset:3072 sc1
  buffer_load_dwordx4 v[76:79], v200, s[16:19], s76 offen offset:0 sc1
  buffer_load_dwordx4 v[80:83], v200, s[16:19], s76 offen offset:1024 sc1
  buffer_load_dwordx4 v[84:87], v200, s[16:19], s76 offen offset:2048 sc1
  s_waitcnt vmcnt(7)
  v_bitop3_b32 v254, v52, v56, 1 bitop3:0x2a
  v_cmp_ne_u32 vcc, 0, v254
  s_cbranch_vccnz L_retry_230
  s_branch L_ret_231
L_go_232:
  s_mov_b32 s89, 0
  s_waitcnt vmcnt(0)
  s_branch L_ret_231
L_retry_233:
  s_sub_u32 s89, s89, 1
  s_cbranch_scc1 L_go_235
  buffer_load_dwordx4 v[60:63], v201, s[16:19], s77 offen offset:0 sc1
  buffer_load_dwordx4 v[64:67], v201, s[16:19], s77 offen offset:1024 sc1
  buffer_load_dwordx4 v[68:71], v201, s[16:19], s77 offen offset:2048 sc1
  buffer_load_dwordx4 v[72:75], v201, s[16:19], s77 offen offset:3072 sc1
  buffer_load_dwordx4 v[76:79], v200, s[16:19], s76 offen offset:0 sc1
  buffer_load_dwordx4 v[80:83], v200, s[16:19], s76 offen offset:1024 sc1
  buffer_load_dwordx4 v[84:87], v200, s[16:19], s76 offen offset:2048 sc1
  buffer_load_dwordx4 v[88:91], v200, s[16:19], s76 offen offset:3072 sc1
  s_waitcnt vmcnt(0)
  v_bitop3_b32 v254, v60, v64, 1 bitop3:0x2a
  v_cmp_ne_u32 vcc, 0, v254
  s_cbranch_vccnz L_retry_233
  s_branch L_ret_234
L_go_235:
  s_mov_b32 s89, 0
  s_waitcnt vmcnt(0)
  s_branch L_ret_234
L_retry_236:
  s_sub_u32 s89, s89, 1
  s_cbranch_scc1 L_go_238
  buffer_load_dwordx4 v[68:71], v201, s[16:19], s77 offen offset:2048 sc1
  buffer_load_dwordx4 v[72:75], v201, s[16:19], s77 offen offset:3072 sc1
  buffer_load_dwordx4 v[76:79], v200, s[16:19], s76 offen offset:0 sc1
  buffer_load_dwordx4 v[80:83], v200, s[16:19], s76 offen offset:1024 sc1
  buffer_load_dwordx4 v[84:87], v200, s[16:19], s76 offen offset:2048 sc1
  buffer_load_dwordx4 v[88:91], v200, s[16:19], s76 offen offset:3072 sc1
  s_waitcnt vmcnt(0)
  v_bitop3_b32 v254, v68, v72, 1 bitop3:0x2a
  v_cmp_ne_u32 vcc, 0, v254
  s_cbranch_vccnz L_retry_236
  s_branch L_ret_237
L_go_238:
  s_mov_b32 s89, 0
  s_waitcnt vmcnt(0)
  s_branch L_ret_237
L_retry_239:
  s_sub_u32 s89, s89, 1
  s_cbranch_scc1 L_go_241
  buffer_load_dwordx4 v[76:79], v200, s[16:19], s76 offen offset:0 sc1
  buffer_load_dwordx4 v[80:83], v200, s[16:19], s76 offen offset:1024 sc1
  buffer_load_dwordx4 v[84:87], v200, s[16:19], s76 offen offset:2048 sc1
  buffer_load_dwordx4 v[88:91], v200, s[16:19], s76 offen offset:3072 sc1
  s_waitcnt vmcnt(0)
  v_bitop3_b32 v254, v76, v80, 1 bitop3:0x2a
  v_cmp_ne_u32 vcc, 0, v254
  s_cbranch_vccnz L_retry_239
  s_branch L_ret_240
L_go_241:
  s_mov_b32 s89, 0
  s_waitcnt vmcnt(0)
  s_branch L_ret_240
L_retry_242:
  s_sub_u32 s89, s89, 1
  s_cbranch_scc1 L_go_244
  buffer_load_dwordx4 v[84:87], v200, s[16:19], s76 offen offset:2048 sc1
  buffer_load_dwordx4 v[88:91], v200, s[16:19], s76 offen offset:3072 sc1
  s_waitcnt vmcnt(0)
  v_bitop3_b32 v254, v84, v88, 1 bitop3:0x2a
  v_cmp_ne_u32 vcc, 0, v254
  s_cbranch_vccnz L_retry_242
  s_branch L_ret_243
L_go_244:
  s_mov_b32 s89, 0
  s_waitcnt vmcnt(0)
  s_branch L_ret_243
L_rdy_247:
  s_sub_u32 s89, s89, 1
  s_cbranch_scc1 L_rgo_249
  buffer_load_dword v29, v28, s[16:19], s54 offen offset:0 sc1
  s_waitcnt vmcnt(0)
  v_xor_b32 v254, s88, v29
  v_cmp_lt_u32 vcc, 31, v254
  s_cbranch_vccnz L_rdy_247
  s_branch L_rret_248
L_rgo_249:
  s_mov_b32 s89, 0
  s_waitcnt vmcnt(0)
  s_branch L_rret_248
L_p6idle_245:
  s_lshr_b32 s97, s94, 1
  s_lshl_b32 s97, s97, 1
  s_and_b32 s91, s92, 1
  s_add_u32 s97, s97, s91
  s_lshl_b32 s97, s97, 2
  s_add_u32 s97, s97, s95
  s_mul_i32 s97, s97, 14336
  v_lshlrev_b32 v28, 7, v0
  buffer_load_dword a5, v28, s[36:39], s97 offen
  s_mov_b32 exec_hi, 0xffff
  s_add_u32 s72, s97, 8192
  buffer_load_dword a5, v28, s[36:39], s72 offen
  s_mov_b64 exec, -1
  s_waitcnt vmcnt(0)
  s_mul_i32 s72, s71, 14336
  s_mov_b64 exec, 0x3fff
  buffer_load_dword a5, v243, s[36:39], s72 offen
  s_mov_b64 exec, -1
  s_waitcnt vmcnt(0) lgkmcnt(0)
  s_barrier
  s_add_u32 m0, s73, 64512
  s_add_u32 s87, s70, 0
  buffer_load_dwordx4 v234, s[36:39], s87 offen lds
  buffer_load_dwordx4 v233, s[36:39], s87 offen offset:1024 lds
  buffer_load_dwordx4 v232, s[36:39], s87 offen offset:2048 lds
  buffer_load_dwordx4 v231, s[36:39], s87 offen offset:3072 lds
  s_add_u32 m0, s73, 0
  s_add_u32 s87, s65, 0
  buffer_load_dwordx4 v234, s[36:39], s87 offen lds
  buffer_load_dwordx4 v233, s[36:39], s87 offen offset:1024 lds
  buffer_load_dwordx4 v232, s[36:39], s87 offen offset:2048 lds
  buffer_load_dwordx4 v231, s[36:39], s87 offen offset:3072 lds
  s_add_u32 m0, s73, 16384
  s_add_u32 s87, s56, 0
  buffer_load_dwordx4 v234, s[36:39], s87 offen lds
  buffer_load_dwordx4 v233, s[36:39], s87 offen offset:1024 lds
  buffer_load_dwordx4 v232, s[36:39], s87 offen offset:2048 lds
  buffer_load_dwordx4 v231, s[36:39], s87 offen offset:3072 lds
  s_add_u32 m0, s73, 32768
  s_add_u32 s87, s70, 32768
  buffer_load_dwordx4 v234, s[36:39], s87 offen lds
  buffer_load_dwordx4 v233, s[36:39], s87 offen offset:1024 lds
  buffer_load_dwordx4 v232, s[36:39], s87 offen offset:2048 lds
  buffer_load_dwordx4 v231, s[36:39], s87 offen offset:3072 lds
  s_waitcnt vmcnt(12)
  ds_read_b64_tr_b16 a[8:9], v229 offset:64512
  ds_read_b64_tr_b16 a[10:11], v229 offset:65024
  ds_read_b64_tr_b16 a[12:13], v1 offset:64512
  ds_read_b64_tr_b16 a[14:15], v1 offset:65024
  ds_read_b64_tr_b16 a[16:17], v2 offset:64512
  ds_read_b64_tr_b16 a[18:19], v2 offset:65024
  ds_read_b64_tr_b16 a[20:21], v3 offset:64512
  ds_read_b64_tr_b16 a[22:23], v3 offset:65024
  s_waitcnt vmcnt(8)
  ds_read_b64_tr_b16 a[24:25], v229 offset:0
  ds_read_b64_tr_b16 a[26:27], v229 offset:512
  s_waitcnt lgkmcnt(2)
  s_add_u32 m0, s73, 64512
  s_add_u32 s87, s65, 32768
  buffer_load_dwordx4 v234, s[36:39], s87 offen lds
  ds_read_b64_tr_b16 a[28:29], v1 offset:0
  ds_read_b64_tr_b16 a[30:31], v1 offset:512
  buffer_load_dwordx4 v233, s[36:39], s87 offen offset:1024 lds
  ds_read_b64_tr_b16 a[32:33], v2 offset:0
  ds_read_b64_tr_b16 a[34:35], v2 offset:512
  buffer_load_dwordx4 v232, s[36:39], s87 offen offset:2048 lds
  ds_read_b64_tr_b16 a[36:37], v3 offset:0
  ds_read_b64_tr_b16 a[38:39], v3 offset:512
  buffer_load_dwordx4 v231, s[36:39], s87 offen offset:3072 lds
  s_waitcnt vmcnt(8)
  ds_read_b64_tr_b16 a[40:41], v229 offset:16384
  ds_read_b64_tr_b16 a[42:43], v229 offset:16896
  s_waitcnt lgkmcnt(2)
  s_add_u32 m0, s73, 0
  s_add_u32 s87, s56, 32768
  buffer_load_dwordx4 v234, s[36:39], s87 offen lds
  ds_read_b64_tr_b16 a[44:45], v1 offset:16384
  ds_read_b64_tr_b16 a[46:47], v1 offset:16896
  buffer_load_dwordx4 v233, s[36:39], s87 offen offset:1024 lds
  ds_read_b64_tr_b16 a[48:49], v2 offset:16384
  ds_read_b64_tr_b16 a[50:51], v2 offset:16896
  buffer_load_dwordx4 v232, s[36:39], s87 offen offset:2048 lds
  ds_read_b64_tr_b16 a[52:53], v3 offset:16384
  ds_read_b64_tr_b16 a[54:55], v3 offset:16896
  buffer_load_dwordx4 v231, s[36:39], s87 offen offset:3072 lds
  s_waitcnt vmcnt(8)
  ds_read_b64_tr_b16 a[56:57], v229 offset:32768
  ds_read_b64_tr_b16 a[58:59], v229 offset:33280
  s_waitcnt lgkmcnt(2)
  s_add_u32 m0, s73, 16384
  s_add_u32 s87, s55, 0
  buffer_load_dwordx4 v234, s[36:39], s87 offen lds
  ds_read_b64_tr_b16 a[60:61], v1 offset:32768
  ds_read_b64_tr_b16 a[62:63], v1 offset:33280
  buffer_load_dwordx4 v233, s[36:39], s87 offen offset:1024 lds
  ds_read_b64_tr_b16 a[64:65], v2 offset:32768
  ds_read_b64_tr_b16 a[66:67], v2 offset:33280
  buffer_load_dwordx4 v232, s[36:39], s87 offen offset:2048 lds
  ds_read_b64_tr_b16 a[68:69], v3 offset:32768
  ds_read_b64_tr_b16 a[70:71], v3 offset:33280
  buffer_load_dwordx4 v231, s[36:39], s87 offen offset:3072 lds
  s_waitcnt vmcnt(8)
  ds_read_b64_tr_b16 a[72:73], v229 offset:64512
  ds_read_b64_tr_b16 a[74:75], v229 offset:65024
  s_waitcnt lgkmcnt(2)
  s_add_u32 m0, s73, 32768
  s_add_u32 s87, s70, 65536
  buffer_load_dwordx4 v234, s[36:39], s87 offen lds
  ds_read_b64_tr_b16 a[76:77], v1 offset:64512
  ds_read_b64_tr_b16 a[78:79], v1 offset:65024
  buffer_load_dwordx4 v233, s[36:39], s87 offen offset:1024 lds
  ds_read_b64_tr_b16 a[80:81], v2 offset:64512
  ds_read_b64_tr_b16 a[82:83], v2 offset:65024
  buffer_load_dwordx4 v232, s[36:39], s87 offen offset:2048 lds
  ds_read_b64_tr_b16 a[84:85], v3 offset:64512
  ds_read_b64_tr_b16 a[86:87], v3 offset:65024
  buffer_load_dwordx4 v231, s[36:39], s87 offen offset:3072 lds
  s_waitcnt vmcnt(8)
  ds_read_b64_tr_b16 a[88:89], v229 offset:0
  ds_read_b64_tr_b16 a[90:91], v229 offset:512
  s_waitcnt lgkmcnt(2)
  s_add_u32 m0, s73, 64512
  s_add_u32 s87, s65, 65536
  buffer_load_dwordx4 v234, s[36:39], s87 offen lds
  ds_read_b64_tr_b16 a[92:93], v1 offset:0
  ds_read_b64_tr_b16 a[94:95], v1 offset:512
  buffer_load_dwordx4 v233, s[36:39], s87 offen offset:1024 lds
  ds_read_b64_tr_b16 a[96:97], v2 offset:0
  ds_read_b64_tr_b16 a[98:99], v2 offset:512
  buffer_load_dwordx4 v232, s[36:39], s87 offen offset:2048 lds
  ds_read_b64_tr_b16 a[100:101], v3 offset:0
  ds_read_b64_tr_b16 a[102:103], v3 offset:512
  buffer_load_dwordx4 v231, s[36:39], s87 offen offset:3072 lds
  s_waitcnt vmcnt(8)
  ds_read_b64_tr_b16 a[104:105], v229 offset:16384
  ds_read_b64_tr_b16 a[106:107], v229 offset:16896
  s_waitcnt lgkmcnt(2)
  s_add_u32 m0, s73, 0
  s_add_u32 s87, s56, 65536
  buffer_load_dwordx4 v234, s[36:39], s87 offen lds
  ds_read_b64_tr_b16 a[108:109], v1 offset:16384
  ds_read_b64_tr_b16 a[110:111], v1 offset:16896
  buffer_load_dwordx4 v233, s[36:39], s87 offen offset:1024 lds
  ds_read_b64_tr_b16 a[112:113], v2 offset:16384
  ds_read_b64_tr_b16 a[114:115], v2 offset:16896
  buffer_load_dwordx4 v232, s[36:39], s87 offen offset:2048 lds
  ds_read_b64_tr_b16 a[116:117], v3 offset:16384
  ds_read_b64_tr_b16 a[118:119], v3 offset:16896
  buffer_load_dwordx4 v231, s[36:39], s87 offen offset:3072 lds
  s_waitcnt vmcnt(8)
  ds_read_b64_tr_b16 a[120:121], v229 offset:32768
  ds_read_b64_tr_b16 a[122:123], v229 offset:33280
  s_waitcnt lgkmcnt(2)
  s_add_u32 m0, s73, 16384
  s_add_u32 s87, s55, 65536
  buffer_load_dwordx4 v234, s[36:39], s87 offen lds
  ds_read_b64_tr_b16 a[124:125], v1 offset:32768
  ds_read_b64_tr_b16 a[126:127], v1 offset:33280
  buffer_load_dwordx4 v233, s[36:39], s87 offen offset:1024 lds
  ds_read_b64_tr_b16 a[128:129], v2 offset:32768
  ds_read_b64_tr_b16 a[130:131], v2 offset:33280
  buffer_load_dwordx4 v232, s[36:39], s87 offen offset:2048 lds
  ds_read_b64_tr_b16 a[132:133], v3 offset:32768
  ds_read_b64_tr_b16 a[134:135], v3 offset:33280
  buffer_load_dwordx4 v231, s[36:39], s87 offen offset:3072 lds
  v_bfe_u32 v29, v0, 1, 2
  v_mov_b32 v28, s70
  v_cmp_eq_u32 vcc, 1, v29
  v_mov_b32 v255, s65
  s_nop 0
  v_cndmask_b32 v28, v28, v255, vcc
  v_cmp_eq_u32 vcc, 2, v29
  v_mov_b32 v255, s56
  s_nop 0
  v_cndmask_b32 v28, v28, v255, vcc
  v_cmp_eq_u32 vcc, 3, v29
  v_mov_b32 v255, s55
  s_nop 0
  v_cndmask_b32 v28, v28, v255, vcc
  v_lshrrev_b32 v28, 17, v28
  v_and_b32 v29, 1, v0
  v_lshl_add_u32 v28, v28, 2, v29
  s_and_b32 s91, s94, 1
  s_lshl_b32 s91, s91, 1
  v_add_u32 v28, s91, v28
  v_lshlrev_b32 v28, 2, v28
  buffer_load_dword v29, v28, s[16:19], s54 offen offset:0 sc1
  s_lshr_b32 s97, s70, 19
  s_lshl_b32 s97, s97, 16
  s_bfe_u32 s74, s70, 262159
  s_lshl_b32 s74, s74, 10
  s_add_u32 s97, s97, s74
  s_lshr_b32 s96, s65, 19
  s_lshl_b32 s96, s96, 16
  s_bfe_u32 s74, s65, 262159
  s_lshl_b32 s74, s74, 10
  s_add_u32 s96, s96, s74
  s_lshr_b32 s77, s56, 19
  s_lshl_b32 s77, s77, 16
  s_bfe_u32 s74, s56, 262159
  s_lshl_b32 s74, s74, 10
  s_add_u32 s77, s77, s74
  s_lshr_b32 s76, s55, 19
  s_lshl_b32 s76, s76, 16
  s_bfe_u32 s74, s55, 262159
  s_lshl_b32 s74, s74, 10
  s_add_u32 s76, s76, s74
  v_add_u32 v32, s97, v253
  v_add_u32 v33, s96, v253
  v_add_u32 v34, s77, v253
  v_add_u32 v35, s76, v253
  s_add_u32 s74, s95, 1
  s_and_b32 s74, s74, 3
  s_lshl_b32 s74, s74, 14
  s_add_u32 s97, s74, s86
  s_add_u32 s69, s95, 2
  s_and_b32 s69, s69, 3
  s_lshl_b32 s69, s69, 14
  s_add_u32 s96, s69, s86
  s_add_u32 s68, s95, 3
  s_and_b32 s68, s68, 3
  s_lshl_b32 s68, s68, 14
  s_add_u32 s77, s68, s86
  s_lshl_b32 s76, s95, 14
  s_add_u32 s76, s76, s86
  s_waitcnt vmcnt(0)
  v_xor_b32 v254, s88, v29
  v_cmp_lt_u32 vcc, 31, v254
  s_cbranch_vccnz L_rdy_247
L_rret_248:
  buffer_load_dwordx4 v[44:47], v32, s[16:19], s97 offen offset:0 sc1
  buffer_load_dwordx4 v[48:51], v33, s[16:19], s97 offen offset:0 sc1
  buffer_load_dwordx4 v[52:55], v34, s[16:19], s97 offen offset:0 sc1
  buffer_load_dwordx4 v[56:59], v32, s[16:19], s97 offen offset:1024 sc1
  buffer_load_dwordx4 v[60:63], v33, s[16:19], s97 offen offset:1024 sc1
  buffer_load_dwordx4 v[64:67], v34, s[16:19], s97 offen offset:1024 sc1
  buffer_load_dwordx4 v[68:71], v35, s[16:19], s97 offen offset:0 sc1
  buffer_load_dwordx4 v[72:75], v32, s[16:19], s96 offen offset:0 sc1
  buffer_load_dwordx4 v[76:79], v33, s[16:19], s96 offen offset:0 sc1
  buffer_load_dwordx4 v[80:83], v34, s[16:19], s96 offen offset:0 sc1
  buffer_load_dwordx4 v[84:87], v32, s[16:19], s96 offen offset:1024 sc1
  buffer_load_dwordx4 v[88:91], v33, s[16:19], s96 offen offset:1024 sc1
  buffer_load_dwordx4 v[92:95], v34, s[16:19], s96 offen offset:1024 sc1
  buffer_load_dwordx4 v[96:99], v35, s[16:19], s96 offen offset:0 sc1
  buffer_load_dwordx4 v[100:103], v32, s[16:19], s77 offen offset:0 sc1
  buffer_load_dwordx4 v[104:107], v33, s[16:19], s77 offen offset:0 sc1
  buffer_load_dwordx4 v[108:111], v34, s[16:19], s77 offen offset:0 sc1
  buffer_load_dwordx4 v[112:115], v32, s[16:19], s77 offen offset:1024 sc1
  buffer_load_dwordx4 v[116:119], v33, s[16:19], s77 offen offset:1024 sc1
  buffer_load_dwordx4 v[120:123], v34, s[16:19], s77 offen offset:1024 sc1
  buffer_load_dwordx4 v[124:127], v35, s[16:19], s77 offen offset:0 sc1
  buffer_load_dwordx4 v[128:131], v32, s[16:19], s76 offen offset:0 sc1
  buffer_load_dwordx4 v[132:135], v33, s[16:19], s76 offen offset:0 sc1
  buffer_load_dwordx4 v[136:139], v34, s[16:19], s76 offen offset:0 sc1
  s_waitcnt vmcnt(0) lgkmcnt(0)
  s_branch L_p6join_246
L_retry_250:
  s_sub_u32 s89, s89, 1
  s_cbranch_scc1 L_go_252
  s_add_u32 s67, s63, 331776
  buffer_load_dwordx2 v[220:221], v241, s[16:19], s67 offen offset:0 sc1
  buffer_load_dwordx2 v[222:223], v241, s[16:19], s67 offen offset:128 sc1
  buffer_load_dwordx2 v[224:225], v241, s[16:19], s67 offen offset:256 sc1
  buffer_load_dwordx2 v[226:227], v241, s[16:19], s67 offen offset:384 sc1
  s_waitcnt vmcnt(0)
  v_max3_u32 v254, v220, v221, v222
  v_max3_u32 v254, v254, v223, v224
  v_max3_u32 v254, v254, v225, v226
  v_max_u32 v254, v254, v227
  v_cmp_eq_u32 vcc, -1, v254
  s_cbranch_vccnz L_retry_250
  s_branch L_ret_251
L_go_252:
  s_mov_b32 s89, 0
  s_waitcnt vmcnt(0)
  s_branch L_ret_251
L_retry_253:
  s_sub_u32 s89, s89, 1
  s_cbranch_scc1 L_go_255
  buffer_load_dwordx4 v[28:31], v245, s[16:19], s97 offen offset:0 sc1
  buffer_load_dwordx4 v[32:35], v245, s[16:19], s97 offen offset:512 sc1
  buffer_load_dwordx4 v[36:39], v245, s[16:19], s97 offen offset:1024 sc1
  buffer_load_dwordx4 v[40:43], v245, s[16:19], s97 offen offset:1536 sc1
  buffer_load_dwordx4 v[44:47], v245, s[16:19], s97 offen offset:2048 sc1
  buffer_load_dwordx4 v[48:51], v245, s[16:19], s97 offen offset:2560 sc1
  buffer_load_dwordx4 v[52:55], v245, s[16:19], s97 offen offset:3072 sc1
  buffer_load_dwordx4 v[56:59], v245, s[16:19], s97 offen offset:3584 sc1
  buffer_load_dwordx4 v[60:63], v245, s[16:19], s96 offen offset:0 sc1
  buffer_load_dwordx4 v[64:67], v245, s[16:19], s96 offen offset:512 sc1
  s_waitcnt vmcnt(8)
  v_bitop3_b32 v254, v28, v32, 1 bitop3:0x7e
  v_and_b32 v254, 0x10001, v254
  v_cmp_ne_u32 vcc, 0, v254
  s_cbranch_vccnz L_retry_253
  s_branch L_ret_254
L_go_255:
  s_mov_b32 s89, 0
  s_waitcnt vmcnt(0)
  s_branch L_ret_254
L_retry_256:
  s_sub_u32 s89, s89, 1
  s_cbranch_scc1 L_go_258
  buffer_load_dwordx4 v[36:39], v245, s[16:19], s97 offen offset:1024 sc1
  buffer_load_dwordx4 v[40:43], v245, s[16:19], s97 offen offset:1536 sc1
  buffer_load_dwordx4 v[44:47], v245, s[16:19], s97 offen offset:2048 sc1
  buffer_load_dwordx4 v[48:51], v245, s[16:19], s97 offen offset:2560 sc1
  buffer_load_dwordx4 v[52:55], v245, s[16:19], s97 offen offset:3072 sc1
  buffer_load_dwordx4 v[56:59], v245, s[16:19], s97 offen offset:3584 sc1
  buffer_load_dwordx4 v[60:63], v245, s[16:19], s96 offen offset:0 sc1
  buffer_load_dwordx4 v[64:67], v245, s[16:19], s96 offen offset:512 sc1
  buffer_load_dwordx4 v[68:71], v245, s[16:19], s96 offen offset:1024 sc1
  buffer_load_dwordx4 v[72:75], v245, s[16:19], s96 offen offset:1536 sc1
  s_waitcnt vmcnt(8)
  v_bitop3_b32 v254, v36, v40, 1 bitop3:0x7e
  v_and_b32 v254, 0x10001, v254
  v_cmp_ne_u32 vcc, 0, v254
  s_cbranch_vccnz L_retry_256
  s_branch L_ret_257
L_go_258:
  s_mov_b32 s89, 0
  s_waitcnt vmcnt(0)
  s_branch L_ret_257
L_retry_259:
  s_sub_u32 s89, s89, 1
  s_cbranch_scc1 L_go_261
  buffer_load_dwordx4 v[44:47], v245, s[16:19], s97 offen offset:2048 sc1
  buffer_load_dwordx4 v[48:51], v245, s[16:19], s97 offen offset:2560 sc1
  buffer_load_dwordx4 v[52:55], v245, s[16:19], s97 offen offset:3072 sc1
  buffer_load_dwordx4 v[56:59], v245, s[16:19], s97 offen offset:3584 sc1
  buffer_load_dwordx4 v[60:63], v245, s[16:19], s96 offen offset:0 sc1
  buffer_load_dwordx4 v[64:67], v245, s[16:19], s96 offen offset:512 sc1
  buffer_load_dwordx4 v[68:71], v245, s[16:19], s96 offen offset:1024 sc1
  buffer_load_dwordx4 v[72:75], v245, s[16:19], s96 offen offset:1536 sc1
  buffer_load_dwordx4 v[76:79], v245, s[16:19], s96 offen offset:2048 sc1
  buffer_load_dwordx4 v[80:83], v245, s[16:19], s96 offen offset:2560 sc1
  s_waitcnt vmcnt(8)
  v_bitop3_b32 v254, v44, v48, 1 bitop3:0x7e
  v_and_b32 v254, 0x10001, v254
  v_cmp_ne_u32 vcc, 0, v254
  s_cbranch_vccnz L_retry_259
  s_branch L_ret_260
L_go_261:
  s_mov_b32 s89, 0
  s_waitcnt vmcnt(0)
  s_branch L_ret_260
L_rdy_262:
  s_sub_u32 s89, s89, 1
  s_cbranch_scc1 L_rgo_264
  buffer_load_dword v220, v221, s[16:19], 0 offen sc1
  s_waitcnt vmcnt(0)
  v_xor_b32 v254, s88, v220
  v_cmp_lt_u32 vcc, 31, v254
  s_cbranch_vccnz L_rdy_262
  s_branch L_rret_263
L_rgo_264:
  s_mov_b32 s89, 0
  s_waitcnt vmcnt(0)
  s_branch L_rret_263
L_retry_265:
  s_sub_u32 s89, s89, 1
  s_cbranch_scc1 L_go_267
  buffer_load_dwordx4 v[52:55], v245, s[16:19], s97 offen offset:3072 sc1
  buffer_load_dwordx4 v[56:59], v245, s[16:19], s97 offen offset:3584 sc1
  buffer_load_dwordx4 v[60:63], v245, s[16:19], s96 offen offset:0 sc1
  buffer_load_dwordx4 v[64:67], v245, s[16:19], s96 offen offset:512 sc1
  buffer_load_dwordx4 v[68:71], v245, s[16:19], s96 offen offset:1024 sc1
  buffer_load_dwordx4 v[72:75], v245, s[16:19], s96 offen offset:1536 sc1
  buffer_load_dwordx4 v[76:79], v245, s[16:19], s96 offen offset:2048 sc1
  buffer_load_dwordx4 v[80:83], v245, s[16:19], s96 offen offset:2560 sc1
  buffer_load_dwordx4 v[84:87], v245, s[16:19], s96 offen offset:3072 sc1
  buffer_load_dwordx4 v[88:91], v245, s[16:19], s96 offen offset:3584 sc1
  s_waitcnt vmcnt(8)
  v_bitop3_b32 v254, v52, v56, 1 bitop3:0x7e
  v_and_b32 v254, 0x10001, v254
  v_cmp_ne_u32 vcc, 0, v254
  s_cbranch_vccnz L_retry_265
  s_branch L_ret_266
L_go_267:
  s_mov_b32 s89, 0
  s_waitcnt vmcnt(0)
  s_branch L_ret_266
L_retry_268:
  s_sub_u32 s89, s89, 1
  s_cbranch_scc1 L_go_270
  buffer_load_dwordx4 v[60:63], v245, s[16:19], s96 offen offset:0 sc1
  buffer_load_dwordx4 v[64:67], v245, s[16:19], s96 offen offset:512 sc1
  buffer_load_dwordx4 v[68:71], v245, s[16:19], s96 offen offset:1024 sc1
  buffer_load_dwordx4 v[72:75], v245, s[16:19], s96 offen offset:1536 sc1
  buffer_load_dwordx4 v[76:79], v245, s[16:19], s96 offen offset:2048 sc1
  buffer_load_dwordx4 v[80:83], v245, s[16:19], s96 offen offset:2560 sc1
  buffer_load_dwordx4 v[84:87], v245, s[16:19], s96 offen offset:3072 sc1
  buffer_load_dwordx4 v[88:91], v245, s[16:19], s96 offen offset:3584 sc1
  buffer_load_dwordx4 v[92:95], v245, s[16:19], s77 offen offset:0 sc1
  buffer_load_dwordx4 v[96:99], v245, s[16:19], s77 offen offset:512 sc1
  s_waitcnt vmcnt(8)
  v_bitop3_b32 v254, v60, v64, 1 bitop3:0x7e
  v_and_b32 v254, 0x10001, v254
  v_cmp_ne_u32 vcc, 0, v254
  s_cbranch_vccnz L_retry_268
  s_branch L_ret_269
L_go_270:
  s_mov_b32 s89, 0
  s_waitcnt vmcnt(0)
  s_branch L_ret_269
L_retry_271:
  s_sub_u32 s89, s89, 1
  s_cbranch_scc1 L_go_273
  buffer_load_dwordx4 v[68:71], v245, s[16:19], s96 offen offset:1024 sc1
  buffer_load_dwordx4 v[72:75], v245, s[16:19], s96 offen offset:1536 sc1
  buffer_load_dwordx4 v[76:79], v245, s[16:19], s96 offen offset:2048 sc1
  buffer_load_dwordx4 v[80:83], v245, s[16:19], s96 offen offset:2560 sc1
  buffer_load_dwordx4 v[84:87], v245, s[16:19], s96 offen offset:3072 sc1
  buffer_load_dwordx4 v[88:91], v245, s[16:19], s96 offen offset:3584 sc1
  buffer_load_dwordx4 v[92:95], v245, s[16:19], s77 offen offset:0 sc1
  buffer_load_dwordx4 v[96:99], v245, s[16:19], s77 offen offset:512 sc1
  buffer_load_dwordx4 v[100:103], v245, s[16:19], s77 offen offset:1024 sc1
  buffer_load_dwordx4 v[104:107], v245, s[16:19], s77 offen offset:1536 sc1
  s_waitcnt vmcnt(8)
  v_bitop3_b32 v254, v68, v72, 1 bitop3:0x7e
  v_and_b32 v254, 0x10001, v254
  v_cmp_ne_u32 vcc, 0, v254
  s_cbranch_vccnz L_retry_271
  s_branch L_ret_272
L_go_273:
  s_mov_b32 s89, 0
  s_waitcnt vmcnt(0)
  s_branch L_ret_272
L_retry_274:
  s_sub_u32 s89, s89, 1
  s_cbranch_scc1 L_go_276
  buffer_load_dwordx4 v[76:79], v245, s[16:19], s96 offen offset:2048 sc1
  buffer_load_dwordx4 v[80:83], v245, s[16:19], s96 offen offset:2560 sc1
  buffer_load_dwordx4 v[84:87], v245, s[16:19], s96 offen offset:3072 sc1
  buffer_load_dwordx4 v[88:91], v245, s[16:19], s96 offen offset:3584 sc1
  buffer_load_dwordx4 v[92:95], v245, s[16:19], s77 offen offset:0 sc1
  buffer_load_dwordx4 v[96:99], v245, s[16:19], s77 offen offset:512 sc1
  buffer_load_dwordx4 v[100:103], v245, s[16:19], s77 offen offset:1024 sc1
  buffer_load_dwordx4 v[104:107], v245, s[16:19], s77 offen offset:1536 sc1
  buffer_load_dwordx4 v[108:111], v245, s[16:19], s77 offen offset:2048 sc1
  buffer_load_dwordx4 v[112:115], v245, s[16:19], s77 offen offset:2560 sc1
  s_waitcnt vmcnt(0)
  v_bitop3_b32 v254, v76, v80, 1 bitop3:0x7e
  v_and_b32 v254, 0x10001, v254
  v_cmp_ne_u32 vcc, 0, v254
  s_cbranch_vccnz L_retry_274
  s_branch L_ret_275
L_go_276:
  s_mov_b32 s89, 0
  s_waitcnt vmcnt(0)
  s_branch L_ret_275
L_retry_277:
  s_sub_u32 s89, s89, 1
  s_cbranch_scc1 L_go_279
  buffer_load_dwordx4 v[84:87], v245, s[16:19], s96 offen offset:3072 sc1
  buffer_load_dwordx4 v[88:91], v245, s[16:19], s96 offen offset:3584 sc1
  buffer_load_dwordx4 v[92:95], v245, s[16:19], s77 offen offset:0 sc1
  buffer_load_dwordx4 v[96:99], v245, s[16:19], s77 offen offset:512 sc1
  buffer_load_dwordx4 v[100:103], v245, s[16:19], s77 offen offset:1024 sc1
  buffer_load_dwordx4 v[104:107], v245, s[16:19], s77 offen offset:1536 sc1
  buffer_load_dwordx4 v[108:111], v245, s[16:19], s77 offen offset:2048 sc1
  buffer_load_dwordx4 v[112:115], v245, s[16:19], s77 offen offset:2560 sc1
  buffer_load_dwordx4 v[116:119], v245, s[16:19], s77 offen offset:3072 sc1
  buffer_load_dwordx4 v[120:123], v245, s[16:19], s77 offen offset:3584 sc1
  s_waitcnt vmcnt(0)
  v_bitop3_b32 v254, v84, v88, 1 bitop3:0x7e
  v_and_b32 v254, 0x10001, v254
  v_cmp_ne_u32 vcc, 0, v254
  s_cbranch_vccnz L_retry_277
  s_branch L_ret_278
L_go_279:
  s_mov_b32 s89, 0
  s_waitcnt vmcnt(0)
  s_branch L_ret_278
L_retry_280:
  s_sub_u32 s89, s89, 1
  s_cbranch_scc1 L_go_282
  buffer_load_dwordx4 v[92:95], v245, s[16:19], s77 offen offset:0 sc1
  buffer_load_dwordx4 v[96:99], v245, s[16:19], s77 offen offset:512 sc1
  buffer_load_dwordx4 v[100:103], v245, s[16:19], s77 offen offset:1024 sc1
  buffer_load_dwordx4 v[104:107], v245, s[16:19], s77 offen offset:1536 sc1
  buffer_load_dwordx4 v[108:111], v245, s[16:19], s77 offen offset:2048 sc1
  buffer_load_dwordx4 v[112:115], v245, s[16:19], s77 offen offset:2560 sc1
  buffer_load_dwordx4 v[116:119], v245, s[16:19], s77 offen offset:3072 sc1
  buffer_load_dwordx4 v[120:123], v245, s[16:19], s77 offen offset:3584 sc1
  buffer_load_dwordx4 v[124:127], v245, s[16:19], s76 offen offset:0 sc1
  buffer_load_dwordx4 v[128:131], v245, s[16:19], s76 offen offset:512 sc1
  s_waitcnt vmcnt(0)
  v_bitop3_b32 v254, v92, v96, 1 bitop3:0x7e
  v_and_b32 v254, 0x10001, v254
  v_cmp_ne_u32 vcc, 0, v254
  s_cbranch_vccnz L_retry_280
  s_branch L_ret_281
L_go_282:
  s_mov_b32 s89, 0
  s_waitcnt vmcnt(0)
  s_branch L_ret_281
L_retry_283:
  s_sub_u32 s89, s89, 1
  s_cbranch_scc1 L_go_285
  buffer_load_dwordx4 v[100:103], v245, s[16:19], s77 offen offset:1024 sc1
  buffer_load_dwordx4 v[104:107], v245, s[16:19], s77 offen offset:1536 sc1
  buffer_load_dwordx4 v[108:111], v245, s[16:19], s77 offen offset:2048 sc1
  buffer_load_dwordx4 v[112:115], v245, s[16:19], s77 offen offset:2560 sc1
  buffer_load_dwordx4 v[116:119], v245, s[16:19], s77 offen offset:3072 sc1
  buffer_load_dwordx4 v[120:123], v245, s[16:19], s77 offen offset:3584 sc1
  buffer_load_dwordx4 v[124:127], v245, s[16:19], s76 offen offset:0 sc1
  buffer_load_dwordx4 v[128:131], v245, s[16:19], s76 offen offset:512 sc1
  buffer_load_dwordx4 v[132:135], v245, s[16:19], s76 offen offset:1024 sc1
  buffer_load_dwordx4 v[136:139], v245, s[16:19], s76 offen offset:1536 sc1
  s_waitcnt vmcnt(0)
  v_bitop3_b32 v254, v100, v104, 1 bitop3:0x7e
  v_and_b32 v254, 0x10001, v254
  v_cmp_ne_u32 vcc, 0, v254
  s_cbranch_vccnz L_retry_283
  s_branch L_ret_284
L_go_285:
  s_mov_b32 s89, 0
  s_waitcnt vmcnt(0)
  s_branch L_ret_284
L_retry_286:
  s_sub_u32 s89, s89, 1
  s_cbranch_scc1 L_go_288
  buffer_load_dwordx4 v[108:111], v245, s[16:19], s77 offen offset:2048 sc1
  buffer_load_dwordx4 v[112:115], v245, s[16:19], s77 offen offset:2560 sc1
  buffer_load_dwordx4 v[116:119], v245, s[16:19], s77 offen offset:3072 sc1
  buffer_load_dwordx4 v[120:123], v245, s[16:19], s77 offen offset:3584 sc1
  buffer_load_dwordx4 v[124:127], v245, s[16:19], s76 offen offset:0 sc1
  buffer_load_dwordx4 v[128:131], v245, s[16:19], s76 offen offset:512 sc1
  buffer_load_dwordx4 v[132:135], v245, s[16:19], s76 offen offset:1024 sc1
  buffer_load_dwordx4 v[136:139], v245, s[16:19], s76 offen offset:1536 sc1
  buffer_load_dwordx4 v[140:143], v245, s[16:19], s76 offen offset:2048 sc1
  buffer_load_dwordx4 v[144:147], v245, s[16:19], s76 offen offset:2560 sc1
  s_waitcnt vmcnt(8)
  v_bitop3_b32 v254, v108, v112, 1 bitop3:0x7e
  v_and_b32 v254, 0x10001, v254
  v_cmp_ne_u32 vcc, 0, v254
  s_cbranch_vccnz L_retry_286
  s_branch L_ret_287
L_go_288:
  s_mov_b32 s89, 0
  s_waitcnt vmcnt(0)
  s_branch L_ret_287
L_retry_289:
  s_sub_u32 s89, s89, 1
  s_cbranch_scc1 L_go_291
  buffer_load_dwordx4 v[116:119], v245, s[16:19], s77 offen offset:3072 sc1
  buffer_load_dwordx4 v[120:123], v245, s[16:19], s77 offen offset:3584 sc1
  buffer_load_dwordx4 v[124:127], v245, s[16:19], s76 offen offset:0 sc1
  buffer_load_dwordx4 v[128:131], v245, s[16:19], s76 offen offset:512 sc1
  buffer_load_dwordx4 v[132:135], v245, s[16:19], s76 offen offset:1024 sc1
  buffer_load_dwordx4 v[136:139], v245, s[16:19], s76 offen offset:1536 sc1
  buffer_load_dwordx4 v[140:143], v245, s[16:19], s76 offen offset:2048 sc1
  buffer_load_dwordx4 v[144:147], v245, s[16:19], s76 offen offset:2560 sc1
  buffer_load_dwordx4 v[148:151], v245, s[16:19], s76 offen offset:3072 sc1
  buffer_load_dwordx4 v[152:155], v245, s[16:19], s76 offen offset:3584 sc1
  s_waitcnt vmcnt(8)
  v_bitop3_b32 v254, v116, v120, 1 bitop3:0x7e
  v_and_b32 v254, 0x10001, v254
  v_cmp_ne_u32 vcc, 0, v254
  s_cbranch_vccnz L_retry_289
  s_branch L_ret_290
L_go_291:
  s_mov_b32 s89, 0
  s_waitcnt vmcnt(0)
  s_branch L_ret_290
L_retry_292:
  s_sub_u32 s89, s89, 1
  s_cbranch_scc1 L_go_294
  buffer_load_dwordx4 v[124:127], v245, s[16:19], s76 offen offset:0 sc1
  buffer_load_dwordx4 v[128:131], v245, s[16:19], s76 offen offset:512 sc1
  buffer_load_dwordx4 v[132:135], v245, s[16:19], s76 offen offset:1024 sc1
  buffer_load_dwordx4 v[136:139], v245, s[16:19], s76 offen offset:1536 sc1
  buffer_load_dwordx4 v[140:143], v245, s[16:19], s76 offen offset:2048 sc1
  buffer_load_dwordx4 v[144:147], v245, s[16:19], s76 offen offset:2560 sc1
  buffer_load_dwordx4 v[148:151], v245, s[16:19], s76 offen offset:3072 sc1
  buffer_load_dwordx4 v[152:155], v245, s[16:19], s76 offen offset:3584 sc1
  s_waitcnt vmcnt(0)
  v_bitop3_b32 v254, v124, v128, 1 bitop3:0x7e
  v_and_b32 v254, 0x10001, v254
  v_cmp_ne_u32 vcc, 0, v254
  s_cbranch_vccnz L_retry_292
  s_branch L_ret_293
L_go_294:
  s_mov_b32 s89, 0
  s_waitcnt vmcnt(0)
  s_branch L_ret_293
L_retry_295:
  s_sub_u32 s89, s89, 1
  s_cbranch_scc1 L_go_297
  buffer_load_dwordx4 v[132:135], v245, s[16:19], s76 offen offset:1024 sc1
  buffer_load_dwordx4 v[136:139], v245, s[16:19], s76 offen offset:1536 sc1
  buffer_load_dwordx4 v[140:143], v245, s[16:19], s76 offen offset:2048 sc1
  buffer_load_dwordx4 v[144:147], v245, s[16:19], s76 offen offset:2560 sc1
  buffer_load_dwordx4 v[148:151], v245, s[16:19], s76 offen offset:3072 sc1
  buffer_load_dwordx4 v[152:155], v245, s[16:19], s76 offen offset:3584 sc1
  s_waitcnt vmcnt(0)
  v_bitop3_b32 v254, v132, v136, 1 bitop3:0x7e
  v_and_b32 v254, 0x10001, v254
  v_cmp_ne_u32 vcc, 0, v254
  s_cbranch_vccnz L_retry_295
  s_branch L_ret_296
L_go_297:
  s_mov_b32 s89, 0
  s_waitcnt vmcnt(0)
  s_branch L_ret_296
L_retry_298:
  s_sub_u32 s89, s89, 1
  s_cbranch_scc1 L_go_300
  buffer_load_dwordx4 v[140:143], v245, s[16:19], s76 offen offset:2048 sc1
  buffer_load_dwordx4 v[144:147], v245, s[16:19], s76 offen offset:2560 sc1
  buffer_load_dwordx4 v[148:151], v245, s[16:19], s76 offen offset:3072 sc1
  buffer_load_dwordx4 v[152:155], v245, s[16:19], s76 offen offset:3584 sc1
  s_waitcnt vmcnt(0)
  v_bitop3_b32 v254, v140, v144, 1 bitop3:0x7e
  v_and_b32 v254, 0x10001, v254
  v_cmp_ne_u32 vcc, 0, v254
  s_cbranch_vccnz L_retry_298
  s_branch L_ret_299
L_go_300:
  s_mov_b32 s89, 0
  s_waitcnt vmcnt(0)
  s_branch L_ret_299
L_retry_301:
  s_sub_u32 s89, s89, 1
  s_cbranch_scc1 L_go_303
  buffer_load_dwordx4 v[148:151], v245, s[16:19], s76 offen offset:3072 sc1
  buffer_load_dwordx4 v[152:155], v245, s[16:19], s76 offen offset:3584 sc1
  s_waitcnt vmcnt(0)
  v_bitop3_b32 v254, v148, v152, 1 bitop3:0x7e
  v_and_b32 v254, 0x10001, v254
  v_cmp_ne_u32 vcc, 0, v254
  s_cbranch_vccnz L_retry_301
  s_branch L_ret_302
L_go_303:
  s_mov_b32 s89, 0
  s_waitcnt vmcnt(0)
  s_branch L_ret_302
L_rdy_304:
  s_sub_u32 s89, s89, 1
  s_cbranch_scc1 L_rgo_306
  buffer_load_dword v29, v28, s[16:19], s54 offen offset:0 sc1
  s_waitcnt vmcnt(0)
  v_xor_b32 v254, s88, v29
  v_cmp_lt_u32 vcc, 31, v254
  s_cbranch_vccnz L_rdy_304
  s_branch L_rret_305
L_rgo_306:
  s_mov_b32 s89, 0
  s_waitcnt vmcnt(0)
  s_branch L_rret_305
L_rdy_307:
  s_sub_u32 s89, s89, 1
  s_cbranch_scc1 L_rgo_309
  buffer_load_dword v29, v28, s[16:19], s54 offen offset:256 sc1
  s_waitcnt vmcnt(0)
  v_xor_b32 v254, s88, v29
  v_cmp_lt_u32 vcc, 31, v254
  s_cbranch_vccnz L_rdy_307
  s_branch L_rret_308
L_rgo_309:
  s_mov_b32 s89, 0
  s_waitcnt vmcnt(0)
  s_branch L_rret_308
L_rdy_310:
  s_sub_u32 s89, s89, 1
  s_cbranch_scc1 L_rgo_312
  buffer_load_dword v29, v28, s[16:19], s54 offen offset:512 sc1
  s_waitcnt vmcnt(0)
  v_xor_b32 v254, s88, v29
  v_cmp_lt_u32 vcc, 31, v254
  s_cbranch_vccnz L_rdy_310
  s_branch L_rret_311
L_rgo_312:
  s_mov_b32 s89, 0
  s_waitcnt vmcnt(0)
  s_branch L_rret_311

.section .rodata,"a"
.p2align 6
.amdhsa_kernel sequential_preLN__sliding_block__mixer_s_mlp__prompt_kernel
  .amdhsa_next_free_vgpr 512
  .amdhsa_next_free_sgpr 102
  .amdhsa_accum_offset 256
  .amdhsa_group_segment_fixed_size 0
  .amdhsa_kernarg_size 88
  .amdhsa_user_sgpr_count 2
  .amdhsa_user_sgpr_kernarg_segment_ptr 1
  .amdhsa_system_sgpr_workgroup_id_x 1
  .amdhsa_float_denorm_mode_32 3
.end_amdhsa_kernel
```
